```python
import torch

def _softmax(x, axis=-1):
    return torch.softmax(x, dim=axis)
def _gelu(x):
    return torch.nn.functional.gelu(x, approximate="tanh")
def _silu(x):
    return torch.nn.functional.silu(x)
def _sigmoid(x):
    return torch.sigmoid(x)
def _layernorm(x, axis=-1, eps=1e-5):
    m = x.mean(dim=axis, keepdim=True)
    v = x.var(dim=axis, keepdim=True, unbiased=False)
    return (x - m) / torch.sqrt(v + eps)
def _scatter_add(tgt, idx, src, axis=0):
    return tgt.clone().index_add_(axis, idx, src)
def _segment_sum(src, seg, n):
    out = torch.zeros((n,) + src.shape[1:], dtype=src.dtype)
    return out.index_add_(0, seg, src)
def _pad(x, pw):
    flat = tuple(v for pair in reversed(pw) for v in pair)
    return torch.nn.functional.pad(x, flat)

kernel_name = 'parallel_sum__compressed_kv_cla__moe_arch_mod__prompt'

def setup_inputs():

    _w = (lambda a: (lambda t: t.to(torch.bfloat16) if t.is_floating_point() else t)(torch.as_tensor(a)))
    def _A_setup():
        B, H, Sq, Sk, D, M = 1, 32, 2048, 2048, 128, 576
        Dc = 4 * D
        return {
            "x": _w((lambda *s: torch.randn(*s, dtype=torch.bfloat16) * 0.05)(B, Sq, M)),
            "c_kv": _w((lambda *s: torch.randn(*s, dtype=torch.bfloat16) * 1.6)(B, Sk, Dc)),
            "w_q": _w((lambda *s: torch.randn(*s, dtype=torch.bfloat16) * 0.8)(M, H, D) * (M ** -0.5)),
            "w_uk": _w((lambda *s: torch.randn(*s, dtype=torch.bfloat16) * 0.8)(Dc, H, D) * (Dc ** -0.5)),
            "w_uv": _w((lambda *s: torch.randn(*s, dtype=torch.bfloat16) * 1.6)(Dc, H, D) * (Dc ** -0.5)),
            "w_o": _w((lambda *s: torch.randn(*s, dtype=torch.bfloat16) * 1.6)(H, D, M) * ((H * D) ** -0.5)),
        }
    _A_in = _A_setup()

    def _B_setup():
        B, S, D, F, C = 1, 2048, 576, 4608, 8
        return {
            "x": _w((lambda *s: torch.randn(*s, dtype=torch.bfloat16) * 0.05)(B, S, D)),
            "w_r": _w((lambda *s: torch.randn(*s, dtype=torch.bfloat16) * 0.05)(D)),
            "w_gate": _w((lambda *s: torch.randn(*s, dtype=torch.bfloat16) * 0.05)(D, F)),
            "w_up": _w((lambda *s: torch.randn(*s, dtype=torch.bfloat16) * 0.05)(D, F)),
            "w_down": _w((lambda *s: torch.randn(*s, dtype=torch.bfloat16) * 0.05)(F, D)),
        }
    _B_in = _B_setup()

    return {
        "A_x": _A_in["x"],
        "A_c_kv": _A_in["c_kv"],
        "A_w_q": _A_in["w_q"],
        "A_w_uk": _A_in["w_uk"],
        "A_w_uv": _A_in["w_uv"],
        "A_w_o": _A_in["w_o"],
        "B_x": _B_in["x"],
        "B_w_r": _B_in["w_r"],
        "B_w_gate": _B_in["w_gate"],
        "B_w_up": _B_in["w_up"],
        "B_w_down": _B_in["w_down"],
    }

def reference(A_x, A_c_kv, A_w_q, A_w_uk, A_w_uv, A_w_o, B_x, B_w_r, B_w_gate, B_w_up, B_w_down):
    def _A_ref(x, c_kv, w_q, w_uk, w_uv, w_o):
        B, Sq, M = x.shape[0], x.shape[1], x.shape[2]
        Sk = c_kv.shape[1]
        H, D = w_q.shape[1], w_q.shape[2]
        q = torch.einsum("bqm,mhd->bhqd", x, w_q)
        k = torch.einsum("bkc,chd->bhkd", c_kv, w_uk)
        v = torch.einsum("bkc,chd->bhkd", c_kv, w_uv)
        scores = torch.einsum("bhqd,bhkd->bhqk", q, k) * (D ** -0.5)
        off = Sk - Sq
        qi = torch.arange(Sq)[:, None]
        kj = torch.arange(Sk)[None, :]
        cmask = kj <= (qi + off)
        scores = torch.where(cmask[None, None], scores, -1e9)
        p = _softmax(scores, axis=-1)
        ctx = torch.einsum("bhqk,bhkd->bhqd", p, v)
        return torch.einsum("bhqd,hdm->bqm", ctx, w_o)

    def _B_ref(x, w_r, w_gate, w_up, w_down):
        B, S, D = x.shape
        C = 8
        r = x @ w_r
        idx = torch.argsort(-r, axis=-1)[:, :C]
        idx_e = (lambda x, n, axis: torch.repeat_interleave(x, n, dim=axis))(idx.reshape(B, C, 1), D, axis=2)
        x_sel = (lambda x, i, axis: torch.take_along_dim(x, i, dim=axis))(x, idx_e, axis=1)
        g = _silu(x_sel @ w_gate)
        u = x_sel @ w_up
        y = (g * u) @ w_down
        r_sel = _sigmoid((lambda x, i, axis: torch.take_along_dim(x, i, dim=axis))(r, idx, axis=1))
        y = y * r_sel.reshape(B, C, 1)
        b_off = (torch.arange(B) * S).reshape(B, 1)
        flat_idx = (idx + b_off).reshape(B * C)
        zero = (x * 0.0).reshape(B * S, D)
        upd = _scatter_add(zero, flat_idx, y.reshape(B * C, D), axis=0)
        return x + upd.reshape(B, S, D)

    x = A_x
    xn = _layernorm(x, axis=-1)
    return x + _A_ref(xn, A_c_kv, A_w_q, A_w_uk, A_w_uv, A_w_o) + _B_ref(xn, B_w_r, B_w_gate, B_w_up, B_w_down)
```

```asm
; @launch grid=(256,1,1) block=(512,1,1) lds=163840
.amdgcn_target "amdgcn-amd-amdhsa--gfx950"
.text
.globl parallel_sum__compressed_kv_cla__moe_arch_mod__prompt_kernel
.p2align 8
.type parallel_sum__compressed_kv_cla__moe_arch_mod__prompt_kernel,@function
parallel_sum__compressed_kv_cla__moe_arch_mod__prompt_kernel:
    s_cmp_ge_u32 s2, 256
    s_cbranch_scc1 parallel_sum__compressed_kv_cla__moe_arch_mod__prompt_kernel_end
    s_load_dwordx2 s[4:5], s[0:1], 16
    s_load_dwordx2 s[6:7], s[0:1], 104
    s_load_dwordx2 s[24:25], s[0:1], 40
    s_load_dwordx4 s[28:31], s[0:1], 64
    s_load_dwordx2 s[26:27], s[0:1], 80
    s_load_dwordx4 s[56:59], s[0:1], 0
    s_load_dwordx4 s[60:63], s[0:1], 24
    s_load_dwordx2 s[64:65], s[0:1], 56
    s_load_dwordx2 s[72:73], s[0:1], 96
    v_lshrrev_b32 v1, 6, v0
    v_and_b32 v2, 63, v0
    v_readfirstlane_b32 s36, v1
    v_and_b32 v2, 63, v0
    v_mov_b32 v192, v2
    v_mov_b32 v191, v0
    s_and_b32 s47, s2, 7
    s_lshr_b32 s48, s2, 3
    s_bfe_u32 s76, s48, 0x10001
    s_and_b32 s49, s48, 1
    s_lshl_b32 s78, s47, 1
    s_add_u32 s78, s78, s49
    s_lshr_b32 s77, s48, 2
    s_sub_u32 s77, 7, s77
    v_lshrrev_b32 v4, 3, v2
    v_lshlrev_b32 v7, 10, v4
    v_lshrrev_b32 v4, 1, v4
    v_and_b32 v5, 7, v2
    v_xor_b32 v6, v5, v4
    v_lshl_add_u32 v6, v6, 4, v7
    s_lshl_b32 s47, s77, 18
    s_lshl_b32 s48, s36, 15
    s_add_u32 s47, s47, s48
    v_add_u32 v188, s47, v6
    v_xor_b32 v197, 64, v188
    v_add_u32 v197, 8192, v197
    v_lshrrev_b32 v4, 5, v2
    v_bfe_u32 v5, v2, 1, 4
    s_lshl_b32 s49, s36, 1
    s_and_b32 s49, s49, 4
    v_xor_b32 v5, s49, v5
    v_and_b32 v6, 1, v2
    s_lshl_b32 s47, s78, 9
    s_add_u32 s47, s47, s48
    v_add_u32 v7, 0, v4
    v_xor_b32 v24, v5, v7
    v_lshl_add_u32 v24, v24, 1, v6
    v_lshlrev_b32 v24, 4, v24
    v_lshl_add_u32 v24, v7, 13, v24
    v_add_u32 v189, s47, v24
    v_add_u32 v7, 2, v4
    v_xor_b32 v24, v5, v7
    v_lshl_add_u32 v24, v24, 1, v6
    v_lshlrev_b32 v24, 4, v24
    v_lshl_add_u32 v24, v7, 13, v24
    v_add_u32 v190, s47, v24
    s_lshl_b32 s82, s36, 11
    s_mov_b32 s83, s82
    s_lshl_b32 s82, s36, 12
    s_mov_b32 s79, 0
    s_mov_b32 s80, 16384
    s_mov_b32 s81, 0
    s_lshl_b32 s84, s2, 3
    s_add_u32 s84, s84, s36
    s_cmp_eq_u32 s76, 0
    s_waitcnt lgkmcnt(0)
    s_mov_b32 s16, s56
    s_mov_b32 s17, s57
    s_mov_b32 s18, 0x240000
    s_mov_b32 s19, 0x20000
    s_mov_b32 s56, s58
    s_mov_b32 s57, s59
    s_mov_b32 s58, 0x200000
    s_mov_b32 s59, 0x20000
    s_cselect_b32 s60, s60, s62
    s_cselect_b32 s61, s61, s63
    s_mov_b32 s62, 0x400000
    s_mov_b32 s63, 0x20000
    s_add_u32 m0, s83, 131072
    s_nop 0
    buffer_load_dwordx4 v189, s[60:63], s81 offen lds
    s_add_u32 m0, s83, 132096
    s_nop 0
    buffer_load_dwordx4 v190, s[60:63], s81 offen lds
    s_add_u32 s81, s81, 262144
    s_add_u32 m0, s82, 65536
    s_nop 0
    buffer_load_dwordx4 v188, s[56:59], s79 offen lds
    s_add_u32 m0, s82, 66560
    s_nop 0
    buffer_load_dwordx4 v197, s[56:59], s79 offen lds
    s_add_u32 s79, s79, 128
    s_add_u32 m0, s82, 67584
    s_nop 0
    buffer_load_dwordx4 v188, s[56:59], s80 offen lds
    s_add_u32 m0, s82, 68608
    s_nop 0
    buffer_load_dwordx4 v197, s[56:59], s80 offen lds
    s_add_u32 s80, s80, 128
    s_add_u32 m0, s83, 0
    s_nop 0
    buffer_load_dwordx4 v189, s[60:63], s81 offen lds
    s_add_u32 m0, s83, 1024
    s_nop 0
    buffer_load_dwordx4 v190, s[60:63], s81 offen lds
    s_add_u32 s81, s81, 262144
    s_mov_b32 s20, s64
    s_mov_b32 s21, s65
    s_mov_b32 s22, 1152
    s_mov_b32 s23, 0x20000
    s_mul_i32 s47, s84, 1152
    v_lshlrev_b32 v3, 5, v2
    v_mov_b32 v4, 0x40000000
    v_cmp_gt_u32 vcc, 36, v2
    v_lshlrev_b32 v193, 6, v2
    s_memrealtime s[64:65]
    v_cndmask_b32 v3, v4, v3, vcc
    v_cmp_eq_u32 vcc, 0, v0
    v_mov_b32 v5, 0
    v_mov_b32 v232, v3
    v_cndmask_b32 v196, v4, v5, vcc
    s_mov_b32 s85, s47
    s_mov_b32 s74, 256
    s_mov_b32 s75, 0x20000
    s_cmp_eq_u32 s2, 0
    s_cbranch_scc0 parallel_sum__compressed_kv_cla__moe_arch_mod__prompt_kernel_p1_notag
    s_waitcnt lgkmcnt(0)
    s_or_b32 s64, s64, 1
    v_mov_b32 v198, s64
    buffer_store_dword v198, v196, s[72:75], 0 offen sc1
parallel_sum__compressed_kv_cla__moe_arch_mod__prompt_kernel_p1_notag:
    s_getpc_b64 s[34:35]
parallel_sum__compressed_kv_cla__moe_arch_mod__prompt_kernel_p1_pc:
    s_lshr_b32 s48, s2, 3
    s_mul_i32 s49, s48, 5958
    s_lshr_b32 s49, s49, 16
    s_mul_i32 s49, s49, 11
    s_sub_u32 s48, s48, s49
    s_lshl_b32 s48, s48, 13
    v_lshlrev_b32 v233, 7, v2
    v_add_u32 v233, s48, v233
    v_min_u32 v233, parallel_sum__compressed_kv_cla__moe_arch_mod__prompt_kernel_end-parallel_sum__compressed_kv_cla__moe_arch_mod__prompt_kernel_p1_pc-4, v233
    s_cmp_eq_u32 s36, 7
    s_cbranch_scc0 parallel_sum__compressed_kv_cla__moe_arch_mod__prompt_kernel_p1_nocpf
    global_load_dword v194, v233, s[34:35]
parallel_sum__compressed_kv_cla__moe_arch_mod__prompt_kernel_p1_nocpf:
    v_lshlrev_b32 v233, 7, v2
    v_cmp_gt_u32 vcc, 8, v2
    s_lshl_b32 s86, s84, 10
    s_nop 0
    v_cndmask_b32 v233, v4, v233, vcc
    buffer_load_dword v194, v233, s[56:59], s86 offen
    v_and_b32 v4, 15, v2
    v_lshrrev_b32 v5, 1, v4
    v_lshlrev_b32 v4, 7, v4
    v_lshrrev_b32 v7, 4, v2
    v_xor_b32 v5, v5, v7
    s_and_b32 s47, s36, 1
    s_lshl_b32 s47, s47, 14
    s_add_u32 s47, s47, 65536
    v_add_u32 v4, s47, v4
    v_lshl_add_u32 v176, v5, 4, v4
    v_bfe_u32 v6, v2, 2, 2
    v_lshl_add_u32 v5, v7, 3, v6
    v_lshlrev_b32 v5, 9, v5
    v_and_b32 v4, 3, v2
    v_lshl_add_u32 v5, v4, 3, v5
    v_and_b32 v7, 1, v7
    v_lshl_add_u32 v6, v7, 2, v6
    s_lshr_b32 s47, s36, 1
    s_lshl_b32 s47, s47, 2
    s_add_u32 s48, s47, 0
    v_xor_b32 v7, s48, v6
    v_lshl_add_u32 v177, v7, 5, v5
    s_add_u32 s48, s47, 1
    v_xor_b32 v7, s48, v6
    v_lshl_add_u32 v178, v7, 5, v5
    s_add_u32 s48, s47, 2
    v_xor_b32 v7, s48, v6
    v_lshl_add_u32 v179, v7, 5, v5
    s_add_u32 s48, s47, 3
    v_xor_b32 v7, s48, v6
    v_lshl_add_u32 v180, v7, 5, v5
    v_xor_b32 v181, 64, v176
    v_add_u32 v182, 0x20000, v177
    v_add_u32 v183, 0x20000, v178
    v_add_u32 v240, 0x20000, v179
    v_add_u32 v241, 0x20000, v180
    v_and_b32 v4, 15, v2
    v_bfe_u32 v5, v2, 4, 1
    v_lshl_add_u32 v4, v5, 5, v4
    v_lshrrev_b32 v5, 5, v2
    v_lshl_add_u32 v4, v5, 4, v4
    v_lshlrev_b32 v242, 4, v4
    s_lshr_b32 s68, s36, 2
    s_lshl_b32 s48, s78, 1
    s_add_u32 s68, s68, s48
    s_lshl_b32 s68, s68, 6
    s_lshl_b32 s48, s77, 3
    s_add_u32 s68, s68, s48
    s_and_b32 s48, s36, 1
    s_lshl_b32 s48, s48, 2
    s_add_u32 s68, s68, s48
    s_lshl_b32 s68, s68, 14
    s_lshl_b32 s48, s76, 13
    s_add_u32 s68, s68, s48
    s_bfe_u32 s48, s36, 0x10001
    s_lshl_b32 s48, s48, 12
    s_add_u32 s68, s68, s48
    s_add_u32 s68, s68, 0x800000
    s_mov_b32 s69, 0x3e0293ee
    s_cmp_eq_u32 s76, 0
    s_cselect_b32 s69, s69, 1.0
    s_lshl_b32 s66, s78, 4
    s_lshl_b32 s67, s77, 1
    s_add_u32 s66, s66, s67
    s_add_u32 s66, s66, s76
    s_lshl_b32 s66, s66, 6
    s_add_u32 s66, s66, 0x784000
    s_mov_b32 s67, 0x780000
    s_cmp_eq_u32 s36, 4
    s_cselect_b32 s48, 0, 0x40000000
    v_add_u32 v184, s48, v193
    v_add_u32 v185, 4096, v184
    v_add_u32 v186, 8192, v184
    v_add_u32 v187, 12288, v184
    s_and_b32 s47, s2, 7
    s_lshr_b32 s48, s2, 3
    s_and_b32 s49, s48, 3
    s_lshl_b32 s37, s47, 2
    s_add_u32 s37, s37, s49
    s_lshr_b32 s38, s48, 2
    s_lshl_b32 s47, s38, 2
    s_add_u32 s47, s47, s36
    s_sub_u32 s48, 67, s47
    s_cmp_lt_u32 s36, 4
    s_cselect_b32 s39, s47, s48
    s_add_u32 s40, s39, 1
    s_lshl_b32 s47, s38, 1
    s_sub_u32 s45, 32, s47
    v_lshlrev_b32 v243, 4, v2
    v_lshrrev_b32 v3, 4, v2
    v_bfe_u32 v4, v2, 1, 3
    v_xor_b32 v4, v4, v3
    v_and_b32 v5, 1, v2
    v_lshl_add_u32 v4, v4, 1, v5
    v_lshlrev_b32 v4, 4, v4
    v_lshl_add_u32 v245, v3, 13, v4
    v_xor_b32 v244, 128, v245
    v_and_b32 v4, 15, v2
    v_lshlrev_b32 v4, 4, v4
    v_lshl_add_u32 v255, v3, 9, v4
    s_mul_i32 s55, s39, 36864
    s_lshl_b32 s44, s36, 13
    s_lshl_b32 s43, s36, 18
    s_lshl_b32 s47, s37, 8
    s_add_u32 s43, s43, s47
    s_and_b32 s54, s43, 0x7ffff
    s_lshl_b32 s47, s37, 20
    s_add_u32 s47, s47, 0x800000
    s_cmp_lt_u32 s36, 4
    s_waitcnt lgkmcnt(0)
    s_mov_b32 s8, s4
    s_mov_b32 s9, s5
    s_mov_b32 s10, 0x480000
    s_mov_b32 s11, 0x20000
    s_mov_b32 s12, s6
    s_mov_b32 s13, s7
    s_mov_b32 s14, 0x10000000
    s_mov_b32 s15, 0x20000
    s_mov_b32 s52, 0x47800000
    v_bfe_u32 v4, v2, 2, 2
    v_lshrrev_b32 v5, 4, v2
    v_lshl_add_u32 v6, v5, 3, v4
    v_lshlrev_b32 v6, 8, v6
    v_and_b32 v7, 3, v2
    v_lshl_add_u32 v6, v7, 3, v6
    v_and_b32 v7, 1, v5
    v_lshl_add_u32 v4, v7, 2, v4
    v_xor_b32 v7, 0, v4
    v_lshl_add_u32 v246, v7, 5, v6
    v_xor_b32 v7, 1, v4
    v_lshl_add_u32 v247, v7, 5, v6
    v_xor_b32 v7, 2, v4
    v_lshl_add_u32 v248, v7, 5, v6
    v_xor_b32 v7, 3, v4
    v_lshl_add_u32 v249, v7, 5, v6
    v_xor_b32 v7, 4, v4
    v_lshl_add_u32 v250, v7, 5, v6
    v_xor_b32 v7, 5, v4
    v_lshl_add_u32 v251, v7, 5, v6
    v_xor_b32 v7, 6, v4
    v_lshl_add_u32 v252, v7, 5, v6
    v_xor_b32 v7, 7, v4
    v_lshl_add_u32 v253, v7, 5, v6
    v_lshrrev_b32 v5, 5, v2
    v_and_b32 v7, 31, v2
    v_lshlrev_b32 v5, 2, v5
    s_lshr_b32 s70, s37, 1
    s_lshl_b32 s70, s70, 10
    s_add_u32 s70, s70, 0x784000
    s_lshl_b32 s33, s36, 12
    s_lshl_b32 s34, s36, 17
    s_lshl_b32 s47, s37, 8
    s_add_u32 s34, s34, s47
    s_waitcnt vmcnt(3)
    s_barrier
    ds_read_b128 v[128:131], v176 offset:0
    ds_read_b128 v[132:135], v176 offset:2048
    ds_read_b128 v[136:139], v176 offset:4096
    ds_read_b128 v[140:143], v176 offset:6144
    ds_read_b64_tr_b16 v[160:161], v182 offset:0
    ds_read_b64_tr_b16 v[162:163], v182 offset:2048
    ds_read_b64_tr_b16 v[164:165], v183 offset:0
    ds_read_b64_tr_b16 v[166:167], v183 offset:2048
    ds_read_b64_tr_b16 v[168:169], v240 offset:0
    ds_read_b64_tr_b16 v[170:171], v240 offset:2048
    ds_read_b64_tr_b16 v[172:173], v241 offset:0
    ds_read_b64_tr_b16 v[174:175], v241 offset:2048
    s_cmp_eq_u32 s76, 0
    s_cbranch_scc0 parallel_sum__compressed_kv_cla__moe_arch_mod__prompt_kernel_p1_vtypeA
    s_waitcnt lgkmcnt(6)
    v_mfma_f32_16x16x32_bf16 v[0:3], v[160:163], v[128:131], 0
    ds_read_b128 v[144:147], v176 offset:8192
    ds_read_b128 v[148:151], v176 offset:10240
    v_mfma_f32_16x16x32_bf16 v[16:19], v[160:163], v[132:135], 0
    v_mfma_f32_16x16x32_bf16 v[32:35], v[160:163], v[136:139], 0
    ds_read_b128 v[152:155], v176 offset:12288
    ds_read_b128 v[156:159], v176 offset:14336
    v_mfma_f32_16x16x32_bf16 v[48:51], v[160:163], v[140:143], 0
    s_waitcnt lgkmcnt(8)
    v_mfma_f32_16x16x32_bf16 v[4:7], v[164:167], v[128:131], 0
    v_mfma_f32_16x16x32_bf16 v[20:23], v[164:167], v[132:135], 0
    s_add_u32 m0, s83, 16384
    s_nop 0
    buffer_load_dwordx4 v189, s[60:63], s81 offen lds
    v_mfma_f32_16x16x32_bf16 v[36:39], v[164:167], v[136:139], 0
    v_mfma_f32_16x16x32_bf16 v[52:55], v[164:167], v[140:143], 0
    s_add_u32 m0, s83, 17408
    s_nop 0
    buffer_load_dwordx4 v190, s[60:63], s81 offen lds
    s_add_u32 s81, s81, 262144
    s_waitcnt lgkmcnt(6)
    v_mfma_f32_16x16x32_bf16 v[8:11], v[168:171], v[128:131], 0
    v_mfma_f32_16x16x32_bf16 v[24:27], v[168:171], v[132:135], 0
    s_add_u32 m0, s82, 98304
    s_nop 0
    buffer_load_dwordx4 v188, s[56:59], s79 offen lds
    v_mfma_f32_16x16x32_bf16 v[40:43], v[168:171], v[136:139], 0
    v_mfma_f32_16x16x32_bf16 v[56:59], v[168:171], v[140:143], 0
    s_add_u32 m0, s82, 99328
    s_nop 0
    buffer_load_dwordx4 v197, s[56:59], s79 offen lds
    s_add_u32 s79, s79, 128
    s_waitcnt lgkmcnt(4)
    v_mfma_f32_16x16x32_bf16 v[12:15], v[172:175], v[128:131], 0
    v_mfma_f32_16x16x32_bf16 v[28:31], v[172:175], v[132:135], 0
    s_add_u32 m0, s82, 100352
    s_nop 0
    buffer_load_dwordx4 v188, s[56:59], s80 offen lds
    v_mfma_f32_16x16x32_bf16 v[44:47], v[172:175], v[136:139], 0
    v_mfma_f32_16x16x32_bf16 v[60:63], v[172:175], v[140:143], 0
    s_add_u32 m0, s82, 101376
    s_nop 0
    buffer_load_dwordx4 v197, s[56:59], s80 offen lds
    s_add_u32 s80, s80, 128
    s_waitcnt lgkmcnt(0)
    v_mfma_f32_16x16x32_bf16 v[64:67], v[160:163], v[144:147], 0
    s_waitcnt vmcnt(7)
    s_barrier
    ds_read_b128 v[128:131], v181 offset:0
    ds_read_b128 v[132:135], v181 offset:2048
    v_mfma_f32_16x16x32_bf16 v[80:83], v[160:163], v[148:151], 0
    ds_read_b128 v[136:139], v181 offset:4096
    ds_read_b128 v[140:143], v181 offset:6144
    v_mfma_f32_16x16x32_bf16 v[96:99], v[160:163], v[152:155], 0
    v_mfma_f32_16x16x32_bf16 v[112:115], v[160:163], v[156:159], 0
    ds_read_b64_tr_b16 v[160:161], v177 offset:0
    ds_read_b64_tr_b16 v[162:163], v177 offset:2048
    v_mfma_f32_16x16x32_bf16 v[68:71], v[164:167], v[144:147], 0
    v_mfma_f32_16x16x32_bf16 v[84:87], v[164:167], v[148:151], 0
    s_add_u32 m0, s83, 32768
    s_nop 0
    buffer_load_dwordx4 v189, s[60:63], s81 offen lds
    v_mfma_f32_16x16x32_bf16 v[100:103], v[164:167], v[152:155], 0
    v_mfma_f32_16x16x32_bf16 v[116:119], v[164:167], v[156:159], 0
    ds_read_b64_tr_b16 v[164:165], v178 offset:0
    ds_read_b64_tr_b16 v[166:167], v178 offset:2048
    v_mfma_f32_16x16x32_bf16 v[72:75], v[168:171], v[144:147], 0
    v_mfma_f32_16x16x32_bf16 v[88:91], v[168:171], v[148:151], 0
    s_add_u32 m0, s83, 33792
    s_nop 0
    buffer_load_dwordx4 v190, s[60:63], s81 offen lds
    s_add_u32 s81, s81, 262144
    v_mfma_f32_16x16x32_bf16 v[104:107], v[168:171], v[152:155], 0
    v_mfma_f32_16x16x32_bf16 v[120:123], v[168:171], v[156:159], 0
    ds_read_b64_tr_b16 v[168:169], v179 offset:0
    ds_read_b64_tr_b16 v[170:171], v179 offset:2048
    v_mfma_f32_16x16x32_bf16 v[76:79], v[172:175], v[144:147], 0
    v_mfma_f32_16x16x32_bf16 v[92:95], v[172:175], v[148:151], 0
    s_add_u32 m0, s83, 49152
    s_nop 0
    buffer_load_dwordx4 v189, s[60:63], s81 offen lds
    v_mfma_f32_16x16x32_bf16 v[108:111], v[172:175], v[152:155], 0
    v_mfma_f32_16x16x32_bf16 v[124:127], v[172:175], v[156:159], 0
    ds_read_b64_tr_b16 v[172:173], v180 offset:0
    ds_read_b64_tr_b16 v[174:175], v180 offset:2048
    s_waitcnt lgkmcnt(6)
    v_mfma_f32_16x16x32_bf16 v[0:3], v[160:163], v[128:131], v[0:3]
    ds_read_b128 v[144:147], v181 offset:8192
    ds_read_b128 v[148:151], v181 offset:10240
    v_mfma_f32_16x16x32_bf16 v[16:19], v[160:163], v[132:135], v[16:19]
    v_mfma_f32_16x16x32_bf16 v[32:35], v[160:163], v[136:139], v[32:35]
    ds_read_b128 v[152:155], v181 offset:12288
    ds_read_b128 v[156:159], v181 offset:14336
    v_mfma_f32_16x16x32_bf16 v[48:51], v[160:163], v[140:143], v[48:51]
    s_waitcnt lgkmcnt(8)
    v_mfma_f32_16x16x32_bf16 v[4:7], v[164:167], v[128:131], v[4:7]
    v_mfma_f32_16x16x32_bf16 v[20:23], v[164:167], v[132:135], v[20:23]
    s_add_u32 m0, s83, 50176
    s_nop 0
    buffer_load_dwordx4 v190, s[60:63], s81 offen lds
    s_add_u32 s81, s81, 262144
    v_mfma_f32_16x16x32_bf16 v[36:39], v[164:167], v[136:139], v[36:39]
    v_mfma_f32_16x16x32_bf16 v[52:55], v[164:167], v[140:143], v[52:55]
    buffer_load_dwordx4 v[200:203], v232, s[16:19], s85 offen
    s_waitcnt lgkmcnt(6)
    v_mfma_f32_16x16x32_bf16 v[8:11], v[168:171], v[128:131], v[8:11]
    v_mfma_f32_16x16x32_bf16 v[24:27], v[168:171], v[132:135], v[24:27]
    buffer_load_dwordx4 v[204:207], v232, s[16:19], s85 offen offset:16
    v_mfma_f32_16x16x32_bf16 v[40:43], v[168:171], v[136:139], v[40:43]
    v_mfma_f32_16x16x32_bf16 v[56:59], v[168:171], v[140:143], v[56:59]
    buffer_load_dwordx4 v[208:211], v232, s[20:23], 0 offen
    s_waitcnt lgkmcnt(4)
    v_mfma_f32_16x16x32_bf16 v[12:15], v[172:175], v[128:131], v[12:15]
    v_mfma_f32_16x16x32_bf16 v[28:31], v[172:175], v[132:135], v[28:31]
    buffer_load_dwordx4 v[212:215], v232, s[20:23], 0 offen offset:16
    s_lshl_b32 s16, s37, 20
    s_add_u32 s16, s16, 0x800000
    s_add_u32 s16, s6, s16
    s_addc_u32 s17, s7, 0
    s_mov_b32 s18, 0x100000
    s_mov_b32 s19, 0x20000
    s_cmp_eq_u32 s36, 1
    s_cselect_b32 s20, s28, s24
    s_cselect_b32 s21, s29, s25
    s_cmp_eq_u32 s36, 2
    s_cselect_b32 s20, s30, s20
    s_cselect_b32 s21, s31, s21
    s_cmp_eq_u32 s36, 3
    s_cselect_b32 s20, s26, s20
    s_cselect_b32 s21, s27, s21
    s_cmp_eq_u32 s36, 0
    s_mov_b32 s22, 20736
    s_cselect_b32 s22, 18432, s22
    s_mul_i32 s32, s2, s22
    s_add_u32 s22, s32, s22
    s_mov_b32 s23, 0x20000
    v_mfma_f32_16x16x32_bf16 v[44:47], v[172:175], v[136:139], v[44:47]
    v_mfma_f32_16x16x32_bf16 v[60:63], v[172:175], v[140:143], v[60:63]
    s_add_u32 m0, s83, 131072
    s_nop 0
    buffer_load_dwordx4 v189, s[60:63], s81 offen lds
    s_waitcnt lgkmcnt(0)
    v_mfma_f32_16x16x32_bf16 v[64:67], v[160:163], v[144:147], v[64:67]
    s_waitcnt vmcnt(9)
    s_barrier
    ds_read_b128 v[128:131], v176 offset:32768
    ds_read_b128 v[132:135], v176 offset:34816
    v_mfma_f32_16x16x32_bf16 v[80:83], v[160:163], v[148:151], v[80:83]
    ds_read_b128 v[136:139], v176 offset:36864
    ds_read_b128 v[140:143], v176 offset:38912
    v_mfma_f32_16x16x32_bf16 v[96:99], v[160:163], v[152:155], v[96:99]
    v_mfma_f32_16x16x32_bf16 v[112:115], v[160:163], v[156:159], v[112:115]
    ds_read_b64_tr_b16 v[160:161], v177 offset:16384
    ds_read_b64_tr_b16 v[162:163], v177 offset:18432
    v_mfma_f32_16x16x32_bf16 v[68:71], v[164:167], v[144:147], v[68:71]
    v_mfma_f32_16x16x32_bf16 v[84:87], v[164:167], v[148:151], v[84:87]
    s_add_u32 m0, s82, 65536
    s_nop 0
    buffer_load_dwordx4 v188, s[56:59], s79 offen lds
    v_mfma_f32_16x16x32_bf16 v[100:103], v[164:167], v[152:155], v[100:103]
    v_mfma_f32_16x16x32_bf16 v[116:119], v[164:167], v[156:159], v[116:119]
    ds_read_b64_tr_b16 v[164:165], v178 offset:16384
    ds_read_b64_tr_b16 v[166:167], v178 offset:18432
    v_mfma_f32_16x16x32_bf16 v[72:75], v[168:171], v[144:147], v[72:75]
    v_mfma_f32_16x16x32_bf16 v[88:91], v[168:171], v[148:151], v[88:91]
    s_add_u32 m0, s82, 66560
    s_nop 0
    buffer_load_dwordx4 v197, s[56:59], s79 offen lds
    s_add_u32 s79, s79, 128
    v_mfma_f32_16x16x32_bf16 v[104:107], v[168:171], v[152:155], v[104:107]
    v_mfma_f32_16x16x32_bf16 v[120:123], v[168:171], v[156:159], v[120:123]
    ds_read_b64_tr_b16 v[168:169], v179 offset:16384
    ds_read_b64_tr_b16 v[170:171], v179 offset:18432
    v_mfma_f32_16x16x32_bf16 v[76:79], v[172:175], v[144:147], v[76:79]
    v_mfma_f32_16x16x32_bf16 v[92:95], v[172:175], v[148:151], v[92:95]
    s_add_u32 m0, s82, 67584
    s_nop 0
    buffer_load_dwordx4 v188, s[56:59], s80 offen lds
    v_mfma_f32_16x16x32_bf16 v[108:111], v[172:175], v[152:155], v[108:111]
    v_mfma_f32_16x16x32_bf16 v[124:127], v[172:175], v[156:159], v[124:127]
    ds_read_b64_tr_b16 v[172:173], v180 offset:16384
    ds_read_b64_tr_b16 v[174:175], v180 offset:18432
    s_waitcnt lgkmcnt(6)
    v_mfma_f32_16x16x32_bf16 v[0:3], v[160:163], v[128:131], v[0:3]
    ds_read_b128 v[144:147], v176 offset:40960
    ds_read_b128 v[148:151], v176 offset:43008
    v_mfma_f32_16x16x32_bf16 v[16:19], v[160:163], v[132:135], v[16:19]
    v_mfma_f32_16x16x32_bf16 v[32:35], v[160:163], v[136:139], v[32:35]
    ds_read_b128 v[152:155], v176 offset:45056
    ds_read_b128 v[156:159], v176 offset:47104
    v_mfma_f32_16x16x32_bf16 v[48:51], v[160:163], v[140:143], v[48:51]
    s_waitcnt lgkmcnt(8)
    v_mfma_f32_16x16x32_bf16 v[4:7], v[164:167], v[128:131], v[4:7]
    v_mfma_f32_16x16x32_bf16 v[20:23], v[164:167], v[132:135], v[20:23]
    s_add_u32 m0, s82, 68608
    s_nop 0
    buffer_load_dwordx4 v197, s[56:59], s80 offen lds
    s_add_u32 s80, s80, 128
    v_mfma_f32_16x16x32_bf16 v[36:39], v[164:167], v[136:139], v[36:39]
    v_mfma_f32_16x16x32_bf16 v[52:55], v[164:167], v[140:143], v[52:55]
    s_add_u32 m0, s83, 132096
    s_nop 0
    buffer_load_dwordx4 v190, s[60:63], s81 offen lds
    s_add_u32 s81, s81, 262144
    s_waitcnt lgkmcnt(6)
    v_mfma_f32_16x16x32_bf16 v[8:11], v[168:171], v[128:131], v[8:11]
    v_mfma_f32_16x16x32_bf16 v[24:27], v[168:171], v[132:135], v[24:27]
    s_add_u32 m0, s83, 0
    s_nop 0
    buffer_load_dwordx4 v189, s[60:63], s81 offen lds
    v_mfma_f32_16x16x32_bf16 v[40:43], v[168:171], v[136:139], v[40:43]
    v_mfma_f32_16x16x32_bf16 v[56:59], v[168:171], v[140:143], v[56:59]
    s_add_u32 m0, s83, 1024
    s_nop 0
    buffer_load_dwordx4 v190, s[60:63], s81 offen lds
    s_add_u32 s81, s81, 262144
    s_waitcnt lgkmcnt(4)
    v_mfma_f32_16x16x32_bf16 v[12:15], v[172:175], v[128:131], v[12:15]
    v_mfma_f32_16x16x32_bf16 v[28:31], v[172:175], v[132:135], v[28:31]
    v_mfma_f32_16x16x32_bf16 v[44:47], v[172:175], v[136:139], v[44:47]
    v_mfma_f32_16x16x32_bf16 v[60:63], v[172:175], v[140:143], v[60:63]
    s_waitcnt lgkmcnt(0)
    v_mfma_f32_16x16x32_bf16 v[64:67], v[160:163], v[144:147], v[64:67]
    s_waitcnt vmcnt(14)
    s_barrier
    ds_read_b128 v[128:131], v181 offset:32768
    ds_read_b128 v[132:135], v181 offset:34816
    v_mfma_f32_16x16x32_bf16 v[80:83], v[160:163], v[148:151], v[80:83]
    ds_read_b128 v[136:139], v181 offset:36864
    ds_read_b128 v[140:143], v181 offset:38912
    v_mfma_f32_16x16x32_bf16 v[96:99], v[160:163], v[152:155], v[96:99]
    v_mfma_f32_16x16x32_bf16 v[112:115], v[160:163], v[156:159], v[112:115]
    ds_read_b64_tr_b16 v[160:161], v177 offset:32768
    ds_read_b64_tr_b16 v[162:163], v177 offset:34816
    v_mfma_f32_16x16x32_bf16 v[68:71], v[164:167], v[144:147], v[68:71]
    v_mfma_f32_16x16x32_bf16 v[84:87], v[164:167], v[148:151], v[84:87]
    s_add_u32 m0, s83, 16384
    s_nop 0
    buffer_load_dwordx4 v189, s[60:63], s81 offen lds
    v_mfma_f32_16x16x32_bf16 v[100:103], v[164:167], v[152:155], v[100:103]
    v_mfma_f32_16x16x32_bf16 v[116:119], v[164:167], v[156:159], v[116:119]
    ds_read_b64_tr_b16 v[164:165], v178 offset:32768
    ds_read_b64_tr_b16 v[166:167], v178 offset:34816
    v_mfma_f32_16x16x32_bf16 v[72:75], v[168:171], v[144:147], v[72:75]
    v_mfma_f32_16x16x32_bf16 v[88:91], v[168:171], v[148:151], v[88:91]
    s_add_u32 m0, s83, 17408
    s_nop 0
    buffer_load_dwordx4 v190, s[60:63], s81 offen lds
    s_add_u32 s81, s81, 262144
    v_mfma_f32_16x16x32_bf16 v[104:107], v[168:171], v[152:155], v[104:107]
    v_mfma_f32_16x16x32_bf16 v[120:123], v[168:171], v[156:159], v[120:123]
    ds_read_b64_tr_b16 v[168:169], v179 offset:32768
    ds_read_b64_tr_b16 v[170:171], v179 offset:34816
    v_mfma_f32_16x16x32_bf16 v[76:79], v[172:175], v[144:147], v[76:79]
    v_mfma_f32_16x16x32_bf16 v[92:95], v[172:175], v[148:151], v[92:95]
    v_mfma_f32_16x16x32_bf16 v[108:111], v[172:175], v[152:155], v[108:111]
    v_mfma_f32_16x16x32_bf16 v[124:127], v[172:175], v[156:159], v[124:127]
    ds_read_b64_tr_b16 v[172:173], v180 offset:32768
    ds_read_b64_tr_b16 v[174:175], v180 offset:34816
    s_waitcnt lgkmcnt(6)
    v_mfma_f32_16x16x32_bf16 v[0:3], v[160:163], v[128:131], v[0:3]
    ds_read_b128 v[144:147], v181 offset:40960
    ds_read_b128 v[148:151], v181 offset:43008
    v_mfma_f32_16x16x32_bf16 v[16:19], v[160:163], v[132:135], v[16:19]
    s_waitcnt vmcnt(10)
    v_lshlrev_b32 v216, 16, v200
    v_and_b32 v217, 0xffff0000, v200
    v_lshlrev_b32 v218, 16, v201
    v_and_b32 v219, 0xffff0000, v201
    v_lshlrev_b32 v220, 16, v202
    v_mfma_f32_16x16x32_bf16 v[32:35], v[160:163], v[136:139], v[32:35]
    ds_read_b128 v[152:155], v181 offset:45056
    ds_read_b128 v[156:159], v181 offset:47104
    v_mfma_f32_16x16x32_bf16 v[48:51], v[160:163], v[140:143], v[48:51]
    v_and_b32 v221, 0xffff0000, v202
    v_lshlrev_b32 v222, 16, v203
    v_and_b32 v223, 0xffff0000, v203
    v_lshlrev_b32 v224, 16, v204
    v_and_b32 v225, 0xffff0000, v204
    s_waitcnt lgkmcnt(8)
    v_mfma_f32_16x16x32_bf16 v[4:7], v[164:167], v[128:131], v[4:7]
    v_mfma_f32_16x16x32_bf16 v[20:23], v[164:167], v[132:135], v[20:23]
    v_lshlrev_b32 v226, 16, v205
    v_and_b32 v227, 0xffff0000, v205
    v_lshlrev_b32 v228, 16, v206
    v_and_b32 v229, 0xffff0000, v206
    v_lshlrev_b32 v230, 16, v207
    v_mfma_f32_16x16x32_bf16 v[36:39], v[164:167], v[136:139], v[36:39]
    v_mfma_f32_16x16x32_bf16 v[52:55], v[164:167], v[140:143], v[52:55]
    v_and_b32 v231, 0xffff0000, v207
    v_add_f32 v232, v216, v217
    v_add_f32 v232, v232, v218
    v_add_f32 v232, v232, v219
    v_add_f32 v232, v232, v220
    s_waitcnt lgkmcnt(6)
    v_mfma_f32_16x16x32_bf16 v[8:11], v[168:171], v[128:131], v[8:11]
    v_mfma_f32_16x16x32_bf16 v[24:27], v[168:171], v[132:135], v[24:27]
    v_add_f32 v232, v232, v221
    v_add_f32 v232, v232, v222
    v_add_f32 v232, v232, v223
    v_add_f32 v232, v232, v224
    v_add_f32 v232, v232, v225
    v_mfma_f32_16x16x32_bf16 v[40:43], v[168:171], v[136:139], v[40:43]
    v_mfma_f32_16x16x32_bf16 v[56:59], v[168:171], v[140:143], v[56:59]
    v_add_f32 v232, v232, v226
    v_add_f32 v232, v232, v227
    v_add_f32 v232, v232, v228
    v_add_f32 v232, v232, v229
    v_add_f32 v232, v232, v230
    s_waitcnt lgkmcnt(4)
    v_mfma_f32_16x16x32_bf16 v[12:15], v[172:175], v[128:131], v[12:15]
    v_mfma_f32_16x16x32_bf16 v[28:31], v[172:175], v[132:135], v[28:31]
    v_add_f32 v232, v232, v231
    s_nop 1
    v_add_f32_dpp v232, v232, v232 row_shr:1 row_mask:0xf bank_mask:0xf
    s_nop 1
    v_add_f32_dpp v232, v232, v232 row_shr:2 row_mask:0xf bank_mask:0xf
    v_mfma_f32_16x16x32_bf16 v[44:47], v[172:175], v[136:139], v[44:47]
    v_mfma_f32_16x16x32_bf16 v[60:63], v[172:175], v[140:143], v[60:63]
    s_nop 1
    v_add_f32_dpp v232, v232, v232 row_shr:4 row_mask:0xf bank_mask:0xf
    s_nop 1
    v_add_f32_dpp v232, v232, v232 row_shr:8 row_mask:0xf bank_mask:0xf
    s_nop 1
    s_waitcnt lgkmcnt(0)
    v_mfma_f32_16x16x32_bf16 v[64:67], v[160:163], v[144:147], v[64:67]
    s_waitcnt vmcnt(5)
    s_barrier
    ds_read_b128 v[128:131], v176 offset:0
    ds_read_b128 v[132:135], v176 offset:2048
    v_mfma_f32_16x16x32_bf16 v[80:83], v[160:163], v[148:151], v[80:83]
    ds_read_b128 v[136:139], v176 offset:4096
    ds_read_b128 v[140:143], v176 offset:6144
    v_add_f32_dpp v232, v232, v232 row_bcast:15 row_mask:0xa bank_mask:0xf
    s_nop 1
    v_add_f32_dpp v232, v232, v232 row_bcast:31 row_mask:0xc bank_mask:0xf
    s_nop 1
    v_readlane_b32 s85, v232, 63
    v_mfma_f32_16x16x32_bf16 v[96:99], v[160:163], v[152:155], v[96:99]
    v_mfma_f32_16x16x32_bf16 v[112:115], v[160:163], v[156:159], v[112:115]
    ds_read_b64_tr_b16 v[160:161], v177 offset:49152
    ds_read_b64_tr_b16 v[162:163], v177 offset:51200
    v_mov_b32 v233, 0x3ae38e39
    s_nop 1
    v_mul_f32 v233, s85, v233
    v_sub_f32 v236, v216, v233
    v_mul_f32 v232, v236, v236
    v_mfma_f32_16x16x32_bf16 v[68:71], v[164:167], v[144:147], v[68:71]
    v_mfma_f32_16x16x32_bf16 v[84:87], v[164:167], v[148:151], v[84:87]
    s_add_u32 m0, s82, 98304
    s_nop 0
    buffer_load_dwordx4 v188, s[56:59], s79 offen lds
    v_sub_f32 v236, v217, v233
    v_fmac_f32 v232, v236, v236
    v_sub_f32 v236, v218, v233
    v_fmac_f32 v232, v236, v236
    v_sub_f32 v236, v219, v233
    v_mfma_f32_16x16x32_bf16 v[100:103], v[164:167], v[152:155], v[100:103]
    v_mfma_f32_16x16x32_bf16 v[116:119], v[164:167], v[156:159], v[116:119]
    ds_read_b64_tr_b16 v[164:165], v178 offset:49152
    ds_read_b64_tr_b16 v[166:167], v178 offset:51200
    v_fmac_f32 v232, v236, v236
    v_sub_f32 v236, v220, v233
    v_fmac_f32 v232, v236, v236
    v_sub_f32 v236, v221, v233
    v_fmac_f32 v232, v236, v236
    v_mfma_f32_16x16x32_bf16 v[72:75], v[168:171], v[144:147], v[72:75]
    v_mfma_f32_16x16x32_bf16 v[88:91], v[168:171], v[148:151], v[88:91]
    s_add_u32 m0, s82, 99328
    s_nop 0
    buffer_load_dwordx4 v197, s[56:59], s79 offen lds
    s_add_u32 s79, s79, 128
    v_sub_f32 v236, v222, v233
    v_fmac_f32 v232, v236, v236
    v_sub_f32 v236, v223, v233
    v_fmac_f32 v232, v236, v236
    v_sub_f32 v236, v224, v233
    v_mfma_f32_16x16x32_bf16 v[104:107], v[168:171], v[152:155], v[104:107]
    v_mfma_f32_16x16x32_bf16 v[120:123], v[168:171], v[156:159], v[120:123]
    ds_read_b64_tr_b16 v[168:169], v179 offset:49152
    ds_read_b64_tr_b16 v[170:171], v179 offset:51200
    v_fmac_f32 v232, v236, v236
    v_sub_f32 v236, v225, v233
    v_fmac_f32 v232, v236, v236
    v_sub_f32 v236, v226, v233
    v_fmac_f32 v232, v236, v236
    v_mfma_f32_16x16x32_bf16 v[76:79], v[172:175], v[144:147], v[76:79]
    v_mfma_f32_16x16x32_bf16 v[92:95], v[172:175], v[148:151], v[92:95]
    s_add_u32 m0, s82, 100352
    s_nop 0
    buffer_load_dwordx4 v188, s[56:59], s80 offen lds
    v_sub_f32 v236, v227, v233
    v_fmac_f32 v232, v236, v236
    v_sub_f32 v236, v228, v233
    v_fmac_f32 v232, v236, v236
    v_sub_f32 v236, v229, v233
    v_mfma_f32_16x16x32_bf16 v[108:111], v[172:175], v[152:155], v[108:111]
    v_mfma_f32_16x16x32_bf16 v[124:127], v[172:175], v[156:159], v[124:127]
    ds_read_b64_tr_b16 v[172:173], v180 offset:49152
    ds_read_b64_tr_b16 v[174:175], v180 offset:51200
    v_fmac_f32 v232, v236, v236
    v_sub_f32 v236, v230, v233
    v_fmac_f32 v232, v236, v236
    v_sub_f32 v236, v231, v233
    v_fmac_f32 v232, v236, v236
    s_waitcnt lgkmcnt(6)
    v_mfma_f32_16x16x32_bf16 v[0:3], v[160:163], v[128:131], v[0:3]
    ds_read_b128 v[144:147], v176 offset:8192
    ds_read_b128 v[148:151], v176 offset:10240
    v_mfma_f32_16x16x32_bf16 v[16:19], v[160:163], v[132:135], v[16:19]
    v_cmp_gt_u32 vcc, 36, v192
    s_nop 1
    v_cndmask_b32 v232, 0, v232, vcc
    s_nop 1
    v_add_f32_dpp v232, v232, v232 row_shr:1 row_mask:0xf bank_mask:0xf
    v_mfma_f32_16x16x32_bf16 v[32:35], v[160:163], v[136:139], v[32:35]
    ds_read_b128 v[152:155], v176 offset:12288
    ds_read_b128 v[156:159], v176 offset:14336
    v_mfma_f32_16x16x32_bf16 v[48:51], v[160:163], v[140:143], v[48:51]
    s_nop 1
    v_add_f32_dpp v232, v232, v232 row_shr:2 row_mask:0xf bank_mask:0xf
    s_nop 1
    v_add_f32_dpp v232, v232, v232 row_shr:4 row_mask:0xf bank_mask:0xf
    s_nop 1
    s_waitcnt lgkmcnt(8)
    v_mfma_f32_16x16x32_bf16 v[4:7], v[164:167], v[128:131], v[4:7]
    v_mfma_f32_16x16x32_bf16 v[20:23], v[164:167], v[132:135], v[20:23]
    s_add_u32 m0, s82, 101376
    s_nop 0
    buffer_load_dwordx4 v197, s[56:59], s80 offen lds
    s_add_u32 s80, s80, 128
    v_add_f32_dpp v232, v232, v232 row_shr:8 row_mask:0xf bank_mask:0xf
    s_nop 1
    v_add_f32_dpp v232, v232, v232 row_bcast:15 row_mask:0xa bank_mask:0xf
    s_nop 1
    v_add_f32_dpp v232, v232, v232 row_bcast:31 row_mask:0xc bank_mask:0xf
    v_mfma_f32_16x16x32_bf16 v[36:39], v[164:167], v[136:139], v[36:39]
    v_mfma_f32_16x16x32_bf16 v[52:55], v[164:167], v[140:143], v[52:55]
    s_add_u32 m0, s83, 32768
    s_nop 0
    buffer_load_dwordx4 v189, s[60:63], s81 offen lds
    s_nop 1
    v_readlane_b32 s85, v232, 63
    v_mov_b32 v234, 0x3ae38e39
    s_nop 1
    v_mul_f32 v234, s85, v234
    s_waitcnt lgkmcnt(6)
    v_mfma_f32_16x16x32_bf16 v[8:11], v[168:171], v[128:131], v[8:11]
    v_mfma_f32_16x16x32_bf16 v[24:27], v[168:171], v[132:135], v[24:27]
    s_add_u32 m0, s83, 33792
    s_nop 0
    buffer_load_dwordx4 v190, s[60:63], s81 offen lds
    s_add_u32 s81, s81, 262144
    v_cvt_pk_bf16_f32 v236, v233, v234
    v_lshlrev_b32 v233, 16, v236
    v_and_b32 v234, 0xffff0000, v236
    v_add_f32 v234, 0x3727c5ac, v234
    v_cvt_pk_bf16_f32 v234, v234, v234
    v_mfma_f32_16x16x32_bf16 v[40:43], v[168:171], v[136:139], v[40:43]
    v_mfma_f32_16x16x32_bf16 v[56:59], v[168:171], v[140:143], v[56:59]
    v_lshlrev_b32 v234, 16, v234
    v_sqrt_f32 v234, v234
    s_nop 0
    v_cvt_pk_bf16_f32 v234, v234, v234
    v_lshlrev_b32 v234, 16, v234
    s_waitcnt lgkmcnt(4)
    v_mfma_f32_16x16x32_bf16 v[12:15], v[172:175], v[128:131], v[12:15]
    v_mfma_f32_16x16x32_bf16 v[28:31], v[172:175], v[132:135], v[28:31]
    v_rcp_f32 v235, v234
    v_mov_b32 v232, 0
    v_sub_f32 v216, v216, v233
    v_sub_f32 v217, v217, v233
    v_cvt_pk_bf16_f32 v236, v216, v217
    v_mfma_f32_16x16x32_bf16 v[44:47], v[172:175], v[136:139], v[44:47]
    v_mfma_f32_16x16x32_bf16 v[60:63], v[172:175], v[140:143], v[60:63]
    v_lshlrev_b32 v216, 16, v236
    v_and_b32 v217, 0xffff0000, v236
    v_mul_f32 v237, v216, v235
    v_fma_f32 v238, -v237, v234, v216
    v_fma_f32 v216, v238, v235, v237
    s_waitcnt lgkmcnt(0)
    v_mfma_f32_16x16x32_bf16 v[64:67], v[160:163], v[144:147], v[64:67]
    s_waitcnt vmcnt(10)
    s_barrier
    ds_read_b128 v[128:131], v181 offset:0
    ds_read_b128 v[132:135], v181 offset:2048
    v_mfma_f32_16x16x32_bf16 v[80:83], v[160:163], v[148:151], v[80:83]
    ds_read_b128 v[136:139], v181 offset:4096
    ds_read_b128 v[140:143], v181 offset:6144
    v_mul_f32 v237, v217, v235
    v_fma_f32 v238, -v237, v234, v217
    v_fma_f32 v217, v238, v235, v237
    v_cvt_pk_bf16_f32 v200, v216, v217
    v_lshlrev_b32 v216, 16, v200
    v_mfma_f32_16x16x32_bf16 v[96:99], v[160:163], v[152:155], v[96:99]
    v_mfma_f32_16x16x32_bf16 v[112:115], v[160:163], v[156:159], v[112:115]
    ds_read_b64_tr_b16 v[160:161], v182 offset:0
    ds_read_b64_tr_b16 v[162:163], v182 offset:2048
    v_and_b32 v217, 0xffff0000, v200
    v_lshlrev_b32 v236, 16, v208
    v_and_b32 v237, 0xffff0000, v208
    v_fmac_f32 v232, v216, v236
    v_fmac_f32 v232, v217, v237
    v_mfma_f32_16x16x32_bf16 v[68:71], v[164:167], v[144:147], v[68:71]
    v_mfma_f32_16x16x32_bf16 v[84:87], v[164:167], v[148:151], v[84:87]
    s_add_u32 m0, s83, 49152
    s_nop 0
    buffer_load_dwordx4 v189, s[60:63], s81 offen lds
    v_sub_f32 v218, v218, v233
    v_sub_f32 v219, v219, v233
    v_cvt_pk_bf16_f32 v236, v218, v219
    v_lshlrev_b32 v218, 16, v236
    v_and_b32 v219, 0xffff0000, v236
    v_mfma_f32_16x16x32_bf16 v[100:103], v[164:167], v[152:155], v[100:103]
    v_mfma_f32_16x16x32_bf16 v[116:119], v[164:167], v[156:159], v[116:119]
    ds_read_b64_tr_b16 v[164:165], v183 offset:0
    ds_read_b64_tr_b16 v[166:167], v183 offset:2048
    v_mul_f32 v237, v218, v235
    v_fma_f32 v238, -v237, v234, v218
    v_fma_f32 v218, v238, v235, v237
    v_mul_f32 v237, v219, v235
    v_fma_f32 v238, -v237, v234, v219
    v_mfma_f32_16x16x32_bf16 v[72:75], v[168:171], v[144:147], v[72:75]
    v_mfma_f32_16x16x32_bf16 v[88:91], v[168:171], v[148:151], v[88:91]
    s_add_u32 m0, s83, 50176
    s_nop 0
    buffer_load_dwordx4 v190, s[60:63], s81 offen lds
    s_add_u32 s81, s81, 262144
    v_fma_f32 v219, v238, v235, v237
    v_cvt_pk_bf16_f32 v201, v218, v219
    v_lshlrev_b32 v218, 16, v201
    v_and_b32 v219, 0xffff0000, v201
    v_lshlrev_b32 v236, 16, v209
    v_mfma_f32_16x16x32_bf16 v[104:107], v[168:171], v[152:155], v[104:107]
    v_mfma_f32_16x16x32_bf16 v[120:123], v[168:171], v[156:159], v[120:123]
    ds_read_b64_tr_b16 v[168:169], v240 offset:0
    ds_read_b64_tr_b16 v[170:171], v240 offset:2048
    v_and_b32 v237, 0xffff0000, v209
    v_fmac_f32 v232, v218, v236
    v_fmac_f32 v232, v219, v237
    v_sub_f32 v220, v220, v233
    v_sub_f32 v221, v221, v233
    v_mfma_f32_16x16x32_bf16 v[76:79], v[172:175], v[144:147], v[76:79]
    v_mfma_f32_16x16x32_bf16 v[92:95], v[172:175], v[148:151], v[92:95]
    v_cvt_pk_bf16_f32 v236, v220, v221
    v_lshlrev_b32 v220, 16, v236
    v_and_b32 v221, 0xffff0000, v236
    v_mul_f32 v237, v220, v235
    v_fma_f32 v238, -v237, v234, v220
    v_mfma_f32_16x16x32_bf16 v[108:111], v[172:175], v[152:155], v[108:111]
    v_mfma_f32_16x16x32_bf16 v[124:127], v[172:175], v[156:159], v[124:127]
    ds_read_b64_tr_b16 v[172:173], v241 offset:0
    ds_read_b64_tr_b16 v[174:175], v241 offset:2048
    v_fma_f32 v220, v238, v235, v237
    v_mul_f32 v237, v221, v235
    v_fma_f32 v238, -v237, v234, v221
    v_fma_f32 v221, v238, v235, v237
    v_cvt_pk_bf16_f32 v202, v220, v221
    s_waitcnt lgkmcnt(6)
    v_mfma_f32_16x16x32_bf16 v[0:3], v[160:163], v[128:131], v[0:3]
    ds_read_b128 v[144:147], v181 offset:8192
    ds_read_b128 v[148:151], v181 offset:10240
    v_mfma_f32_16x16x32_bf16 v[16:19], v[160:163], v[132:135], v[16:19]
    v_lshlrev_b32 v220, 16, v202
    v_and_b32 v221, 0xffff0000, v202
    v_lshlrev_b32 v236, 16, v210
    v_and_b32 v237, 0xffff0000, v210
    v_fmac_f32 v232, v220, v236
    v_mfma_f32_16x16x32_bf16 v[32:35], v[160:163], v[136:139], v[32:35]
    ds_read_b128 v[152:155], v181 offset:12288
    ds_read_b128 v[156:159], v181 offset:14336
    v_mfma_f32_16x16x32_bf16 v[48:51], v[160:163], v[140:143], v[48:51]
    v_fmac_f32 v232, v221, v237
    v_sub_f32 v222, v222, v233
    v_sub_f32 v223, v223, v233
    v_cvt_pk_bf16_f32 v236, v222, v223
    v_lshlrev_b32 v222, 16, v236
    s_waitcnt lgkmcnt(8)
    v_mfma_f32_16x16x32_bf16 v[4:7], v[164:167], v[128:131], v[4:7]
    v_mfma_f32_16x16x32_bf16 v[20:23], v[164:167], v[132:135], v[20:23]
    v_and_b32 v223, 0xffff0000, v236
    v_mul_f32 v237, v222, v235
    v_fma_f32 v238, -v237, v234, v222
    v_fma_f32 v222, v238, v235, v237
    v_mul_f32 v237, v223, v235
    v_mfma_f32_16x16x32_bf16 v[36:39], v[164:167], v[136:139], v[36:39]
    v_mfma_f32_16x16x32_bf16 v[52:55], v[164:167], v[140:143], v[52:55]
    v_fma_f32 v238, -v237, v234, v223
    v_fma_f32 v223, v238, v235, v237
    v_cvt_pk_bf16_f32 v203, v222, v223
    v_lshlrev_b32 v222, 16, v203
    v_and_b32 v223, 0xffff0000, v203
    s_waitcnt lgkmcnt(6)
    v_mfma_f32_16x16x32_bf16 v[8:11], v[168:171], v[128:131], v[8:11]
    v_mfma_f32_16x16x32_bf16 v[24:27], v[168:171], v[132:135], v[24:27]
    v_lshlrev_b32 v236, 16, v211
    v_and_b32 v237, 0xffff0000, v211
    v_fmac_f32 v232, v222, v236
    v_fmac_f32 v232, v223, v237
    v_sub_f32 v224, v224, v233
    v_mfma_f32_16x16x32_bf16 v[40:43], v[168:171], v[136:139], v[40:43]
    v_mfma_f32_16x16x32_bf16 v[56:59], v[168:171], v[140:143], v[56:59]
    v_sub_f32 v225, v225, v233
    v_cvt_pk_bf16_f32 v236, v224, v225
    v_lshlrev_b32 v224, 16, v236
    v_and_b32 v225, 0xffff0000, v236
    v_mul_f32 v237, v224, v235
    s_waitcnt lgkmcnt(4)
    v_mfma_f32_16x16x32_bf16 v[12:15], v[172:175], v[128:131], v[12:15]
    v_mfma_f32_16x16x32_bf16 v[28:31], v[172:175], v[132:135], v[28:31]
    v_fma_f32 v238, -v237, v234, v224
    v_fma_f32 v224, v238, v235, v237
    v_mul_f32 v237, v225, v235
    v_fma_f32 v238, -v237, v234, v225
    v_fma_f32 v225, v238, v235, v237
    v_mfma_f32_16x16x32_bf16 v[44:47], v[172:175], v[136:139], v[44:47]
    v_mfma_f32_16x16x32_bf16 v[60:63], v[172:175], v[140:143], v[60:63]
    v_cvt_pk_bf16_f32 v204, v224, v225
    v_lshlrev_b32 v224, 16, v204
    v_and_b32 v225, 0xffff0000, v204
    v_lshlrev_b32 v236, 16, v212
    v_and_b32 v237, 0xffff0000, v212
    s_waitcnt lgkmcnt(0)
    v_mfma_f32_16x16x32_bf16 v[64:67], v[160:163], v[144:147], v[64:67]
    s_waitcnt vmcnt(4)
    s_barrier
    ds_read_b128 v[128:131], v176 offset:32768
    ds_read_b128 v[132:135], v176 offset:34816
    v_mfma_f32_16x16x32_bf16 v[80:83], v[160:163], v[148:151], v[80:83]
    ds_read_b128 v[136:139], v176 offset:36864
    ds_read_b128 v[140:143], v176 offset:38912
    v_fmac_f32 v232, v224, v236
    v_fmac_f32 v232, v225, v237
    v_sub_f32 v226, v226, v233
    v_sub_f32 v227, v227, v233
    v_cvt_pk_bf16_f32 v236, v226, v227
    v_mfma_f32_16x16x32_bf16 v[96:99], v[160:163], v[152:155], v[96:99]
    v_mfma_f32_16x16x32_bf16 v[112:115], v[160:163], v[156:159], v[112:115]
    ds_read_b64_tr_b16 v[160:161], v177 offset:0
    ds_read_b64_tr_b16 v[162:163], v177 offset:2048
    v_lshlrev_b32 v226, 16, v236
    v_and_b32 v227, 0xffff0000, v236
    v_mul_f32 v237, v226, v235
    v_fma_f32 v238, -v237, v234, v226
    v_fma_f32 v226, v238, v235, v237
    v_mfma_f32_16x16x32_bf16 v[68:71], v[164:167], v[144:147], v[68:71]
    v_mfma_f32_16x16x32_bf16 v[84:87], v[164:167], v[148:151], v[84:87]
    s_add_u32 m0, s82, 65536
    s_nop 0
    buffer_load_dwordx4 v188, s[56:59], s79 offen lds
    v_mul_f32 v237, v227, v235
    v_fma_f32 v238, -v237, v234, v227
    v_fma_f32 v227, v238, v235, v237
    v_cvt_pk_bf16_f32 v205, v226, v227
    v_lshlrev_b32 v226, 16, v205
    v_mfma_f32_16x16x32_bf16 v[100:103], v[164:167], v[152:155], v[100:103]
    v_mfma_f32_16x16x32_bf16 v[116:119], v[164:167], v[156:159], v[116:119]
    ds_read_b64_tr_b16 v[164:165], v178 offset:0
    ds_read_b64_tr_b16 v[166:167], v178 offset:2048
    v_and_b32 v227, 0xffff0000, v205
    v_lshlrev_b32 v236, 16, v213
    v_and_b32 v237, 0xffff0000, v213
    v_fmac_f32 v232, v226, v236
    v_fmac_f32 v232, v227, v237
    v_mfma_f32_16x16x32_bf16 v[72:75], v[168:171], v[144:147], v[72:75]
    v_mfma_f32_16x16x32_bf16 v[88:91], v[168:171], v[148:151], v[88:91]
    s_add_u32 m0, s82, 66560
    s_nop 0
    buffer_load_dwordx4 v197, s[56:59], s79 offen lds
    s_add_u32 s79, s79, 128
    v_sub_f32 v228, v228, v233
    v_sub_f32 v229, v229, v233
    v_cvt_pk_bf16_f32 v236, v228, v229
    v_lshlrev_b32 v228, 16, v236
    v_and_b32 v229, 0xffff0000, v236
    v_mfma_f32_16x16x32_bf16 v[104:107], v[168:171], v[152:155], v[104:107]
    v_mfma_f32_16x16x32_bf16 v[120:123], v[168:171], v[156:159], v[120:123]
    ds_read_b64_tr_b16 v[168:169], v179 offset:0
    ds_read_b64_tr_b16 v[170:171], v179 offset:2048
    v_mul_f32 v237, v228, v235
    v_fma_f32 v238, -v237, v234, v228
    v_fma_f32 v228, v238, v235, v237
    v_mul_f32 v237, v229, v235
    v_fma_f32 v238, -v237, v234, v229
    v_mfma_f32_16x16x32_bf16 v[76:79], v[172:175], v[144:147], v[76:79]
    v_mfma_f32_16x16x32_bf16 v[92:95], v[172:175], v[148:151], v[92:95]
    s_add_u32 m0, s82, 67584
    s_nop 0
    buffer_load_dwordx4 v188, s[56:59], s80 offen lds
    v_fma_f32 v229, v238, v235, v237
    v_cvt_pk_bf16_f32 v206, v228, v229
    v_lshlrev_b32 v228, 16, v206
    v_and_b32 v229, 0xffff0000, v206
    v_lshlrev_b32 v236, 16, v214
    v_mfma_f32_16x16x32_bf16 v[108:111], v[172:175], v[152:155], v[108:111]
    v_mfma_f32_16x16x32_bf16 v[124:127], v[172:175], v[156:159], v[124:127]
    ds_read_b64_tr_b16 v[172:173], v180 offset:0
    ds_read_b64_tr_b16 v[174:175], v180 offset:2048
    v_and_b32 v237, 0xffff0000, v214
    v_fmac_f32 v232, v228, v236
    v_fmac_f32 v232, v229, v237
    v_sub_f32 v230, v230, v233
    v_sub_f32 v231, v231, v233
    s_waitcnt lgkmcnt(6)
    v_mfma_f32_16x16x32_bf16 v[0:3], v[160:163], v[128:131], v[0:3]
    ds_read_b128 v[144:147], v176 offset:40960
    ds_read_b128 v[148:151], v176 offset:43008
    v_mfma_f32_16x16x32_bf16 v[16:19], v[160:163], v[132:135], v[16:19]
    v_cvt_pk_bf16_f32 v236, v230, v231
    v_lshlrev_b32 v230, 16, v236
    v_and_b32 v231, 0xffff0000, v236
    v_mul_f32 v237, v230, v235
    v_fma_f32 v238, -v237, v234, v230
    v_mfma_f32_16x16x32_bf16 v[32:35], v[160:163], v[136:139], v[32:35]
    ds_read_b128 v[152:155], v176 offset:45056
    ds_read_b128 v[156:159], v176 offset:47104
    v_mfma_f32_16x16x32_bf16 v[48:51], v[160:163], v[140:143], v[48:51]
    v_fma_f32 v230, v238, v235, v237
    v_mul_f32 v237, v231, v235
    v_fma_f32 v238, -v237, v234, v231
    v_fma_f32 v231, v238, v235, v237
    v_cvt_pk_bf16_f32 v207, v230, v231
    s_waitcnt lgkmcnt(8)
    v_mfma_f32_16x16x32_bf16 v[4:7], v[164:167], v[128:131], v[4:7]
    v_mfma_f32_16x16x32_bf16 v[20:23], v[164:167], v[132:135], v[20:23]
    s_add_u32 m0, s82, 68608
    s_nop 0
    buffer_load_dwordx4 v197, s[56:59], s80 offen lds
    s_add_u32 s80, s80, 128
    v_lshlrev_b32 v230, 16, v207
    v_and_b32 v231, 0xffff0000, v207
    v_lshlrev_b32 v236, 16, v215
    v_and_b32 v237, 0xffff0000, v215
    v_fmac_f32 v232, v230, v236
    v_mfma_f32_16x16x32_bf16 v[36:39], v[164:167], v[136:139], v[36:39]
    v_mfma_f32_16x16x32_bf16 v[52:55], v[164:167], v[140:143], v[52:55]
    s_add_u32 m0, s83, 131072
    s_nop 0
    buffer_load_dwordx4 v189, s[60:63], s81 offen lds
    v_fmac_f32 v232, v231, v237
    s_lshl_b32 s85, s36, 4
    s_add_u32 s85, s85, 147456
    v_min_u32 v239, 36, v192
    v_lshl_add_u32 v239, v239, 8, s85
    s_waitcnt lgkmcnt(6)
    v_mfma_f32_16x16x32_bf16 v[8:11], v[168:171], v[128:131], v[8:11]
    v_mfma_f32_16x16x32_bf16 v[24:27], v[168:171], v[132:135], v[24:27]
    s_add_u32 m0, s83, 132096
    s_nop 0
    buffer_load_dwordx4 v190, s[60:63], s81 offen lds
    s_add_u32 s81, s81, 262144
    v_mov_b32 v236, 0x40000000
    ds_write_b128 v239, v[200:203]
    ds_write_b128 v239, v[204:207] offset:128
    s_nop 1
    v_add_f32_dpp v232, v232, v232 row_shr:1 row_mask:0xf bank_mask:0xf
    v_mfma_f32_16x16x32_bf16 v[40:43], v[168:171], v[136:139], v[40:43]
    v_mfma_f32_16x16x32_bf16 v[56:59], v[168:171], v[140:143], v[56:59]
    buffer_load_dword v198, off, s[72:75], 0 sc1
    s_nop 1
    v_add_f32_dpp v232, v232, v232 row_shr:2 row_mask:0xf bank_mask:0xf
    s_nop 1
    v_add_f32_dpp v232, v232, v232 row_shr:4 row_mask:0xf bank_mask:0xf
    s_nop 1
    s_waitcnt lgkmcnt(4)
    v_mfma_f32_16x16x32_bf16 v[12:15], v[172:175], v[128:131], v[12:15]
    v_mfma_f32_16x16x32_bf16 v[28:31], v[172:175], v[132:135], v[28:31]
    v_add_f32_dpp v232, v232, v232 row_shr:8 row_mask:0xf bank_mask:0xf
    s_nop 1
    v_add_f32_dpp v232, v232, v232 row_bcast:15 row_mask:0xa bank_mask:0xf
    s_nop 1
    v_add_f32_dpp v232, v232, v232 row_bcast:31 row_mask:0xc bank_mask:0xf
    v_mfma_f32_16x16x32_bf16 v[44:47], v[172:175], v[136:139], v[44:47]
    v_mfma_f32_16x16x32_bf16 v[60:63], v[172:175], v[140:143], v[60:63]
    s_nop 1
    v_cvt_pk_bf16_f32 v232, v232, v232
    v_and_b32 v232, 0xffff, v232
    v_xor_b32 v237, 0xffff, v232
    v_or_b32 v238, 0x8000, v232
    s_waitcnt lgkmcnt(0)
    v_mfma_f32_16x16x32_bf16 v[64:67], v[160:163], v[144:147], v[64:67]
    s_waitcnt vmcnt(15)
    s_barrier
    ds_read_b128 v[128:131], v181 offset:32768
    ds_read_b128 v[132:135], v181 offset:34816
    v_mfma_f32_16x16x32_bf16 v[80:83], v[160:163], v[148:151], v[80:83]
    ds_read_b128 v[136:139], v181 offset:36864
    ds_read_b128 v[140:143], v181 offset:38912
    v_cmp_lt_u32 vcc, 0x7fff, v232
    s_sub_u32 s86, 2047, s84
    s_nop 0
    v_cndmask_b32 v232, v238, v237, vcc
    v_lshlrev_b32 v232, 16, v232
    v_mfma_f32_16x16x32_bf16 v[96:99], v[160:163], v[152:155], v[96:99]
    v_mfma_f32_16x16x32_bf16 v[112:115], v[160:163], v[156:159], v[112:115]
    ds_read_b64_tr_b16 v[160:161], v177 offset:16384
    ds_read_b64_tr_b16 v[162:163], v177 offset:18432
    v_or_b32 v232, s86, v232
    v_cmp_eq_u32 vcc, 63, v192
    s_lshl_b32 s85, s36, 2
    s_add_u32 s85, s85, 157184
    v_mov_b32 v237, s85
    v_mfma_f32_16x16x32_bf16 v[68:71], v[164:167], v[144:147], v[68:71]
    v_mfma_f32_16x16x32_bf16 v[84:87], v[164:167], v[148:151], v[84:87]
    s_add_u32 m0, s83, 0
    s_nop 0
    buffer_load_dwordx4 v189, s[60:63], s81 offen lds
    v_mov_b32 v238, 157248
    v_cndmask_b32 v239, v238, v237, vcc
    ds_write_b32 v239, v232
    v_mfma_f32_16x16x32_bf16 v[100:103], v[164:167], v[152:155], v[100:103]
    v_mfma_f32_16x16x32_bf16 v[116:119], v[164:167], v[156:159], v[116:119]
    ds_read_b64_tr_b16 v[164:165], v178 offset:16384
    ds_read_b64_tr_b16 v[166:167], v178 offset:18432
    v_mfma_f32_16x16x32_bf16 v[72:75], v[168:171], v[144:147], v[72:75]
    v_mfma_f32_16x16x32_bf16 v[88:91], v[168:171], v[148:151], v[88:91]
    s_add_u32 m0, s83, 1024
    s_nop 0
    buffer_load_dwordx4 v190, s[60:63], s81 offen lds
    s_add_u32 s81, s81, 262144
    v_mfma_f32_16x16x32_bf16 v[104:107], v[168:171], v[152:155], v[104:107]
    v_mfma_f32_16x16x32_bf16 v[120:123], v[168:171], v[156:159], v[120:123]
    ds_read_b64_tr_b16 v[168:169], v179 offset:16384
    ds_read_b64_tr_b16 v[170:171], v179 offset:18432
    v_mfma_f32_16x16x32_bf16 v[76:79], v[172:175], v[144:147], v[76:79]
    v_mfma_f32_16x16x32_bf16 v[92:95], v[172:175], v[148:151], v[92:95]
    v_mfma_f32_16x16x32_bf16 v[108:111], v[172:175], v[152:155], v[108:111]
    v_mfma_f32_16x16x32_bf16 v[124:127], v[172:175], v[156:159], v[124:127]
    ds_read_b64_tr_b16 v[172:173], v180 offset:16384
    ds_read_b64_tr_b16 v[174:175], v180 offset:18432
    s_waitcnt lgkmcnt(6)
    v_mfma_f32_16x16x32_bf16 v[0:3], v[160:163], v[128:131], v[0:3]
    ds_read_b128 v[144:147], v181 offset:40960
    ds_read_b128 v[148:151], v181 offset:43008
    v_mfma_f32_16x16x32_bf16 v[16:19], v[160:163], v[132:135], v[16:19]
    v_mfma_f32_16x16x32_bf16 v[32:35], v[160:163], v[136:139], v[32:35]
    ds_read_b128 v[152:155], v181 offset:45056
    ds_read_b128 v[156:159], v181 offset:47104
    v_mfma_f32_16x16x32_bf16 v[48:51], v[160:163], v[140:143], v[48:51]
    s_waitcnt lgkmcnt(8)
    v_mfma_f32_16x16x32_bf16 v[4:7], v[164:167], v[128:131], v[4:7]
    v_mfma_f32_16x16x32_bf16 v[20:23], v[164:167], v[132:135], v[20:23]
    v_mfma_f32_16x16x32_bf16 v[36:39], v[164:167], v[136:139], v[36:39]
    v_mfma_f32_16x16x32_bf16 v[52:55], v[164:167], v[140:143], v[52:55]
    s_waitcnt lgkmcnt(6)
    v_mfma_f32_16x16x32_bf16 v[8:11], v[168:171], v[128:131], v[8:11]
    v_mfma_f32_16x16x32_bf16 v[24:27], v[168:171], v[132:135], v[24:27]
    v_mfma_f32_16x16x32_bf16 v[40:43], v[168:171], v[136:139], v[40:43]
    v_mfma_f32_16x16x32_bf16 v[56:59], v[168:171], v[140:143], v[56:59]
    s_waitcnt lgkmcnt(4)
    v_mfma_f32_16x16x32_bf16 v[12:15], v[172:175], v[128:131], v[12:15]
    v_mfma_f32_16x16x32_bf16 v[28:31], v[172:175], v[132:135], v[28:31]
    v_mfma_f32_16x16x32_bf16 v[44:47], v[172:175], v[136:139], v[44:47]
    v_mfma_f32_16x16x32_bf16 v[60:63], v[172:175], v[140:143], v[60:63]
    s_waitcnt lgkmcnt(0)
    v_mfma_f32_16x16x32_bf16 v[64:67], v[160:163], v[144:147], v[64:67]
    s_waitcnt vmcnt(5)
    s_barrier
    ds_read_b128 v[128:131], v176 offset:0
    ds_read_b128 v[132:135], v176 offset:2048
    v_mfma_f32_16x16x32_bf16 v[80:83], v[160:163], v[148:151], v[80:83]
    ds_read_b128 v[136:139], v176 offset:4096
    ds_read_b128 v[140:143], v176 offset:6144
    v_mfma_f32_16x16x32_bf16 v[96:99], v[160:163], v[152:155], v[96:99]
    v_mfma_f32_16x16x32_bf16 v[112:115], v[160:163], v[156:159], v[112:115]
    ds_read_b64_tr_b16 v[160:161], v177 offset:32768
    ds_read_b64_tr_b16 v[162:163], v177 offset:34816
    v_mfma_f32_16x16x32_bf16 v[68:71], v[164:167], v[144:147], v[68:71]
    v_mfma_f32_16x16x32_bf16 v[84:87], v[164:167], v[148:151], v[84:87]
    s_add_u32 m0, s82, 98304
    s_nop 0
    buffer_load_dwordx4 v188, s[56:59], s79 offen lds
    v_mfma_f32_16x16x32_bf16 v[100:103], v[164:167], v[152:155], v[100:103]
    v_mfma_f32_16x16x32_bf16 v[116:119], v[164:167], v[156:159], v[116:119]
    ds_read_b64_tr_b16 v[164:165], v178 offset:32768
    ds_read_b64_tr_b16 v[166:167], v178 offset:34816
    v_mfma_f32_16x16x32_bf16 v[72:75], v[168:171], v[144:147], v[72:75]
    v_mfma_f32_16x16x32_bf16 v[88:91], v[168:171], v[148:151], v[88:91]
    s_add_u32 m0, s82, 99328
    s_nop 0
    buffer_load_dwordx4 v197, s[56:59], s79 offen lds
    s_add_u32 s79, s79, 128
    v_mfma_f32_16x16x32_bf16 v[104:107], v[168:171], v[152:155], v[104:107]
    v_mfma_f32_16x16x32_bf16 v[120:123], v[168:171], v[156:159], v[120:123]
    ds_read_b64_tr_b16 v[168:169], v179 offset:32768
    ds_read_b64_tr_b16 v[170:171], v179 offset:34816
    v_mfma_f32_16x16x32_bf16 v[76:79], v[172:175], v[144:147], v[76:79]
    v_mfma_f32_16x16x32_bf16 v[92:95], v[172:175], v[148:151], v[92:95]
    s_add_u32 m0, s82, 100352
    s_nop 0
    buffer_load_dwordx4 v188, s[56:59], s80 offen lds
    v_mfma_f32_16x16x32_bf16 v[108:111], v[172:175], v[152:155], v[108:111]
    v_mfma_f32_16x16x32_bf16 v[124:127], v[172:175], v[156:159], v[124:127]
    ds_read_b64_tr_b16 v[172:173], v180 offset:32768
    ds_read_b64_tr_b16 v[174:175], v180 offset:34816
    s_waitcnt lgkmcnt(6)
    v_mfma_f32_16x16x32_bf16 v[0:3], v[160:163], v[128:131], v[0:3]
    s_waitcnt vmcnt(5)
    s_mov_b32 s35, 0x100000
parallel_sum__compressed_kv_cla__moe_arch_mod__prompt_kernel_p1A_tag0:
    v_readfirstlane_b32 s87, v198
    s_sub_u32 s35, s35, 1
    s_cbranch_scc1 parallel_sum__compressed_kv_cla__moe_arch_mod__prompt_kernel_p1A_tag0_ok
    s_cmp_lg_u32 s87, 0
    s_cbranch_scc1 parallel_sum__compressed_kv_cla__moe_arch_mod__prompt_kernel_p1A_tag0_ok
    buffer_load_dword v198, off, s[72:75], 0 sc1
    s_waitcnt vmcnt(0)
    s_branch parallel_sum__compressed_kv_cla__moe_arch_mod__prompt_kernel_p1A_tag0
parallel_sum__compressed_kv_cla__moe_arch_mod__prompt_kernel_p1A_tag0_ok:
    ds_read_b128 v[144:147], v176 offset:8192
    ds_read_b128 v[148:151], v176 offset:10240
    v_mfma_f32_16x16x32_bf16 v[16:19], v[160:163], v[132:135], v[16:19]
    v_mfma_f32_16x16x32_bf16 v[32:35], v[160:163], v[136:139], v[32:35]
    ds_read_b128 v[152:155], v176 offset:12288
    ds_read_b128 v[156:159], v176 offset:14336
    v_mfma_f32_16x16x32_bf16 v[48:51], v[160:163], v[140:143], v[48:51]
    s_waitcnt lgkmcnt(8)
    v_mfma_f32_16x16x32_bf16 v[4:7], v[164:167], v[128:131], v[4:7]
    v_mfma_f32_16x16x32_bf16 v[20:23], v[164:167], v[132:135], v[20:23]
    s_add_u32 m0, s82, 101376
    s_nop 0
    buffer_load_dwordx4 v197, s[56:59], s80 offen lds
    s_add_u32 s80, s80, 128
    v_mfma_f32_16x16x32_bf16 v[36:39], v[164:167], v[136:139], v[36:39]
    v_mfma_f32_16x16x32_bf16 v[52:55], v[164:167], v[140:143], v[52:55]
    s_add_u32 m0, s83, 16384
    s_nop 0
    buffer_load_dwordx4 v189, s[60:63], s81 offen lds
    s_waitcnt lgkmcnt(6)
    v_mfma_f32_16x16x32_bf16 v[8:11], v[168:171], v[128:131], v[8:11]
    v_mfma_f32_16x16x32_bf16 v[24:27], v[168:171], v[132:135], v[24:27]
    s_add_u32 m0, s83, 17408
    s_nop 0
    buffer_load_dwordx4 v190, s[60:63], s81 offen lds
    s_add_u32 s81, s81, 262144
    v_mfma_f32_16x16x32_bf16 v[40:43], v[168:171], v[136:139], v[40:43]
    v_mfma_f32_16x16x32_bf16 v[56:59], v[168:171], v[140:143], v[56:59]
    s_mul_i32 s49, s84, 2304
    buffer_load_dword v194, v193, s[8:11], s49 offen
    s_waitcnt lgkmcnt(4)
    v_mfma_f32_16x16x32_bf16 v[12:15], v[172:175], v[128:131], v[12:15]
    v_mfma_f32_16x16x32_bf16 v[28:31], v[172:175], v[132:135], v[28:31]
    v_mfma_f32_16x16x32_bf16 v[44:47], v[172:175], v[136:139], v[44:47]
    v_mfma_f32_16x16x32_bf16 v[60:63], v[172:175], v[140:143], v[60:63]
    s_waitcnt lgkmcnt(0)
    v_mfma_f32_16x16x32_bf16 v[64:67], v[160:163], v[144:147], v[64:67]
    s_waitcnt vmcnt(16)
    s_barrier
    ds_read_b128 v[128:131], v181 offset:0
    ds_read_b128 v[132:135], v181 offset:2048
    v_mfma_f32_16x16x32_bf16 v[80:83], v[160:163], v[148:151], v[80:83]
    ds_read_b128 v[136:139], v181 offset:4096
    ds_read_b128 v[140:143], v181 offset:6144
    s_lshl_b32 s85, s36, 10
    v_add_u32 v232, s85, v243
    v_add_u32 v232, 147456, v232
    ds_read_b128 v[200:203], v232
    v_mov_b32 v233, 155648
    v_mfma_f32_16x16x32_bf16 v[96:99], v[160:163], v[152:155], v[96:99]
    v_mfma_f32_16x16x32_bf16 v[112:115], v[160:163], v[156:159], v[112:115]
    ds_read_b64_tr_b16 v[160:161], v177 offset:49152
    ds_read_b64_tr_b16 v[162:163], v177 offset:51200
    v_add_u32 v233, v233, v243
    ds_read_b128 v[204:207], v233
    v_lshrrev_b32 v234, 2, v243
    v_add_u32 v236, 157184, v234
    ds_read_b32 v236, v236
    v_mfma_f32_16x16x32_bf16 v[68:71], v[164:167], v[144:147], v[68:71]
    v_mfma_f32_16x16x32_bf16 v[84:87], v[164:167], v[148:151], v[84:87]
    s_add_u32 m0, s83, 32768
    s_nop 0
    buffer_load_dwordx4 v189, s[60:63], s81 offen lds
    v_lshrrev_b32 v232, 3, v192
    v_lshlrev_b32 v232, 9, v232
    v_and_b32 v233, 7, v192
    v_lshl_add_u32 v232, v233, 4, v232
    s_lshr_b32 s85, s2, 2
    v_mfma_f32_16x16x32_bf16 v[100:103], v[164:167], v[152:155], v[100:103]
    v_mfma_f32_16x16x32_bf16 v[116:119], v[164:167], v[156:159], v[116:119]
    ds_read_b64_tr_b16 v[164:165], v178 offset:49152
    ds_read_b64_tr_b16 v[166:167], v178 offset:51200
    s_mul_i32 s85, s85, 36864
    s_and_b32 s86, s2, 3
    s_lshl_b32 s86, s86, 7
    s_add_u32 s85, s85, s86
    s_add_u32 s85, s85, 0x0
    v_mfma_f32_16x16x32_bf16 v[72:75], v[168:171], v[144:147], v[72:75]
    v_mfma_f32_16x16x32_bf16 v[88:91], v[168:171], v[148:151], v[88:91]
    s_add_u32 m0, s83, 33792
    s_nop 0
    buffer_load_dwordx4 v190, s[60:63], s81 offen lds
    s_add_u32 s81, s81, 262144
    s_lshl_b32 s86, s36, 12
    s_add_u32 s86, s86, s85
    s_add_u32 s85, s85, 32768
    v_mov_b32 v237, 0x40000000
    v_cmp_gt_u32 vcc, 64, v191
    v_mfma_f32_16x16x32_bf16 v[104:107], v[168:171], v[152:155], v[104:107]
    v_mfma_f32_16x16x32_bf16 v[120:123], v[168:171], v[156:159], v[120:123]
    ds_read_b64_tr_b16 v[168:169], v179 offset:49152
    ds_read_b64_tr_b16 v[170:171], v179 offset:51200
    s_waitcnt lgkmcnt(0)
    buffer_store_dwordx4 v[200:203], v232, s[12:15], s86 offen sc1
    v_cndmask_b32 v233, v237, v232, vcc
    buffer_store_dwordx4 v[204:207], v233, s[12:15], s85 offen sc1
    v_cmp_gt_u32 vcc, 8, v191
    v_mfma_f32_16x16x32_bf16 v[76:79], v[172:175], v[144:147], v[76:79]
    v_mfma_f32_16x16x32_bf16 v[92:95], v[172:175], v[148:151], v[92:95]
    s_lshl_b32 s85, s2, 5
    s_add_u32 s85, s85, 0x240000
    v_cndmask_b32 v233, v237, v234, vcc
    buffer_store_dword v236, v233, s[12:15], s85 offen sc1
    v_mov_b32 v195, s87
    v_mfma_f32_16x16x32_bf16 v[108:111], v[172:175], v[152:155], v[108:111]
    v_mfma_f32_16x16x32_bf16 v[124:127], v[172:175], v[156:159], v[124:127]
    ds_read_b64_tr_b16 v[172:173], v180 offset:49152
    ds_read_b64_tr_b16 v[174:175], v180 offset:51200
    s_lshl_b32 s85, s2, 6
    s_add_u32 s85, s85, 0x780000
    s_waitcnt lgkmcnt(6)
    v_mfma_f32_16x16x32_bf16 v[0:3], v[160:163], v[128:131], v[0:3]
    ds_read_b128 v[144:147], v181 offset:8192
    ds_read_b128 v[148:151], v181 offset:10240
    v_mfma_f32_16x16x32_bf16 v[16:19], v[160:163], v[132:135], v[16:19]
    v_mfma_f32_16x16x32_bf16 v[32:35], v[160:163], v[136:139], v[32:35]
    ds_read_b128 v[152:155], v181 offset:12288
    ds_read_b128 v[156:159], v181 offset:14336
    v_mfma_f32_16x16x32_bf16 v[48:51], v[160:163], v[140:143], v[48:51]
    s_waitcnt lgkmcnt(8)
    v_mfma_f32_16x16x32_bf16 v[4:7], v[164:167], v[128:131], v[4:7]
    v_mfma_f32_16x16x32_bf16 v[20:23], v[164:167], v[132:135], v[20:23]
    v_mfma_f32_16x16x32_bf16 v[36:39], v[164:167], v[136:139], v[36:39]
    v_mfma_f32_16x16x32_bf16 v[52:55], v[164:167], v[140:143], v[52:55]
    s_waitcnt lgkmcnt(6)
    v_mfma_f32_16x16x32_bf16 v[8:11], v[168:171], v[128:131], v[8:11]
    v_mfma_f32_16x16x32_bf16 v[24:27], v[168:171], v[132:135], v[24:27]
    v_mfma_f32_16x16x32_bf16 v[40:43], v[168:171], v[136:139], v[40:43]
    v_mfma_f32_16x16x32_bf16 v[56:59], v[168:171], v[140:143], v[56:59]
    s_waitcnt lgkmcnt(4)
    v_mfma_f32_16x16x32_bf16 v[12:15], v[172:175], v[128:131], v[12:15]
    v_mfma_f32_16x16x32_bf16 v[28:31], v[172:175], v[132:135], v[28:31]
    v_mfma_f32_16x16x32_bf16 v[44:47], v[172:175], v[136:139], v[44:47]
    v_mfma_f32_16x16x32_bf16 v[60:63], v[172:175], v[140:143], v[60:63]
    s_waitcnt lgkmcnt(0)
    v_mfma_f32_16x16x32_bf16 v[64:67], v[160:163], v[144:147], v[64:67]
    s_waitcnt vmcnt(8)
    s_barrier
    ds_read_b128 v[128:131], v176 offset:32768
    ds_read_b128 v[132:135], v176 offset:34816
    v_mfma_f32_16x16x32_bf16 v[80:83], v[160:163], v[148:151], v[80:83]
    ds_read_b128 v[136:139], v176 offset:36864
    ds_read_b128 v[140:143], v176 offset:38912
    v_mfma_f32_16x16x32_bf16 v[96:99], v[160:163], v[152:155], v[96:99]
    v_mfma_f32_16x16x32_bf16 v[112:115], v[160:163], v[156:159], v[112:115]
    ds_read_b64_tr_b16 v[160:161], v182 offset:0
    ds_read_b64_tr_b16 v[162:163], v182 offset:2048
    v_mfma_f32_16x16x32_bf16 v[68:71], v[164:167], v[144:147], v[68:71]
    v_mfma_f32_16x16x32_bf16 v[84:87], v[164:167], v[148:151], v[84:87]
    s_add_u32 m0, s82, 65536
    s_nop 0
    buffer_load_dwordx4 v188, s[56:59], s79 offen lds
    v_mfma_f32_16x16x32_bf16 v[100:103], v[164:167], v[152:155], v[100:103]
    v_mfma_f32_16x16x32_bf16 v[116:119], v[164:167], v[156:159], v[116:119]
    ds_read_b64_tr_b16 v[164:165], v183 offset:0
    ds_read_b64_tr_b16 v[166:167], v183 offset:2048
    v_mfma_f32_16x16x32_bf16 v[72:75], v[168:171], v[144:147], v[72:75]
    v_mfma_f32_16x16x32_bf16 v[88:91], v[168:171], v[148:151], v[88:91]
    s_add_u32 m0, s82, 66560
    s_nop 0
    buffer_load_dwordx4 v197, s[56:59], s79 offen lds
    s_add_u32 s79, s79, 128
    v_mfma_f32_16x16x32_bf16 v[104:107], v[168:171], v[152:155], v[104:107]
    v_mfma_f32_16x16x32_bf16 v[120:123], v[168:171], v[156:159], v[120:123]
    ds_read_b64_tr_b16 v[168:169], v240 offset:0
    ds_read_b64_tr_b16 v[170:171], v240 offset:2048
    v_mfma_f32_16x16x32_bf16 v[76:79], v[172:175], v[144:147], v[76:79]
    v_mfma_f32_16x16x32_bf16 v[92:95], v[172:175], v[148:151], v[92:95]
    s_add_u32 m0, s82, 67584
    s_nop 0
    buffer_load_dwordx4 v188, s[56:59], s80 offen lds
    v_mfma_f32_16x16x32_bf16 v[108:111], v[172:175], v[152:155], v[108:111]
    v_mfma_f32_16x16x32_bf16 v[124:127], v[172:175], v[156:159], v[124:127]
    ds_read_b64_tr_b16 v[172:173], v241 offset:0
    ds_read_b64_tr_b16 v[174:175], v241 offset:2048
    s_waitcnt lgkmcnt(6)
    v_mfma_f32_16x16x32_bf16 v[0:3], v[160:163], v[128:131], v[0:3]
    ds_read_b128 v[144:147], v176 offset:40960
    ds_read_b128 v[148:151], v176 offset:43008
    v_mfma_f32_16x16x32_bf16 v[16:19], v[160:163], v[132:135], v[16:19]
    v_mfma_f32_16x16x32_bf16 v[32:35], v[160:163], v[136:139], v[32:35]
    ds_read_b128 v[152:155], v176 offset:45056
    ds_read_b128 v[156:159], v176 offset:47104
    v_mfma_f32_16x16x32_bf16 v[48:51], v[160:163], v[140:143], v[48:51]
    s_waitcnt lgkmcnt(8)
    v_mfma_f32_16x16x32_bf16 v[4:7], v[164:167], v[128:131], v[4:7]
    v_mfma_f32_16x16x32_bf16 v[20:23], v[164:167], v[132:135], v[20:23]
    s_add_u32 m0, s82, 68608
    s_nop 0
    buffer_load_dwordx4 v197, s[56:59], s80 offen lds
    s_add_u32 s80, s80, 128
    v_mfma_f32_16x16x32_bf16 v[36:39], v[164:167], v[136:139], v[36:39]
    v_mfma_f32_16x16x32_bf16 v[52:55], v[164:167], v[140:143], v[52:55]
    s_add_u32 m0, s83, 49152
    s_nop 0
    buffer_load_dwordx4 v189, s[60:63], s81 offen lds
    s_waitcnt lgkmcnt(6)
    v_mfma_f32_16x16x32_bf16 v[8:11], v[168:171], v[128:131], v[8:11]
    v_mfma_f32_16x16x32_bf16 v[24:27], v[168:171], v[132:135], v[24:27]
    s_add_u32 m0, s83, 50176
    s_nop 0
    buffer_load_dwordx4 v190, s[60:63], s81 offen lds
    s_add_u32 s81, s81, 262144
    v_mfma_f32_16x16x32_bf16 v[40:43], v[168:171], v[136:139], v[40:43]
    v_mfma_f32_16x16x32_bf16 v[56:59], v[168:171], v[140:143], v[56:59]
    s_waitcnt lgkmcnt(4)
    v_mfma_f32_16x16x32_bf16 v[12:15], v[172:175], v[128:131], v[12:15]
    v_mfma_f32_16x16x32_bf16 v[28:31], v[172:175], v[132:135], v[28:31]
    v_mfma_f32_16x16x32_bf16 v[44:47], v[172:175], v[136:139], v[44:47]
    v_mfma_f32_16x16x32_bf16 v[60:63], v[172:175], v[140:143], v[60:63]
    s_waitcnt lgkmcnt(0)
    v_mfma_f32_16x16x32_bf16 v[64:67], v[160:163], v[144:147], v[64:67]
    s_waitcnt vmcnt(18)
    s_barrier
    ds_read_b128 v[128:131], v181 offset:32768
    ds_read_b128 v[132:135], v181 offset:34816
    v_mfma_f32_16x16x32_bf16 v[80:83], v[160:163], v[148:151], v[80:83]
    ds_read_b128 v[136:139], v181 offset:36864
    ds_read_b128 v[140:143], v181 offset:38912
    v_mfma_f32_16x16x32_bf16 v[96:99], v[160:163], v[152:155], v[96:99]
    v_mfma_f32_16x16x32_bf16 v[112:115], v[160:163], v[156:159], v[112:115]
    ds_read_b64_tr_b16 v[160:161], v177 offset:0
    ds_read_b64_tr_b16 v[162:163], v177 offset:2048
    v_mfma_f32_16x16x32_bf16 v[68:71], v[164:167], v[144:147], v[68:71]
    v_mfma_f32_16x16x32_bf16 v[84:87], v[164:167], v[148:151], v[84:87]
    s_add_u32 m0, s83, 131072
    s_nop 0
    buffer_load_dwordx4 v189, s[60:63], s81 offen lds
    v_mfma_f32_16x16x32_bf16 v[100:103], v[164:167], v[152:155], v[100:103]
    v_mfma_f32_16x16x32_bf16 v[116:119], v[164:167], v[156:159], v[116:119]
    ds_read_b64_tr_b16 v[164:165], v178 offset:0
    ds_read_b64_tr_b16 v[166:167], v178 offset:2048
    v_mfma_f32_16x16x32_bf16 v[72:75], v[168:171], v[144:147], v[72:75]
    v_mfma_f32_16x16x32_bf16 v[88:91], v[168:171], v[148:151], v[88:91]
    s_add_u32 m0, s83, 132096
    s_nop 0
    buffer_load_dwordx4 v190, s[60:63], s81 offen lds
    s_add_u32 s81, s81, 262144
    v_mfma_f32_16x16x32_bf16 v[104:107], v[168:171], v[152:155], v[104:107]
    v_mfma_f32_16x16x32_bf16 v[120:123], v[168:171], v[156:159], v[120:123]
    ds_read_b64_tr_b16 v[168:169], v179 offset:0
    ds_read_b64_tr_b16 v[170:171], v179 offset:2048
    v_mfma_f32_16x16x32_bf16 v[76:79], v[172:175], v[144:147], v[76:79]
    v_mfma_f32_16x16x32_bf16 v[92:95], v[172:175], v[148:151], v[92:95]
    v_mfma_f32_16x16x32_bf16 v[108:111], v[172:175], v[152:155], v[108:111]
    v_mfma_f32_16x16x32_bf16 v[124:127], v[172:175], v[156:159], v[124:127]
    ds_read_b64_tr_b16 v[172:173], v180 offset:0
    ds_read_b64_tr_b16 v[174:175], v180 offset:2048
    s_waitcnt lgkmcnt(6)
    v_mfma_f32_16x16x32_bf16 v[0:3], v[160:163], v[128:131], v[0:3]
    ds_read_b128 v[144:147], v181 offset:40960
    ds_read_b128 v[148:151], v181 offset:43008
    v_mfma_f32_16x16x32_bf16 v[16:19], v[160:163], v[132:135], v[16:19]
    v_mfma_f32_16x16x32_bf16 v[32:35], v[160:163], v[136:139], v[32:35]
    ds_read_b128 v[152:155], v181 offset:45056
    ds_read_b128 v[156:159], v181 offset:47104
    v_mfma_f32_16x16x32_bf16 v[48:51], v[160:163], v[140:143], v[48:51]
    s_waitcnt lgkmcnt(8)
    v_mfma_f32_16x16x32_bf16 v[4:7], v[164:167], v[128:131], v[4:7]
    v_mfma_f32_16x16x32_bf16 v[20:23], v[164:167], v[132:135], v[20:23]
    v_mfma_f32_16x16x32_bf16 v[36:39], v[164:167], v[136:139], v[36:39]
    v_mfma_f32_16x16x32_bf16 v[52:55], v[164:167], v[140:143], v[52:55]
    s_waitcnt lgkmcnt(6)
    v_mfma_f32_16x16x32_bf16 v[8:11], v[168:171], v[128:131], v[8:11]
    v_mfma_f32_16x16x32_bf16 v[24:27], v[168:171], v[132:135], v[24:27]
    v_mfma_f32_16x16x32_bf16 v[40:43], v[168:171], v[136:139], v[40:43]
    v_mfma_f32_16x16x32_bf16 v[56:59], v[168:171], v[140:143], v[56:59]
    s_waitcnt lgkmcnt(4)
    v_mfma_f32_16x16x32_bf16 v[12:15], v[172:175], v[128:131], v[12:15]
    v_mfma_f32_16x16x32_bf16 v[28:31], v[172:175], v[132:135], v[28:31]
    v_mfma_f32_16x16x32_bf16 v[44:47], v[172:175], v[136:139], v[44:47]
    v_mfma_f32_16x16x32_bf16 v[60:63], v[172:175], v[140:143], v[60:63]
    s_waitcnt lgkmcnt(0)
    v_mfma_f32_16x16x32_bf16 v[64:67], v[160:163], v[144:147], v[64:67]
    s_waitcnt vmcnt(4)
    s_barrier
    buffer_store_dword v195, v196, s[12:15], s85 offen sc1
    ds_read_b128 v[128:131], v176 offset:0
    ds_read_b128 v[132:135], v176 offset:2048
    v_mfma_f32_16x16x32_bf16 v[80:83], v[160:163], v[148:151], v[80:83]
    ds_read_b128 v[136:139], v176 offset:4096
    ds_read_b128 v[140:143], v176 offset:6144
    v_mfma_f32_16x16x32_bf16 v[96:99], v[160:163], v[152:155], v[96:99]
    v_mfma_f32_16x16x32_bf16 v[112:115], v[160:163], v[156:159], v[112:115]
    ds_read_b64_tr_b16 v[160:161], v177 offset:16384
    ds_read_b64_tr_b16 v[162:163], v177 offset:18432
    v_mfma_f32_16x16x32_bf16 v[68:71], v[164:167], v[144:147], v[68:71]
    v_mfma_f32_16x16x32_bf16 v[84:87], v[164:167], v[148:151], v[84:87]
    s_add_u32 m0, s82, 98304
    s_nop 0
    buffer_load_dwordx4 v188, s[56:59], s79 offen lds
    v_mfma_f32_16x16x32_bf16 v[100:103], v[164:167], v[152:155], v[100:103]
    v_mfma_f32_16x16x32_bf16 v[116:119], v[164:167], v[156:159], v[116:119]
    ds_read_b64_tr_b16 v[164:165], v178 offset:16384
    ds_read_b64_tr_b16 v[166:167], v178 offset:18432
    v_mfma_f32_16x16x32_bf16 v[72:75], v[168:171], v[144:147], v[72:75]
    v_mfma_f32_16x16x32_bf16 v[88:91], v[168:171], v[148:151], v[88:91]
    s_add_u32 m0, s82, 99328
    s_nop 0
    buffer_load_dwordx4 v197, s[56:59], s79 offen lds
    s_add_u32 s79, s79, 128
    v_mfma_f32_16x16x32_bf16 v[104:107], v[168:171], v[152:155], v[104:107]
    v_mfma_f32_16x16x32_bf16 v[120:123], v[168:171], v[156:159], v[120:123]
    ds_read_b64_tr_b16 v[168:169], v179 offset:16384
    ds_read_b64_tr_b16 v[170:171], v179 offset:18432
    v_mfma_f32_16x16x32_bf16 v[76:79], v[172:175], v[144:147], v[76:79]
    v_mfma_f32_16x16x32_bf16 v[92:95], v[172:175], v[148:151], v[92:95]
    s_add_u32 m0, s82, 100352
    s_nop 0
    buffer_load_dwordx4 v188, s[56:59], s80 offen lds
    v_mfma_f32_16x16x32_bf16 v[108:111], v[172:175], v[152:155], v[108:111]
    v_mfma_f32_16x16x32_bf16 v[124:127], v[172:175], v[156:159], v[124:127]
    ds_read_b64_tr_b16 v[172:173], v180 offset:16384
    ds_read_b64_tr_b16 v[174:175], v180 offset:18432
    s_waitcnt lgkmcnt(6)
    v_mfma_f32_16x16x32_bf16 v[0:3], v[160:163], v[128:131], v[0:3]
    ds_read_b128 v[144:147], v176 offset:8192
    ds_read_b128 v[148:151], v176 offset:10240
    v_mfma_f32_16x16x32_bf16 v[16:19], v[160:163], v[132:135], v[16:19]
    v_mfma_f32_16x16x32_bf16 v[32:35], v[160:163], v[136:139], v[32:35]
    ds_read_b128 v[152:155], v176 offset:12288
    ds_read_b128 v[156:159], v176 offset:14336
    v_mfma_f32_16x16x32_bf16 v[48:51], v[160:163], v[140:143], v[48:51]
    s_waitcnt lgkmcnt(8)
    v_mfma_f32_16x16x32_bf16 v[4:7], v[164:167], v[128:131], v[4:7]
    v_mfma_f32_16x16x32_bf16 v[20:23], v[164:167], v[132:135], v[20:23]
    s_add_u32 m0, s82, 101376
    s_nop 0
    buffer_load_dwordx4 v197, s[56:59], s80 offen lds
    s_add_u32 s80, s80, 128
    v_mfma_f32_16x16x32_bf16 v[36:39], v[164:167], v[136:139], v[36:39]
    v_mfma_f32_16x16x32_bf16 v[52:55], v[164:167], v[140:143], v[52:55]
    s_waitcnt lgkmcnt(6)
    v_mfma_f32_16x16x32_bf16 v[8:11], v[168:171], v[128:131], v[8:11]
    v_mfma_f32_16x16x32_bf16 v[24:27], v[168:171], v[132:135], v[24:27]
    v_mfma_f32_16x16x32_bf16 v[40:43], v[168:171], v[136:139], v[40:43]
    v_mfma_f32_16x16x32_bf16 v[56:59], v[168:171], v[140:143], v[56:59]
    s_waitcnt lgkmcnt(4)
    v_mfma_f32_16x16x32_bf16 v[12:15], v[172:175], v[128:131], v[12:15]
    v_mfma_f32_16x16x32_bf16 v[28:31], v[172:175], v[132:135], v[28:31]
    v_mfma_f32_16x16x32_bf16 v[44:47], v[172:175], v[136:139], v[44:47]
    v_mfma_f32_16x16x32_bf16 v[60:63], v[172:175], v[140:143], v[60:63]
    s_waitcnt lgkmcnt(0)
    v_mfma_f32_16x16x32_bf16 v[64:67], v[160:163], v[144:147], v[64:67]
    s_waitcnt vmcnt(16)
    s_barrier
    ds_read_b128 v[128:131], v181 offset:0
    ds_read_b128 v[132:135], v181 offset:2048
    v_mfma_f32_16x16x32_bf16 v[80:83], v[160:163], v[148:151], v[80:83]
    ds_read_b128 v[136:139], v181 offset:4096
    ds_read_b128 v[140:143], v181 offset:6144
    v_mfma_f32_16x16x32_bf16 v[96:99], v[160:163], v[152:155], v[96:99]
    v_mfma_f32_16x16x32_bf16 v[112:115], v[160:163], v[156:159], v[112:115]
    ds_read_b64_tr_b16 v[160:161], v177 offset:32768
    ds_read_b64_tr_b16 v[162:163], v177 offset:34816
    v_mfma_f32_16x16x32_bf16 v[68:71], v[164:167], v[144:147], v[68:71]
    v_mfma_f32_16x16x32_bf16 v[84:87], v[164:167], v[148:151], v[84:87]
    s_add_u32 m0, s33, 0
    s_add_u32 s49, s34, 0
    buffer_load_dwordx4 v245, s[8:11], s49 offen lds
    v_mfma_f32_16x16x32_bf16 v[100:103], v[164:167], v[152:155], v[100:103]
    v_mfma_f32_16x16x32_bf16 v[116:119], v[164:167], v[156:159], v[116:119]
    ds_read_b64_tr_b16 v[164:165], v178 offset:32768
    ds_read_b64_tr_b16 v[166:167], v178 offset:34816
    v_mfma_f32_16x16x32_bf16 v[72:75], v[168:171], v[144:147], v[72:75]
    v_mfma_f32_16x16x32_bf16 v[88:91], v[168:171], v[148:151], v[88:91]
    s_add_u32 m0, s33, 1024
    s_add_u32 s49, s34, 32768
    buffer_load_dwordx4 v245, s[8:11], s49 offen lds
    v_mfma_f32_16x16x32_bf16 v[104:107], v[168:171], v[152:155], v[104:107]
    v_mfma_f32_16x16x32_bf16 v[120:123], v[168:171], v[156:159], v[120:123]
    ds_read_b64_tr_b16 v[168:169], v179 offset:32768
    ds_read_b64_tr_b16 v[170:171], v179 offset:34816
    v_mfma_f32_16x16x32_bf16 v[76:79], v[172:175], v[144:147], v[76:79]
    v_mfma_f32_16x16x32_bf16 v[92:95], v[172:175], v[148:151], v[92:95]
    s_add_u32 m0, s33, 2048
    s_add_u32 s49, s34, 65536
    buffer_load_dwordx4 v244, s[8:11], s49 offen lds
    v_mfma_f32_16x16x32_bf16 v[108:111], v[172:175], v[152:155], v[108:111]
    v_mfma_f32_16x16x32_bf16 v[124:127], v[172:175], v[156:159], v[124:127]
    ds_read_b64_tr_b16 v[172:173], v180 offset:32768
    ds_read_b64_tr_b16 v[174:175], v180 offset:34816
    s_waitcnt lgkmcnt(6)
    v_mfma_f32_16x16x32_bf16 v[0:3], v[160:163], v[128:131], v[0:3]
    ds_read_b128 v[144:147], v181 offset:8192
    ds_read_b128 v[148:151], v181 offset:10240
    v_mfma_f32_16x16x32_bf16 v[16:19], v[160:163], v[132:135], v[16:19]
    v_mfma_f32_16x16x32_bf16 v[32:35], v[160:163], v[136:139], v[32:35]
    ds_read_b128 v[152:155], v181 offset:12288
    ds_read_b128 v[156:159], v181 offset:14336
    v_mfma_f32_16x16x32_bf16 v[48:51], v[160:163], v[140:143], v[48:51]
    s_waitcnt lgkmcnt(8)
    v_mfma_f32_16x16x32_bf16 v[4:7], v[164:167], v[128:131], v[4:7]
    v_mfma_f32_16x16x32_bf16 v[20:23], v[164:167], v[132:135], v[20:23]
    s_add_u32 m0, s33, 3072
    s_add_u32 s49, s34, 98304
    buffer_load_dwordx4 v244, s[8:11], s49 offen lds
    v_mfma_f32_16x16x32_bf16 v[36:39], v[164:167], v[136:139], v[36:39]
    v_mfma_f32_16x16x32_bf16 v[52:55], v[164:167], v[140:143], v[52:55]
    s_waitcnt lgkmcnt(6)
    v_mfma_f32_16x16x32_bf16 v[8:11], v[168:171], v[128:131], v[8:11]
    v_mfma_f32_16x16x32_bf16 v[24:27], v[168:171], v[132:135], v[24:27]
    v_mfma_f32_16x16x32_bf16 v[40:43], v[168:171], v[136:139], v[40:43]
    v_mfma_f32_16x16x32_bf16 v[56:59], v[168:171], v[140:143], v[56:59]
    s_waitcnt lgkmcnt(4)
    v_mfma_f32_16x16x32_bf16 v[12:15], v[172:175], v[128:131], v[12:15]
    v_mfma_f32_16x16x32_bf16 v[28:31], v[172:175], v[132:135], v[28:31]
    v_mfma_f32_16x16x32_bf16 v[44:47], v[172:175], v[136:139], v[44:47]
    v_mfma_f32_16x16x32_bf16 v[60:63], v[172:175], v[140:143], v[60:63]
    s_waitcnt lgkmcnt(0)
    v_mfma_f32_16x16x32_bf16 v[64:67], v[160:163], v[144:147], v[64:67]
    s_waitcnt vmcnt(4)
    s_barrier
    ds_read_b128 v[128:131], v176 offset:32768
    ds_read_b128 v[132:135], v176 offset:34816
    v_mfma_f32_16x16x32_bf16 v[80:83], v[160:163], v[148:151], v[80:83]
    ds_read_b128 v[136:139], v176 offset:36864
    ds_read_b128 v[140:143], v176 offset:38912
    v_mfma_f32_16x16x32_bf16 v[96:99], v[160:163], v[152:155], v[96:99]
    v_mfma_f32_16x16x32_bf16 v[112:115], v[160:163], v[156:159], v[112:115]
    ds_read_b64_tr_b16 v[160:161], v177 offset:49152
    ds_read_b64_tr_b16 v[162:163], v177 offset:51200
    v_mfma_f32_16x16x32_bf16 v[68:71], v[164:167], v[144:147], v[68:71]
    v_mfma_f32_16x16x32_bf16 v[84:87], v[164:167], v[148:151], v[84:87]
    buffer_load_dword v200, v184, s[12:15], s67 offen offset:0 sc1
    v_mfma_f32_16x16x32_bf16 v[100:103], v[164:167], v[152:155], v[100:103]
    v_mfma_f32_16x16x32_bf16 v[116:119], v[164:167], v[156:159], v[116:119]
    ds_read_b64_tr_b16 v[164:165], v178 offset:49152
    ds_read_b64_tr_b16 v[166:167], v178 offset:51200
    v_mfma_f32_16x16x32_bf16 v[72:75], v[168:171], v[144:147], v[72:75]
    v_mfma_f32_16x16x32_bf16 v[88:91], v[168:171], v[148:151], v[88:91]
    buffer_load_dword v201, v185, s[12:15], s67 offen offset:0 sc1
    v_mfma_f32_16x16x32_bf16 v[104:107], v[168:171], v[152:155], v[104:107]
    v_mfma_f32_16x16x32_bf16 v[120:123], v[168:171], v[156:159], v[120:123]
    ds_read_b64_tr_b16 v[168:169], v179 offset:49152
    ds_read_b64_tr_b16 v[170:171], v179 offset:51200
    v_mfma_f32_16x16x32_bf16 v[76:79], v[172:175], v[144:147], v[76:79]
    v_mfma_f32_16x16x32_bf16 v[92:95], v[172:175], v[148:151], v[92:95]
    buffer_load_dword v202, v186, s[12:15], s67 offen offset:0 sc1
    v_mfma_f32_16x16x32_bf16 v[108:111], v[172:175], v[152:155], v[108:111]
    v_mfma_f32_16x16x32_bf16 v[124:127], v[172:175], v[156:159], v[124:127]
    ds_read_b64_tr_b16 v[172:173], v180 offset:49152
    ds_read_b64_tr_b16 v[174:175], v180 offset:51200
    s_waitcnt lgkmcnt(6)
    v_mfma_f32_16x16x32_bf16 v[0:3], v[160:163], v[128:131], v[0:3]
    ds_read_b128 v[144:147], v176 offset:40960
    ds_read_b128 v[148:151], v176 offset:43008
    v_mfma_f32_16x16x32_bf16 v[16:19], v[160:163], v[132:135], v[16:19]
    v_mfma_f32_16x16x32_bf16 v[32:35], v[160:163], v[136:139], v[32:35]
    ds_read_b128 v[152:155], v176 offset:45056
    ds_read_b128 v[156:159], v176 offset:47104
    v_mfma_f32_16x16x32_bf16 v[48:51], v[160:163], v[140:143], v[48:51]
    s_waitcnt lgkmcnt(8)
    v_mfma_f32_16x16x32_bf16 v[4:7], v[164:167], v[128:131], v[4:7]
    v_mfma_f32_16x16x32_bf16 v[20:23], v[164:167], v[132:135], v[20:23]
    buffer_load_dword v203, v187, s[12:15], s67 offen offset:0 sc1
    v_mfma_f32_16x16x32_bf16 v[36:39], v[164:167], v[136:139], v[36:39]
    v_mfma_f32_16x16x32_bf16 v[52:55], v[164:167], v[140:143], v[52:55]
    s_add_u32 m0, s33, 65536
    s_add_u32 s49, s34, 2097152
    buffer_load_dwordx4 v245, s[8:11], s49 offen lds
    s_waitcnt lgkmcnt(6)
    v_mfma_f32_16x16x32_bf16 v[8:11], v[168:171], v[128:131], v[8:11]
    v_mfma_f32_16x16x32_bf16 v[24:27], v[168:171], v[132:135], v[24:27]
    s_add_u32 m0, s33, 66560
    s_add_u32 s49, s34, 2129920
    buffer_load_dwordx4 v245, s[8:11], s49 offen lds
    v_mfma_f32_16x16x32_bf16 v[40:43], v[168:171], v[136:139], v[40:43]
    v_mfma_f32_16x16x32_bf16 v[56:59], v[168:171], v[140:143], v[56:59]
    s_add_u32 m0, s33, 67584
    s_add_u32 s49, s34, 2162688
    buffer_load_dwordx4 v244, s[8:11], s49 offen lds
    s_waitcnt lgkmcnt(4)
    v_mfma_f32_16x16x32_bf16 v[12:15], v[172:175], v[128:131], v[12:15]
    v_mfma_f32_16x16x32_bf16 v[28:31], v[172:175], v[132:135], v[28:31]
    s_add_u32 m0, s33, 68608
    s_add_u32 s49, s34, 2195456
    buffer_load_dwordx4 v244, s[8:11], s49 offen lds
    v_mfma_f32_16x16x32_bf16 v[44:47], v[172:175], v[136:139], v[44:47]
    v_mfma_f32_16x16x32_bf16 v[60:63], v[172:175], v[140:143], v[60:63]
    s_waitcnt lgkmcnt(0)
    v_mfma_f32_16x16x32_bf16 v[64:67], v[160:163], v[144:147], v[64:67]
    s_cmp_eq_u32 s36, 4
    s_cbranch_scc0 parallel_sum__compressed_kv_cla__moe_arch_mod__prompt_kernel_p1A_lnc0
    s_waitcnt vmcnt(4)
    s_mov_b32 s35, 0x40000
parallel_sum__compressed_kv_cla__moe_arch_mod__prompt_kernel_chk_ln0:
    v_xor_b32 v200, s87, v200
    v_xor_b32 v201, s87, v201
    v_xor_b32 v202, s87, v202
    v_xor_b32 v203, s87, v203
    v_or_b32 v200, v200, v201
    v_or_b32 v200, v200, v202
    v_or_b32 v200, v200, v203
    v_cmp_ne_u32 s[84:85], 0, v200
    s_nop 1
    s_cmp_eq_u64 s[84:85], 0
    s_cbranch_scc1 parallel_sum__compressed_kv_cla__moe_arch_mod__prompt_kernel_chk_ln0_ok
    s_sub_u32 s35, s35, 1
    s_cbranch_scc1 parallel_sum__compressed_kv_cla__moe_arch_mod__prompt_kernel_chk_ln0_ok
    s_sleep 1
    buffer_load_dword v200, v184, s[12:15], s67 offen offset:0 sc1
    buffer_load_dword v201, v185, s[12:15], s67 offen offset:0 sc1
    buffer_load_dword v202, v186, s[12:15], s67 offen offset:0 sc1
    buffer_load_dword v203, v187, s[12:15], s67 offen offset:0 sc1
    s_waitcnt vmcnt(0)
    s_branch parallel_sum__compressed_kv_cla__moe_arch_mod__prompt_kernel_chk_ln0
parallel_sum__compressed_kv_cla__moe_arch_mod__prompt_kernel_chk_ln0_ok:
parallel_sum__compressed_kv_cla__moe_arch_mod__prompt_kernel_p1A_lnc0:
    s_waitcnt vmcnt(17)
    s_barrier
    ds_read_b128 v[128:131], v181 offset:32768
    ds_read_b128 v[132:135], v181 offset:34816
    v_mfma_f32_16x16x32_bf16 v[80:83], v[160:163], v[148:151], v[80:83]
    ds_read_b128 v[136:139], v181 offset:36864
    ds_read_b128 v[140:143], v181 offset:38912
    v_mfma_f32_16x16x32_bf16 v[96:99], v[160:163], v[152:155], v[96:99]
    v_mfma_f32_16x16x32_bf16 v[112:115], v[160:163], v[156:159], v[112:115]
    ds_read_b64_tr_b16 v[160:161], v182 offset:0
    ds_read_b64_tr_b16 v[162:163], v182 offset:2048
    v_mfma_f32_16x16x32_bf16 v[68:71], v[164:167], v[144:147], v[68:71]
    v_mfma_f32_16x16x32_bf16 v[84:87], v[164:167], v[148:151], v[84:87]
    s_add_u32 m0, s33, 32768
    s_add_u32 s49, s34, 1048576
    buffer_load_dwordx4 v245, s[8:11], s49 offen lds
    v_mfma_f32_16x16x32_bf16 v[100:103], v[164:167], v[152:155], v[100:103]
    v_mfma_f32_16x16x32_bf16 v[116:119], v[164:167], v[156:159], v[116:119]
    ds_read_b64_tr_b16 v[164:165], v183 offset:0
    ds_read_b64_tr_b16 v[166:167], v183 offset:2048
    v_mfma_f32_16x16x32_bf16 v[72:75], v[168:171], v[144:147], v[72:75]
    v_mfma_f32_16x16x32_bf16 v[88:91], v[168:171], v[148:151], v[88:91]
    s_add_u32 m0, s33, 33792
    s_add_u32 s49, s34, 1081344
    buffer_load_dwordx4 v245, s[8:11], s49 offen lds
    v_mfma_f32_16x16x32_bf16 v[104:107], v[168:171], v[152:155], v[104:107]
    v_mfma_f32_16x16x32_bf16 v[120:123], v[168:171], v[156:159], v[120:123]
    ds_read_b64_tr_b16 v[168:169], v240 offset:0
    ds_read_b64_tr_b16 v[170:171], v240 offset:2048
    v_mfma_f32_16x16x32_bf16 v[76:79], v[172:175], v[144:147], v[76:79]
    v_mfma_f32_16x16x32_bf16 v[92:95], v[172:175], v[148:151], v[92:95]
    s_add_u32 m0, s33, 34816
    s_add_u32 s49, s34, 1114112
    buffer_load_dwordx4 v244, s[8:11], s49 offen lds
    v_mfma_f32_16x16x32_bf16 v[108:111], v[172:175], v[152:155], v[108:111]
    v_mfma_f32_16x16x32_bf16 v[124:127], v[172:175], v[156:159], v[124:127]
    ds_read_b64_tr_b16 v[172:173], v241 offset:0
    ds_read_b64_tr_b16 v[174:175], v241 offset:2048
    s_waitcnt lgkmcnt(6)
    v_mfma_f32_16x16x32_bf16 v[0:3], v[160:163], v[128:131], v[0:3]
    ds_read_b128 v[144:147], v181 offset:40960
    ds_read_b128 v[148:151], v181 offset:43008
    v_mfma_f32_16x16x32_bf16 v[16:19], v[160:163], v[132:135], v[16:19]
    v_mfma_f32_16x16x32_bf16 v[32:35], v[160:163], v[136:139], v[32:35]
    ds_read_b128 v[152:155], v181 offset:45056
    ds_read_b128 v[156:159], v181 offset:47104
    v_mfma_f32_16x16x32_bf16 v[48:51], v[160:163], v[140:143], v[48:51]
    s_waitcnt lgkmcnt(8)
    v_mfma_f32_16x16x32_bf16 v[4:7], v[164:167], v[128:131], v[4:7]
    v_mfma_f32_16x16x32_bf16 v[20:23], v[164:167], v[132:135], v[20:23]
    s_add_u32 m0, s33, 35840
    s_add_u32 s49, s34, 1146880
    buffer_load_dwordx4 v244, s[8:11], s49 offen lds
    v_mfma_f32_16x16x32_bf16 v[36:39], v[164:167], v[136:139], v[36:39]
    v_mfma_f32_16x16x32_bf16 v[52:55], v[164:167], v[140:143], v[52:55]
    buffer_load_dwordx4 v[192:195], v255, s[12:15], s55 offen offset:0 sc1
    s_waitcnt lgkmcnt(6)
    v_mfma_f32_16x16x32_bf16 v[8:11], v[168:171], v[128:131], v[8:11]
    v_mfma_f32_16x16x32_bf16 v[24:27], v[168:171], v[132:135], v[24:27]
    buffer_load_dwordx4 v[196:199], v255, s[12:15], s55 offen offset:256 sc1
    v_mfma_f32_16x16x32_bf16 v[40:43], v[168:171], v[136:139], v[40:43]
    v_mfma_f32_16x16x32_bf16 v[56:59], v[168:171], v[140:143], v[56:59]
    buffer_load_dwordx4 v[200:203], v255, s[12:15], s55 offen offset:2048 sc1
    s_waitcnt lgkmcnt(4)
    v_mfma_f32_16x16x32_bf16 v[12:15], v[172:175], v[128:131], v[12:15]
    v_mfma_f32_16x16x32_bf16 v[28:31], v[172:175], v[132:135], v[28:31]
    buffer_load_dwordx4 v[204:207], v255, s[12:15], s55 offen offset:2304 sc1
    v_mfma_f32_16x16x32_bf16 v[44:47], v[172:175], v[136:139], v[44:47]
    v_mfma_f32_16x16x32_bf16 v[60:63], v[172:175], v[140:143], v[60:63]
    s_add_u32 s55, s55, 4096
    buffer_load_dwordx4 v[208:211], v255, s[12:15], s55 offen offset:0 sc1
    s_waitcnt lgkmcnt(0)
    v_mfma_f32_16x16x32_bf16 v[64:67], v[160:163], v[144:147], v[64:67]
    v_mfma_f32_16x16x32_bf16 v[80:83], v[160:163], v[148:151], v[80:83]
    buffer_load_dwordx4 v[212:215], v255, s[12:15], s55 offen offset:256 sc1
    v_mfma_f32_16x16x32_bf16 v[96:99], v[160:163], v[152:155], v[96:99]
    v_mfma_f32_16x16x32_bf16 v[112:115], v[160:163], v[156:159], v[112:115]
    v_mfma_f32_16x16x32_bf16 v[68:71], v[164:167], v[144:147], v[68:71]
    v_mfma_f32_16x16x32_bf16 v[84:87], v[164:167], v[148:151], v[84:87]
    v_mfma_f32_16x16x32_bf16 v[100:103], v[164:167], v[152:155], v[100:103]
    v_mfma_f32_16x16x32_bf16 v[116:119], v[164:167], v[156:159], v[116:119]
    v_mfma_f32_16x16x32_bf16 v[72:75], v[168:171], v[144:147], v[72:75]
    v_mfma_f32_16x16x32_bf16 v[88:91], v[168:171], v[148:151], v[88:91]
    v_mfma_f32_16x16x32_bf16 v[104:107], v[168:171], v[152:155], v[104:107]
    v_mfma_f32_16x16x32_bf16 v[120:123], v[168:171], v[156:159], v[120:123]
    v_mfma_f32_16x16x32_bf16 v[76:79], v[172:175], v[144:147], v[76:79]
    v_mfma_f32_16x16x32_bf16 v[92:95], v[172:175], v[148:151], v[92:95]
    v_mfma_f32_16x16x32_bf16 v[108:111], v[172:175], v[152:155], v[108:111]
    v_mfma_f32_16x16x32_bf16 v[124:127], v[172:175], v[156:159], v[124:127]
    s_branch parallel_sum__compressed_kv_cla__moe_arch_mod__prompt_kernel_p1_epi
parallel_sum__compressed_kv_cla__moe_arch_mod__prompt_kernel_p1_vtypeA:
    s_waitcnt lgkmcnt(6)
    v_mfma_f32_16x16x32_bf16 v[0:3], v[128:131], v[160:163], 0
    ds_read_b128 v[144:147], v176 offset:8192
    ds_read_b128 v[148:151], v176 offset:10240
    v_mfma_f32_16x16x32_bf16 v[4:7], v[132:135], v[160:163], 0
    v_mfma_f32_16x16x32_bf16 v[32:35], v[136:139], v[160:163], 0
    ds_read_b128 v[152:155], v176 offset:12288
    ds_read_b128 v[156:159], v176 offset:14336
    v_mfma_f32_16x16x32_bf16 v[36:39], v[140:143], v[160:163], 0
    s_waitcnt lgkmcnt(8)
    v_mfma_f32_16x16x32_bf16 v[16:19], v[128:131], v[164:167], 0
    v_mfma_f32_16x16x32_bf16 v[20:23], v[132:135], v[164:167], 0
    s_add_u32 m0, s83, 16384
    s_nop 0
    buffer_load_dwordx4 v189, s[60:63], s81 offen lds
    v_mfma_f32_16x16x32_bf16 v[48:51], v[136:139], v[164:167], 0
    v_mfma_f32_16x16x32_bf16 v[52:55], v[140:143], v[164:167], 0
    s_add_u32 m0, s83, 17408
    s_nop 0
    buffer_load_dwordx4 v190, s[60:63], s81 offen lds
    s_add_u32 s81, s81, 262144
    s_waitcnt lgkmcnt(6)
    v_mfma_f32_16x16x32_bf16 v[8:11], v[128:131], v[168:171], 0
    v_mfma_f32_16x16x32_bf16 v[12:15], v[132:135], v[168:171], 0
    s_add_u32 m0, s82, 98304
    s_nop 0
    buffer_load_dwordx4 v188, s[56:59], s79 offen lds
    v_mfma_f32_16x16x32_bf16 v[40:43], v[136:139], v[168:171], 0
    v_mfma_f32_16x16x32_bf16 v[44:47], v[140:143], v[168:171], 0
    s_add_u32 m0, s82, 99328
    s_nop 0
    buffer_load_dwordx4 v197, s[56:59], s79 offen lds
    s_add_u32 s79, s79, 128
    s_waitcnt lgkmcnt(4)
    v_mfma_f32_16x16x32_bf16 v[24:27], v[128:131], v[172:175], 0
    v_mfma_f32_16x16x32_bf16 v[28:31], v[132:135], v[172:175], 0
    s_add_u32 m0, s82, 100352
    s_nop 0
    buffer_load_dwordx4 v188, s[56:59], s80 offen lds
    v_mfma_f32_16x16x32_bf16 v[56:59], v[136:139], v[172:175], 0
    v_mfma_f32_16x16x32_bf16 v[60:63], v[140:143], v[172:175], 0
    s_add_u32 m0, s82, 101376
    s_nop 0
    buffer_load_dwordx4 v197, s[56:59], s80 offen lds
    s_add_u32 s80, s80, 128
    s_waitcnt lgkmcnt(0)
    v_mfma_f32_16x16x32_bf16 v[64:67], v[144:147], v[160:163], 0
    s_waitcnt vmcnt(7)
    s_barrier
    ds_read_b128 v[128:131], v181 offset:0
    ds_read_b128 v[132:135], v181 offset:2048
    v_mfma_f32_16x16x32_bf16 v[68:71], v[148:151], v[160:163], 0
    ds_read_b128 v[136:139], v181 offset:4096
    ds_read_b128 v[140:143], v181 offset:6144
    v_mfma_f32_16x16x32_bf16 v[96:99], v[152:155], v[160:163], 0
    v_mfma_f32_16x16x32_bf16 v[100:103], v[156:159], v[160:163], 0
    ds_read_b64_tr_b16 v[160:161], v177 offset:0
    ds_read_b64_tr_b16 v[162:163], v177 offset:2048
    v_mfma_f32_16x16x32_bf16 v[80:83], v[144:147], v[164:167], 0
    v_mfma_f32_16x16x32_bf16 v[84:87], v[148:151], v[164:167], 0
    s_add_u32 m0, s83, 32768
    s_nop 0
    buffer_load_dwordx4 v189, s[60:63], s81 offen lds
    v_mfma_f32_16x16x32_bf16 v[112:115], v[152:155], v[164:167], 0
    v_mfma_f32_16x16x32_bf16 v[116:119], v[156:159], v[164:167], 0
    ds_read_b64_tr_b16 v[164:165], v178 offset:0
    ds_read_b64_tr_b16 v[166:167], v178 offset:2048
    v_mfma_f32_16x16x32_bf16 v[72:75], v[144:147], v[168:171], 0
    v_mfma_f32_16x16x32_bf16 v[76:79], v[148:151], v[168:171], 0
    s_add_u32 m0, s83, 33792
    s_nop 0
    buffer_load_dwordx4 v190, s[60:63], s81 offen lds
    s_add_u32 s81, s81, 262144
    v_mfma_f32_16x16x32_bf16 v[104:107], v[152:155], v[168:171], 0
    v_mfma_f32_16x16x32_bf16 v[108:111], v[156:159], v[168:171], 0
    ds_read_b64_tr_b16 v[168:169], v179 offset:0
    ds_read_b64_tr_b16 v[170:171], v179 offset:2048
    v_mfma_f32_16x16x32_bf16 v[88:91], v[144:147], v[172:175], 0
    v_mfma_f32_16x16x32_bf16 v[92:95], v[148:151], v[172:175], 0
    s_add_u32 m0, s83, 49152
    s_nop 0
    buffer_load_dwordx4 v189, s[60:63], s81 offen lds
    v_mfma_f32_16x16x32_bf16 v[120:123], v[152:155], v[172:175], 0
    v_mfma_f32_16x16x32_bf16 v[124:127], v[156:159], v[172:175], 0
    ds_read_b64_tr_b16 v[172:173], v180 offset:0
    ds_read_b64_tr_b16 v[174:175], v180 offset:2048
    s_waitcnt lgkmcnt(6)
    v_mfma_f32_16x16x32_bf16 v[0:3], v[128:131], v[160:163], v[0:3]
    ds_read_b128 v[144:147], v181 offset:8192
    ds_read_b128 v[148:151], v181 offset:10240
    v_mfma_f32_16x16x32_bf16 v[4:7], v[132:135], v[160:163], v[4:7]
    v_mfma_f32_16x16x32_bf16 v[32:35], v[136:139], v[160:163], v[32:35]
    ds_read_b128 v[152:155], v181 offset:12288
    ds_read_b128 v[156:159], v181 offset:14336
    v_mfma_f32_16x16x32_bf16 v[36:39], v[140:143], v[160:163], v[36:39]
    s_waitcnt lgkmcnt(8)
    v_mfma_f32_16x16x32_bf16 v[16:19], v[128:131], v[164:167], v[16:19]
    v_mfma_f32_16x16x32_bf16 v[20:23], v[132:135], v[164:167], v[20:23]
    s_add_u32 m0, s83, 50176
    s_nop 0
    buffer_load_dwordx4 v190, s[60:63], s81 offen lds
    s_add_u32 s81, s81, 262144
    v_mfma_f32_16x16x32_bf16 v[48:51], v[136:139], v[164:167], v[48:51]
    v_mfma_f32_16x16x32_bf16 v[52:55], v[140:143], v[164:167], v[52:55]
    buffer_load_dwordx4 v[200:203], v232, s[16:19], s85 offen
    s_waitcnt lgkmcnt(6)
    v_mfma_f32_16x16x32_bf16 v[8:11], v[128:131], v[168:171], v[8:11]
    v_mfma_f32_16x16x32_bf16 v[12:15], v[132:135], v[168:171], v[12:15]
    buffer_load_dwordx4 v[204:207], v232, s[16:19], s85 offen offset:16
    v_mfma_f32_16x16x32_bf16 v[40:43], v[136:139], v[168:171], v[40:43]
    v_mfma_f32_16x16x32_bf16 v[44:47], v[140:143], v[168:171], v[44:47]
    buffer_load_dwordx4 v[208:211], v232, s[20:23], 0 offen
    s_waitcnt lgkmcnt(4)
    v_mfma_f32_16x16x32_bf16 v[24:27], v[128:131], v[172:175], v[24:27]
    v_mfma_f32_16x16x32_bf16 v[28:31], v[132:135], v[172:175], v[28:31]
    buffer_load_dwordx4 v[212:215], v232, s[20:23], 0 offen offset:16
    s_lshl_b32 s16, s37, 20
    s_add_u32 s16, s16, 0x800000
    s_add_u32 s16, s6, s16
    s_addc_u32 s17, s7, 0
    s_mov_b32 s18, 0x100000
    s_mov_b32 s19, 0x20000
    s_cmp_eq_u32 s36, 1
    s_cselect_b32 s20, s28, s24
    s_cselect_b32 s21, s29, s25
    s_cmp_eq_u32 s36, 2
    s_cselect_b32 s20, s30, s20
    s_cselect_b32 s21, s31, s21
    s_cmp_eq_u32 s36, 3
    s_cselect_b32 s20, s26, s20
    s_cselect_b32 s21, s27, s21
    s_cmp_eq_u32 s36, 0
    s_mov_b32 s22, 20736
    s_cselect_b32 s22, 18432, s22
    s_mul_i32 s32, s2, s22
    s_add_u32 s22, s32, s22
    s_mov_b32 s23, 0x20000
    v_mfma_f32_16x16x32_bf16 v[56:59], v[136:139], v[172:175], v[56:59]
    v_mfma_f32_16x16x32_bf16 v[60:63], v[140:143], v[172:175], v[60:63]
    s_add_u32 m0, s83, 131072
    s_nop 0
    buffer_load_dwordx4 v189, s[60:63], s81 offen lds
    s_waitcnt lgkmcnt(0)
    v_mfma_f32_16x16x32_bf16 v[64:67], v[144:147], v[160:163], v[64:67]
    s_waitcnt vmcnt(9)
    s_barrier
    ds_read_b128 v[128:131], v176 offset:32768
    ds_read_b128 v[132:135], v176 offset:34816
    v_mfma_f32_16x16x32_bf16 v[68:71], v[148:151], v[160:163], v[68:71]
    ds_read_b128 v[136:139], v176 offset:36864
    ds_read_b128 v[140:143], v176 offset:38912
    v_mfma_f32_16x16x32_bf16 v[96:99], v[152:155], v[160:163], v[96:99]
    v_mfma_f32_16x16x32_bf16 v[100:103], v[156:159], v[160:163], v[100:103]
    ds_read_b64_tr_b16 v[160:161], v177 offset:16384
    ds_read_b64_tr_b16 v[162:163], v177 offset:18432
    v_mfma_f32_16x16x32_bf16 v[80:83], v[144:147], v[164:167], v[80:83]
    v_mfma_f32_16x16x32_bf16 v[84:87], v[148:151], v[164:167], v[84:87]
    s_add_u32 m0, s82, 65536
    s_nop 0
    buffer_load_dwordx4 v188, s[56:59], s79 offen lds
    v_mfma_f32_16x16x32_bf16 v[112:115], v[152:155], v[164:167], v[112:115]
    v_mfma_f32_16x16x32_bf16 v[116:119], v[156:159], v[164:167], v[116:119]
    ds_read_b64_tr_b16 v[164:165], v178 offset:16384
    ds_read_b64_tr_b16 v[166:167], v178 offset:18432
    v_mfma_f32_16x16x32_bf16 v[72:75], v[144:147], v[168:171], v[72:75]
    v_mfma_f32_16x16x32_bf16 v[76:79], v[148:151], v[168:171], v[76:79]
    s_add_u32 m0, s82, 66560
    s_nop 0
    buffer_load_dwordx4 v197, s[56:59], s79 offen lds
    s_add_u32 s79, s79, 128
    v_mfma_f32_16x16x32_bf16 v[104:107], v[152:155], v[168:171], v[104:107]
    v_mfma_f32_16x16x32_bf16 v[108:111], v[156:159], v[168:171], v[108:111]
    ds_read_b64_tr_b16 v[168:169], v179 offset:16384
    ds_read_b64_tr_b16 v[170:171], v179 offset:18432
    v_mfma_f32_16x16x32_bf16 v[88:91], v[144:147], v[172:175], v[88:91]
    v_mfma_f32_16x16x32_bf16 v[92:95], v[148:151], v[172:175], v[92:95]
    s_add_u32 m0, s82, 67584
    s_nop 0
    buffer_load_dwordx4 v188, s[56:59], s80 offen lds
    v_mfma_f32_16x16x32_bf16 v[120:123], v[152:155], v[172:175], v[120:123]
    v_mfma_f32_16x16x32_bf16 v[124:127], v[156:159], v[172:175], v[124:127]
    ds_read_b64_tr_b16 v[172:173], v180 offset:16384
    ds_read_b64_tr_b16 v[174:175], v180 offset:18432
    s_waitcnt lgkmcnt(6)
    v_mfma_f32_16x16x32_bf16 v[0:3], v[128:131], v[160:163], v[0:3]
    ds_read_b128 v[144:147], v176 offset:40960
    ds_read_b128 v[148:151], v176 offset:43008
    v_mfma_f32_16x16x32_bf16 v[4:7], v[132:135], v[160:163], v[4:7]
    v_mfma_f32_16x16x32_bf16 v[32:35], v[136:139], v[160:163], v[32:35]
    ds_read_b128 v[152:155], v176 offset:45056
    ds_read_b128 v[156:159], v176 offset:47104
    v_mfma_f32_16x16x32_bf16 v[36:39], v[140:143], v[160:163], v[36:39]
    s_waitcnt lgkmcnt(8)
    v_mfma_f32_16x16x32_bf16 v[16:19], v[128:131], v[164:167], v[16:19]
    v_mfma_f32_16x16x32_bf16 v[20:23], v[132:135], v[164:167], v[20:23]
    s_add_u32 m0, s82, 68608
    s_nop 0
    buffer_load_dwordx4 v197, s[56:59], s80 offen lds
    s_add_u32 s80, s80, 128
    v_mfma_f32_16x16x32_bf16 v[48:51], v[136:139], v[164:167], v[48:51]
    v_mfma_f32_16x16x32_bf16 v[52:55], v[140:143], v[164:167], v[52:55]
    s_add_u32 m0, s83, 132096
    s_nop 0
    buffer_load_dwordx4 v190, s[60:63], s81 offen lds
    s_add_u32 s81, s81, 262144
    s_waitcnt lgkmcnt(6)
    v_mfma_f32_16x16x32_bf16 v[8:11], v[128:131], v[168:171], v[8:11]
    v_mfma_f32_16x16x32_bf16 v[12:15], v[132:135], v[168:171], v[12:15]
    s_add_u32 m0, s83, 0
    s_nop 0
    buffer_load_dwordx4 v189, s[60:63], s81 offen lds
    v_mfma_f32_16x16x32_bf16 v[40:43], v[136:139], v[168:171], v[40:43]
    v_mfma_f32_16x16x32_bf16 v[44:47], v[140:143], v[168:171], v[44:47]
    s_add_u32 m0, s83, 1024
    s_nop 0
    buffer_load_dwordx4 v190, s[60:63], s81 offen lds
    s_add_u32 s81, s81, 262144
    s_waitcnt lgkmcnt(4)
    v_mfma_f32_16x16x32_bf16 v[24:27], v[128:131], v[172:175], v[24:27]
    v_mfma_f32_16x16x32_bf16 v[28:31], v[132:135], v[172:175], v[28:31]
    v_mfma_f32_16x16x32_bf16 v[56:59], v[136:139], v[172:175], v[56:59]
    v_mfma_f32_16x16x32_bf16 v[60:63], v[140:143], v[172:175], v[60:63]
    s_waitcnt lgkmcnt(0)
    v_mfma_f32_16x16x32_bf16 v[64:67], v[144:147], v[160:163], v[64:67]
    s_waitcnt vmcnt(14)
    s_barrier
    ds_read_b128 v[128:131], v181 offset:32768
    ds_read_b128 v[132:135], v181 offset:34816
    v_mfma_f32_16x16x32_bf16 v[68:71], v[148:151], v[160:163], v[68:71]
    ds_read_b128 v[136:139], v181 offset:36864
    ds_read_b128 v[140:143], v181 offset:38912
    v_mfma_f32_16x16x32_bf16 v[96:99], v[152:155], v[160:163], v[96:99]
    v_mfma_f32_16x16x32_bf16 v[100:103], v[156:159], v[160:163], v[100:103]
    ds_read_b64_tr_b16 v[160:161], v177 offset:32768
    ds_read_b64_tr_b16 v[162:163], v177 offset:34816
    v_mfma_f32_16x16x32_bf16 v[80:83], v[144:147], v[164:167], v[80:83]
    v_mfma_f32_16x16x32_bf16 v[84:87], v[148:151], v[164:167], v[84:87]
    s_add_u32 m0, s83, 16384
    s_nop 0
    buffer_load_dwordx4 v189, s[60:63], s81 offen lds
    v_mfma_f32_16x16x32_bf16 v[112:115], v[152:155], v[164:167], v[112:115]
    v_mfma_f32_16x16x32_bf16 v[116:119], v[156:159], v[164:167], v[116:119]
    ds_read_b64_tr_b16 v[164:165], v178 offset:32768
    ds_read_b64_tr_b16 v[166:167], v178 offset:34816
    v_mfma_f32_16x16x32_bf16 v[72:75], v[144:147], v[168:171], v[72:75]
    v_mfma_f32_16x16x32_bf16 v[76:79], v[148:151], v[168:171], v[76:79]
    s_add_u32 m0, s83, 17408
    s_nop 0
    buffer_load_dwordx4 v190, s[60:63], s81 offen lds
    s_add_u32 s81, s81, 262144
    v_mfma_f32_16x16x32_bf16 v[104:107], v[152:155], v[168:171], v[104:107]
    v_mfma_f32_16x16x32_bf16 v[108:111], v[156:159], v[168:171], v[108:111]
    ds_read_b64_tr_b16 v[168:169], v179 offset:32768
    ds_read_b64_tr_b16 v[170:171], v179 offset:34816
    v_mfma_f32_16x16x32_bf16 v[88:91], v[144:147], v[172:175], v[88:91]
    v_mfma_f32_16x16x32_bf16 v[92:95], v[148:151], v[172:175], v[92:95]
    v_mfma_f32_16x16x32_bf16 v[120:123], v[152:155], v[172:175], v[120:123]
    v_mfma_f32_16x16x32_bf16 v[124:127], v[156:159], v[172:175], v[124:127]
    ds_read_b64_tr_b16 v[172:173], v180 offset:32768
    ds_read_b64_tr_b16 v[174:175], v180 offset:34816
    s_waitcnt lgkmcnt(6)
    v_mfma_f32_16x16x32_bf16 v[0:3], v[128:131], v[160:163], v[0:3]
    ds_read_b128 v[144:147], v181 offset:40960
    ds_read_b128 v[148:151], v181 offset:43008
    v_mfma_f32_16x16x32_bf16 v[4:7], v[132:135], v[160:163], v[4:7]
    s_waitcnt vmcnt(10)
    v_lshlrev_b32 v216, 16, v200
    v_and_b32 v217, 0xffff0000, v200
    v_lshlrev_b32 v218, 16, v201
    v_and_b32 v219, 0xffff0000, v201
    v_lshlrev_b32 v220, 16, v202
    v_mfma_f32_16x16x32_bf16 v[32:35], v[136:139], v[160:163], v[32:35]
    ds_read_b128 v[152:155], v181 offset:45056
    ds_read_b128 v[156:159], v181 offset:47104
    v_mfma_f32_16x16x32_bf16 v[36:39], v[140:143], v[160:163], v[36:39]
    v_and_b32 v221, 0xffff0000, v202
    v_lshlrev_b32 v222, 16, v203
    v_and_b32 v223, 0xffff0000, v203
    v_lshlrev_b32 v224, 16, v204
    v_and_b32 v225, 0xffff0000, v204
    s_waitcnt lgkmcnt(8)
    v_mfma_f32_16x16x32_bf16 v[16:19], v[128:131], v[164:167], v[16:19]
    v_mfma_f32_16x16x32_bf16 v[20:23], v[132:135], v[164:167], v[20:23]
    v_lshlrev_b32 v226, 16, v205
    v_and_b32 v227, 0xffff0000, v205
    v_lshlrev_b32 v228, 16, v206
    v_and_b32 v229, 0xffff0000, v206
    v_lshlrev_b32 v230, 16, v207
    v_mfma_f32_16x16x32_bf16 v[48:51], v[136:139], v[164:167], v[48:51]
    v_mfma_f32_16x16x32_bf16 v[52:55], v[140:143], v[164:167], v[52:55]
    v_and_b32 v231, 0xffff0000, v207
    v_add_f32 v232, v216, v217
    v_add_f32 v232, v232, v218
    v_add_f32 v232, v232, v219
    v_add_f32 v232, v232, v220
    s_waitcnt lgkmcnt(6)
    v_mfma_f32_16x16x32_bf16 v[8:11], v[128:131], v[168:171], v[8:11]
    v_mfma_f32_16x16x32_bf16 v[12:15], v[132:135], v[168:171], v[12:15]
    v_add_f32 v232, v232, v221
    v_add_f32 v232, v232, v222
    v_add_f32 v232, v232, v223
    v_add_f32 v232, v232, v224
    v_add_f32 v232, v232, v225
    v_mfma_f32_16x16x32_bf16 v[40:43], v[136:139], v[168:171], v[40:43]
    v_mfma_f32_16x16x32_bf16 v[44:47], v[140:143], v[168:171], v[44:47]
    v_add_f32 v232, v232, v226
    v_add_f32 v232, v232, v227
    v_add_f32 v232, v232, v228
    v_add_f32 v232, v232, v229
    v_add_f32 v232, v232, v230
    s_waitcnt lgkmcnt(4)
    v_mfma_f32_16x16x32_bf16 v[24:27], v[128:131], v[172:175], v[24:27]
    v_mfma_f32_16x16x32_bf16 v[28:31], v[132:135], v[172:175], v[28:31]
    v_add_f32 v232, v232, v231
    s_nop 1
    v_add_f32_dpp v232, v232, v232 row_shr:1 row_mask:0xf bank_mask:0xf
    s_nop 1
    v_add_f32_dpp v232, v232, v232 row_shr:2 row_mask:0xf bank_mask:0xf
    v_mfma_f32_16x16x32_bf16 v[56:59], v[136:139], v[172:175], v[56:59]
    v_mfma_f32_16x16x32_bf16 v[60:63], v[140:143], v[172:175], v[60:63]
    s_nop 1
    v_add_f32_dpp v232, v232, v232 row_shr:4 row_mask:0xf bank_mask:0xf
    s_nop 1
    v_add_f32_dpp v232, v232, v232 row_shr:8 row_mask:0xf bank_mask:0xf
    s_nop 1
    s_waitcnt lgkmcnt(0)
    v_mfma_f32_16x16x32_bf16 v[64:67], v[144:147], v[160:163], v[64:67]
    s_waitcnt vmcnt(5)
    s_barrier
    ds_read_b128 v[128:131], v176 offset:0
    ds_read_b128 v[132:135], v176 offset:2048
    v_mfma_f32_16x16x32_bf16 v[68:71], v[148:151], v[160:163], v[68:71]
    ds_read_b128 v[136:139], v176 offset:4096
    ds_read_b128 v[140:143], v176 offset:6144
    v_add_f32_dpp v232, v232, v232 row_bcast:15 row_mask:0xa bank_mask:0xf
    s_nop 1
    v_add_f32_dpp v232, v232, v232 row_bcast:31 row_mask:0xc bank_mask:0xf
    s_nop 1
    v_readlane_b32 s85, v232, 63
    v_mfma_f32_16x16x32_bf16 v[96:99], v[152:155], v[160:163], v[96:99]
    v_mfma_f32_16x16x32_bf16 v[100:103], v[156:159], v[160:163], v[100:103]
    ds_read_b64_tr_b16 v[160:161], v177 offset:49152
    ds_read_b64_tr_b16 v[162:163], v177 offset:51200
    v_mov_b32 v233, 0x3ae38e39
    s_nop 1
    v_mul_f32 v233, s85, v233
    v_sub_f32 v236, v216, v233
    v_mul_f32 v232, v236, v236
    v_mfma_f32_16x16x32_bf16 v[80:83], v[144:147], v[164:167], v[80:83]
    v_mfma_f32_16x16x32_bf16 v[84:87], v[148:151], v[164:167], v[84:87]
    s_add_u32 m0, s82, 98304
    s_nop 0
    buffer_load_dwordx4 v188, s[56:59], s79 offen lds
    v_sub_f32 v236, v217, v233
    v_fmac_f32 v232, v236, v236
    v_sub_f32 v236, v218, v233
    v_fmac_f32 v232, v236, v236
    v_sub_f32 v236, v219, v233
    v_mfma_f32_16x16x32_bf16 v[112:115], v[152:155], v[164:167], v[112:115]
    v_mfma_f32_16x16x32_bf16 v[116:119], v[156:159], v[164:167], v[116:119]
    ds_read_b64_tr_b16 v[164:165], v178 offset:49152
    ds_read_b64_tr_b16 v[166:167], v178 offset:51200
    v_fmac_f32 v232, v236, v236
    v_sub_f32 v236, v220, v233
    v_fmac_f32 v232, v236, v236
    v_sub_f32 v236, v221, v233
    v_fmac_f32 v232, v236, v236
    v_mfma_f32_16x16x32_bf16 v[72:75], v[144:147], v[168:171], v[72:75]
    v_mfma_f32_16x16x32_bf16 v[76:79], v[148:151], v[168:171], v[76:79]
    s_add_u32 m0, s82, 99328
    s_nop 0
    buffer_load_dwordx4 v197, s[56:59], s79 offen lds
    s_add_u32 s79, s79, 128
    v_sub_f32 v236, v222, v233
    v_fmac_f32 v232, v236, v236
    v_sub_f32 v236, v223, v233
    v_fmac_f32 v232, v236, v236
    v_sub_f32 v236, v224, v233
    v_mfma_f32_16x16x32_bf16 v[104:107], v[152:155], v[168:171], v[104:107]
    v_mfma_f32_16x16x32_bf16 v[108:111], v[156:159], v[168:171], v[108:111]
    ds_read_b64_tr_b16 v[168:169], v179 offset:49152
    ds_read_b64_tr_b16 v[170:171], v179 offset:51200
    v_fmac_f32 v232, v236, v236
    v_sub_f32 v236, v225, v233
    v_fmac_f32 v232, v236, v236
    v_sub_f32 v236, v226, v233
    v_fmac_f32 v232, v236, v236
    v_mfma_f32_16x16x32_bf16 v[88:91], v[144:147], v[172:175], v[88:91]
    v_mfma_f32_16x16x32_bf16 v[92:95], v[148:151], v[172:175], v[92:95]
    s_add_u32 m0, s82, 100352
    s_nop 0
    buffer_load_dwordx4 v188, s[56:59], s80 offen lds
    v_sub_f32 v236, v227, v233
    v_fmac_f32 v232, v236, v236
    v_sub_f32 v236, v228, v233
    v_fmac_f32 v232, v236, v236
    v_sub_f32 v236, v229, v233
    v_mfma_f32_16x16x32_bf16 v[120:123], v[152:155], v[172:175], v[120:123]
    v_mfma_f32_16x16x32_bf16 v[124:127], v[156:159], v[172:175], v[124:127]
    ds_read_b64_tr_b16 v[172:173], v180 offset:49152
    ds_read_b64_tr_b16 v[174:175], v180 offset:51200
    v_fmac_f32 v232, v236, v236
    v_sub_f32 v236, v230, v233
    v_fmac_f32 v232, v236, v236
    v_sub_f32 v236, v231, v233
    v_fmac_f32 v232, v236, v236
    s_waitcnt lgkmcnt(6)
    v_mfma_f32_16x16x32_bf16 v[0:3], v[128:131], v[160:163], v[0:3]
    ds_read_b128 v[144:147], v176 offset:8192
    ds_read_b128 v[148:151], v176 offset:10240
    v_mfma_f32_16x16x32_bf16 v[4:7], v[132:135], v[160:163], v[4:7]
    v_cmp_gt_u32 vcc, 36, v192
    s_nop 1
    v_cndmask_b32 v232, 0, v232, vcc
    s_nop 1
    v_add_f32_dpp v232, v232, v232 row_shr:1 row_mask:0xf bank_mask:0xf
    v_mfma_f32_16x16x32_bf16 v[32:35], v[136:139], v[160:163], v[32:35]
    ds_read_b128 v[152:155], v176 offset:12288
    ds_read_b128 v[156:159], v176 offset:14336
    v_mfma_f32_16x16x32_bf16 v[36:39], v[140:143], v[160:163], v[36:39]
    s_nop 1
    v_add_f32_dpp v232, v232, v232 row_shr:2 row_mask:0xf bank_mask:0xf
    s_nop 1
    v_add_f32_dpp v232, v232, v232 row_shr:4 row_mask:0xf bank_mask:0xf
    s_nop 1
    s_waitcnt lgkmcnt(8)
    v_mfma_f32_16x16x32_bf16 v[16:19], v[128:131], v[164:167], v[16:19]
    v_mfma_f32_16x16x32_bf16 v[20:23], v[132:135], v[164:167], v[20:23]
    s_add_u32 m0, s82, 101376
    s_nop 0
    buffer_load_dwordx4 v197, s[56:59], s80 offen lds
    s_add_u32 s80, s80, 128
    v_add_f32_dpp v232, v232, v232 row_shr:8 row_mask:0xf bank_mask:0xf
    s_nop 1
    v_add_f32_dpp v232, v232, v232 row_bcast:15 row_mask:0xa bank_mask:0xf
    s_nop 1
    v_add_f32_dpp v232, v232, v232 row_bcast:31 row_mask:0xc bank_mask:0xf
    v_mfma_f32_16x16x32_bf16 v[48:51], v[136:139], v[164:167], v[48:51]
    v_mfma_f32_16x16x32_bf16 v[52:55], v[140:143], v[164:167], v[52:55]
    s_add_u32 m0, s83, 32768
    s_nop 0
    buffer_load_dwordx4 v189, s[60:63], s81 offen lds
    s_nop 1
    v_readlane_b32 s85, v232, 63
    v_mov_b32 v234, 0x3ae38e39
    s_nop 1
    v_mul_f32 v234, s85, v234
    s_waitcnt lgkmcnt(6)
    v_mfma_f32_16x16x32_bf16 v[8:11], v[128:131], v[168:171], v[8:11]
    v_mfma_f32_16x16x32_bf16 v[12:15], v[132:135], v[168:171], v[12:15]
    s_add_u32 m0, s83, 33792
    s_nop 0
    buffer_load_dwordx4 v190, s[60:63], s81 offen lds
    s_add_u32 s81, s81, 262144
    v_cvt_pk_bf16_f32 v236, v233, v234
    v_lshlrev_b32 v233, 16, v236
    v_and_b32 v234, 0xffff0000, v236
    v_add_f32 v234, 0x3727c5ac, v234
    v_cvt_pk_bf16_f32 v234, v234, v234
    v_mfma_f32_16x16x32_bf16 v[40:43], v[136:139], v[168:171], v[40:43]
    v_mfma_f32_16x16x32_bf16 v[44:47], v[140:143], v[168:171], v[44:47]
    v_lshlrev_b32 v234, 16, v234
    v_sqrt_f32 v234, v234
    s_nop 0
    v_cvt_pk_bf16_f32 v234, v234, v234
    v_lshlrev_b32 v234, 16, v234
    s_waitcnt lgkmcnt(4)
    v_mfma_f32_16x16x32_bf16 v[24:27], v[128:131], v[172:175], v[24:27]
    v_mfma_f32_16x16x32_bf16 v[28:31], v[132:135], v[172:175], v[28:31]
    v_rcp_f32 v235, v234
    v_mov_b32 v232, 0
    v_sub_f32 v216, v216, v233
    v_sub_f32 v217, v217, v233
    v_cvt_pk_bf16_f32 v236, v216, v217
    v_mfma_f32_16x16x32_bf16 v[56:59], v[136:139], v[172:175], v[56:59]
    v_mfma_f32_16x16x32_bf16 v[60:63], v[140:143], v[172:175], v[60:63]
    v_lshlrev_b32 v216, 16, v236
    v_and_b32 v217, 0xffff0000, v236
    v_mul_f32 v237, v216, v235
    v_fma_f32 v238, -v237, v234, v216
    v_fma_f32 v216, v238, v235, v237
    s_waitcnt lgkmcnt(0)
    v_mfma_f32_16x16x32_bf16 v[64:67], v[144:147], v[160:163], v[64:67]
    s_waitcnt vmcnt(10)
    s_barrier
    ds_read_b128 v[128:131], v181 offset:0
    ds_read_b128 v[132:135], v181 offset:2048
    v_mfma_f32_16x16x32_bf16 v[68:71], v[148:151], v[160:163], v[68:71]
    ds_read_b128 v[136:139], v181 offset:4096
    ds_read_b128 v[140:143], v181 offset:6144
    v_mul_f32 v237, v217, v235
    v_fma_f32 v238, -v237, v234, v217
    v_fma_f32 v217, v238, v235, v237
    v_cvt_pk_bf16_f32 v200, v216, v217
    v_lshlrev_b32 v216, 16, v200
    v_mfma_f32_16x16x32_bf16 v[96:99], v[152:155], v[160:163], v[96:99]
    v_mfma_f32_16x16x32_bf16 v[100:103], v[156:159], v[160:163], v[100:103]
    ds_read_b64_tr_b16 v[160:161], v182 offset:0
    ds_read_b64_tr_b16 v[162:163], v182 offset:2048
    v_and_b32 v217, 0xffff0000, v200
    v_lshlrev_b32 v236, 16, v208
    v_and_b32 v237, 0xffff0000, v208
    v_fmac_f32 v232, v216, v236
    v_fmac_f32 v232, v217, v237
    v_mfma_f32_16x16x32_bf16 v[80:83], v[144:147], v[164:167], v[80:83]
    v_mfma_f32_16x16x32_bf16 v[84:87], v[148:151], v[164:167], v[84:87]
    s_add_u32 m0, s83, 49152
    s_nop 0
    buffer_load_dwordx4 v189, s[60:63], s81 offen lds
    v_sub_f32 v218, v218, v233
    v_sub_f32 v219, v219, v233
    v_cvt_pk_bf16_f32 v236, v218, v219
    v_lshlrev_b32 v218, 16, v236
    v_and_b32 v219, 0xffff0000, v236
    v_mfma_f32_16x16x32_bf16 v[112:115], v[152:155], v[164:167], v[112:115]
    v_mfma_f32_16x16x32_bf16 v[116:119], v[156:159], v[164:167], v[116:119]
    ds_read_b64_tr_b16 v[164:165], v183 offset:0
    ds_read_b64_tr_b16 v[166:167], v183 offset:2048
    v_mul_f32 v237, v218, v235
    v_fma_f32 v238, -v237, v234, v218
    v_fma_f32 v218, v238, v235, v237
    v_mul_f32 v237, v219, v235
    v_fma_f32 v238, -v237, v234, v219
    v_mfma_f32_16x16x32_bf16 v[72:75], v[144:147], v[168:171], v[72:75]
    v_mfma_f32_16x16x32_bf16 v[76:79], v[148:151], v[168:171], v[76:79]
    s_add_u32 m0, s83, 50176
    s_nop 0
    buffer_load_dwordx4 v190, s[60:63], s81 offen lds
    s_add_u32 s81, s81, 262144
    v_fma_f32 v219, v238, v235, v237
    v_cvt_pk_bf16_f32 v201, v218, v219
    v_lshlrev_b32 v218, 16, v201
    v_and_b32 v219, 0xffff0000, v201
    v_lshlrev_b32 v236, 16, v209
    v_mfma_f32_16x16x32_bf16 v[104:107], v[152:155], v[168:171], v[104:107]
    v_mfma_f32_16x16x32_bf16 v[108:111], v[156:159], v[168:171], v[108:111]
    ds_read_b64_tr_b16 v[168:169], v240 offset:0
    ds_read_b64_tr_b16 v[170:171], v240 offset:2048
    v_and_b32 v237, 0xffff0000, v209
    v_fmac_f32 v232, v218, v236
    v_fmac_f32 v232, v219, v237
    v_sub_f32 v220, v220, v233
    v_sub_f32 v221, v221, v233
    v_mfma_f32_16x16x32_bf16 v[88:91], v[144:147], v[172:175], v[88:91]
    v_mfma_f32_16x16x32_bf16 v[92:95], v[148:151], v[172:175], v[92:95]
    v_cvt_pk_bf16_f32 v236, v220, v221
    v_lshlrev_b32 v220, 16, v236
    v_and_b32 v221, 0xffff0000, v236
    v_mul_f32 v237, v220, v235
    v_fma_f32 v238, -v237, v234, v220
    v_mfma_f32_16x16x32_bf16 v[120:123], v[152:155], v[172:175], v[120:123]
    v_mfma_f32_16x16x32_bf16 v[124:127], v[156:159], v[172:175], v[124:127]
    ds_read_b64_tr_b16 v[172:173], v241 offset:0
    ds_read_b64_tr_b16 v[174:175], v241 offset:2048
    v_fma_f32 v220, v238, v235, v237
    v_mul_f32 v237, v221, v235
    v_fma_f32 v238, -v237, v234, v221
    v_fma_f32 v221, v238, v235, v237
    v_cvt_pk_bf16_f32 v202, v220, v221
    s_waitcnt lgkmcnt(6)
    v_mfma_f32_16x16x32_bf16 v[0:3], v[128:131], v[160:163], v[0:3]
    ds_read_b128 v[144:147], v181 offset:8192
    ds_read_b128 v[148:151], v181 offset:10240
    v_mfma_f32_16x16x32_bf16 v[4:7], v[132:135], v[160:163], v[4:7]
    v_lshlrev_b32 v220, 16, v202
    v_and_b32 v221, 0xffff0000, v202
    v_lshlrev_b32 v236, 16, v210
    v_and_b32 v237, 0xffff0000, v210
    v_fmac_f32 v232, v220, v236
    v_mfma_f32_16x16x32_bf16 v[32:35], v[136:139], v[160:163], v[32:35]
    ds_read_b128 v[152:155], v181 offset:12288
    ds_read_b128 v[156:159], v181 offset:14336
    v_mfma_f32_16x16x32_bf16 v[36:39], v[140:143], v[160:163], v[36:39]
    v_fmac_f32 v232, v221, v237
    v_sub_f32 v222, v222, v233
    v_sub_f32 v223, v223, v233
    v_cvt_pk_bf16_f32 v236, v222, v223
    v_lshlrev_b32 v222, 16, v236
    s_waitcnt lgkmcnt(8)
    v_mfma_f32_16x16x32_bf16 v[16:19], v[128:131], v[164:167], v[16:19]
    v_mfma_f32_16x16x32_bf16 v[20:23], v[132:135], v[164:167], v[20:23]
    v_and_b32 v223, 0xffff0000, v236
    v_mul_f32 v237, v222, v235
    v_fma_f32 v238, -v237, v234, v222
    v_fma_f32 v222, v238, v235, v237
    v_mul_f32 v237, v223, v235
    v_mfma_f32_16x16x32_bf16 v[48:51], v[136:139], v[164:167], v[48:51]
    v_mfma_f32_16x16x32_bf16 v[52:55], v[140:143], v[164:167], v[52:55]
    v_fma_f32 v238, -v237, v234, v223
    v_fma_f32 v223, v238, v235, v237
    v_cvt_pk_bf16_f32 v203, v222, v223
    v_lshlrev_b32 v222, 16, v203
    v_and_b32 v223, 0xffff0000, v203
    s_waitcnt lgkmcnt(6)
    v_mfma_f32_16x16x32_bf16 v[8:11], v[128:131], v[168:171], v[8:11]
    v_mfma_f32_16x16x32_bf16 v[12:15], v[132:135], v[168:171], v[12:15]
    v_lshlrev_b32 v236, 16, v211
    v_and_b32 v237, 0xffff0000, v211
    v_fmac_f32 v232, v222, v236
    v_fmac_f32 v232, v223, v237
    v_sub_f32 v224, v224, v233
    v_mfma_f32_16x16x32_bf16 v[40:43], v[136:139], v[168:171], v[40:43]
    v_mfma_f32_16x16x32_bf16 v[44:47], v[140:143], v[168:171], v[44:47]
    v_sub_f32 v225, v225, v233
    v_cvt_pk_bf16_f32 v236, v224, v225
    v_lshlrev_b32 v224, 16, v236
    v_and_b32 v225, 0xffff0000, v236
    v_mul_f32 v237, v224, v235
    s_waitcnt lgkmcnt(4)
    v_mfma_f32_16x16x32_bf16 v[24:27], v[128:131], v[172:175], v[24:27]
    v_mfma_f32_16x16x32_bf16 v[28:31], v[132:135], v[172:175], v[28:31]
    v_fma_f32 v238, -v237, v234, v224
    v_fma_f32 v224, v238, v235, v237
    v_mul_f32 v237, v225, v235
    v_fma_f32 v238, -v237, v234, v225
    v_fma_f32 v225, v238, v235, v237
    v_mfma_f32_16x16x32_bf16 v[56:59], v[136:139], v[172:175], v[56:59]
    v_mfma_f32_16x16x32_bf16 v[60:63], v[140:143], v[172:175], v[60:63]
    v_cvt_pk_bf16_f32 v204, v224, v225
    v_lshlrev_b32 v224, 16, v204
    v_and_b32 v225, 0xffff0000, v204
    v_lshlrev_b32 v236, 16, v212
    v_and_b32 v237, 0xffff0000, v212
    s_waitcnt lgkmcnt(0)
    v_mfma_f32_16x16x32_bf16 v[64:67], v[144:147], v[160:163], v[64:67]
    s_waitcnt vmcnt(4)
    s_barrier
    ds_read_b128 v[128:131], v176 offset:32768
    ds_read_b128 v[132:135], v176 offset:34816
    v_mfma_f32_16x16x32_bf16 v[68:71], v[148:151], v[160:163], v[68:71]
    ds_read_b128 v[136:139], v176 offset:36864
    ds_read_b128 v[140:143], v176 offset:38912
    v_fmac_f32 v232, v224, v236
    v_fmac_f32 v232, v225, v237
    v_sub_f32 v226, v226, v233
    v_sub_f32 v227, v227, v233
    v_cvt_pk_bf16_f32 v236, v226, v227
    v_mfma_f32_16x16x32_bf16 v[96:99], v[152:155], v[160:163], v[96:99]
    v_mfma_f32_16x16x32_bf16 v[100:103], v[156:159], v[160:163], v[100:103]
    ds_read_b64_tr_b16 v[160:161], v177 offset:0
    ds_read_b64_tr_b16 v[162:163], v177 offset:2048
    v_lshlrev_b32 v226, 16, v236
    v_and_b32 v227, 0xffff0000, v236
    v_mul_f32 v237, v226, v235
    v_fma_f32 v238, -v237, v234, v226
    v_fma_f32 v226, v238, v235, v237
    v_mfma_f32_16x16x32_bf16 v[80:83], v[144:147], v[164:167], v[80:83]
    v_mfma_f32_16x16x32_bf16 v[84:87], v[148:151], v[164:167], v[84:87]
    s_add_u32 m0, s82, 65536
    s_nop 0
    buffer_load_dwordx4 v188, s[56:59], s79 offen lds
    v_mul_f32 v237, v227, v235
    v_fma_f32 v238, -v237, v234, v227
    v_fma_f32 v227, v238, v235, v237
    v_cvt_pk_bf16_f32 v205, v226, v227
    v_lshlrev_b32 v226, 16, v205
    v_mfma_f32_16x16x32_bf16 v[112:115], v[152:155], v[164:167], v[112:115]
    v_mfma_f32_16x16x32_bf16 v[116:119], v[156:159], v[164:167], v[116:119]
    ds_read_b64_tr_b16 v[164:165], v178 offset:0
    ds_read_b64_tr_b16 v[166:167], v178 offset:2048
    v_and_b32 v227, 0xffff0000, v205
    v_lshlrev_b32 v236, 16, v213
    v_and_b32 v237, 0xffff0000, v213
    v_fmac_f32 v232, v226, v236
    v_fmac_f32 v232, v227, v237
    v_mfma_f32_16x16x32_bf16 v[72:75], v[144:147], v[168:171], v[72:75]
    v_mfma_f32_16x16x32_bf16 v[76:79], v[148:151], v[168:171], v[76:79]
    s_add_u32 m0, s82, 66560
    s_nop 0
    buffer_load_dwordx4 v197, s[56:59], s79 offen lds
    s_add_u32 s79, s79, 128
    v_sub_f32 v228, v228, v233
    v_sub_f32 v229, v229, v233
    v_cvt_pk_bf16_f32 v236, v228, v229
    v_lshlrev_b32 v228, 16, v236
    v_and_b32 v229, 0xffff0000, v236
    v_mfma_f32_16x16x32_bf16 v[104:107], v[152:155], v[168:171], v[104:107]
    v_mfma_f32_16x16x32_bf16 v[108:111], v[156:159], v[168:171], v[108:111]
    ds_read_b64_tr_b16 v[168:169], v179 offset:0
    ds_read_b64_tr_b16 v[170:171], v179 offset:2048
    v_mul_f32 v237, v228, v235
    v_fma_f32 v238, -v237, v234, v228
    v_fma_f32 v228, v238, v235, v237
    v_mul_f32 v237, v229, v235
    v_fma_f32 v238, -v237, v234, v229
    v_mfma_f32_16x16x32_bf16 v[88:91], v[144:147], v[172:175], v[88:91]
    v_mfma_f32_16x16x32_bf16 v[92:95], v[148:151], v[172:175], v[92:95]
    s_add_u32 m0, s82, 67584
    s_nop 0
    buffer_load_dwordx4 v188, s[56:59], s80 offen lds
    v_fma_f32 v229, v238, v235, v237
    v_cvt_pk_bf16_f32 v206, v228, v229
    v_lshlrev_b32 v228, 16, v206
    v_and_b32 v229, 0xffff0000, v206
    v_lshlrev_b32 v236, 16, v214
    v_mfma_f32_16x16x32_bf16 v[120:123], v[152:155], v[172:175], v[120:123]
    v_mfma_f32_16x16x32_bf16 v[124:127], v[156:159], v[172:175], v[124:127]
    ds_read_b64_tr_b16 v[172:173], v180 offset:0
    ds_read_b64_tr_b16 v[174:175], v180 offset:2048
    v_and_b32 v237, 0xffff0000, v214
    v_fmac_f32 v232, v228, v236
    v_fmac_f32 v232, v229, v237
    v_sub_f32 v230, v230, v233
    v_sub_f32 v231, v231, v233
    s_waitcnt lgkmcnt(6)
    v_mfma_f32_16x16x32_bf16 v[0:3], v[128:131], v[160:163], v[0:3]
    ds_read_b128 v[144:147], v176 offset:40960
    ds_read_b128 v[148:151], v176 offset:43008
    v_mfma_f32_16x16x32_bf16 v[4:7], v[132:135], v[160:163], v[4:7]
    v_cvt_pk_bf16_f32 v236, v230, v231
    v_lshlrev_b32 v230, 16, v236
    v_and_b32 v231, 0xffff0000, v236
    v_mul_f32 v237, v230, v235
    v_fma_f32 v238, -v237, v234, v230
    v_mfma_f32_16x16x32_bf16 v[32:35], v[136:139], v[160:163], v[32:35]
    ds_read_b128 v[152:155], v176 offset:45056
    ds_read_b128 v[156:159], v176 offset:47104
    v_mfma_f32_16x16x32_bf16 v[36:39], v[140:143], v[160:163], v[36:39]
    v_fma_f32 v230, v238, v235, v237
    v_mul_f32 v237, v231, v235
    v_fma_f32 v238, -v237, v234, v231
    v_fma_f32 v231, v238, v235, v237
    v_cvt_pk_bf16_f32 v207, v230, v231
    s_waitcnt lgkmcnt(8)
    v_mfma_f32_16x16x32_bf16 v[16:19], v[128:131], v[164:167], v[16:19]
    v_mfma_f32_16x16x32_bf16 v[20:23], v[132:135], v[164:167], v[20:23]
    s_add_u32 m0, s82, 68608
    s_nop 0
    buffer_load_dwordx4 v197, s[56:59], s80 offen lds
    s_add_u32 s80, s80, 128
    v_lshlrev_b32 v230, 16, v207
    v_and_b32 v231, 0xffff0000, v207
    v_lshlrev_b32 v236, 16, v215
    v_and_b32 v237, 0xffff0000, v215
    v_fmac_f32 v232, v230, v236
    v_mfma_f32_16x16x32_bf16 v[48:51], v[136:139], v[164:167], v[48:51]
    v_mfma_f32_16x16x32_bf16 v[52:55], v[140:143], v[164:167], v[52:55]
    s_add_u32 m0, s83, 131072
    s_nop 0
    buffer_load_dwordx4 v189, s[60:63], s81 offen lds
    v_fmac_f32 v232, v231, v237
    s_lshl_b32 s85, s36, 4
    s_add_u32 s85, s85, 147456
    v_min_u32 v239, 36, v192
    v_lshl_add_u32 v239, v239, 8, s85
    s_waitcnt lgkmcnt(6)
    v_mfma_f32_16x16x32_bf16 v[8:11], v[128:131], v[168:171], v[8:11]
    v_mfma_f32_16x16x32_bf16 v[12:15], v[132:135], v[168:171], v[12:15]
    s_add_u32 m0, s83, 132096
    s_nop 0
    buffer_load_dwordx4 v190, s[60:63], s81 offen lds
    s_add_u32 s81, s81, 262144
    v_mov_b32 v236, 0x40000000
    ds_write_b128 v239, v[200:203]
    ds_write_b128 v239, v[204:207] offset:128
    s_nop 1
    v_add_f32_dpp v232, v232, v232 row_shr:1 row_mask:0xf bank_mask:0xf
    v_mfma_f32_16x16x32_bf16 v[40:43], v[136:139], v[168:171], v[40:43]
    v_mfma_f32_16x16x32_bf16 v[44:47], v[140:143], v[168:171], v[44:47]
    buffer_load_dword v198, off, s[72:75], 0 sc1
    s_nop 1
    v_add_f32_dpp v232, v232, v232 row_shr:2 row_mask:0xf bank_mask:0xf
    s_nop 1
    v_add_f32_dpp v232, v232, v232 row_shr:4 row_mask:0xf bank_mask:0xf
    s_nop 1
    s_waitcnt lgkmcnt(4)
    v_mfma_f32_16x16x32_bf16 v[24:27], v[128:131], v[172:175], v[24:27]
    v_mfma_f32_16x16x32_bf16 v[28:31], v[132:135], v[172:175], v[28:31]
    v_add_f32_dpp v232, v232, v232 row_shr:8 row_mask:0xf bank_mask:0xf
    s_nop 1
    v_add_f32_dpp v232, v232, v232 row_bcast:15 row_mask:0xa bank_mask:0xf
    s_nop 1
    v_add_f32_dpp v232, v232, v232 row_bcast:31 row_mask:0xc bank_mask:0xf
    v_mfma_f32_16x16x32_bf16 v[56:59], v[136:139], v[172:175], v[56:59]
    v_mfma_f32_16x16x32_bf16 v[60:63], v[140:143], v[172:175], v[60:63]
    s_nop 1
    v_cvt_pk_bf16_f32 v232, v232, v232
    v_and_b32 v232, 0xffff, v232
    v_xor_b32 v237, 0xffff, v232
    v_or_b32 v238, 0x8000, v232
    s_waitcnt lgkmcnt(0)
    v_mfma_f32_16x16x32_bf16 v[64:67], v[144:147], v[160:163], v[64:67]
    s_waitcnt vmcnt(15)
    s_barrier
    ds_read_b128 v[128:131], v181 offset:32768
    ds_read_b128 v[132:135], v181 offset:34816
    v_mfma_f32_16x16x32_bf16 v[68:71], v[148:151], v[160:163], v[68:71]
    ds_read_b128 v[136:139], v181 offset:36864
    ds_read_b128 v[140:143], v181 offset:38912
    v_cmp_lt_u32 vcc, 0x7fff, v232
    s_sub_u32 s86, 2047, s84
    s_nop 0
    v_cndmask_b32 v232, v238, v237, vcc
    v_lshlrev_b32 v232, 16, v232
    v_mfma_f32_16x16x32_bf16 v[96:99], v[152:155], v[160:163], v[96:99]
    v_mfma_f32_16x16x32_bf16 v[100:103], v[156:159], v[160:163], v[100:103]
    ds_read_b64_tr_b16 v[160:161], v177 offset:16384
    ds_read_b64_tr_b16 v[162:163], v177 offset:18432
    v_or_b32 v232, s86, v232
    v_cmp_eq_u32 vcc, 63, v192
    s_lshl_b32 s85, s36, 2
    s_add_u32 s85, s85, 157184
    v_mov_b32 v237, s85
    v_mfma_f32_16x16x32_bf16 v[80:83], v[144:147], v[164:167], v[80:83]
    v_mfma_f32_16x16x32_bf16 v[84:87], v[148:151], v[164:167], v[84:87]
    s_add_u32 m0, s83, 0
    s_nop 0
    buffer_load_dwordx4 v189, s[60:63], s81 offen lds
    v_mov_b32 v238, 157248
    v_cndmask_b32 v239, v238, v237, vcc
    ds_write_b32 v239, v232
    v_mfma_f32_16x16x32_bf16 v[112:115], v[152:155], v[164:167], v[112:115]
    v_mfma_f32_16x16x32_bf16 v[116:119], v[156:159], v[164:167], v[116:119]
    ds_read_b64_tr_b16 v[164:165], v178 offset:16384
    ds_read_b64_tr_b16 v[166:167], v178 offset:18432
    v_mfma_f32_16x16x32_bf16 v[72:75], v[144:147], v[168:171], v[72:75]
    v_mfma_f32_16x16x32_bf16 v[76:79], v[148:151], v[168:171], v[76:79]
    s_add_u32 m0, s83, 1024
    s_nop 0
    buffer_load_dwordx4 v190, s[60:63], s81 offen lds
    s_add_u32 s81, s81, 262144
    v_mfma_f32_16x16x32_bf16 v[104:107], v[152:155], v[168:171], v[104:107]
    v_mfma_f32_16x16x32_bf16 v[108:111], v[156:159], v[168:171], v[108:111]
    ds_read_b64_tr_b16 v[168:169], v179 offset:16384
    ds_read_b64_tr_b16 v[170:171], v179 offset:18432
    v_mfma_f32_16x16x32_bf16 v[88:91], v[144:147], v[172:175], v[88:91]
    v_mfma_f32_16x16x32_bf16 v[92:95], v[148:151], v[172:175], v[92:95]
    v_mfma_f32_16x16x32_bf16 v[120:123], v[152:155], v[172:175], v[120:123]
    v_mfma_f32_16x16x32_bf16 v[124:127], v[156:159], v[172:175], v[124:127]
    ds_read_b64_tr_b16 v[172:173], v180 offset:16384
    ds_read_b64_tr_b16 v[174:175], v180 offset:18432
    s_waitcnt lgkmcnt(6)
    v_mfma_f32_16x16x32_bf16 v[0:3], v[128:131], v[160:163], v[0:3]
    ds_read_b128 v[144:147], v181 offset:40960
    ds_read_b128 v[148:151], v181 offset:43008
    v_mfma_f32_16x16x32_bf16 v[4:7], v[132:135], v[160:163], v[4:7]
    v_mfma_f32_16x16x32_bf16 v[32:35], v[136:139], v[160:163], v[32:35]
    ds_read_b128 v[152:155], v181 offset:45056
    ds_read_b128 v[156:159], v181 offset:47104
    v_mfma_f32_16x16x32_bf16 v[36:39], v[140:143], v[160:163], v[36:39]
    s_waitcnt lgkmcnt(8)
    v_mfma_f32_16x16x32_bf16 v[16:19], v[128:131], v[164:167], v[16:19]
    v_mfma_f32_16x16x32_bf16 v[20:23], v[132:135], v[164:167], v[20:23]
    v_mfma_f32_16x16x32_bf16 v[48:51], v[136:139], v[164:167], v[48:51]
    v_mfma_f32_16x16x32_bf16 v[52:55], v[140:143], v[164:167], v[52:55]
    s_waitcnt lgkmcnt(6)
    v_mfma_f32_16x16x32_bf16 v[8:11], v[128:131], v[168:171], v[8:11]
    v_mfma_f32_16x16x32_bf16 v[12:15], v[132:135], v[168:171], v[12:15]
    v_mfma_f32_16x16x32_bf16 v[40:43], v[136:139], v[168:171], v[40:43]
    v_mfma_f32_16x16x32_bf16 v[44:47], v[140:143], v[168:171], v[44:47]
    s_waitcnt lgkmcnt(4)
    v_mfma_f32_16x16x32_bf16 v[24:27], v[128:131], v[172:175], v[24:27]
    v_mfma_f32_16x16x32_bf16 v[28:31], v[132:135], v[172:175], v[28:31]
    v_mfma_f32_16x16x32_bf16 v[56:59], v[136:139], v[172:175], v[56:59]
    v_mfma_f32_16x16x32_bf16 v[60:63], v[140:143], v[172:175], v[60:63]
    s_waitcnt lgkmcnt(0)
    v_mfma_f32_16x16x32_bf16 v[64:67], v[144:147], v[160:163], v[64:67]
    s_waitcnt vmcnt(5)
    s_barrier
    ds_read_b128 v[128:131], v176 offset:0
    ds_read_b128 v[132:135], v176 offset:2048
    v_mfma_f32_16x16x32_bf16 v[68:71], v[148:151], v[160:163], v[68:71]
    ds_read_b128 v[136:139], v176 offset:4096
    ds_read_b128 v[140:143], v176 offset:6144
    v_mfma_f32_16x16x32_bf16 v[96:99], v[152:155], v[160:163], v[96:99]
    v_mfma_f32_16x16x32_bf16 v[100:103], v[156:159], v[160:163], v[100:103]
    ds_read_b64_tr_b16 v[160:161], v177 offset:32768
    ds_read_b64_tr_b16 v[162:163], v177 offset:34816
    v_mfma_f32_16x16x32_bf16 v[80:83], v[144:147], v[164:167], v[80:83]
    v_mfma_f32_16x16x32_bf16 v[84:87], v[148:151], v[164:167], v[84:87]
    s_add_u32 m0, s82, 98304
    s_nop 0
    buffer_load_dwordx4 v188, s[56:59], s79 offen lds
    v_mfma_f32_16x16x32_bf16 v[112:115], v[152:155], v[164:167], v[112:115]
    v_mfma_f32_16x16x32_bf16 v[116:119], v[156:159], v[164:167], v[116:119]
    ds_read_b64_tr_b16 v[164:165], v178 offset:32768
    ds_read_b64_tr_b16 v[166:167], v178 offset:34816
    v_mfma_f32_16x16x32_bf16 v[72:75], v[144:147], v[168:171], v[72:75]
    v_mfma_f32_16x16x32_bf16 v[76:79], v[148:151], v[168:171], v[76:79]
    s_add_u32 m0, s82, 99328
    s_nop 0
    buffer_load_dwordx4 v197, s[56:59], s79 offen lds
    s_add_u32 s79, s79, 128
    v_mfma_f32_16x16x32_bf16 v[104:107], v[152:155], v[168:171], v[104:107]
    v_mfma_f32_16x16x32_bf16 v[108:111], v[156:159], v[168:171], v[108:111]
    ds_read_b64_tr_b16 v[168:169], v179 offset:32768
    ds_read_b64_tr_b16 v[170:171], v179 offset:34816
    v_mfma_f32_16x16x32_bf16 v[88:91], v[144:147], v[172:175], v[88:91]
    v_mfma_f32_16x16x32_bf16 v[92:95], v[148:151], v[172:175], v[92:95]
    s_add_u32 m0, s82, 100352
    s_nop 0
    buffer_load_dwordx4 v188, s[56:59], s80 offen lds
    v_mfma_f32_16x16x32_bf16 v[120:123], v[152:155], v[172:175], v[120:123]
    v_mfma_f32_16x16x32_bf16 v[124:127], v[156:159], v[172:175], v[124:127]
    ds_read_b64_tr_b16 v[172:173], v180 offset:32768
    ds_read_b64_tr_b16 v[174:175], v180 offset:34816
    s_waitcnt lgkmcnt(6)
    v_mfma_f32_16x16x32_bf16 v[0:3], v[128:131], v[160:163], v[0:3]
    s_waitcnt vmcnt(5)
    s_mov_b32 s35, 0x100000
parallel_sum__compressed_kv_cla__moe_arch_mod__prompt_kernel_p1A_tag1:
    v_readfirstlane_b32 s87, v198
    s_sub_u32 s35, s35, 1
    s_cbranch_scc1 parallel_sum__compressed_kv_cla__moe_arch_mod__prompt_kernel_p1A_tag1_ok
    s_cmp_lg_u32 s87, 0
    s_cbranch_scc1 parallel_sum__compressed_kv_cla__moe_arch_mod__prompt_kernel_p1A_tag1_ok
    buffer_load_dword v198, off, s[72:75], 0 sc1
    s_waitcnt vmcnt(0)
    s_branch parallel_sum__compressed_kv_cla__moe_arch_mod__prompt_kernel_p1A_tag1
parallel_sum__compressed_kv_cla__moe_arch_mod__prompt_kernel_p1A_tag1_ok:
    ds_read_b128 v[144:147], v176 offset:8192
    ds_read_b128 v[148:151], v176 offset:10240
    v_mfma_f32_16x16x32_bf16 v[4:7], v[132:135], v[160:163], v[4:7]
    v_mfma_f32_16x16x32_bf16 v[32:35], v[136:139], v[160:163], v[32:35]
    ds_read_b128 v[152:155], v176 offset:12288
    ds_read_b128 v[156:159], v176 offset:14336
    v_mfma_f32_16x16x32_bf16 v[36:39], v[140:143], v[160:163], v[36:39]
    s_waitcnt lgkmcnt(8)
    v_mfma_f32_16x16x32_bf16 v[16:19], v[128:131], v[164:167], v[16:19]
    v_mfma_f32_16x16x32_bf16 v[20:23], v[132:135], v[164:167], v[20:23]
    s_add_u32 m0, s82, 101376
    s_nop 0
    buffer_load_dwordx4 v197, s[56:59], s80 offen lds
    s_add_u32 s80, s80, 128
    v_mfma_f32_16x16x32_bf16 v[48:51], v[136:139], v[164:167], v[48:51]
    v_mfma_f32_16x16x32_bf16 v[52:55], v[140:143], v[164:167], v[52:55]
    s_add_u32 m0, s83, 16384
    s_nop 0
    buffer_load_dwordx4 v189, s[60:63], s81 offen lds
    s_waitcnt lgkmcnt(6)
    v_mfma_f32_16x16x32_bf16 v[8:11], v[128:131], v[168:171], v[8:11]
    v_mfma_f32_16x16x32_bf16 v[12:15], v[132:135], v[168:171], v[12:15]
    s_add_u32 m0, s83, 17408
    s_nop 0
    buffer_load_dwordx4 v190, s[60:63], s81 offen lds
    s_add_u32 s81, s81, 262144
    v_mfma_f32_16x16x32_bf16 v[40:43], v[136:139], v[168:171], v[40:43]
    v_mfma_f32_16x16x32_bf16 v[44:47], v[140:143], v[168:171], v[44:47]
    s_mul_i32 s49, s84, 2304
    buffer_load_dword v194, v193, s[8:11], s49 offen
    s_waitcnt lgkmcnt(4)
    v_mfma_f32_16x16x32_bf16 v[24:27], v[128:131], v[172:175], v[24:27]
    v_mfma_f32_16x16x32_bf16 v[28:31], v[132:135], v[172:175], v[28:31]
    v_mfma_f32_16x16x32_bf16 v[56:59], v[136:139], v[172:175], v[56:59]
    v_mfma_f32_16x16x32_bf16 v[60:63], v[140:143], v[172:175], v[60:63]
    s_waitcnt lgkmcnt(0)
    v_mfma_f32_16x16x32_bf16 v[64:67], v[144:147], v[160:163], v[64:67]
    s_waitcnt vmcnt(16)
    s_barrier
    ds_read_b128 v[128:131], v181 offset:0
    ds_read_b128 v[132:135], v181 offset:2048
    v_mfma_f32_16x16x32_bf16 v[68:71], v[148:151], v[160:163], v[68:71]
    ds_read_b128 v[136:139], v181 offset:4096
    ds_read_b128 v[140:143], v181 offset:6144
    s_lshl_b32 s85, s36, 10
    v_add_u32 v232, s85, v243
    v_add_u32 v232, 147456, v232
    ds_read_b128 v[200:203], v232
    v_mov_b32 v233, 155648
    v_mfma_f32_16x16x32_bf16 v[96:99], v[152:155], v[160:163], v[96:99]
    v_mfma_f32_16x16x32_bf16 v[100:103], v[156:159], v[160:163], v[100:103]
    ds_read_b64_tr_b16 v[160:161], v177 offset:49152
    ds_read_b64_tr_b16 v[162:163], v177 offset:51200
    v_add_u32 v233, v233, v243
    ds_read_b128 v[204:207], v233
    v_lshrrev_b32 v234, 2, v243
    v_add_u32 v236, 157184, v234
    ds_read_b32 v236, v236
    v_mfma_f32_16x16x32_bf16 v[80:83], v[144:147], v[164:167], v[80:83]
    v_mfma_f32_16x16x32_bf16 v[84:87], v[148:151], v[164:167], v[84:87]
    s_add_u32 m0, s83, 32768
    s_nop 0
    buffer_load_dwordx4 v189, s[60:63], s81 offen lds
    v_lshrrev_b32 v232, 3, v192
    v_lshlrev_b32 v232, 9, v232
    v_and_b32 v233, 7, v192
    v_lshl_add_u32 v232, v233, 4, v232
    s_lshr_b32 s85, s2, 2
    v_mfma_f32_16x16x32_bf16 v[112:115], v[152:155], v[164:167], v[112:115]
    v_mfma_f32_16x16x32_bf16 v[116:119], v[156:159], v[164:167], v[116:119]
    ds_read_b64_tr_b16 v[164:165], v178 offset:49152
    ds_read_b64_tr_b16 v[166:167], v178 offset:51200
    s_mul_i32 s85, s85, 36864
    s_and_b32 s86, s2, 3
    s_lshl_b32 s86, s86, 7
    s_add_u32 s85, s85, s86
    s_add_u32 s85, s85, 0x0
    v_mfma_f32_16x16x32_bf16 v[72:75], v[144:147], v[168:171], v[72:75]
    v_mfma_f32_16x16x32_bf16 v[76:79], v[148:151], v[168:171], v[76:79]
    s_add_u32 m0, s83, 33792
    s_nop 0
    buffer_load_dwordx4 v190, s[60:63], s81 offen lds
    s_add_u32 s81, s81, 262144
    s_lshl_b32 s86, s36, 12
    s_add_u32 s86, s86, s85
    s_add_u32 s85, s85, 32768
    v_mov_b32 v237, 0x40000000
    v_cmp_gt_u32 vcc, 64, v191
    v_mfma_f32_16x16x32_bf16 v[104:107], v[152:155], v[168:171], v[104:107]
    v_mfma_f32_16x16x32_bf16 v[108:111], v[156:159], v[168:171], v[108:111]
    ds_read_b64_tr_b16 v[168:169], v179 offset:49152
    ds_read_b64_tr_b16 v[170:171], v179 offset:51200
    s_waitcnt lgkmcnt(0)
    buffer_store_dwordx4 v[200:203], v232, s[12:15], s86 offen sc1
    v_cndmask_b32 v233, v237, v232, vcc
    buffer_store_dwordx4 v[204:207], v233, s[12:15], s85 offen sc1
    v_cmp_gt_u32 vcc, 8, v191
    v_mfma_f32_16x16x32_bf16 v[88:91], v[144:147], v[172:175], v[88:91]
    v_mfma_f32_16x16x32_bf16 v[92:95], v[148:151], v[172:175], v[92:95]
    s_lshl_b32 s85, s2, 5
    s_add_u32 s85, s85, 0x240000
    v_cndmask_b32 v233, v237, v234, vcc
    buffer_store_dword v236, v233, s[12:15], s85 offen sc1
    v_mov_b32 v195, s87
    v_mfma_f32_16x16x32_bf16 v[120:123], v[152:155], v[172:175], v[120:123]
    v_mfma_f32_16x16x32_bf16 v[124:127], v[156:159], v[172:175], v[124:127]
    ds_read_b64_tr_b16 v[172:173], v180 offset:49152
    ds_read_b64_tr_b16 v[174:175], v180 offset:51200
    s_lshl_b32 s85, s2, 6
    s_add_u32 s85, s85, 0x780000
    s_waitcnt lgkmcnt(6)
    v_mfma_f32_16x16x32_bf16 v[0:3], v[128:131], v[160:163], v[0:3]
    ds_read_b128 v[144:147], v181 offset:8192
    ds_read_b128 v[148:151], v181 offset:10240
    v_mfma_f32_16x16x32_bf16 v[4:7], v[132:135], v[160:163], v[4:7]
    v_mfma_f32_16x16x32_bf16 v[32:35], v[136:139], v[160:163], v[32:35]
    ds_read_b128 v[152:155], v181 offset:12288
    ds_read_b128 v[156:159], v181 offset:14336
    v_mfma_f32_16x16x32_bf16 v[36:39], v[140:143], v[160:163], v[36:39]
    s_waitcnt lgkmcnt(8)
    v_mfma_f32_16x16x32_bf16 v[16:19], v[128:131], v[164:167], v[16:19]
    v_mfma_f32_16x16x32_bf16 v[20:23], v[132:135], v[164:167], v[20:23]
    v_mfma_f32_16x16x32_bf16 v[48:51], v[136:139], v[164:167], v[48:51]
    v_mfma_f32_16x16x32_bf16 v[52:55], v[140:143], v[164:167], v[52:55]
    s_waitcnt lgkmcnt(6)
    v_mfma_f32_16x16x32_bf16 v[8:11], v[128:131], v[168:171], v[8:11]
    v_mfma_f32_16x16x32_bf16 v[12:15], v[132:135], v[168:171], v[12:15]
    v_mfma_f32_16x16x32_bf16 v[40:43], v[136:139], v[168:171], v[40:43]
    v_mfma_f32_16x16x32_bf16 v[44:47], v[140:143], v[168:171], v[44:47]
    s_waitcnt lgkmcnt(4)
    v_mfma_f32_16x16x32_bf16 v[24:27], v[128:131], v[172:175], v[24:27]
    v_mfma_f32_16x16x32_bf16 v[28:31], v[132:135], v[172:175], v[28:31]
    v_mfma_f32_16x16x32_bf16 v[56:59], v[136:139], v[172:175], v[56:59]
    v_mfma_f32_16x16x32_bf16 v[60:63], v[140:143], v[172:175], v[60:63]
    s_waitcnt lgkmcnt(0)
    v_mfma_f32_16x16x32_bf16 v[64:67], v[144:147], v[160:163], v[64:67]
    s_waitcnt vmcnt(8)
    s_barrier
    ds_read_b128 v[128:131], v176 offset:32768
    ds_read_b128 v[132:135], v176 offset:34816
    v_mfma_f32_16x16x32_bf16 v[68:71], v[148:151], v[160:163], v[68:71]
    ds_read_b128 v[136:139], v176 offset:36864
    ds_read_b128 v[140:143], v176 offset:38912
    v_mfma_f32_16x16x32_bf16 v[96:99], v[152:155], v[160:163], v[96:99]
    v_mfma_f32_16x16x32_bf16 v[100:103], v[156:159], v[160:163], v[100:103]
    ds_read_b64_tr_b16 v[160:161], v182 offset:0
    ds_read_b64_tr_b16 v[162:163], v182 offset:2048
    v_mfma_f32_16x16x32_bf16 v[80:83], v[144:147], v[164:167], v[80:83]
    v_mfma_f32_16x16x32_bf16 v[84:87], v[148:151], v[164:167], v[84:87]
    s_add_u32 m0, s82, 65536
    s_nop 0
    buffer_load_dwordx4 v188, s[56:59], s79 offen lds
    v_mfma_f32_16x16x32_bf16 v[112:115], v[152:155], v[164:167], v[112:115]
    v_mfma_f32_16x16x32_bf16 v[116:119], v[156:159], v[164:167], v[116:119]
    ds_read_b64_tr_b16 v[164:165], v183 offset:0
    ds_read_b64_tr_b16 v[166:167], v183 offset:2048
    v_mfma_f32_16x16x32_bf16 v[72:75], v[144:147], v[168:171], v[72:75]
    v_mfma_f32_16x16x32_bf16 v[76:79], v[148:151], v[168:171], v[76:79]
    s_add_u32 m0, s82, 66560
    s_nop 0
    buffer_load_dwordx4 v197, s[56:59], s79 offen lds
    s_add_u32 s79, s79, 128
    v_mfma_f32_16x16x32_bf16 v[104:107], v[152:155], v[168:171], v[104:107]
    v_mfma_f32_16x16x32_bf16 v[108:111], v[156:159], v[168:171], v[108:111]
    ds_read_b64_tr_b16 v[168:169], v240 offset:0
    ds_read_b64_tr_b16 v[170:171], v240 offset:2048
    v_mfma_f32_16x16x32_bf16 v[88:91], v[144:147], v[172:175], v[88:91]
    v_mfma_f32_16x16x32_bf16 v[92:95], v[148:151], v[172:175], v[92:95]
    s_add_u32 m0, s82, 67584
    s_nop 0
    buffer_load_dwordx4 v188, s[56:59], s80 offen lds
    v_mfma_f32_16x16x32_bf16 v[120:123], v[152:155], v[172:175], v[120:123]
    v_mfma_f32_16x16x32_bf16 v[124:127], v[156:159], v[172:175], v[124:127]
    ds_read_b64_tr_b16 v[172:173], v241 offset:0
    ds_read_b64_tr_b16 v[174:175], v241 offset:2048
    s_waitcnt lgkmcnt(6)
    v_mfma_f32_16x16x32_bf16 v[0:3], v[128:131], v[160:163], v[0:3]
    ds_read_b128 v[144:147], v176 offset:40960
    ds_read_b128 v[148:151], v176 offset:43008
    v_mfma_f32_16x16x32_bf16 v[4:7], v[132:135], v[160:163], v[4:7]
    v_mfma_f32_16x16x32_bf16 v[32:35], v[136:139], v[160:163], v[32:35]
    ds_read_b128 v[152:155], v176 offset:45056
    ds_read_b128 v[156:159], v176 offset:47104
    v_mfma_f32_16x16x32_bf16 v[36:39], v[140:143], v[160:163], v[36:39]
    s_waitcnt lgkmcnt(8)
    v_mfma_f32_16x16x32_bf16 v[16:19], v[128:131], v[164:167], v[16:19]
    v_mfma_f32_16x16x32_bf16 v[20:23], v[132:135], v[164:167], v[20:23]
    s_add_u32 m0, s82, 68608
    s_nop 0
    buffer_load_dwordx4 v197, s[56:59], s80 offen lds
    s_add_u32 s80, s80, 128
    v_mfma_f32_16x16x32_bf16 v[48:51], v[136:139], v[164:167], v[48:51]
    v_mfma_f32_16x16x32_bf16 v[52:55], v[140:143], v[164:167], v[52:55]
    s_add_u32 m0, s83, 49152
    s_nop 0
    buffer_load_dwordx4 v189, s[60:63], s81 offen lds
    s_waitcnt lgkmcnt(6)
    v_mfma_f32_16x16x32_bf16 v[8:11], v[128:131], v[168:171], v[8:11]
    v_mfma_f32_16x16x32_bf16 v[12:15], v[132:135], v[168:171], v[12:15]
    s_add_u32 m0, s83, 50176
    s_nop 0
    buffer_load_dwordx4 v190, s[60:63], s81 offen lds
    s_add_u32 s81, s81, 262144
    v_mfma_f32_16x16x32_bf16 v[40:43], v[136:139], v[168:171], v[40:43]
    v_mfma_f32_16x16x32_bf16 v[44:47], v[140:143], v[168:171], v[44:47]
    s_waitcnt lgkmcnt(4)
    v_mfma_f32_16x16x32_bf16 v[24:27], v[128:131], v[172:175], v[24:27]
    v_mfma_f32_16x16x32_bf16 v[28:31], v[132:135], v[172:175], v[28:31]
    v_mfma_f32_16x16x32_bf16 v[56:59], v[136:139], v[172:175], v[56:59]
    v_mfma_f32_16x16x32_bf16 v[60:63], v[140:143], v[172:175], v[60:63]
    s_waitcnt lgkmcnt(0)
    v_mfma_f32_16x16x32_bf16 v[64:67], v[144:147], v[160:163], v[64:67]
    s_waitcnt vmcnt(18)
    s_barrier
    ds_read_b128 v[128:131], v181 offset:32768
    ds_read_b128 v[132:135], v181 offset:34816
    v_mfma_f32_16x16x32_bf16 v[68:71], v[148:151], v[160:163], v[68:71]
    ds_read_b128 v[136:139], v181 offset:36864
    ds_read_b128 v[140:143], v181 offset:38912
    v_mfma_f32_16x16x32_bf16 v[96:99], v[152:155], v[160:163], v[96:99]
    v_mfma_f32_16x16x32_bf16 v[100:103], v[156:159], v[160:163], v[100:103]
    ds_read_b64_tr_b16 v[160:161], v177 offset:0
    ds_read_b64_tr_b16 v[162:163], v177 offset:2048
    v_mfma_f32_16x16x32_bf16 v[80:83], v[144:147], v[164:167], v[80:83]
    v_mfma_f32_16x16x32_bf16 v[84:87], v[148:151], v[164:167], v[84:87]
    s_add_u32 m0, s83, 131072
    s_nop 0
    buffer_load_dwordx4 v189, s[60:63], s81 offen lds
    v_mfma_f32_16x16x32_bf16 v[112:115], v[152:155], v[164:167], v[112:115]
    v_mfma_f32_16x16x32_bf16 v[116:119], v[156:159], v[164:167], v[116:119]
    ds_read_b64_tr_b16 v[164:165], v178 offset:0
    ds_read_b64_tr_b16 v[166:167], v178 offset:2048
    v_mfma_f32_16x16x32_bf16 v[72:75], v[144:147], v[168:171], v[72:75]
    v_mfma_f32_16x16x32_bf16 v[76:79], v[148:151], v[168:171], v[76:79]
    s_add_u32 m0, s83, 132096
    s_nop 0
    buffer_load_dwordx4 v190, s[60:63], s81 offen lds
    s_add_u32 s81, s81, 262144
    v_mfma_f32_16x16x32_bf16 v[104:107], v[152:155], v[168:171], v[104:107]
    v_mfma_f32_16x16x32_bf16 v[108:111], v[156:159], v[168:171], v[108:111]
    ds_read_b64_tr_b16 v[168:169], v179 offset:0
    ds_read_b64_tr_b16 v[170:171], v179 offset:2048
    v_mfma_f32_16x16x32_bf16 v[88:91], v[144:147], v[172:175], v[88:91]
    v_mfma_f32_16x16x32_bf16 v[92:95], v[148:151], v[172:175], v[92:95]
    v_mfma_f32_16x16x32_bf16 v[120:123], v[152:155], v[172:175], v[120:123]
    v_mfma_f32_16x16x32_bf16 v[124:127], v[156:159], v[172:175], v[124:127]
    ds_read_b64_tr_b16 v[172:173], v180 offset:0
    ds_read_b64_tr_b16 v[174:175], v180 offset:2048
    s_waitcnt lgkmcnt(6)
    v_mfma_f32_16x16x32_bf16 v[0:3], v[128:131], v[160:163], v[0:3]
    ds_read_b128 v[144:147], v181 offset:40960
    ds_read_b128 v[148:151], v181 offset:43008
    v_mfma_f32_16x16x32_bf16 v[4:7], v[132:135], v[160:163], v[4:7]
    v_mfma_f32_16x16x32_bf16 v[32:35], v[136:139], v[160:163], v[32:35]
    ds_read_b128 v[152:155], v181 offset:45056
    ds_read_b128 v[156:159], v181 offset:47104
    v_mfma_f32_16x16x32_bf16 v[36:39], v[140:143], v[160:163], v[36:39]
    s_waitcnt lgkmcnt(8)
    v_mfma_f32_16x16x32_bf16 v[16:19], v[128:131], v[164:167], v[16:19]
    v_mfma_f32_16x16x32_bf16 v[20:23], v[132:135], v[164:167], v[20:23]
    v_mfma_f32_16x16x32_bf16 v[48:51], v[136:139], v[164:167], v[48:51]
    v_mfma_f32_16x16x32_bf16 v[52:55], v[140:143], v[164:167], v[52:55]
    s_waitcnt lgkmcnt(6)
    v_mfma_f32_16x16x32_bf16 v[8:11], v[128:131], v[168:171], v[8:11]
    v_mfma_f32_16x16x32_bf16 v[12:15], v[132:135], v[168:171], v[12:15]
    v_mfma_f32_16x16x32_bf16 v[40:43], v[136:139], v[168:171], v[40:43]
    v_mfma_f32_16x16x32_bf16 v[44:47], v[140:143], v[168:171], v[44:47]
    s_waitcnt lgkmcnt(4)
    v_mfma_f32_16x16x32_bf16 v[24:27], v[128:131], v[172:175], v[24:27]
    v_mfma_f32_16x16x32_bf16 v[28:31], v[132:135], v[172:175], v[28:31]
    v_mfma_f32_16x16x32_bf16 v[56:59], v[136:139], v[172:175], v[56:59]
    v_mfma_f32_16x16x32_bf16 v[60:63], v[140:143], v[172:175], v[60:63]
    s_waitcnt lgkmcnt(0)
    v_mfma_f32_16x16x32_bf16 v[64:67], v[144:147], v[160:163], v[64:67]
    s_waitcnt vmcnt(4)
    s_barrier
    buffer_store_dword v195, v196, s[12:15], s85 offen sc1
    ds_read_b128 v[128:131], v176 offset:0
    ds_read_b128 v[132:135], v176 offset:2048
    v_mfma_f32_16x16x32_bf16 v[68:71], v[148:151], v[160:163], v[68:71]
    ds_read_b128 v[136:139], v176 offset:4096
    ds_read_b128 v[140:143], v176 offset:6144
    v_mfma_f32_16x16x32_bf16 v[96:99], v[152:155], v[160:163], v[96:99]
    v_mfma_f32_16x16x32_bf16 v[100:103], v[156:159], v[160:163], v[100:103]
    ds_read_b64_tr_b16 v[160:161], v177 offset:16384
    ds_read_b64_tr_b16 v[162:163], v177 offset:18432
    v_mfma_f32_16x16x32_bf16 v[80:83], v[144:147], v[164:167], v[80:83]
    v_mfma_f32_16x16x32_bf16 v[84:87], v[148:151], v[164:167], v[84:87]
    s_add_u32 m0, s82, 98304
    s_nop 0
    buffer_load_dwordx4 v188, s[56:59], s79 offen lds
    v_mfma_f32_16x16x32_bf16 v[112:115], v[152:155], v[164:167], v[112:115]
    v_mfma_f32_16x16x32_bf16 v[116:119], v[156:159], v[164:167], v[116:119]
    ds_read_b64_tr_b16 v[164:165], v178 offset:16384
    ds_read_b64_tr_b16 v[166:167], v178 offset:18432
    v_mfma_f32_16x16x32_bf16 v[72:75], v[144:147], v[168:171], v[72:75]
    v_mfma_f32_16x16x32_bf16 v[76:79], v[148:151], v[168:171], v[76:79]
    s_add_u32 m0, s82, 99328
    s_nop 0
    buffer_load_dwordx4 v197, s[56:59], s79 offen lds
    s_add_u32 s79, s79, 128
    v_mfma_f32_16x16x32_bf16 v[104:107], v[152:155], v[168:171], v[104:107]
    v_mfma_f32_16x16x32_bf16 v[108:111], v[156:159], v[168:171], v[108:111]
    ds_read_b64_tr_b16 v[168:169], v179 offset:16384
    ds_read_b64_tr_b16 v[170:171], v179 offset:18432
    v_mfma_f32_16x16x32_bf16 v[88:91], v[144:147], v[172:175], v[88:91]
    v_mfma_f32_16x16x32_bf16 v[92:95], v[148:151], v[172:175], v[92:95]
    s_add_u32 m0, s82, 100352
    s_nop 0
    buffer_load_dwordx4 v188, s[56:59], s80 offen lds
    v_mfma_f32_16x16x32_bf16 v[120:123], v[152:155], v[172:175], v[120:123]
    v_mfma_f32_16x16x32_bf16 v[124:127], v[156:159], v[172:175], v[124:127]
    ds_read_b64_tr_b16 v[172:173], v180 offset:16384
    ds_read_b64_tr_b16 v[174:175], v180 offset:18432
    s_waitcnt lgkmcnt(6)
    v_mfma_f32_16x16x32_bf16 v[0:3], v[128:131], v[160:163], v[0:3]
    ds_read_b128 v[144:147], v176 offset:8192
    ds_read_b128 v[148:151], v176 offset:10240
    v_mfma_f32_16x16x32_bf16 v[4:7], v[132:135], v[160:163], v[4:7]
    v_mfma_f32_16x16x32_bf16 v[32:35], v[136:139], v[160:163], v[32:35]
    ds_read_b128 v[152:155], v176 offset:12288
    ds_read_b128 v[156:159], v176 offset:14336
    v_mfma_f32_16x16x32_bf16 v[36:39], v[140:143], v[160:163], v[36:39]
    s_waitcnt lgkmcnt(8)
    v_mfma_f32_16x16x32_bf16 v[16:19], v[128:131], v[164:167], v[16:19]
    v_mfma_f32_16x16x32_bf16 v[20:23], v[132:135], v[164:167], v[20:23]
    s_add_u32 m0, s82, 101376
    s_nop 0
    buffer_load_dwordx4 v197, s[56:59], s80 offen lds
    s_add_u32 s80, s80, 128
    v_mfma_f32_16x16x32_bf16 v[48:51], v[136:139], v[164:167], v[48:51]
    v_mfma_f32_16x16x32_bf16 v[52:55], v[140:143], v[164:167], v[52:55]
    s_waitcnt lgkmcnt(6)
    v_mfma_f32_16x16x32_bf16 v[8:11], v[128:131], v[168:171], v[8:11]
    v_mfma_f32_16x16x32_bf16 v[12:15], v[132:135], v[168:171], v[12:15]
    v_mfma_f32_16x16x32_bf16 v[40:43], v[136:139], v[168:171], v[40:43]
    v_mfma_f32_16x16x32_bf16 v[44:47], v[140:143], v[168:171], v[44:47]
    s_waitcnt lgkmcnt(4)
    v_mfma_f32_16x16x32_bf16 v[24:27], v[128:131], v[172:175], v[24:27]
    v_mfma_f32_16x16x32_bf16 v[28:31], v[132:135], v[172:175], v[28:31]
    v_mfma_f32_16x16x32_bf16 v[56:59], v[136:139], v[172:175], v[56:59]
    v_mfma_f32_16x16x32_bf16 v[60:63], v[140:143], v[172:175], v[60:63]
    s_waitcnt lgkmcnt(0)
    v_mfma_f32_16x16x32_bf16 v[64:67], v[144:147], v[160:163], v[64:67]
    s_waitcnt vmcnt(16)
    s_barrier
    ds_read_b128 v[128:131], v181 offset:0
    ds_read_b128 v[132:135], v181 offset:2048
    v_mfma_f32_16x16x32_bf16 v[68:71], v[148:151], v[160:163], v[68:71]
    ds_read_b128 v[136:139], v181 offset:4096
    ds_read_b128 v[140:143], v181 offset:6144
    v_mfma_f32_16x16x32_bf16 v[96:99], v[152:155], v[160:163], v[96:99]
    v_mfma_f32_16x16x32_bf16 v[100:103], v[156:159], v[160:163], v[100:103]
    ds_read_b64_tr_b16 v[160:161], v177 offset:32768
    ds_read_b64_tr_b16 v[162:163], v177 offset:34816
    v_mfma_f32_16x16x32_bf16 v[80:83], v[144:147], v[164:167], v[80:83]
    v_mfma_f32_16x16x32_bf16 v[84:87], v[148:151], v[164:167], v[84:87]
    s_add_u32 m0, s33, 0
    s_add_u32 s49, s34, 0
    buffer_load_dwordx4 v245, s[8:11], s49 offen lds
    v_mfma_f32_16x16x32_bf16 v[112:115], v[152:155], v[164:167], v[112:115]
    v_mfma_f32_16x16x32_bf16 v[116:119], v[156:159], v[164:167], v[116:119]
    ds_read_b64_tr_b16 v[164:165], v178 offset:32768
    ds_read_b64_tr_b16 v[166:167], v178 offset:34816
    v_mfma_f32_16x16x32_bf16 v[72:75], v[144:147], v[168:171], v[72:75]
    v_mfma_f32_16x16x32_bf16 v[76:79], v[148:151], v[168:171], v[76:79]
    s_add_u32 m0, s33, 1024
    s_add_u32 s49, s34, 32768
    buffer_load_dwordx4 v245, s[8:11], s49 offen lds
    v_mfma_f32_16x16x32_bf16 v[104:107], v[152:155], v[168:171], v[104:107]
    v_mfma_f32_16x16x32_bf16 v[108:111], v[156:159], v[168:171], v[108:111]
    ds_read_b64_tr_b16 v[168:169], v179 offset:32768
    ds_read_b64_tr_b16 v[170:171], v179 offset:34816
    v_mfma_f32_16x16x32_bf16 v[88:91], v[144:147], v[172:175], v[88:91]
    v_mfma_f32_16x16x32_bf16 v[92:95], v[148:151], v[172:175], v[92:95]
    s_add_u32 m0, s33, 2048
    s_add_u32 s49, s34, 65536
    buffer_load_dwordx4 v244, s[8:11], s49 offen lds
    v_mfma_f32_16x16x32_bf16 v[120:123], v[152:155], v[172:175], v[120:123]
    v_mfma_f32_16x16x32_bf16 v[124:127], v[156:159], v[172:175], v[124:127]
    ds_read_b64_tr_b16 v[172:173], v180 offset:32768
    ds_read_b64_tr_b16 v[174:175], v180 offset:34816
    s_waitcnt lgkmcnt(6)
    v_mfma_f32_16x16x32_bf16 v[0:3], v[128:131], v[160:163], v[0:3]
    ds_read_b128 v[144:147], v181 offset:8192
    ds_read_b128 v[148:151], v181 offset:10240
    v_mfma_f32_16x16x32_bf16 v[4:7], v[132:135], v[160:163], v[4:7]
    v_mfma_f32_16x16x32_bf16 v[32:35], v[136:139], v[160:163], v[32:35]
    ds_read_b128 v[152:155], v181 offset:12288
    ds_read_b128 v[156:159], v181 offset:14336
    v_mfma_f32_16x16x32_bf16 v[36:39], v[140:143], v[160:163], v[36:39]
    s_waitcnt lgkmcnt(8)
    v_mfma_f32_16x16x32_bf16 v[16:19], v[128:131], v[164:167], v[16:19]
    v_mfma_f32_16x16x32_bf16 v[20:23], v[132:135], v[164:167], v[20:23]
    s_add_u32 m0, s33, 3072
    s_add_u32 s49, s34, 98304
    buffer_load_dwordx4 v244, s[8:11], s49 offen lds
    v_mfma_f32_16x16x32_bf16 v[48:51], v[136:139], v[164:167], v[48:51]
    v_mfma_f32_16x16x32_bf16 v[52:55], v[140:143], v[164:167], v[52:55]
    s_waitcnt lgkmcnt(6)
    v_mfma_f32_16x16x32_bf16 v[8:11], v[128:131], v[168:171], v[8:11]
    v_mfma_f32_16x16x32_bf16 v[12:15], v[132:135], v[168:171], v[12:15]
    v_mfma_f32_16x16x32_bf16 v[40:43], v[136:139], v[168:171], v[40:43]
    v_mfma_f32_16x16x32_bf16 v[44:47], v[140:143], v[168:171], v[44:47]
    s_waitcnt lgkmcnt(4)
    v_mfma_f32_16x16x32_bf16 v[24:27], v[128:131], v[172:175], v[24:27]
    v_mfma_f32_16x16x32_bf16 v[28:31], v[132:135], v[172:175], v[28:31]
    v_mfma_f32_16x16x32_bf16 v[56:59], v[136:139], v[172:175], v[56:59]
    v_mfma_f32_16x16x32_bf16 v[60:63], v[140:143], v[172:175], v[60:63]
    s_waitcnt lgkmcnt(0)
    v_mfma_f32_16x16x32_bf16 v[64:67], v[144:147], v[160:163], v[64:67]
    s_waitcnt vmcnt(4)
    s_barrier
    ds_read_b128 v[128:131], v176 offset:32768
    ds_read_b128 v[132:135], v176 offset:34816
    v_mfma_f32_16x16x32_bf16 v[68:71], v[148:151], v[160:163], v[68:71]
    ds_read_b128 v[136:139], v176 offset:36864
    ds_read_b128 v[140:143], v176 offset:38912
    v_mfma_f32_16x16x32_bf16 v[96:99], v[152:155], v[160:163], v[96:99]
    v_mfma_f32_16x16x32_bf16 v[100:103], v[156:159], v[160:163], v[100:103]
    ds_read_b64_tr_b16 v[160:161], v177 offset:49152
    ds_read_b64_tr_b16 v[162:163], v177 offset:51200
    v_mfma_f32_16x16x32_bf16 v[80:83], v[144:147], v[164:167], v[80:83]
    v_mfma_f32_16x16x32_bf16 v[84:87], v[148:151], v[164:167], v[84:87]
    buffer_load_dword v200, v184, s[12:15], s67 offen offset:0 sc1
    v_mfma_f32_16x16x32_bf16 v[112:115], v[152:155], v[164:167], v[112:115]
    v_mfma_f32_16x16x32_bf16 v[116:119], v[156:159], v[164:167], v[116:119]
    ds_read_b64_tr_b16 v[164:165], v178 offset:49152
    ds_read_b64_tr_b16 v[166:167], v178 offset:51200
    v_mfma_f32_16x16x32_bf16 v[72:75], v[144:147], v[168:171], v[72:75]
    v_mfma_f32_16x16x32_bf16 v[76:79], v[148:151], v[168:171], v[76:79]
    buffer_load_dword v201, v185, s[12:15], s67 offen offset:0 sc1
    v_mfma_f32_16x16x32_bf16 v[104:107], v[152:155], v[168:171], v[104:107]
    v_mfma_f32_16x16x32_bf16 v[108:111], v[156:159], v[168:171], v[108:111]
    ds_read_b64_tr_b16 v[168:169], v179 offset:49152
    ds_read_b64_tr_b16 v[170:171], v179 offset:51200
    v_mfma_f32_16x16x32_bf16 v[88:91], v[144:147], v[172:175], v[88:91]
    v_mfma_f32_16x16x32_bf16 v[92:95], v[148:151], v[172:175], v[92:95]
    buffer_load_dword v202, v186, s[12:15], s67 offen offset:0 sc1
    v_mfma_f32_16x16x32_bf16 v[120:123], v[152:155], v[172:175], v[120:123]
    v_mfma_f32_16x16x32_bf16 v[124:127], v[156:159], v[172:175], v[124:127]
    ds_read_b64_tr_b16 v[172:173], v180 offset:49152
    ds_read_b64_tr_b16 v[174:175], v180 offset:51200
    s_waitcnt lgkmcnt(6)
    v_mfma_f32_16x16x32_bf16 v[0:3], v[128:131], v[160:163], v[0:3]
    ds_read_b128 v[144:147], v176 offset:40960
    ds_read_b128 v[148:151], v176 offset:43008
    v_mfma_f32_16x16x32_bf16 v[4:7], v[132:135], v[160:163], v[4:7]
    v_mfma_f32_16x16x32_bf16 v[32:35], v[136:139], v[160:163], v[32:35]
    ds_read_b128 v[152:155], v176 offset:45056
    ds_read_b128 v[156:159], v176 offset:47104
    v_mfma_f32_16x16x32_bf16 v[36:39], v[140:143], v[160:163], v[36:39]
    s_waitcnt lgkmcnt(8)
    v_mfma_f32_16x16x32_bf16 v[16:19], v[128:131], v[164:167], v[16:19]
    v_mfma_f32_16x16x32_bf16 v[20:23], v[132:135], v[164:167], v[20:23]
    buffer_load_dword v203, v187, s[12:15], s67 offen offset:0 sc1
    v_mfma_f32_16x16x32_bf16 v[48:51], v[136:139], v[164:167], v[48:51]
    v_mfma_f32_16x16x32_bf16 v[52:55], v[140:143], v[164:167], v[52:55]
    s_add_u32 m0, s33, 65536
    s_add_u32 s49, s34, 2097152
    buffer_load_dwordx4 v245, s[8:11], s49 offen lds
    s_waitcnt lgkmcnt(6)
    v_mfma_f32_16x16x32_bf16 v[8:11], v[128:131], v[168:171], v[8:11]
    v_mfma_f32_16x16x32_bf16 v[12:15], v[132:135], v[168:171], v[12:15]
    s_add_u32 m0, s33, 66560
    s_add_u32 s49, s34, 2129920
    buffer_load_dwordx4 v245, s[8:11], s49 offen lds
    v_mfma_f32_16x16x32_bf16 v[40:43], v[136:139], v[168:171], v[40:43]
    v_mfma_f32_16x16x32_bf16 v[44:47], v[140:143], v[168:171], v[44:47]
    s_add_u32 m0, s33, 67584
    s_add_u32 s49, s34, 2162688
    buffer_load_dwordx4 v244, s[8:11], s49 offen lds
    s_waitcnt lgkmcnt(4)
    v_mfma_f32_16x16x32_bf16 v[24:27], v[128:131], v[172:175], v[24:27]
    v_mfma_f32_16x16x32_bf16 v[28:31], v[132:135], v[172:175], v[28:31]
    s_add_u32 m0, s33, 68608
    s_add_u32 s49, s34, 2195456
    buffer_load_dwordx4 v244, s[8:11], s49 offen lds
    v_mfma_f32_16x16x32_bf16 v[56:59], v[136:139], v[172:175], v[56:59]
    v_mfma_f32_16x16x32_bf16 v[60:63], v[140:143], v[172:175], v[60:63]
    s_waitcnt lgkmcnt(0)
    v_mfma_f32_16x16x32_bf16 v[64:67], v[144:147], v[160:163], v[64:67]
    s_cmp_eq_u32 s36, 4
    s_cbranch_scc0 parallel_sum__compressed_kv_cla__moe_arch_mod__prompt_kernel_p1A_lnc1
    s_waitcnt vmcnt(4)
    s_mov_b32 s35, 0x40000
parallel_sum__compressed_kv_cla__moe_arch_mod__prompt_kernel_chk_ln1:
    v_xor_b32 v200, s87, v200
    v_xor_b32 v201, s87, v201
    v_xor_b32 v202, s87, v202
    v_xor_b32 v203, s87, v203
    v_or_b32 v200, v200, v201
    v_or_b32 v200, v200, v202
    v_or_b32 v200, v200, v203
    v_cmp_ne_u32 s[84:85], 0, v200
    s_nop 1
    s_cmp_eq_u64 s[84:85], 0
    s_cbranch_scc1 parallel_sum__compressed_kv_cla__moe_arch_mod__prompt_kernel_chk_ln1_ok
    s_sub_u32 s35, s35, 1
    s_cbranch_scc1 parallel_sum__compressed_kv_cla__moe_arch_mod__prompt_kernel_chk_ln1_ok
    s_sleep 1
    buffer_load_dword v200, v184, s[12:15], s67 offen offset:0 sc1
    buffer_load_dword v201, v185, s[12:15], s67 offen offset:0 sc1
    buffer_load_dword v202, v186, s[12:15], s67 offen offset:0 sc1
    buffer_load_dword v203, v187, s[12:15], s67 offen offset:0 sc1
    s_waitcnt vmcnt(0)
    s_branch parallel_sum__compressed_kv_cla__moe_arch_mod__prompt_kernel_chk_ln1
parallel_sum__compressed_kv_cla__moe_arch_mod__prompt_kernel_chk_ln1_ok:
parallel_sum__compressed_kv_cla__moe_arch_mod__prompt_kernel_p1A_lnc1:
    s_waitcnt vmcnt(17)
    s_barrier
    ds_read_b128 v[128:131], v181 offset:32768
    ds_read_b128 v[132:135], v181 offset:34816
    v_mfma_f32_16x16x32_bf16 v[68:71], v[148:151], v[160:163], v[68:71]
    ds_read_b128 v[136:139], v181 offset:36864
    ds_read_b128 v[140:143], v181 offset:38912
    v_mfma_f32_16x16x32_bf16 v[96:99], v[152:155], v[160:163], v[96:99]
    v_mfma_f32_16x16x32_bf16 v[100:103], v[156:159], v[160:163], v[100:103]
    ds_read_b64_tr_b16 v[160:161], v182 offset:0
    ds_read_b64_tr_b16 v[162:163], v182 offset:2048
    v_mfma_f32_16x16x32_bf16 v[80:83], v[144:147], v[164:167], v[80:83]
    v_mfma_f32_16x16x32_bf16 v[84:87], v[148:151], v[164:167], v[84:87]
    s_add_u32 m0, s33, 32768
    s_add_u32 s49, s34, 1048576
    buffer_load_dwordx4 v245, s[8:11], s49 offen lds
    v_mfma_f32_16x16x32_bf16 v[112:115], v[152:155], v[164:167], v[112:115]
    v_mfma_f32_16x16x32_bf16 v[116:119], v[156:159], v[164:167], v[116:119]
    ds_read_b64_tr_b16 v[164:165], v183 offset:0
    ds_read_b64_tr_b16 v[166:167], v183 offset:2048
    v_mfma_f32_16x16x32_bf16 v[72:75], v[144:147], v[168:171], v[72:75]
    v_mfma_f32_16x16x32_bf16 v[76:79], v[148:151], v[168:171], v[76:79]
    s_add_u32 m0, s33, 33792
    s_add_u32 s49, s34, 1081344
    buffer_load_dwordx4 v245, s[8:11], s49 offen lds
    v_mfma_f32_16x16x32_bf16 v[104:107], v[152:155], v[168:171], v[104:107]
    v_mfma_f32_16x16x32_bf16 v[108:111], v[156:159], v[168:171], v[108:111]
    ds_read_b64_tr_b16 v[168:169], v240 offset:0
    ds_read_b64_tr_b16 v[170:171], v240 offset:2048
    v_mfma_f32_16x16x32_bf16 v[88:91], v[144:147], v[172:175], v[88:91]
    v_mfma_f32_16x16x32_bf16 v[92:95], v[148:151], v[172:175], v[92:95]
    s_add_u32 m0, s33, 34816
    s_add_u32 s49, s34, 1114112
    buffer_load_dwordx4 v244, s[8:11], s49 offen lds
    v_mfma_f32_16x16x32_bf16 v[120:123], v[152:155], v[172:175], v[120:123]
    v_mfma_f32_16x16x32_bf16 v[124:127], v[156:159], v[172:175], v[124:127]
    ds_read_b64_tr_b16 v[172:173], v241 offset:0
    ds_read_b64_tr_b16 v[174:175], v241 offset:2048
    s_waitcnt lgkmcnt(6)
    v_mfma_f32_16x16x32_bf16 v[0:3], v[128:131], v[160:163], v[0:3]
    ds_read_b128 v[144:147], v181 offset:40960
    ds_read_b128 v[148:151], v181 offset:43008
    v_mfma_f32_16x16x32_bf16 v[4:7], v[132:135], v[160:163], v[4:7]
    v_mfma_f32_16x16x32_bf16 v[32:35], v[136:139], v[160:163], v[32:35]
    ds_read_b128 v[152:155], v181 offset:45056
    ds_read_b128 v[156:159], v181 offset:47104
    v_mfma_f32_16x16x32_bf16 v[36:39], v[140:143], v[160:163], v[36:39]
    s_waitcnt lgkmcnt(8)
    v_mfma_f32_16x16x32_bf16 v[16:19], v[128:131], v[164:167], v[16:19]
    v_mfma_f32_16x16x32_bf16 v[20:23], v[132:135], v[164:167], v[20:23]
    s_add_u32 m0, s33, 35840
    s_add_u32 s49, s34, 1146880
    buffer_load_dwordx4 v244, s[8:11], s49 offen lds
    v_mfma_f32_16x16x32_bf16 v[48:51], v[136:139], v[164:167], v[48:51]
    v_mfma_f32_16x16x32_bf16 v[52:55], v[140:143], v[164:167], v[52:55]
    buffer_load_dwordx4 v[192:195], v255, s[12:15], s55 offen offset:0 sc1
    s_waitcnt lgkmcnt(6)
    v_mfma_f32_16x16x32_bf16 v[8:11], v[128:131], v[168:171], v[8:11]
    v_mfma_f32_16x16x32_bf16 v[12:15], v[132:135], v[168:171], v[12:15]
    buffer_load_dwordx4 v[196:199], v255, s[12:15], s55 offen offset:256 sc1
    v_mfma_f32_16x16x32_bf16 v[40:43], v[136:139], v[168:171], v[40:43]
    v_mfma_f32_16x16x32_bf16 v[44:47], v[140:143], v[168:171], v[44:47]
    buffer_load_dwordx4 v[200:203], v255, s[12:15], s55 offen offset:2048 sc1
    s_waitcnt lgkmcnt(4)
    v_mfma_f32_16x16x32_bf16 v[24:27], v[128:131], v[172:175], v[24:27]
    v_mfma_f32_16x16x32_bf16 v[28:31], v[132:135], v[172:175], v[28:31]
    buffer_load_dwordx4 v[204:207], v255, s[12:15], s55 offen offset:2304 sc1
    v_mfma_f32_16x16x32_bf16 v[56:59], v[136:139], v[172:175], v[56:59]
    v_mfma_f32_16x16x32_bf16 v[60:63], v[140:143], v[172:175], v[60:63]
    s_add_u32 s55, s55, 4096
    buffer_load_dwordx4 v[208:211], v255, s[12:15], s55 offen offset:0 sc1
    s_waitcnt lgkmcnt(0)
    v_mfma_f32_16x16x32_bf16 v[64:67], v[144:147], v[160:163], v[64:67]
    v_mfma_f32_16x16x32_bf16 v[68:71], v[148:151], v[160:163], v[68:71]
    buffer_load_dwordx4 v[212:215], v255, s[12:15], s55 offen offset:256 sc1
    v_mfma_f32_16x16x32_bf16 v[96:99], v[152:155], v[160:163], v[96:99]
    v_mfma_f32_16x16x32_bf16 v[100:103], v[156:159], v[160:163], v[100:103]
    v_mfma_f32_16x16x32_bf16 v[80:83], v[144:147], v[164:167], v[80:83]
    v_mfma_f32_16x16x32_bf16 v[84:87], v[148:151], v[164:167], v[84:87]
    v_mfma_f32_16x16x32_bf16 v[112:115], v[152:155], v[164:167], v[112:115]
    v_mfma_f32_16x16x32_bf16 v[116:119], v[156:159], v[164:167], v[116:119]
    v_mfma_f32_16x16x32_bf16 v[72:75], v[144:147], v[168:171], v[72:75]
    v_mfma_f32_16x16x32_bf16 v[76:79], v[148:151], v[168:171], v[76:79]
    v_mfma_f32_16x16x32_bf16 v[104:107], v[152:155], v[168:171], v[104:107]
    v_mfma_f32_16x16x32_bf16 v[108:111], v[156:159], v[168:171], v[108:111]
    v_mfma_f32_16x16x32_bf16 v[88:91], v[144:147], v[172:175], v[88:91]
    v_mfma_f32_16x16x32_bf16 v[92:95], v[148:151], v[172:175], v[92:95]
    v_mfma_f32_16x16x32_bf16 v[120:123], v[152:155], v[172:175], v[120:123]
    v_mfma_f32_16x16x32_bf16 v[124:127], v[156:159], v[172:175], v[124:127]
    s_branch parallel_sum__compressed_kv_cla__moe_arch_mod__prompt_kernel_p1_epi
parallel_sum__compressed_kv_cla__moe_arch_mod__prompt_kernel_p1_epi:
    s_cmp_lt_u32 s36, 4
    s_cbranch_scc0 parallel_sum__compressed_kv_cla__moe_arch_mod__prompt_kernel_B
    s_cmp_lt_u32 s77, 2
    s_cbranch_scc0 parallel_sum__compressed_kv_cla__moe_arch_mod__prompt_kernel_A_qslow
    buffer_load_dwordx4 v[216:219], v255, s[12:15], s55 offen offset:2048 sc1
    buffer_load_dwordx4 v[220:223], v255, s[12:15], s55 offen offset:2304 sc1
    s_add_u32 s55, s55, 4096
    buffer_load_dwordx4 v[224:227], v255, s[12:15], s55 offen offset:0 sc1
    buffer_load_dwordx4 v[228:231], v255, s[12:15], s55 offen offset:256 sc1
    buffer_load_dwordx4 v[232:235], v255, s[12:15], s55 offen offset:2048 sc1
    buffer_load_dwordx4 v[236:239], v255, s[12:15], s55 offen offset:2304 sc1
    s_nop 7
    v_mul_f32 v64, s69, v64
    v_mul_f32 v65, s69, v65
    v_mul_f32 v66, s69, v66
    v_mul_f32 v67, s69, v67
    v_mul_f32 v80, s69, v80
    v_mul_f32 v81, s69, v81
    v_mul_f32 v82, s69, v82
    v_mul_f32 v83, s69, v83
    v_cvt_pk_bf16_f32 v128, v64, v65
    v_cvt_pk_bf16_f32 v129, v66, v67
    v_cvt_pk_bf16_f32 v130, v80, v81
    v_cvt_pk_bf16_f32 v131, v82, v83
    s_nop 1
    v_permlane32_swap_b32 v128, v130
    v_permlane32_swap_b32 v129, v131
    v_mul_f32 v68, s69, v68
    v_mul_f32 v69, s69, v69
    v_mul_f32 v70, s69, v70
    v_mul_f32 v71, s69, v71
    v_mul_f32 v84, s69, v84
    v_mul_f32 v85, s69, v85
    v_mul_f32 v86, s69, v86
    v_mul_f32 v87, s69, v87
    v_cvt_pk_bf16_f32 v132, v68, v69
    v_cvt_pk_bf16_f32 v133, v70, v71
    v_cvt_pk_bf16_f32 v134, v84, v85
    v_cvt_pk_bf16_f32 v135, v86, v87
    s_nop 1
    v_permlane32_swap_b32 v132, v134
    v_permlane32_swap_b32 v133, v135
    v_mul_f32 v72, s69, v72
    v_mul_f32 v73, s69, v73
    v_mul_f32 v74, s69, v74
    v_mul_f32 v75, s69, v75
    v_mul_f32 v88, s69, v88
    v_mul_f32 v89, s69, v89
    v_mul_f32 v90, s69, v90
    v_mul_f32 v91, s69, v91
    v_cvt_pk_bf16_f32 v136, v72, v73
    v_cvt_pk_bf16_f32 v137, v74, v75
    v_cvt_pk_bf16_f32 v138, v88, v89
    v_cvt_pk_bf16_f32 v139, v90, v91
    s_nop 1
    v_permlane32_swap_b32 v136, v138
    v_permlane32_swap_b32 v137, v139
    v_mul_f32 v76, s69, v76
    v_mul_f32 v77, s69, v77
    v_mul_f32 v78, s69, v78
    v_mul_f32 v79, s69, v79
    v_mul_f32 v92, s69, v92
    v_mul_f32 v93, s69, v93
    v_mul_f32 v94, s69, v94
    v_mul_f32 v95, s69, v95
    v_cvt_pk_bf16_f32 v140, v76, v77
    v_cvt_pk_bf16_f32 v141, v78, v79
    v_cvt_pk_bf16_f32 v142, v92, v93
    v_cvt_pk_bf16_f32 v143, v94, v95
    s_nop 1
    v_permlane32_swap_b32 v140, v142
    v_permlane32_swap_b32 v141, v143
    v_mul_f32 v96, s69, v96
    v_mul_f32 v97, s69, v97
    v_mul_f32 v98, s69, v98
    v_mul_f32 v99, s69, v99
    v_mul_f32 v112, s69, v112
    v_mul_f32 v113, s69, v113
    v_mul_f32 v114, s69, v114
    v_mul_f32 v115, s69, v115
    v_cvt_pk_bf16_f32 v144, v96, v97
    v_cvt_pk_bf16_f32 v145, v98, v99
    v_cvt_pk_bf16_f32 v146, v112, v113
    v_cvt_pk_bf16_f32 v147, v114, v115
    s_nop 1
    v_permlane32_swap_b32 v144, v146
    v_permlane32_swap_b32 v145, v147
    v_mul_f32 v100, s69, v100
    v_mul_f32 v101, s69, v101
    v_mul_f32 v102, s69, v102
    v_mul_f32 v103, s69, v103
    v_mul_f32 v116, s69, v116
    v_mul_f32 v117, s69, v117
    v_mul_f32 v118, s69, v118
    v_mul_f32 v119, s69, v119
    v_cvt_pk_bf16_f32 v148, v100, v101
    v_cvt_pk_bf16_f32 v149, v102, v103
    v_cvt_pk_bf16_f32 v150, v116, v117
    v_cvt_pk_bf16_f32 v151, v118, v119
    s_nop 1
    v_permlane32_swap_b32 v148, v150
    v_permlane32_swap_b32 v149, v151
    v_mul_f32 v104, s69, v104
    v_mul_f32 v105, s69, v105
    v_mul_f32 v106, s69, v106
    v_mul_f32 v107, s69, v107
    v_mul_f32 v120, s69, v120
    v_mul_f32 v121, s69, v121
    v_mul_f32 v122, s69, v122
    v_mul_f32 v123, s69, v123
    v_cvt_pk_bf16_f32 v152, v104, v105
    v_cvt_pk_bf16_f32 v153, v106, v107
    v_cvt_pk_bf16_f32 v154, v120, v121
    v_cvt_pk_bf16_f32 v155, v122, v123
    s_nop 1
    v_permlane32_swap_b32 v152, v154
    v_permlane32_swap_b32 v153, v155
    v_mul_f32 v108, s69, v108
    v_mul_f32 v109, s69, v109
    v_mul_f32 v110, s69, v110
    v_mul_f32 v111, s69, v111
    v_mul_f32 v124, s69, v124
    v_mul_f32 v125, s69, v125
    v_mul_f32 v126, s69, v126
    v_mul_f32 v127, s69, v127
    v_cvt_pk_bf16_f32 v156, v108, v109
    v_cvt_pk_bf16_f32 v157, v110, v111
    v_cvt_pk_bf16_f32 v158, v124, v125
    v_cvt_pk_bf16_f32 v159, v126, v127
    s_nop 1
    v_permlane32_swap_b32 v156, v158
    v_permlane32_swap_b32 v157, v159
    s_waitcnt vmcnt(24)
    s_barrier
    ds_read_b64_tr_b16 v[160:161], v246 offset:0
    ds_read_b64_tr_b16 v[162:163], v246 offset:1024
    ds_read_b64_tr_b16 v[164:165], v247 offset:0
    ds_read_b64_tr_b16 v[166:167], v247 offset:1024
    ds_read_b64_tr_b16 v[168:169], v248 offset:0
    ds_read_b64_tr_b16 v[170:171], v248 offset:1024
    ds_read_b64_tr_b16 v[172:173], v249 offset:0
    ds_read_b64_tr_b16 v[174:175], v249 offset:1024
    ds_read_b64_tr_b16 v[176:177], v250 offset:0
    ds_read_b64_tr_b16 v[178:179], v250 offset:1024
    ds_read_b64_tr_b16 v[180:181], v251 offset:0
    ds_read_b64_tr_b16 v[182:183], v251 offset:1024
    s_waitcnt vmcnt(10) lgkmcnt(8)
    v_mfma_f32_16x16x32_bf16 v[64:67], v[160:163], v[192:195], 0
    ds_read_b64_tr_b16 v[184:185], v252 offset:0
    ds_read_b64_tr_b16 v[186:187], v252 offset:1024
    v_mfma_f32_16x16x32_bf16 v[68:71], v[160:163], v[196:199], 0
    s_add_u32 s68, s68, 32768
    buffer_store_dwordx4 v[128:131], v242, s[12:15], s68 offen offset:0 sc1
    v_mul_f32 v0, s69, v0
    v_mul_f32 v1, s69, v1
    v_mul_f32 v2, s69, v2
    v_mul_f32 v3, s69, v3
    v_mfma_f32_16x16x32_bf16 v[72:75], v[164:167], v[192:195], 0
    ds_read_b64_tr_b16 v[188:189], v253 offset:0
    ds_read_b64_tr_b16 v[190:191], v253 offset:1024
    v_mfma_f32_16x16x32_bf16 v[76:79], v[164:167], v[196:199], 0
    buffer_store_dwordx4 v[132:135], v242, s[12:15], s68 offen offset:1024 sc1
    v_mul_f32 v16, s69, v16
    v_mul_f32 v17, s69, v17
    v_mul_f32 v18, s69, v18
    v_mul_f32 v19, s69, v19
    s_waitcnt lgkmcnt(8)
    v_mfma_f32_16x16x32_bf16 v[80:83], v[168:171], v[192:195], 0
    ds_read_b64_tr_b16 v[160:161], v246 offset:8192
    ds_read_b64_tr_b16 v[162:163], v246 offset:9216
    v_mfma_f32_16x16x32_bf16 v[84:87], v[168:171], v[196:199], 0
    buffer_store_dwordx4 v[136:139], v242, s[12:15], s68 offen offset:2048 sc1
    v_cvt_pk_bf16_f32 v0, v0, v1
    v_cvt_pk_bf16_f32 v1, v2, v3
    v_cvt_pk_bf16_f32 v2, v16, v17
    v_cvt_pk_bf16_f32 v3, v18, v19
    v_mfma_f32_16x16x32_bf16 v[88:91], v[172:175], v[192:195], 0
    ds_read_b64_tr_b16 v[164:165], v247 offset:8192
    ds_read_b64_tr_b16 v[166:167], v247 offset:9216
    v_mfma_f32_16x16x32_bf16 v[92:95], v[172:175], v[196:199], 0
    buffer_store_dwordx4 v[140:143], v242, s[12:15], s68 offen offset:3072 sc1
    s_add_u32 s68, s68, 16384
    s_nop 1
    v_permlane32_swap_b32 v0, v2
    v_permlane32_swap_b32 v1, v3
    v_mul_f32 v4, s69, v4
    s_waitcnt lgkmcnt(8)
    v_mfma_f32_16x16x32_bf16 v[96:99], v[176:179], v[192:195], 0
    ds_read_b64_tr_b16 v[168:169], v248 offset:8192
    ds_read_b64_tr_b16 v[170:171], v248 offset:9216
    v_mfma_f32_16x16x32_bf16 v[100:103], v[176:179], v[196:199], 0
    buffer_store_dwordx4 v[144:147], v242, s[12:15], s68 offen offset:0 sc1
    v_mul_f32 v5, s69, v5
    v_mul_f32 v6, s69, v6
    v_mul_f32 v7, s69, v7
    v_mul_f32 v20, s69, v20
    v_mfma_f32_16x16x32_bf16 v[104:107], v[180:183], v[192:195], 0
    ds_read_b64_tr_b16 v[172:173], v249 offset:8192
    ds_read_b64_tr_b16 v[174:175], v249 offset:9216
    v_mfma_f32_16x16x32_bf16 v[108:111], v[180:183], v[196:199], 0
    buffer_store_dwordx4 v[148:151], v242, s[12:15], s68 offen offset:1024 sc1
    v_mul_f32 v21, s69, v21
    v_mul_f32 v22, s69, v22
    v_mul_f32 v23, s69, v23
    v_cvt_pk_bf16_f32 v4, v4, v5
    s_waitcnt lgkmcnt(8)
    v_mfma_f32_16x16x32_bf16 v[112:115], v[184:187], v[192:195], 0
    ds_read_b64_tr_b16 v[176:177], v250 offset:8192
    ds_read_b64_tr_b16 v[178:179], v250 offset:9216
    v_mfma_f32_16x16x32_bf16 v[116:119], v[184:187], v[196:199], 0
    buffer_store_dwordx4 v[152:155], v242, s[12:15], s68 offen offset:2048 sc1
    v_cvt_pk_bf16_f32 v5, v6, v7
    v_cvt_pk_bf16_f32 v6, v20, v21
    v_cvt_pk_bf16_f32 v7, v22, v23
    s_nop 1
    v_mfma_f32_16x16x32_bf16 v[120:123], v[188:191], v[192:195], 0
    ds_read_b64_tr_b16 v[180:181], v251 offset:8192
    ds_read_b64_tr_b16 v[182:183], v251 offset:9216
    v_mfma_f32_16x16x32_bf16 v[124:127], v[188:191], v[196:199], 0
    buffer_store_dwordx4 v[156:159], v242, s[12:15], s68 offen offset:3072 sc1
    s_sub_u32 s68, s68, 49152
    v_permlane32_swap_b32 v4, v6
    v_permlane32_swap_b32 v5, v7
    v_mul_f32 v8, s69, v8
    v_mul_f32 v9, s69, v9
    s_waitcnt vmcnt(16) lgkmcnt(8)
    v_mfma_f32_16x16x32_bf16 v[64:67], v[160:163], v[200:203], v[64:67]
    ds_read_b64_tr_b16 v[184:185], v252 offset:8192
    ds_read_b64_tr_b16 v[186:187], v252 offset:9216
    v_mfma_f32_16x16x32_bf16 v[68:71], v[160:163], v[204:207], v[68:71]
    buffer_store_dwordx4 v[0:3], v242, s[12:15], s68 offen offset:0 sc1
    v_mul_f32 v10, s69, v10
    v_mul_f32 v11, s69, v11
    v_mul_f32 v24, s69, v24
    v_mul_f32 v25, s69, v25
    v_mfma_f32_16x16x32_bf16 v[72:75], v[164:167], v[200:203], v[72:75]
    ds_read_b64_tr_b16 v[188:189], v253 offset:8192
    ds_read_b64_tr_b16 v[190:191], v253 offset:9216
    v_mfma_f32_16x16x32_bf16 v[76:79], v[164:167], v[204:207], v[76:79]
    s_add_u32 s55, s55, 4096
    buffer_load_dwordx4 v[192:195], v255, s[12:15], s55 offen offset:0 sc1
    v_mul_f32 v26, s69, v26
    v_mul_f32 v27, s69, v27
    v_cvt_pk_bf16_f32 v8, v8, v9
    v_cvt_pk_bf16_f32 v9, v10, v11
    s_waitcnt lgkmcnt(8)
    v_mfma_f32_16x16x32_bf16 v[80:83], v[168:171], v[200:203], v[80:83]
    ds_read_b64_tr_b16 v[160:161], v246 offset:16384
    ds_read_b64_tr_b16 v[162:163], v246 offset:17408
    v_mfma_f32_16x16x32_bf16 v[84:87], v[168:171], v[204:207], v[84:87]
    buffer_load_dwordx4 v[196:199], v255, s[12:15], s55 offen offset:256 sc1
    v_cvt_pk_bf16_f32 v10, v24, v25
    v_cvt_pk_bf16_f32 v11, v26, v27
    s_nop 1
    v_permlane32_swap_b32 v8, v10
    v_mfma_f32_16x16x32_bf16 v[88:91], v[172:175], v[200:203], v[88:91]
    ds_read_b64_tr_b16 v[164:165], v247 offset:16384
    ds_read_b64_tr_b16 v[166:167], v247 offset:17408
    v_mfma_f32_16x16x32_bf16 v[92:95], v[172:175], v[204:207], v[92:95]
    s_add_u32 m0, s44, 98304
    s_add_u32 s49, s43, 3145728
    buffer_load_dwordx4 v245, s[8:11], s49 offen lds
    v_permlane32_swap_b32 v9, v11
    v_mul_f32 v12, s69, v12
    v_mul_f32 v13, s69, v13
    v_mul_f32 v14, s69, v14
    s_waitcnt lgkmcnt(8)
    v_mfma_f32_16x16x32_bf16 v[96:99], v[176:179], v[200:203], v[96:99]
    ds_read_b64_tr_b16 v[168:169], v248 offset:16384
    ds_read_b64_tr_b16 v[170:171], v248 offset:17408
    v_mfma_f32_16x16x32_bf16 v[100:103], v[176:179], v[204:207], v[100:103]
    buffer_store_dwordx4 v[4:7], v242, s[12:15], s68 offen offset:1024 sc1
    v_mul_f32 v15, s69, v15
    v_mul_f32 v28, s69, v28
    v_mul_f32 v29, s69, v29
    v_mul_f32 v30, s69, v30
    v_mfma_f32_16x16x32_bf16 v[104:107], v[180:183], v[200:203], v[104:107]
    ds_read_b64_tr_b16 v[172:173], v249 offset:16384
    ds_read_b64_tr_b16 v[174:175], v249 offset:17408
    v_mfma_f32_16x16x32_bf16 v[108:111], v[180:183], v[204:207], v[108:111]
    s_add_u32 m0, s44, 99328
    s_add_u32 s49, s43, 3178496
    buffer_load_dwordx4 v245, s[8:11], s49 offen lds
    v_mul_f32 v31, s69, v31
    v_cvt_pk_bf16_f32 v12, v12, v13
    v_cvt_pk_bf16_f32 v13, v14, v15
    v_cvt_pk_bf16_f32 v14, v28, v29
    s_waitcnt lgkmcnt(8)
    v_mfma_f32_16x16x32_bf16 v[112:115], v[184:187], v[200:203], v[112:115]
    ds_read_b64_tr_b16 v[176:177], v250 offset:16384
    ds_read_b64_tr_b16 v[178:179], v250 offset:17408
    v_mfma_f32_16x16x32_bf16 v[116:119], v[184:187], v[204:207], v[116:119]
    s_add_u32 m0, s44, 100352
    s_add_u32 s49, s43, 3211264
    buffer_load_dwordx4 v244, s[8:11], s49 offen lds
    v_cvt_pk_bf16_f32 v15, v30, v31
    s_nop 1
    v_permlane32_swap_b32 v12, v14
    v_permlane32_swap_b32 v13, v15
    v_mfma_f32_16x16x32_bf16 v[120:123], v[188:191], v[200:203], v[120:123]
    ds_read_b64_tr_b16 v[180:181], v251 offset:16384
    ds_read_b64_tr_b16 v[182:183], v251 offset:17408
    v_mfma_f32_16x16x32_bf16 v[124:127], v[188:191], v[204:207], v[124:127]
    buffer_load_dwordx4 v[200:203], v255, s[12:15], s55 offen offset:2048 sc1
    v_mul_f32 v32, s69, v32
    v_mul_f32 v33, s69, v33
    v_mul_f32 v34, s69, v34
    v_mul_f32 v35, s69, v35
    s_waitcnt vmcnt(22) lgkmcnt(8)
    v_mfma_f32_16x16x32_bf16 v[64:67], v[160:163], v[208:211], v[64:67]
    ds_read_b64_tr_b16 v[184:185], v252 offset:16384
    ds_read_b64_tr_b16 v[186:187], v252 offset:17408
    v_mfma_f32_16x16x32_bf16 v[68:71], v[160:163], v[212:215], v[68:71]
    buffer_store_dwordx4 v[8:11], v242, s[12:15], s68 offen offset:2048 sc1
    v_mul_f32 v48, s69, v48
    v_mul_f32 v49, s69, v49
    v_mul_f32 v50, s69, v50
    v_mul_f32 v51, s69, v51
    v_mfma_f32_16x16x32_bf16 v[72:75], v[164:167], v[208:211], v[72:75]
    ds_read_b64_tr_b16 v[188:189], v253 offset:16384
    ds_read_b64_tr_b16 v[190:191], v253 offset:17408
    v_mfma_f32_16x16x32_bf16 v[76:79], v[164:167], v[212:215], v[76:79]
    buffer_load_dwordx4 v[204:207], v255, s[12:15], s55 offen offset:2304 sc1
    v_cvt_pk_bf16_f32 v16, v32, v33
    v_cvt_pk_bf16_f32 v17, v34, v35
    v_cvt_pk_bf16_f32 v18, v48, v49
    v_cvt_pk_bf16_f32 v19, v50, v51
    s_waitcnt lgkmcnt(8)
    v_mfma_f32_16x16x32_bf16 v[80:83], v[168:171], v[208:211], v[80:83]
    ds_read_b64_tr_b16 v[160:161], v246 offset:24576
    ds_read_b64_tr_b16 v[162:163], v246 offset:25600
    v_mfma_f32_16x16x32_bf16 v[84:87], v[168:171], v[212:215], v[84:87]
    s_add_u32 m0, s44, 101376
    s_add_u32 s49, s43, 3244032
    buffer_load_dwordx4 v244, s[8:11], s49 offen lds
    s_nop 1
    v_permlane32_swap_b32 v16, v18
    v_permlane32_swap_b32 v17, v19
    v_mul_f32 v36, s69, v36
    v_mfma_f32_16x16x32_bf16 v[88:91], v[172:175], v[208:211], v[88:91]
    ds_read_b64_tr_b16 v[164:165], v247 offset:24576
    ds_read_b64_tr_b16 v[166:167], v247 offset:25600
    v_mfma_f32_16x16x32_bf16 v[92:95], v[172:175], v[212:215], v[92:95]
    s_add_u32 m0, s44, 102400
    s_add_u32 s49, s43, 3276800
    buffer_load_dwordx4 v245, s[8:11], s49 offen lds
    v_mul_f32 v37, s69, v37
    v_mul_f32 v38, s69, v38
    v_mul_f32 v39, s69, v39
    v_mul_f32 v52, s69, v52
    s_waitcnt lgkmcnt(8)
    v_mfma_f32_16x16x32_bf16 v[96:99], v[176:179], v[208:211], v[96:99]
    ds_read_b64_tr_b16 v[168:169], v248 offset:24576
    ds_read_b64_tr_b16 v[170:171], v248 offset:25600
    v_mfma_f32_16x16x32_bf16 v[100:103], v[176:179], v[212:215], v[100:103]
    buffer_store_dwordx4 v[12:15], v242, s[12:15], s68 offen offset:3072 sc1
    s_add_u32 s68, s68, 16384
    v_mul_f32 v53, s69, v53
    v_mul_f32 v54, s69, v54
    v_mul_f32 v55, s69, v55
    v_cvt_pk_bf16_f32 v20, v36, v37
    v_mfma_f32_16x16x32_bf16 v[104:107], v[180:183], v[208:211], v[104:107]
    ds_read_b64_tr_b16 v[172:173], v249 offset:24576
    ds_read_b64_tr_b16 v[174:175], v249 offset:25600
    v_mfma_f32_16x16x32_bf16 v[108:111], v[180:183], v[212:215], v[108:111]
    s_add_u32 m0, s44, 103424
    s_add_u32 s49, s43, 3309568
    buffer_load_dwordx4 v245, s[8:11], s49 offen lds
    v_cvt_pk_bf16_f32 v21, v38, v39
    v_cvt_pk_bf16_f32 v22, v52, v53
    v_cvt_pk_bf16_f32 v23, v54, v55
    s_nop 1
    s_waitcnt lgkmcnt(8)
    v_mfma_f32_16x16x32_bf16 v[112:115], v[184:187], v[208:211], v[112:115]
    ds_read_b64_tr_b16 v[176:177], v250 offset:24576
    ds_read_b64_tr_b16 v[178:179], v250 offset:25600
    v_mfma_f32_16x16x32_bf16 v[116:119], v[184:187], v[212:215], v[116:119]
    s_add_u32 m0, s44, 104448
    s_add_u32 s49, s43, 3342336
    buffer_load_dwordx4 v244, s[8:11], s49 offen lds
    v_permlane32_swap_b32 v20, v22
    v_permlane32_swap_b32 v21, v23
    v_mul_f32 v40, s69, v40
    v_mul_f32 v41, s69, v41
    v_mfma_f32_16x16x32_bf16 v[120:123], v[188:191], v[208:211], v[120:123]
    ds_read_b64_tr_b16 v[180:181], v251 offset:24576
    ds_read_b64_tr_b16 v[182:183], v251 offset:25600
    v_mfma_f32_16x16x32_bf16 v[124:127], v[188:191], v[212:215], v[124:127]
    s_add_u32 s55, s55, 4096
    buffer_load_dwordx4 v[208:211], v255, s[12:15], s55 offen offset:0 sc1
    v_mul_f32 v42, s69, v42
    v_mul_f32 v43, s69, v43
    v_mul_f32 v56, s69, v56
    v_mul_f32 v57, s69, v57
    s_waitcnt vmcnt(28) lgkmcnt(8)
    v_mfma_f32_16x16x32_bf16 v[64:67], v[160:163], v[216:219], v[64:67]
    ds_read_b64_tr_b16 v[184:185], v252 offset:24576
    ds_read_b64_tr_b16 v[186:187], v252 offset:25600
    v_mfma_f32_16x16x32_bf16 v[68:71], v[160:163], v[220:223], v[68:71]
    buffer_store_dwordx4 v[16:19], v242, s[12:15], s68 offen offset:0 sc1
    v_mul_f32 v58, s69, v58
    v_mul_f32 v59, s69, v59
    v_cvt_pk_bf16_f32 v24, v40, v41
    v_cvt_pk_bf16_f32 v25, v42, v43
    v_mfma_f32_16x16x32_bf16 v[72:75], v[164:167], v[216:219], v[72:75]
    ds_read_b64_tr_b16 v[188:189], v253 offset:24576
    ds_read_b64_tr_b16 v[190:191], v253 offset:25600
    v_mfma_f32_16x16x32_bf16 v[76:79], v[164:167], v[220:223], v[76:79]
    buffer_load_dwordx4 v[212:215], v255, s[12:15], s55 offen offset:256 sc1
    v_cvt_pk_bf16_f32 v26, v56, v57
    v_cvt_pk_bf16_f32 v27, v58, v59
    s_nop 1
    v_permlane32_swap_b32 v24, v26
    s_waitcnt lgkmcnt(8)
    v_mfma_f32_16x16x32_bf16 v[80:83], v[168:171], v[216:219], v[80:83]
    s_waitcnt vmcnt(38)
    s_barrier
    ds_read_b64_tr_b16 v[160:161], v246 offset:32768
    ds_read_b64_tr_b16 v[162:163], v246 offset:33792
    v_mfma_f32_16x16x32_bf16 v[84:87], v[168:171], v[220:223], v[84:87]
    s_add_u32 m0, s44, 105472
    s_add_u32 s49, s43, 3375104
    buffer_load_dwordx4 v244, s[8:11], s49 offen lds
    v_permlane32_swap_b32 v25, v27
    v_mul_f32 v44, s69, v44
    v_mul_f32 v45, s69, v45
    v_mul_f32 v46, s69, v46
    v_mfma_f32_16x16x32_bf16 v[88:91], v[172:175], v[216:219], v[88:91]
    ds_read_b64_tr_b16 v[164:165], v247 offset:32768
    ds_read_b64_tr_b16 v[166:167], v247 offset:33792
    v_mfma_f32_16x16x32_bf16 v[92:95], v[172:175], v[220:223], v[92:95]
    v_mul_f32 v47, s69, v47
    v_mul_f32 v60, s69, v60
    v_mul_f32 v61, s69, v61
    v_mul_f32 v62, s69, v62
    s_waitcnt lgkmcnt(8)
    v_mfma_f32_16x16x32_bf16 v[96:99], v[176:179], v[216:219], v[96:99]
    ds_read_b64_tr_b16 v[168:169], v248 offset:32768
    ds_read_b64_tr_b16 v[170:171], v248 offset:33792
    v_mfma_f32_16x16x32_bf16 v[100:103], v[176:179], v[220:223], v[100:103]
    buffer_store_dwordx4 v[20:23], v242, s[12:15], s68 offen offset:1024 sc1
    v_mul_f32 v63, s69, v63
    v_cvt_pk_bf16_f32 v28, v44, v45
    v_cvt_pk_bf16_f32 v29, v46, v47
    v_cvt_pk_bf16_f32 v30, v60, v61
    v_mfma_f32_16x16x32_bf16 v[104:107], v[180:183], v[216:219], v[104:107]
    ds_read_b64_tr_b16 v[172:173], v249 offset:32768
    ds_read_b64_tr_b16 v[174:175], v249 offset:33792
    v_mfma_f32_16x16x32_bf16 v[108:111], v[180:183], v[220:223], v[108:111]
    v_cvt_pk_bf16_f32 v31, v62, v63
    s_nop 1
    v_permlane32_swap_b32 v28, v30
    v_permlane32_swap_b32 v29, v31
    s_waitcnt lgkmcnt(8)
    v_mfma_f32_16x16x32_bf16 v[112:115], v[184:187], v[216:219], v[112:115]
    ds_read_b64_tr_b16 v[176:177], v250 offset:32768
    ds_read_b64_tr_b16 v[178:179], v250 offset:33792
    v_mfma_f32_16x16x32_bf16 v[116:119], v[184:187], v[220:223], v[116:119]
    v_mfma_f32_16x16x32_bf16 v[120:123], v[188:191], v[216:219], v[120:123]
    ds_read_b64_tr_b16 v[180:181], v251 offset:32768
    ds_read_b64_tr_b16 v[182:183], v251 offset:33792
    v_mfma_f32_16x16x32_bf16 v[124:127], v[188:191], v[220:223], v[124:127]
    buffer_load_dwordx4 v[216:219], v255, s[12:15], s55 offen offset:2048 sc1
    s_waitcnt vmcnt(31) lgkmcnt(8)
    v_mfma_f32_16x16x32_bf16 v[64:67], v[160:163], v[224:227], v[64:67]
    ds_read_b64_tr_b16 v[184:185], v252 offset:32768
    ds_read_b64_tr_b16 v[186:187], v252 offset:33792
    v_mfma_f32_16x16x32_bf16 v[68:71], v[160:163], v[228:231], v[68:71]
    buffer_store_dwordx4 v[24:27], v242, s[12:15], s68 offen offset:2048 sc1
    v_mfma_f32_16x16x32_bf16 v[72:75], v[164:167], v[224:227], v[72:75]
    ds_read_b64_tr_b16 v[188:189], v253 offset:32768
    ds_read_b64_tr_b16 v[190:191], v253 offset:33792
    v_mfma_f32_16x16x32_bf16 v[76:79], v[164:167], v[228:231], v[76:79]
    buffer_load_dwordx4 v[220:223], v255, s[12:15], s55 offen offset:2304 sc1
    s_waitcnt lgkmcnt(8)
    v_mfma_f32_16x16x32_bf16 v[80:83], v[168:171], v[224:227], v[80:83]
    ds_read_b64_tr_b16 v[160:161], v246 offset:40960
    ds_read_b64_tr_b16 v[162:163], v246 offset:41984
    v_mfma_f32_16x16x32_bf16 v[84:87], v[168:171], v[228:231], v[84:87]
    v_mfma_f32_16x16x32_bf16 v[88:91], v[172:175], v[224:227], v[88:91]
    ds_read_b64_tr_b16 v[164:165], v247 offset:40960
    ds_read_b64_tr_b16 v[166:167], v247 offset:41984
    v_mfma_f32_16x16x32_bf16 v[92:95], v[172:175], v[228:231], v[92:95]
    s_waitcnt lgkmcnt(8)
    v_mfma_f32_16x16x32_bf16 v[96:99], v[176:179], v[224:227], v[96:99]
    ds_read_b64_tr_b16 v[168:169], v248 offset:40960
    ds_read_b64_tr_b16 v[170:171], v248 offset:41984
    v_mfma_f32_16x16x32_bf16 v[100:103], v[176:179], v[228:231], v[100:103]
    buffer_store_dwordx4 v[28:31], v242, s[12:15], s68 offen offset:3072 sc1
    s_add_u32 s68, s68, 16384
    v_mfma_f32_16x16x32_bf16 v[104:107], v[180:183], v[224:227], v[104:107]
    ds_read_b64_tr_b16 v[172:173], v249 offset:40960
    ds_read_b64_tr_b16 v[174:175], v249 offset:41984
    v_mfma_f32_16x16x32_bf16 v[108:111], v[180:183], v[228:231], v[108:111]
    s_waitcnt lgkmcnt(8)
    v_mfma_f32_16x16x32_bf16 v[112:115], v[184:187], v[224:227], v[112:115]
    ds_read_b64_tr_b16 v[176:177], v250 offset:40960
    ds_read_b64_tr_b16 v[178:179], v250 offset:41984
    v_mfma_f32_16x16x32_bf16 v[116:119], v[184:187], v[228:231], v[116:119]
    v_mfma_f32_16x16x32_bf16 v[120:123], v[188:191], v[224:227], v[120:123]
    ds_read_b64_tr_b16 v[180:181], v251 offset:40960
    ds_read_b64_tr_b16 v[182:183], v251 offset:41984
    v_mfma_f32_16x16x32_bf16 v[124:127], v[188:191], v[228:231], v[124:127]
    s_add_u32 s55, s55, 4096
    buffer_load_dwordx4 v[224:227], v255, s[12:15], s55 offen offset:0 sc1
    s_waitcnt vmcnt(33) lgkmcnt(8)
    v_mfma_f32_16x16x32_bf16 v[64:67], v[160:163], v[232:235], v[64:67]
    ds_read_b64_tr_b16 v[184:185], v252 offset:40960
    ds_read_b64_tr_b16 v[186:187], v252 offset:41984
    v_mfma_f32_16x16x32_bf16 v[68:71], v[160:163], v[236:239], v[68:71]
    buffer_load_dwordx4 v[228:231], v255, s[12:15], s55 offen offset:256 sc1
    v_mfma_f32_16x16x32_bf16 v[72:75], v[164:167], v[232:235], v[72:75]
    ds_read_b64_tr_b16 v[188:189], v253 offset:40960
    ds_read_b64_tr_b16 v[190:191], v253 offset:41984
    v_mfma_f32_16x16x32_bf16 v[76:79], v[164:167], v[236:239], v[76:79]
    s_waitcnt lgkmcnt(8)
    v_mfma_f32_16x16x32_bf16 v[80:83], v[168:171], v[232:235], v[80:83]
    ds_read_b64_tr_b16 v[160:161], v246 offset:49152
    ds_read_b64_tr_b16 v[162:163], v246 offset:50176
    v_mfma_f32_16x16x32_bf16 v[84:87], v[168:171], v[236:239], v[84:87]
    v_mfma_f32_16x16x32_bf16 v[88:91], v[172:175], v[232:235], v[88:91]
    ds_read_b64_tr_b16 v[164:165], v247 offset:49152
    ds_read_b64_tr_b16 v[166:167], v247 offset:50176
    v_mfma_f32_16x16x32_bf16 v[92:95], v[172:175], v[236:239], v[92:95]
    s_waitcnt lgkmcnt(8)
    v_mfma_f32_16x16x32_bf16 v[96:99], v[176:179], v[232:235], v[96:99]
    ds_read_b64_tr_b16 v[168:169], v248 offset:49152
    ds_read_b64_tr_b16 v[170:171], v248 offset:50176
    v_mfma_f32_16x16x32_bf16 v[100:103], v[176:179], v[236:239], v[100:103]
    v_mfma_f32_16x16x32_bf16 v[104:107], v[180:183], v[232:235], v[104:107]
    ds_read_b64_tr_b16 v[172:173], v249 offset:49152
    ds_read_b64_tr_b16 v[174:175], v249 offset:50176
    v_mfma_f32_16x16x32_bf16 v[108:111], v[180:183], v[236:239], v[108:111]
    s_waitcnt lgkmcnt(8)
    v_mfma_f32_16x16x32_bf16 v[112:115], v[184:187], v[232:235], v[112:115]
    ds_read_b64_tr_b16 v[176:177], v250 offset:49152
    ds_read_b64_tr_b16 v[178:179], v250 offset:50176
    v_mfma_f32_16x16x32_bf16 v[116:119], v[184:187], v[236:239], v[116:119]
    v_mfma_f32_16x16x32_bf16 v[120:123], v[188:191], v[232:235], v[120:123]
    ds_read_b64_tr_b16 v[180:181], v251 offset:49152
    ds_read_b64_tr_b16 v[182:183], v251 offset:50176
    v_mfma_f32_16x16x32_bf16 v[124:127], v[188:191], v[236:239], v[124:127]
    buffer_load_dwordx4 v[232:235], v255, s[12:15], s55 offen offset:2048 sc1
    s_waitcnt vmcnt(24) lgkmcnt(8)
    v_mfma_f32_16x16x32_bf16 v[64:67], v[160:163], v[192:195], v[64:67]
    ds_read_b64_tr_b16 v[184:185], v252 offset:49152
    ds_read_b64_tr_b16 v[186:187], v252 offset:50176
    v_mfma_f32_16x16x32_bf16 v[68:71], v[160:163], v[196:199], v[68:71]
    buffer_load_dwordx4 v[236:239], v255, s[12:15], s55 offen offset:2304 sc1
    v_mfma_f32_16x16x32_bf16 v[72:75], v[164:167], v[192:195], v[72:75]
    ds_read_b64_tr_b16 v[188:189], v253 offset:49152
    ds_read_b64_tr_b16 v[190:191], v253 offset:50176
    v_mfma_f32_16x16x32_bf16 v[76:79], v[164:167], v[196:199], v[76:79]
    s_waitcnt lgkmcnt(8)
    v_mfma_f32_16x16x32_bf16 v[80:83], v[168:171], v[192:195], v[80:83]
    ds_read_b64_tr_b16 v[160:161], v246 offset:57344
    ds_read_b64_tr_b16 v[162:163], v246 offset:58368
    v_mfma_f32_16x16x32_bf16 v[84:87], v[168:171], v[196:199], v[84:87]
    v_mfma_f32_16x16x32_bf16 v[88:91], v[172:175], v[192:195], v[88:91]
    ds_read_b64_tr_b16 v[164:165], v247 offset:57344
    ds_read_b64_tr_b16 v[166:167], v247 offset:58368
    v_mfma_f32_16x16x32_bf16 v[92:95], v[172:175], v[196:199], v[92:95]
    s_waitcnt lgkmcnt(8)
    v_mfma_f32_16x16x32_bf16 v[96:99], v[176:179], v[192:195], v[96:99]
    ds_read_b64_tr_b16 v[168:169], v248 offset:57344
    ds_read_b64_tr_b16 v[170:171], v248 offset:58368
    v_mfma_f32_16x16x32_bf16 v[100:103], v[176:179], v[196:199], v[100:103]
    v_mfma_f32_16x16x32_bf16 v[104:107], v[180:183], v[192:195], v[104:107]
    ds_read_b64_tr_b16 v[172:173], v249 offset:57344
    ds_read_b64_tr_b16 v[174:175], v249 offset:58368
    v_mfma_f32_16x16x32_bf16 v[108:111], v[180:183], v[196:199], v[108:111]
    s_waitcnt lgkmcnt(8)
    v_mfma_f32_16x16x32_bf16 v[112:115], v[184:187], v[192:195], v[112:115]
    ds_read_b64_tr_b16 v[176:177], v250 offset:57344
    ds_read_b64_tr_b16 v[178:179], v250 offset:58368
    v_mfma_f32_16x16x32_bf16 v[116:119], v[184:187], v[196:199], v[116:119]
    v_mfma_f32_16x16x32_bf16 v[120:123], v[188:191], v[192:195], v[120:123]
    ds_read_b64_tr_b16 v[180:181], v251 offset:57344
    ds_read_b64_tr_b16 v[182:183], v251 offset:58368
    v_mfma_f32_16x16x32_bf16 v[124:127], v[188:191], v[196:199], v[124:127]
    s_add_u32 s55, s55, 4096
    buffer_load_dwordx4 v[192:195], v255, s[12:15], s55 offen offset:0 sc1
    s_waitcnt vmcnt(19) lgkmcnt(8)
    v_mfma_f32_16x16x32_bf16 v[64:67], v[160:163], v[200:203], v[64:67]
    ds_read_b64_tr_b16 v[184:185], v252 offset:57344
    ds_read_b64_tr_b16 v[186:187], v252 offset:58368
    v_mfma_f32_16x16x32_bf16 v[68:71], v[160:163], v[204:207], v[68:71]
    buffer_load_dwordx4 v[196:199], v255, s[12:15], s55 offen offset:256 sc1
    v_mfma_f32_16x16x32_bf16 v[72:75], v[164:167], v[200:203], v[72:75]
    ds_read_b64_tr_b16 v[188:189], v253 offset:57344
    ds_read_b64_tr_b16 v[190:191], v253 offset:58368
    v_mfma_f32_16x16x32_bf16 v[76:79], v[164:167], v[204:207], v[76:79]
    s_waitcnt lgkmcnt(8)
    v_mfma_f32_16x16x32_bf16 v[80:83], v[168:171], v[200:203], v[80:83]
    s_waitcnt vmcnt(6)
    s_barrier
    s_cmp_eq_u32 s36, 0
    s_cbranch_scc0 parallel_sum__compressed_kv_cla__moe_arch_mod__prompt_kernel_A_nopub
    s_cmp_lt_u32 s77, 2
    s_cbranch_scc0 parallel_sum__compressed_kv_cla__moe_arch_mod__prompt_kernel_A_nopub
    v_mov_b32 v254, s87
    s_mov_b64 exec, 1
    buffer_store_dword v254, off, s[12:15], s66 sc1
    s_mov_b64 exec, -1
parallel_sum__compressed_kv_cla__moe_arch_mod__prompt_kernel_A_nopub:
    v_add_u32 v246, 0x10000, v246
    v_add_u32 v247, 0x10000, v247
    v_add_u32 v248, 0x10000, v248
    v_add_u32 v249, 0x10000, v249
    v_add_u32 v250, 0x10000, v250
    v_add_u32 v251, 0x10000, v251
    v_add_u32 v252, 0x10000, v252
    v_add_u32 v253, 0x10000, v253
    ds_read_b64_tr_b16 v[160:161], v246 offset:0
    ds_read_b64_tr_b16 v[162:163], v246 offset:1024
    v_mfma_f32_16x16x32_bf16 v[84:87], v[168:171], v[204:207], v[84:87]
    s_add_u32 m0, s44, 0
    s_add_u32 s49, s54, 4194304
    buffer_load_dwordx4 v245, s[8:11], s49 offen lds
    v_mfma_f32_16x16x32_bf16 v[88:91], v[172:175], v[200:203], v[88:91]
    ds_read_b64_tr_b16 v[164:165], v247 offset:0
    ds_read_b64_tr_b16 v[166:167], v247 offset:1024
    v_mfma_f32_16x16x32_bf16 v[92:95], v[172:175], v[204:207], v[92:95]
    s_add_u32 m0, s44, 1024
    s_add_u32 s49, s54, 4227072
    buffer_load_dwordx4 v245, s[8:11], s49 offen lds
    s_waitcnt lgkmcnt(8)
    v_mfma_f32_16x16x32_bf16 v[96:99], v[176:179], v[200:203], v[96:99]
    ds_read_b64_tr_b16 v[168:169], v248 offset:0
    ds_read_b64_tr_b16 v[170:171], v248 offset:1024
    v_mfma_f32_16x16x32_bf16 v[100:103], v[176:179], v[204:207], v[100:103]
    s_add_u32 m0, s44, 2048
    s_add_u32 s49, s54, 4259840
    buffer_load_dwordx4 v244, s[8:11], s49 offen lds
    v_mfma_f32_16x16x32_bf16 v[104:107], v[180:183], v[200:203], v[104:107]
    ds_read_b64_tr_b16 v[172:173], v249 offset:0
    ds_read_b64_tr_b16 v[174:175], v249 offset:1024
    v_mfma_f32_16x16x32_bf16 v[108:111], v[180:183], v[204:207], v[108:111]
    s_add_u32 m0, s44, 3072
    s_add_u32 s49, s54, 4292608
    buffer_load_dwordx4 v244, s[8:11], s49 offen lds
    s_waitcnt lgkmcnt(8)
    v_mfma_f32_16x16x32_bf16 v[112:115], v[184:187], v[200:203], v[112:115]
    ds_read_b64_tr_b16 v[176:177], v250 offset:0
    ds_read_b64_tr_b16 v[178:179], v250 offset:1024
    v_mfma_f32_16x16x32_bf16 v[116:119], v[184:187], v[204:207], v[116:119]
    s_add_u32 m0, s44, 4096
    s_add_u32 s49, s54, 4325376
    buffer_load_dwordx4 v245, s[8:11], s49 offen lds
    v_mfma_f32_16x16x32_bf16 v[120:123], v[188:191], v[200:203], v[120:123]
    ds_read_b64_tr_b16 v[180:181], v251 offset:0
    ds_read_b64_tr_b16 v[182:183], v251 offset:1024
    v_mfma_f32_16x16x32_bf16 v[124:127], v[188:191], v[204:207], v[124:127]
    buffer_load_dwordx4 v[200:203], v255, s[12:15], s55 offen offset:2048 sc1
    s_waitcnt vmcnt(18) lgkmcnt(8)
    v_mfma_f32_16x16x32_bf16 v[64:67], v[160:163], v[208:211], v[64:67]
    ds_read_b64_tr_b16 v[184:185], v252 offset:0
    ds_read_b64_tr_b16 v[186:187], v252 offset:1024
    v_mfma_f32_16x16x32_bf16 v[68:71], v[160:163], v[212:215], v[68:71]
    buffer_load_dwordx4 v[204:207], v255, s[12:15], s55 offen offset:2304 sc1
    v_mfma_f32_16x16x32_bf16 v[72:75], v[164:167], v[208:211], v[72:75]
    ds_read_b64_tr_b16 v[188:189], v253 offset:0
    ds_read_b64_tr_b16 v[190:191], v253 offset:1024
    v_mfma_f32_16x16x32_bf16 v[76:79], v[164:167], v[212:215], v[76:79]
    s_add_u32 m0, s44, 5120
    s_add_u32 s49, s54, 4358144
    buffer_load_dwordx4 v245, s[8:11], s49 offen lds
    s_waitcnt lgkmcnt(8)
    v_mfma_f32_16x16x32_bf16 v[80:83], v[168:171], v[208:211], v[80:83]
    ds_read_b64_tr_b16 v[160:161], v246 offset:8192
    ds_read_b64_tr_b16 v[162:163], v246 offset:9216
    v_mfma_f32_16x16x32_bf16 v[84:87], v[168:171], v[212:215], v[84:87]
    s_add_u32 m0, s44, 6144
    s_add_u32 s49, s54, 4390912
    buffer_load_dwordx4 v244, s[8:11], s49 offen lds
    v_mfma_f32_16x16x32_bf16 v[88:91], v[172:175], v[208:211], v[88:91]
    ds_read_b64_tr_b16 v[164:165], v247 offset:8192
    ds_read_b64_tr_b16 v[166:167], v247 offset:9216
    v_mfma_f32_16x16x32_bf16 v[92:95], v[172:175], v[212:215], v[92:95]
    s_add_u32 m0, s44, 7168
    s_add_u32 s49, s54, 4423680
    buffer_load_dwordx4 v244, s[8:11], s49 offen lds
    s_waitcnt lgkmcnt(8)
    v_mfma_f32_16x16x32_bf16 v[96:99], v[176:179], v[208:211], v[96:99]
    ds_read_b64_tr_b16 v[168:169], v248 offset:8192
    ds_read_b64_tr_b16 v[170:171], v248 offset:9216
    v_mfma_f32_16x16x32_bf16 v[100:103], v[176:179], v[212:215], v[100:103]
    v_mfma_f32_16x16x32_bf16 v[104:107], v[180:183], v[208:211], v[104:107]
    ds_read_b64_tr_b16 v[172:173], v249 offset:8192
    ds_read_b64_tr_b16 v[174:175], v249 offset:9216
    v_mfma_f32_16x16x32_bf16 v[108:111], v[180:183], v[212:215], v[108:111]
    s_waitcnt lgkmcnt(8)
    v_mfma_f32_16x16x32_bf16 v[112:115], v[184:187], v[208:211], v[112:115]
    ds_read_b64_tr_b16 v[176:177], v250 offset:8192
    ds_read_b64_tr_b16 v[178:179], v250 offset:9216
    v_mfma_f32_16x16x32_bf16 v[116:119], v[184:187], v[212:215], v[116:119]
    v_mfma_f32_16x16x32_bf16 v[120:123], v[188:191], v[208:211], v[120:123]
    ds_read_b64_tr_b16 v[180:181], v251 offset:8192
    ds_read_b64_tr_b16 v[182:183], v251 offset:9216
    v_mfma_f32_16x16x32_bf16 v[124:127], v[188:191], v[212:215], v[124:127]
    s_add_u32 s55, s55, 4096
    buffer_load_dwordx4 v[208:211], v255, s[12:15], s55 offen offset:0 sc1
    s_waitcnt vmcnt(18) lgkmcnt(8)
    v_mfma_f32_16x16x32_bf16 v[64:67], v[160:163], v[216:219], v[64:67]
    ds_read_b64_tr_b16 v[184:185], v252 offset:8192
    ds_read_b64_tr_b16 v[186:187], v252 offset:9216
    v_mfma_f32_16x16x32_bf16 v[68:71], v[160:163], v[220:223], v[68:71]
    buffer_load_dwordx4 v[212:215], v255, s[12:15], s55 offen offset:256 sc1
    v_mfma_f32_16x16x32_bf16 v[72:75], v[164:167], v[216:219], v[72:75]
    ds_read_b64_tr_b16 v[188:189], v253 offset:8192
    ds_read_b64_tr_b16 v[190:191], v253 offset:9216
    v_mfma_f32_16x16x32_bf16 v[76:79], v[164:167], v[220:223], v[76:79]
    s_waitcnt lgkmcnt(8)
    v_mfma_f32_16x16x32_bf16 v[80:83], v[168:171], v[216:219], v[80:83]
    ds_read_b64_tr_b16 v[160:161], v246 offset:16384
    ds_read_b64_tr_b16 v[162:163], v246 offset:17408
    v_mfma_f32_16x16x32_bf16 v[84:87], v[168:171], v[220:223], v[84:87]
    v_mfma_f32_16x16x32_bf16 v[88:91], v[172:175], v[216:219], v[88:91]
    ds_read_b64_tr_b16 v[164:165], v247 offset:16384
    ds_read_b64_tr_b16 v[166:167], v247 offset:17408
    v_mfma_f32_16x16x32_bf16 v[92:95], v[172:175], v[220:223], v[92:95]
    s_waitcnt lgkmcnt(8)
    v_mfma_f32_16x16x32_bf16 v[96:99], v[176:179], v[216:219], v[96:99]
    ds_read_b64_tr_b16 v[168:169], v248 offset:16384
    ds_read_b64_tr_b16 v[170:171], v248 offset:17408
    v_mfma_f32_16x16x32_bf16 v[100:103], v[176:179], v[220:223], v[100:103]
    v_mfma_f32_16x16x32_bf16 v[104:107], v[180:183], v[216:219], v[104:107]
    ds_read_b64_tr_b16 v[172:173], v249 offset:16384
    ds_read_b64_tr_b16 v[174:175], v249 offset:17408
    v_mfma_f32_16x16x32_bf16 v[108:111], v[180:183], v[220:223], v[108:111]
    s_waitcnt lgkmcnt(8)
    v_mfma_f32_16x16x32_bf16 v[112:115], v[184:187], v[216:219], v[112:115]
    ds_read_b64_tr_b16 v[176:177], v250 offset:16384
    ds_read_b64_tr_b16 v[178:179], v250 offset:17408
    v_mfma_f32_16x16x32_bf16 v[116:119], v[184:187], v[220:223], v[116:119]
    v_mfma_f32_16x16x32_bf16 v[120:123], v[188:191], v[216:219], v[120:123]
    ds_read_b64_tr_b16 v[180:181], v251 offset:16384
    ds_read_b64_tr_b16 v[182:183], v251 offset:17408
    v_mfma_f32_16x16x32_bf16 v[124:127], v[188:191], v[220:223], v[124:127]
    buffer_load_dwordx4 v[216:219], v255, s[12:15], s55 offen offset:2048 sc1
    s_waitcnt vmcnt(17) lgkmcnt(8)
    v_mfma_f32_16x16x32_bf16 v[64:67], v[160:163], v[224:227], v[64:67]
    ds_read_b64_tr_b16 v[184:185], v252 offset:16384
    ds_read_b64_tr_b16 v[186:187], v252 offset:17408
    v_mfma_f32_16x16x32_bf16 v[68:71], v[160:163], v[228:231], v[68:71]
    buffer_load_dwordx4 v[220:223], v255, s[12:15], s55 offen offset:2304 sc1
    v_mfma_f32_16x16x32_bf16 v[72:75], v[164:167], v[224:227], v[72:75]
    ds_read_b64_tr_b16 v[188:189], v253 offset:16384
    ds_read_b64_tr_b16 v[190:191], v253 offset:17408
    v_mfma_f32_16x16x32_bf16 v[76:79], v[164:167], v[228:231], v[76:79]
    s_waitcnt lgkmcnt(8)
    v_mfma_f32_16x16x32_bf16 v[80:83], v[168:171], v[224:227], v[80:83]
    ds_read_b64_tr_b16 v[160:161], v246 offset:24576
    ds_read_b64_tr_b16 v[162:163], v246 offset:25600
    v_mfma_f32_16x16x32_bf16 v[84:87], v[168:171], v[228:231], v[84:87]
    v_mfma_f32_16x16x32_bf16 v[88:91], v[172:175], v[224:227], v[88:91]
    ds_read_b64_tr_b16 v[164:165], v247 offset:24576
    ds_read_b64_tr_b16 v[166:167], v247 offset:25600
    v_mfma_f32_16x16x32_bf16 v[92:95], v[172:175], v[228:231], v[92:95]
    s_waitcnt lgkmcnt(8)
    v_mfma_f32_16x16x32_bf16 v[96:99], v[176:179], v[224:227], v[96:99]
    ds_read_b64_tr_b16 v[168:169], v248 offset:24576
    ds_read_b64_tr_b16 v[170:171], v248 offset:25600
    v_mfma_f32_16x16x32_bf16 v[100:103], v[176:179], v[228:231], v[100:103]
    v_mfma_f32_16x16x32_bf16 v[104:107], v[180:183], v[224:227], v[104:107]
    ds_read_b64_tr_b16 v[172:173], v249 offset:24576
    ds_read_b64_tr_b16 v[174:175], v249 offset:25600
    v_mfma_f32_16x16x32_bf16 v[108:111], v[180:183], v[228:231], v[108:111]
    s_waitcnt lgkmcnt(8)
    v_mfma_f32_16x16x32_bf16 v[112:115], v[184:187], v[224:227], v[112:115]
    ds_read_b64_tr_b16 v[176:177], v250 offset:24576
    ds_read_b64_tr_b16 v[178:179], v250 offset:25600
    v_mfma_f32_16x16x32_bf16 v[116:119], v[184:187], v[228:231], v[116:119]
    v_mfma_f32_16x16x32_bf16 v[120:123], v[188:191], v[224:227], v[120:123]
    ds_read_b64_tr_b16 v[180:181], v251 offset:24576
    ds_read_b64_tr_b16 v[182:183], v251 offset:25600
    v_mfma_f32_16x16x32_bf16 v[124:127], v[188:191], v[228:231], v[124:127]
    s_add_u32 s55, s55, 4096
    buffer_load_dwordx4 v[224:227], v255, s[12:15], s55 offen offset:0 sc1
    s_waitcnt vmcnt(17) lgkmcnt(8)
    v_mfma_f32_16x16x32_bf16 v[64:67], v[160:163], v[232:235], v[64:67]
    ds_read_b64_tr_b16 v[184:185], v252 offset:24576
    ds_read_b64_tr_b16 v[186:187], v252 offset:25600
    v_mfma_f32_16x16x32_bf16 v[68:71], v[160:163], v[236:239], v[68:71]
    buffer_load_dwordx4 v[228:231], v255, s[12:15], s55 offen offset:256 sc1
    v_mfma_f32_16x16x32_bf16 v[72:75], v[164:167], v[232:235], v[72:75]
    ds_read_b64_tr_b16 v[188:189], v253 offset:24576
    ds_read_b64_tr_b16 v[190:191], v253 offset:25600
    v_mfma_f32_16x16x32_bf16 v[76:79], v[164:167], v[236:239], v[76:79]
    s_waitcnt lgkmcnt(8)
    v_mfma_f32_16x16x32_bf16 v[80:83], v[168:171], v[232:235], v[80:83]
    s_waitcnt vmcnt(27)
    s_barrier
    ds_read_b64_tr_b16 v[160:161], v246 offset:32768
    ds_read_b64_tr_b16 v[162:163], v246 offset:33792
    v_mfma_f32_16x16x32_bf16 v[84:87], v[168:171], v[236:239], v[84:87]
    v_mfma_f32_16x16x32_bf16 v[88:91], v[172:175], v[232:235], v[88:91]
    ds_read_b64_tr_b16 v[164:165], v247 offset:32768
    ds_read_b64_tr_b16 v[166:167], v247 offset:33792
    v_mfma_f32_16x16x32_bf16 v[92:95], v[172:175], v[236:239], v[92:95]
    s_waitcnt lgkmcnt(8)
    v_mfma_f32_16x16x32_bf16 v[96:99], v[176:179], v[232:235], v[96:99]
    ds_read_b64_tr_b16 v[168:169], v248 offset:32768
    ds_read_b64_tr_b16 v[170:171], v248 offset:33792
    v_mfma_f32_16x16x32_bf16 v[100:103], v[176:179], v[236:239], v[100:103]
    v_mfma_f32_16x16x32_bf16 v[104:107], v[180:183], v[232:235], v[104:107]
    ds_read_b64_tr_b16 v[172:173], v249 offset:32768
    ds_read_b64_tr_b16 v[174:175], v249 offset:33792
    v_mfma_f32_16x16x32_bf16 v[108:111], v[180:183], v[236:239], v[108:111]
    s_waitcnt lgkmcnt(8)
    v_mfma_f32_16x16x32_bf16 v[112:115], v[184:187], v[232:235], v[112:115]
    ds_read_b64_tr_b16 v[176:177], v250 offset:32768
    ds_read_b64_tr_b16 v[178:179], v250 offset:33792
    v_mfma_f32_16x16x32_bf16 v[116:119], v[184:187], v[236:239], v[116:119]
    v_mfma_f32_16x16x32_bf16 v[120:123], v[188:191], v[232:235], v[120:123]
    ds_read_b64_tr_b16 v[180:181], v251 offset:32768
    ds_read_b64_tr_b16 v[182:183], v251 offset:33792
    v_mfma_f32_16x16x32_bf16 v[124:127], v[188:191], v[236:239], v[124:127]
    buffer_load_dwordx4 v[232:235], v255, s[12:15], s55 offen offset:2048 sc1
    s_waitcnt vmcnt(17) lgkmcnt(8)
    v_mfma_f32_16x16x32_bf16 v[64:67], v[160:163], v[192:195], v[64:67]
    ds_read_b64_tr_b16 v[184:185], v252 offset:32768
    ds_read_b64_tr_b16 v[186:187], v252 offset:33792
    v_mfma_f32_16x16x32_bf16 v[68:71], v[160:163], v[196:199], v[68:71]
    buffer_load_dwordx4 v[236:239], v255, s[12:15], s55 offen offset:2304 sc1
    v_mfma_f32_16x16x32_bf16 v[72:75], v[164:167], v[192:195], v[72:75]
    ds_read_b64_tr_b16 v[188:189], v253 offset:32768
    ds_read_b64_tr_b16 v[190:191], v253 offset:33792
    v_mfma_f32_16x16x32_bf16 v[76:79], v[164:167], v[196:199], v[76:79]
    s_waitcnt lgkmcnt(8)
    v_mfma_f32_16x16x32_bf16 v[80:83], v[168:171], v[192:195], v[80:83]
    ds_read_b64_tr_b16 v[160:161], v246 offset:40960
    ds_read_b64_tr_b16 v[162:163], v246 offset:41984
    v_mfma_f32_16x16x32_bf16 v[84:87], v[168:171], v[196:199], v[84:87]
    v_mfma_f32_16x16x32_bf16 v[88:91], v[172:175], v[192:195], v[88:91]
    ds_read_b64_tr_b16 v[164:165], v247 offset:40960
    ds_read_b64_tr_b16 v[166:167], v247 offset:41984
    v_mfma_f32_16x16x32_bf16 v[92:95], v[172:175], v[196:199], v[92:95]
    s_waitcnt lgkmcnt(8)
    v_mfma_f32_16x16x32_bf16 v[96:99], v[176:179], v[192:195], v[96:99]
    ds_read_b64_tr_b16 v[168:169], v248 offset:40960
    ds_read_b64_tr_b16 v[170:171], v248 offset:41984
    v_mfma_f32_16x16x32_bf16 v[100:103], v[176:179], v[196:199], v[100:103]
    v_mfma_f32_16x16x32_bf16 v[104:107], v[180:183], v[192:195], v[104:107]
    ds_read_b64_tr_b16 v[172:173], v249 offset:40960
    ds_read_b64_tr_b16 v[174:175], v249 offset:41984
    v_mfma_f32_16x16x32_bf16 v[108:111], v[180:183], v[196:199], v[108:111]
    s_waitcnt lgkmcnt(8)
    v_mfma_f32_16x16x32_bf16 v[112:115], v[184:187], v[192:195], v[112:115]
    ds_read_b64_tr_b16 v[176:177], v250 offset:40960
    ds_read_b64_tr_b16 v[178:179], v250 offset:41984
    v_mfma_f32_16x16x32_bf16 v[116:119], v[184:187], v[196:199], v[116:119]
    v_mfma_f32_16x16x32_bf16 v[120:123], v[188:191], v[192:195], v[120:123]
    ds_read_b64_tr_b16 v[180:181], v251 offset:40960
    ds_read_b64_tr_b16 v[182:183], v251 offset:41984
    v_mfma_f32_16x16x32_bf16 v[124:127], v[188:191], v[196:199], v[124:127]
    s_waitcnt vmcnt(11) lgkmcnt(8)
    v_mfma_f32_16x16x32_bf16 v[64:67], v[160:163], v[200:203], v[64:67]
    ds_read_b64_tr_b16 v[184:185], v252 offset:40960
    ds_read_b64_tr_b16 v[186:187], v252 offset:41984
    v_mfma_f32_16x16x32_bf16 v[68:71], v[160:163], v[204:207], v[68:71]
    v_mfma_f32_16x16x32_bf16 v[72:75], v[164:167], v[200:203], v[72:75]
    ds_read_b64_tr_b16 v[188:189], v253 offset:40960
    ds_read_b64_tr_b16 v[190:191], v253 offset:41984
    v_mfma_f32_16x16x32_bf16 v[76:79], v[164:167], v[204:207], v[76:79]
    s_waitcnt lgkmcnt(8)
    v_mfma_f32_16x16x32_bf16 v[80:83], v[168:171], v[200:203], v[80:83]
    ds_read_b64_tr_b16 v[160:161], v246 offset:49152
    ds_read_b64_tr_b16 v[162:163], v246 offset:50176
    v_mfma_f32_16x16x32_bf16 v[84:87], v[168:171], v[204:207], v[84:87]
    v_mfma_f32_16x16x32_bf16 v[88:91], v[172:175], v[200:203], v[88:91]
    ds_read_b64_tr_b16 v[164:165], v247 offset:49152
    ds_read_b64_tr_b16 v[166:167], v247 offset:50176
    v_mfma_f32_16x16x32_bf16 v[92:95], v[172:175], v[204:207], v[92:95]
    s_waitcnt lgkmcnt(8)
    v_mfma_f32_16x16x32_bf16 v[96:99], v[176:179], v[200:203], v[96:99]
    ds_read_b64_tr_b16 v[168:169], v248 offset:49152
    ds_read_b64_tr_b16 v[170:171], v248 offset:50176
    v_mfma_f32_16x16x32_bf16 v[100:103], v[176:179], v[204:207], v[100:103]
    v_mfma_f32_16x16x32_bf16 v[104:107], v[180:183], v[200:203], v[104:107]
    ds_read_b64_tr_b16 v[172:173], v249 offset:49152
    ds_read_b64_tr_b16 v[174:175], v249 offset:50176
    v_mfma_f32_16x16x32_bf16 v[108:111], v[180:183], v[204:207], v[108:111]
    s_waitcnt lgkmcnt(8)
    v_mfma_f32_16x16x32_bf16 v[112:115], v[184:187], v[200:203], v[112:115]
    ds_read_b64_tr_b16 v[176:177], v250 offset:49152
    ds_read_b64_tr_b16 v[178:179], v250 offset:50176
    v_mfma_f32_16x16x32_bf16 v[116:119], v[184:187], v[204:207], v[116:119]
    v_mfma_f32_16x16x32_bf16 v[120:123], v[188:191], v[200:203], v[120:123]
    ds_read_b64_tr_b16 v[180:181], v251 offset:49152
    ds_read_b64_tr_b16 v[182:183], v251 offset:50176
    v_mfma_f32_16x16x32_bf16 v[124:127], v[188:191], v[204:207], v[124:127]
    s_waitcnt vmcnt(6) lgkmcnt(8)
    v_mfma_f32_16x16x32_bf16 v[64:67], v[160:163], v[208:211], v[64:67]
    ds_read_b64_tr_b16 v[184:185], v252 offset:49152
    ds_read_b64_tr_b16 v[186:187], v252 offset:50176
    v_mfma_f32_16x16x32_bf16 v[68:71], v[160:163], v[212:215], v[68:71]
    v_lshlrev_b32 v255, 3, v243
    v_mov_b32 v254, 0x40000000
    v_cmp_gt_u32 vcc, 160, v243
    s_nop 1
    v_cndmask_b32 v255, v254, v255, vcc
    v_mfma_f32_16x16x32_bf16 v[72:75], v[164:167], v[208:211], v[72:75]
    ds_read_b64_tr_b16 v[188:189], v253 offset:49152
    ds_read_b64_tr_b16 v[190:191], v253 offset:50176
    v_mfma_f32_16x16x32_bf16 v[76:79], v[164:167], v[212:215], v[76:79]
    s_waitcnt lgkmcnt(8)
    v_mfma_f32_16x16x32_bf16 v[80:83], v[168:171], v[208:211], v[80:83]
    ds_read_b64_tr_b16 v[160:161], v246 offset:57344
    ds_read_b64_tr_b16 v[162:163], v246 offset:58368
    v_mfma_f32_16x16x32_bf16 v[84:87], v[168:171], v[212:215], v[84:87]
    v_mfma_f32_16x16x32_bf16 v[88:91], v[172:175], v[208:211], v[88:91]
    ds_read_b64_tr_b16 v[164:165], v247 offset:57344
    ds_read_b64_tr_b16 v[166:167], v247 offset:58368
    v_mfma_f32_16x16x32_bf16 v[92:95], v[172:175], v[212:215], v[92:95]
    s_waitcnt lgkmcnt(8)
    v_mfma_f32_16x16x32_bf16 v[96:99], v[176:179], v[208:211], v[96:99]
    ds_read_b64_tr_b16 v[168:169], v248 offset:57344
    ds_read_b64_tr_b16 v[170:171], v248 offset:58368
    v_mfma_f32_16x16x32_bf16 v[100:103], v[176:179], v[212:215], v[100:103]
    v_bfe_u32 v196, v243, 4, 2
    v_lshlrev_b32 v196, 6, v196
    buffer_load_dword v192, v196, s[12:15], s70 offen sc1
    v_mfma_f32_16x16x32_bf16 v[104:107], v[180:183], v[208:211], v[104:107]
    ds_read_b64_tr_b16 v[172:173], v249 offset:57344
    ds_read_b64_tr_b16 v[174:175], v249 offset:58368
    v_mfma_f32_16x16x32_bf16 v[108:111], v[180:183], v[212:215], v[108:111]
    s_waitcnt lgkmcnt(8)
    v_mfma_f32_16x16x32_bf16 v[112:115], v[184:187], v[208:211], v[112:115]
    ds_read_b64_tr_b16 v[176:177], v250 offset:57344
    ds_read_b64_tr_b16 v[178:179], v250 offset:58368
    v_mfma_f32_16x16x32_bf16 v[116:119], v[184:187], v[212:215], v[116:119]
    v_mfma_f32_16x16x32_bf16 v[120:123], v[188:191], v[208:211], v[120:123]
    ds_read_b64_tr_b16 v[180:181], v251 offset:57344
    ds_read_b64_tr_b16 v[182:183], v251 offset:58368
    v_mfma_f32_16x16x32_bf16 v[124:127], v[188:191], v[212:215], v[124:127]
    s_waitcnt vmcnt(5) lgkmcnt(8)
    v_mfma_f32_16x16x32_bf16 v[64:67], v[160:163], v[216:219], v[64:67]
    ds_read_b64_tr_b16 v[184:185], v252 offset:57344
    ds_read_b64_tr_b16 v[186:187], v252 offset:58368
    v_mfma_f32_16x16x32_bf16 v[68:71], v[160:163], v[220:223], v[68:71]
    v_mov_b32 v0, 0
    v_mov_b32 v1, 0
    v_mov_b32 v2, 0
    v_mov_b32 v3, 0
    v_mfma_f32_16x16x32_bf16 v[72:75], v[164:167], v[216:219], v[72:75]
    ds_read_b64_tr_b16 v[188:189], v253 offset:57344
    ds_read_b64_tr_b16 v[190:191], v253 offset:58368
    v_mfma_f32_16x16x32_bf16 v[76:79], v[164:167], v[220:223], v[76:79]
    v_mov_b32 v4, 0
    v_mov_b32 v5, 0
    v_mov_b32 v6, 0
    v_mov_b32 v7, 0
    s_waitcnt lgkmcnt(8)
    v_mfma_f32_16x16x32_bf16 v[80:83], v[168:171], v[216:219], v[80:83]
    s_waitcnt vmcnt(9)
    s_barrier
    v_subrev_u32 v246, 0x10000, v246
    v_subrev_u32 v247, 0x10000, v247
    v_subrev_u32 v248, 0x10000, v248
    v_subrev_u32 v249, 0x10000, v249
    v_subrev_u32 v250, 0x10000, v250
    v_subrev_u32 v251, 0x10000, v251
    v_subrev_u32 v252, 0x10000, v252
    v_subrev_u32 v253, 0x10000, v253
    ds_read_b64_tr_b16 v[160:161], v246 offset:0
    ds_read_b64_tr_b16 v[162:163], v246 offset:1024
    v_mfma_f32_16x16x32_bf16 v[84:87], v[168:171], v[220:223], v[84:87]
    v_mov_b32 v8, 0
    v_mov_b32 v9, 0
    v_mov_b32 v10, 0
    v_mov_b32 v11, 0
    v_mfma_f32_16x16x32_bf16 v[88:91], v[172:175], v[216:219], v[88:91]
    ds_read_b64_tr_b16 v[164:165], v247 offset:0
    ds_read_b64_tr_b16 v[166:167], v247 offset:1024
    v_mfma_f32_16x16x32_bf16 v[92:95], v[172:175], v[220:223], v[92:95]
    v_mov_b32 v12, 0
    v_mov_b32 v13, 0
    v_mov_b32 v14, 0
    v_mov_b32 v15, 0
    s_waitcnt lgkmcnt(8)
    v_mfma_f32_16x16x32_bf16 v[96:99], v[176:179], v[216:219], v[96:99]
    ds_read_b64_tr_b16 v[168:169], v248 offset:0
    ds_read_b64_tr_b16 v[170:171], v248 offset:1024
    v_mfma_f32_16x16x32_bf16 v[100:103], v[176:179], v[220:223], v[100:103]
    v_mov_b32 v16, 0
    v_mov_b32 v17, 0
    v_mov_b32 v18, 0
    v_mov_b32 v19, 0
    v_mfma_f32_16x16x32_bf16 v[104:107], v[180:183], v[216:219], v[104:107]
    ds_read_b64_tr_b16 v[172:173], v249 offset:0
    ds_read_b64_tr_b16 v[174:175], v249 offset:1024
    v_mfma_f32_16x16x32_bf16 v[108:111], v[180:183], v[220:223], v[108:111]
    v_mov_b32 v20, 0
    v_mov_b32 v21, 0
    v_mov_b32 v22, 0
    v_mov_b32 v23, 0
    s_waitcnt lgkmcnt(8)
    v_mfma_f32_16x16x32_bf16 v[112:115], v[184:187], v[216:219], v[112:115]
    ds_read_b64_tr_b16 v[176:177], v250 offset:0
    ds_read_b64_tr_b16 v[178:179], v250 offset:1024
    v_mfma_f32_16x16x32_bf16 v[116:119], v[184:187], v[220:223], v[116:119]
    v_mov_b32 v24, 0
    v_mov_b32 v25, 0
    v_mov_b32 v26, 0
    v_mov_b32 v27, 0
    s_waitcnt vmcnt(0)
    s_mov_b32 s35, 0x40000
parallel_sum__compressed_kv_cla__moe_arch_mod__prompt_kernel_chk_kv0fast:
    v_xor_b32 v192, s87, v192
    v_cmp_ne_u32 s[84:85], 0, v192
    s_nop 1
    s_cmp_eq_u64 s[84:85], 0
    s_cbranch_scc1 parallel_sum__compressed_kv_cla__moe_arch_mod__prompt_kernel_chk_kv0fast_ok
    s_sub_u32 s35, s35, 1
    s_cbranch_scc1 parallel_sum__compressed_kv_cla__moe_arch_mod__prompt_kernel_chk_kv0fast_ok
    s_sleep 1
    buffer_load_dword v192, v196, s[12:15], s70 offen sc1
    s_waitcnt vmcnt(0)
    s_branch parallel_sum__compressed_kv_cla__moe_arch_mod__prompt_kernel_chk_kv0fast
parallel_sum__compressed_kv_cla__moe_arch_mod__prompt_kernel_chk_kv0fast_ok:
    v_mfma_f32_16x16x32_bf16 v[120:123], v[188:191], v[216:219], v[120:123]
    ds_read_b64_tr_b16 v[180:181], v251 offset:0
    ds_read_b64_tr_b16 v[182:183], v251 offset:1024
    v_mfma_f32_16x16x32_bf16 v[124:127], v[188:191], v[220:223], v[124:127]
    s_mul_i32 s47, s36, 16384
    s_add_u32 s48, s47, 4294893568
    s_cmp_lt_u32 s36, 2
    s_cselect_b32 s43, s47, s48
    s_add_u32 s44, s44, 32768
    s_mov_b32 m0, s44
    s_max_i32 s53, s43, 0
    s_add_u32 s49, s53, 4096
    buffer_load_dwordx4 v243, s[16:19], s53 offen offset:0 sc1 lds
    v_mov_b32 v28, 0
    v_mov_b32 v29, 0
    v_mov_b32 v30, 0
    v_mov_b32 v31, 0
    s_waitcnt vmcnt(4) lgkmcnt(8)
    v_mfma_f32_16x16x32_bf16 v[64:67], v[160:163], v[224:227], v[64:67]
    ds_read_b64_tr_b16 v[184:185], v252 offset:0
    ds_read_b64_tr_b16 v[186:187], v252 offset:1024
    v_mfma_f32_16x16x32_bf16 v[68:71], v[160:163], v[228:231], v[68:71]
    buffer_load_dwordx4 v243, s[16:19], s53 offen offset:1024 sc1 lds
    v_mov_b32 v32, 0
    v_mov_b32 v33, 0
    v_mov_b32 v34, 0
    v_mov_b32 v35, 0
    v_mfma_f32_16x16x32_bf16 v[72:75], v[164:167], v[224:227], v[72:75]
    ds_read_b64_tr_b16 v[188:189], v253 offset:0
    ds_read_b64_tr_b16 v[190:191], v253 offset:1024
    v_mfma_f32_16x16x32_bf16 v[76:79], v[164:167], v[228:231], v[76:79]
    buffer_load_dwordx4 v243, s[16:19], s53 offen offset:2048 sc1 lds
    v_mov_b32 v36, 0
    v_mov_b32 v37, 0
    v_mov_b32 v38, 0
    v_mov_b32 v39, 0
    s_waitcnt lgkmcnt(8)
    v_mfma_f32_16x16x32_bf16 v[80:83], v[168:171], v[224:227], v[80:83]
    ds_read_b64_tr_b16 v[160:161], v246 offset:8192
    ds_read_b64_tr_b16 v[162:163], v246 offset:9216
    v_mfma_f32_16x16x32_bf16 v[84:87], v[168:171], v[228:231], v[84:87]
    buffer_load_dwordx4 v243, s[16:19], s53 offen offset:3072 sc1 lds
    v_mov_b32 v40, 0
    v_mov_b32 v41, 0
    v_mov_b32 v42, 0
    v_mov_b32 v43, 0
    v_mfma_f32_16x16x32_bf16 v[88:91], v[172:175], v[224:227], v[88:91]
    ds_read_b64_tr_b16 v[164:165], v247 offset:8192
    ds_read_b64_tr_b16 v[166:167], v247 offset:9216
    v_mfma_f32_16x16x32_bf16 v[92:95], v[172:175], v[228:231], v[92:95]
    s_add_u32 m0, s44, 4096
    s_add_u32 s44, s44, 32768
    buffer_load_dwordx4 v243, s[16:19], s49 offen offset:0 sc1 lds
    v_mov_b32 v44, 0
    v_mov_b32 v45, 0
    v_mov_b32 v46, 0
    v_mov_b32 v47, 0
    s_waitcnt lgkmcnt(8)
    v_mfma_f32_16x16x32_bf16 v[96:99], v[176:179], v[224:227], v[96:99]
    ds_read_b64_tr_b16 v[168:169], v248 offset:8192
    ds_read_b64_tr_b16 v[170:171], v248 offset:9216
    v_mfma_f32_16x16x32_bf16 v[100:103], v[176:179], v[228:231], v[100:103]
    buffer_load_dwordx4 v243, s[16:19], s49 offen offset:1024 sc1 lds
    v_mov_b32 v48, 0
    v_mov_b32 v49, 0
    v_mov_b32 v50, 0
    v_mov_b32 v51, 0
    v_mfma_f32_16x16x32_bf16 v[104:107], v[180:183], v[224:227], v[104:107]
    ds_read_b64_tr_b16 v[172:173], v249 offset:8192
    ds_read_b64_tr_b16 v[174:175], v249 offset:9216
    v_mfma_f32_16x16x32_bf16 v[108:111], v[180:183], v[228:231], v[108:111]
    buffer_load_dwordx4 v243, s[16:19], s49 offen offset:2048 sc1 lds
    v_mov_b32 v52, 0
    v_mov_b32 v53, 0
    v_mov_b32 v54, 0
    v_mov_b32 v55, 0
    s_waitcnt lgkmcnt(8)
    v_mfma_f32_16x16x32_bf16 v[112:115], v[184:187], v[224:227], v[112:115]
    ds_read_b64_tr_b16 v[176:177], v250 offset:8192
    ds_read_b64_tr_b16 v[178:179], v250 offset:9216
    v_mfma_f32_16x16x32_bf16 v[116:119], v[184:187], v[228:231], v[116:119]
    buffer_load_dwordx4 v243, s[16:19], s49 offen offset:3072 sc1 lds
    s_add_u32 s43, s43, 32768
    s_and_b32 s44, s44, 0x1ffff
    v_mov_b32 v56, 0
    v_mov_b32 v57, 0
    v_mov_b32 v58, 0
    v_mov_b32 v59, 0
    v_mfma_f32_16x16x32_bf16 v[120:123], v[188:191], v[224:227], v[120:123]
    ds_read_b64_tr_b16 v[180:181], v251 offset:8192
    ds_read_b64_tr_b16 v[182:183], v251 offset:9216
    v_mfma_f32_16x16x32_bf16 v[124:127], v[188:191], v[228:231], v[124:127]
    s_mov_b32 m0, s44
    s_max_i32 s53, s43, 0
    s_add_u32 s49, s53, 4096
    buffer_load_dwordx4 v243, s[16:19], s53 offen offset:0 sc1 lds
    v_mov_b32 v60, 0
    v_mov_b32 v61, 0
    v_mov_b32 v62, 0
    v_mov_b32 v63, 0
    s_waitcnt vmcnt(10) lgkmcnt(8)
    v_mfma_f32_16x16x32_bf16 v[64:67], v[160:163], v[232:235], v[64:67]
    ds_read_b64_tr_b16 v[184:185], v252 offset:8192
    ds_read_b64_tr_b16 v[186:187], v252 offset:9216
    v_mfma_f32_16x16x32_bf16 v[68:71], v[160:163], v[236:239], v[68:71]
    buffer_load_dwordx4 v243, s[16:19], s53 offen offset:1024 sc1 lds
    v_mfma_f32_16x16x32_bf16 v[72:75], v[164:167], v[232:235], v[72:75]
    ds_read_b64_tr_b16 v[188:189], v253 offset:8192
    ds_read_b64_tr_b16 v[190:191], v253 offset:9216
    v_mfma_f32_16x16x32_bf16 v[76:79], v[164:167], v[236:239], v[76:79]
    buffer_load_dwordx4 v243, s[16:19], s53 offen offset:2048 sc1 lds
    s_waitcnt lgkmcnt(8)
    v_mfma_f32_16x16x32_bf16 v[80:83], v[168:171], v[232:235], v[80:83]
    v_mfma_f32_16x16x32_bf16 v[84:87], v[168:171], v[236:239], v[84:87]
    buffer_load_dwordx4 v243, s[16:19], s53 offen offset:3072 sc1 lds
    v_mfma_f32_16x16x32_bf16 v[88:91], v[172:175], v[232:235], v[88:91]
    v_mfma_f32_16x16x32_bf16 v[92:95], v[172:175], v[236:239], v[92:95]
    s_add_u32 m0, s44, 4096
    s_add_u32 s44, s44, 32768
    buffer_load_dwordx4 v243, s[16:19], s49 offen offset:0 sc1 lds
    s_waitcnt lgkmcnt(4)
    v_mfma_f32_16x16x32_bf16 v[96:99], v[176:179], v[232:235], v[96:99]
    v_mfma_f32_16x16x32_bf16 v[100:103], v[176:179], v[236:239], v[100:103]
    buffer_load_dwordx4 v243, s[16:19], s49 offen offset:1024 sc1 lds
    v_mfma_f32_16x16x32_bf16 v[104:107], v[180:183], v[232:235], v[104:107]
    v_mfma_f32_16x16x32_bf16 v[108:111], v[180:183], v[236:239], v[108:111]
    buffer_load_dwordx4 v243, s[16:19], s49 offen offset:2048 sc1 lds
    s_waitcnt lgkmcnt(0)
    v_mfma_f32_16x16x32_bf16 v[112:115], v[184:187], v[232:235], v[112:115]
    v_mfma_f32_16x16x32_bf16 v[116:119], v[184:187], v[236:239], v[116:119]
    buffer_load_dwordx4 v243, s[16:19], s49 offen offset:3072 sc1 lds
    s_add_u32 s43, s43, 32768
    s_and_b32 s44, s44, 0x1ffff
    v_mfma_f32_16x16x32_bf16 v[120:123], v[188:191], v[232:235], v[120:123]
    v_mfma_f32_16x16x32_bf16 v[124:127], v[188:191], v[236:239], v[124:127]
    buffer_load_dword v254, v255, s[20:23], s32 offen
    s_add_u32 s32, s32, 1280
    v_cvt_pk_bf16_f32 v128, v64, v65
    v_cvt_pk_bf16_f32 v129, v66, v67
    v_cvt_pk_bf16_f32 v130, v68, v69
    v_cvt_pk_bf16_f32 v131, v70, v71
    v_cvt_pk_bf16_f32 v132, v72, v73
    v_cvt_pk_bf16_f32 v133, v74, v75
    v_cvt_pk_bf16_f32 v134, v76, v77
    v_cvt_pk_bf16_f32 v135, v78, v79
    v_cvt_pk_bf16_f32 v136, v80, v81
    v_cvt_pk_bf16_f32 v137, v82, v83
    v_cvt_pk_bf16_f32 v138, v84, v85
    v_cvt_pk_bf16_f32 v139, v86, v87
    v_cvt_pk_bf16_f32 v140, v88, v89
    v_cvt_pk_bf16_f32 v141, v90, v91
    v_cvt_pk_bf16_f32 v142, v92, v93
    v_cvt_pk_bf16_f32 v143, v94, v95
    v_cvt_pk_bf16_f32 v144, v96, v97
    v_cvt_pk_bf16_f32 v145, v98, v99
    v_cvt_pk_bf16_f32 v146, v100, v101
    v_cvt_pk_bf16_f32 v147, v102, v103
    v_cvt_pk_bf16_f32 v148, v104, v105
    v_cvt_pk_bf16_f32 v149, v106, v107
    v_cvt_pk_bf16_f32 v150, v108, v109
    v_cvt_pk_bf16_f32 v151, v110, v111
    v_cvt_pk_bf16_f32 v152, v112, v113
    v_cvt_pk_bf16_f32 v153, v114, v115
    v_cvt_pk_bf16_f32 v154, v116, v117
    v_cvt_pk_bf16_f32 v155, v118, v119
    v_cvt_pk_bf16_f32 v156, v120, v121
    v_cvt_pk_bf16_f32 v157, v122, v123
    v_cvt_pk_bf16_f32 v158, v124, v125
    v_cvt_pk_bf16_f32 v159, v126, v127
    v_mov_b32 v246, 0xff800000
    v_bfe_u32 v244, v243, 4, 5
    v_lshrrev_b32 v247, 9, v243
    v_lshlrev_b32 v247, 2, v247
    v_sub_u32 v244, v244, v247
    s_nop 1
    v_permlane16_swap_b32 v128, v130
    v_permlane16_swap_b32 v129, v131
    v_permlane16_swap_b32 v132, v134
    v_permlane16_swap_b32 v133, v135
    v_permlane16_swap_b32 v136, v138
    v_permlane16_swap_b32 v137, v139
    v_permlane16_swap_b32 v140, v142
    v_permlane16_swap_b32 v141, v143
    v_permlane16_swap_b32 v144, v146
    v_permlane16_swap_b32 v145, v147
    v_permlane16_swap_b32 v148, v150
    v_permlane16_swap_b32 v149, v151
    v_permlane16_swap_b32 v152, v154
    v_permlane16_swap_b32 v153, v155
    v_permlane16_swap_b32 v156, v158
    v_permlane16_swap_b32 v157, v159
    s_nop 1
    v_permlane32_swap_b32 v128, v130
    v_permlane32_swap_b32 v129, v131
    v_permlane32_swap_b32 v132, v134
    v_permlane32_swap_b32 v133, v135
    v_permlane32_swap_b32 v136, v138
    v_permlane32_swap_b32 v137, v139
    v_permlane32_swap_b32 v140, v142
    v_permlane32_swap_b32 v141, v143
    v_permlane32_swap_b32 v144, v146
    v_permlane32_swap_b32 v145, v147
    v_permlane32_swap_b32 v148, v150
    v_permlane32_swap_b32 v149, v151
    v_permlane32_swap_b32 v152, v154
    v_permlane32_swap_b32 v153, v155
    v_permlane32_swap_b32 v156, v158
    v_permlane32_swap_b32 v157, v159
    v_mov_b32 v120, 0
    v_mov_b32 v121, 0
    v_mov_b32 v122, 0
    v_mov_b32 v123, 0
    v_mov_b32 v124, 0
    v_mov_b32 v125, 0
    v_mov_b32 v126, 0
    v_mov_b32 v127, 0
    v_mov_b32 v96, 0
    v_mov_b32 v97, 0
    v_mov_b32 v98, 0
    v_mov_b32 v99, 0
    v_mov_b32 v100, 0
    v_mov_b32 v101, 0
    v_mov_b32 v102, 0
    v_mov_b32 v103, 0
    v_mov_b32 v104, 0
    v_mov_b32 v105, 0
    v_mov_b32 v106, 0
    v_mov_b32 v107, 0
    v_mov_b32 v108, 0
    v_mov_b32 v109, 0
    v_mov_b32 v110, 0
    v_mov_b32 v111, 0
    s_waitcnt vmcnt(9)
    s_branch parallel_sum__compressed_kv_cla__moe_arch_mod__prompt_kernel_A_qdone
parallel_sum__compressed_kv_cla__moe_arch_mod__prompt_kernel_A_qslow:
    buffer_load_dwordx4 v[216:219], v255, s[12:15], s55 offen offset:2048 sc1
    buffer_load_dwordx4 v[220:223], v255, s[12:15], s55 offen offset:2304 sc1
    s_add_u32 s55, s55, 4096
    buffer_load_dwordx4 v[224:227], v255, s[12:15], s55 offen offset:0 sc1
    buffer_load_dwordx4 v[228:231], v255, s[12:15], s55 offen offset:256 sc1
    buffer_load_dwordx4 v[232:235], v255, s[12:15], s55 offen offset:2048 sc1
    buffer_load_dwordx4 v[236:239], v255, s[12:15], s55 offen offset:2304 sc1
    s_nop 7
    v_mul_f32 v64, s69, v64
    v_mul_f32 v65, s69, v65
    v_mul_f32 v66, s69, v66
    v_mul_f32 v67, s69, v67
    v_mul_f32 v80, s69, v80
    v_mul_f32 v81, s69, v81
    v_mul_f32 v82, s69, v82
    v_mul_f32 v83, s69, v83
    v_cvt_pk_bf16_f32 v128, v64, v65
    v_cvt_pk_bf16_f32 v129, v66, v67
    v_cvt_pk_bf16_f32 v130, v80, v81
    v_cvt_pk_bf16_f32 v131, v82, v83
    s_nop 1
    v_permlane32_swap_b32 v128, v130
    v_permlane32_swap_b32 v129, v131
    v_mul_f32 v68, s69, v68
    v_mul_f32 v69, s69, v69
    v_mul_f32 v70, s69, v70
    v_mul_f32 v71, s69, v71
    v_mul_f32 v84, s69, v84
    v_mul_f32 v85, s69, v85
    v_mul_f32 v86, s69, v86
    v_mul_f32 v87, s69, v87
    v_cvt_pk_bf16_f32 v132, v68, v69
    v_cvt_pk_bf16_f32 v133, v70, v71
    v_cvt_pk_bf16_f32 v134, v84, v85
    v_cvt_pk_bf16_f32 v135, v86, v87
    s_nop 1
    v_permlane32_swap_b32 v132, v134
    v_permlane32_swap_b32 v133, v135
    v_mul_f32 v72, s69, v72
    v_mul_f32 v73, s69, v73
    v_mul_f32 v74, s69, v74
    v_mul_f32 v75, s69, v75
    v_mul_f32 v88, s69, v88
    v_mul_f32 v89, s69, v89
    v_mul_f32 v90, s69, v90
    v_mul_f32 v91, s69, v91
    v_cvt_pk_bf16_f32 v136, v72, v73
    v_cvt_pk_bf16_f32 v137, v74, v75
    v_cvt_pk_bf16_f32 v138, v88, v89
    v_cvt_pk_bf16_f32 v139, v90, v91
    s_nop 1
    v_permlane32_swap_b32 v136, v138
    v_permlane32_swap_b32 v137, v139
    v_mul_f32 v76, s69, v76
    v_mul_f32 v77, s69, v77
    v_mul_f32 v78, s69, v78
    v_mul_f32 v79, s69, v79
    v_mul_f32 v92, s69, v92
    v_mul_f32 v93, s69, v93
    v_mul_f32 v94, s69, v94
    v_mul_f32 v95, s69, v95
    v_cvt_pk_bf16_f32 v140, v76, v77
    v_cvt_pk_bf16_f32 v141, v78, v79
    v_cvt_pk_bf16_f32 v142, v92, v93
    v_cvt_pk_bf16_f32 v143, v94, v95
    s_nop 1
    v_permlane32_swap_b32 v140, v142
    v_permlane32_swap_b32 v141, v143
    v_mul_f32 v96, s69, v96
    v_mul_f32 v97, s69, v97
    v_mul_f32 v98, s69, v98
    v_mul_f32 v99, s69, v99
    v_mul_f32 v112, s69, v112
    v_mul_f32 v113, s69, v113
    v_mul_f32 v114, s69, v114
    v_mul_f32 v115, s69, v115
    v_cvt_pk_bf16_f32 v144, v96, v97
    v_cvt_pk_bf16_f32 v145, v98, v99
    v_cvt_pk_bf16_f32 v146, v112, v113
    v_cvt_pk_bf16_f32 v147, v114, v115
    s_nop 1
    v_permlane32_swap_b32 v144, v146
    v_permlane32_swap_b32 v145, v147
    v_mul_f32 v100, s69, v100
    v_mul_f32 v101, s69, v101
    v_mul_f32 v102, s69, v102
    v_mul_f32 v103, s69, v103
    v_mul_f32 v116, s69, v116
    v_mul_f32 v117, s69, v117
    v_mul_f32 v118, s69, v118
    v_mul_f32 v119, s69, v119
    v_cvt_pk_bf16_f32 v148, v100, v101
    v_cvt_pk_bf16_f32 v149, v102, v103
    v_cvt_pk_bf16_f32 v150, v116, v117
    v_cvt_pk_bf16_f32 v151, v118, v119
    s_nop 1
    v_permlane32_swap_b32 v148, v150
    v_permlane32_swap_b32 v149, v151
    v_mul_f32 v104, s69, v104
    v_mul_f32 v105, s69, v105
    v_mul_f32 v106, s69, v106
    v_mul_f32 v107, s69, v107
    v_mul_f32 v120, s69, v120
    v_mul_f32 v121, s69, v121
    v_mul_f32 v122, s69, v122
    v_mul_f32 v123, s69, v123
    v_cvt_pk_bf16_f32 v152, v104, v105
    v_cvt_pk_bf16_f32 v153, v106, v107
    v_cvt_pk_bf16_f32 v154, v120, v121
    v_cvt_pk_bf16_f32 v155, v122, v123
    s_nop 1
    v_permlane32_swap_b32 v152, v154
    v_permlane32_swap_b32 v153, v155
    v_mul_f32 v108, s69, v108
    v_mul_f32 v109, s69, v109
    v_mul_f32 v110, s69, v110
    v_mul_f32 v111, s69, v111
    v_mul_f32 v124, s69, v124
    v_mul_f32 v125, s69, v125
    v_mul_f32 v126, s69, v126
    v_mul_f32 v127, s69, v127
    v_cvt_pk_bf16_f32 v156, v108, v109
    v_cvt_pk_bf16_f32 v157, v110, v111
    v_cvt_pk_bf16_f32 v158, v124, v125
    v_cvt_pk_bf16_f32 v159, v126, v127
    s_nop 1
    v_permlane32_swap_b32 v156, v158
    v_permlane32_swap_b32 v157, v159
    s_waitcnt vmcnt(24)
    s_barrier
    ds_read_b64_tr_b16 v[160:161], v246 offset:0
    ds_read_b64_tr_b16 v[162:163], v246 offset:1024
    ds_read_b64_tr_b16 v[164:165], v247 offset:0
    ds_read_b64_tr_b16 v[166:167], v247 offset:1024
    ds_read_b64_tr_b16 v[168:169], v248 offset:0
    ds_read_b64_tr_b16 v[170:171], v248 offset:1024
    ds_read_b64_tr_b16 v[172:173], v249 offset:0
    ds_read_b64_tr_b16 v[174:175], v249 offset:1024
    ds_read_b64_tr_b16 v[176:177], v250 offset:0
    ds_read_b64_tr_b16 v[178:179], v250 offset:1024
    ds_read_b64_tr_b16 v[180:181], v251 offset:0
    ds_read_b64_tr_b16 v[182:183], v251 offset:1024
    s_waitcnt vmcnt(10) lgkmcnt(8)
    v_mfma_f32_16x16x32_bf16 v[64:67], v[160:163], v[192:195], 0
    ds_read_b64_tr_b16 v[184:185], v252 offset:0
    ds_read_b64_tr_b16 v[186:187], v252 offset:1024
    v_mfma_f32_16x16x32_bf16 v[68:71], v[160:163], v[196:199], 0
    s_add_u32 m0, s44, 98304
    s_add_u32 s49, s43, 3145728
    buffer_load_dwordx4 v245, s[8:11], s49 offen lds
    v_mul_f32 v0, s69, v0
    v_mul_f32 v1, s69, v1
    v_mul_f32 v2, s69, v2
    v_mul_f32 v3, s69, v3
    v_mfma_f32_16x16x32_bf16 v[72:75], v[164:167], v[192:195], 0
    ds_read_b64_tr_b16 v[188:189], v253 offset:0
    ds_read_b64_tr_b16 v[190:191], v253 offset:1024
    v_mfma_f32_16x16x32_bf16 v[76:79], v[164:167], v[196:199], 0
    s_add_u32 m0, s44, 99328
    s_add_u32 s49, s43, 3178496
    buffer_load_dwordx4 v245, s[8:11], s49 offen lds
    v_mul_f32 v16, s69, v16
    v_mul_f32 v17, s69, v17
    v_mul_f32 v18, s69, v18
    v_mul_f32 v19, s69, v19
    s_waitcnt lgkmcnt(8)
    v_mfma_f32_16x16x32_bf16 v[80:83], v[168:171], v[192:195], 0
    ds_read_b64_tr_b16 v[160:161], v246 offset:8192
    ds_read_b64_tr_b16 v[162:163], v246 offset:9216
    v_mfma_f32_16x16x32_bf16 v[84:87], v[168:171], v[196:199], 0
    s_add_u32 m0, s44, 100352
    s_add_u32 s49, s43, 3211264
    buffer_load_dwordx4 v244, s[8:11], s49 offen lds
    v_cvt_pk_bf16_f32 v0, v0, v1
    v_cvt_pk_bf16_f32 v1, v2, v3
    v_cvt_pk_bf16_f32 v2, v16, v17
    v_cvt_pk_bf16_f32 v3, v18, v19
    v_mfma_f32_16x16x32_bf16 v[88:91], v[172:175], v[192:195], 0
    ds_read_b64_tr_b16 v[164:165], v247 offset:8192
    ds_read_b64_tr_b16 v[166:167], v247 offset:9216
    v_mfma_f32_16x16x32_bf16 v[92:95], v[172:175], v[196:199], 0
    s_add_u32 m0, s44, 101376
    s_add_u32 s49, s43, 3244032
    buffer_load_dwordx4 v244, s[8:11], s49 offen lds
    s_nop 1
    v_permlane32_swap_b32 v0, v2
    v_permlane32_swap_b32 v1, v3
    v_mul_f32 v4, s69, v4
    s_waitcnt lgkmcnt(8)
    v_mfma_f32_16x16x32_bf16 v[96:99], v[176:179], v[192:195], 0
    ds_read_b64_tr_b16 v[168:169], v248 offset:8192
    ds_read_b64_tr_b16 v[170:171], v248 offset:9216
    v_mfma_f32_16x16x32_bf16 v[100:103], v[176:179], v[196:199], 0
    s_add_u32 m0, s44, 102400
    s_add_u32 s49, s43, 3276800
    buffer_load_dwordx4 v245, s[8:11], s49 offen lds
    v_mul_f32 v5, s69, v5
    v_mul_f32 v6, s69, v6
    v_mul_f32 v7, s69, v7
    v_mul_f32 v20, s69, v20
    v_mfma_f32_16x16x32_bf16 v[104:107], v[180:183], v[192:195], 0
    ds_read_b64_tr_b16 v[172:173], v249 offset:8192
    ds_read_b64_tr_b16 v[174:175], v249 offset:9216
    v_mfma_f32_16x16x32_bf16 v[108:111], v[180:183], v[196:199], 0
    s_add_u32 m0, s44, 103424
    s_add_u32 s49, s43, 3309568
    buffer_load_dwordx4 v245, s[8:11], s49 offen lds
    v_mul_f32 v21, s69, v21
    v_mul_f32 v22, s69, v22
    v_mul_f32 v23, s69, v23
    v_cvt_pk_bf16_f32 v4, v4, v5
    s_waitcnt lgkmcnt(8)
    v_mfma_f32_16x16x32_bf16 v[112:115], v[184:187], v[192:195], 0
    ds_read_b64_tr_b16 v[176:177], v250 offset:8192
    ds_read_b64_tr_b16 v[178:179], v250 offset:9216
    v_mfma_f32_16x16x32_bf16 v[116:119], v[184:187], v[196:199], 0
    s_add_u32 m0, s44, 104448
    s_add_u32 s49, s43, 3342336
    buffer_load_dwordx4 v244, s[8:11], s49 offen lds
    v_cvt_pk_bf16_f32 v5, v6, v7
    v_cvt_pk_bf16_f32 v6, v20, v21
    v_cvt_pk_bf16_f32 v7, v22, v23
    s_nop 1
    v_mfma_f32_16x16x32_bf16 v[120:123], v[188:191], v[192:195], 0
    ds_read_b64_tr_b16 v[180:181], v251 offset:8192
    ds_read_b64_tr_b16 v[182:183], v251 offset:9216
    v_mfma_f32_16x16x32_bf16 v[124:127], v[188:191], v[196:199], 0
    s_add_u32 s55, s55, 4096
    buffer_load_dwordx4 v[192:195], v255, s[12:15], s55 offen offset:0 sc1
    v_permlane32_swap_b32 v4, v6
    v_permlane32_swap_b32 v5, v7
    v_mul_f32 v8, s69, v8
    v_mul_f32 v9, s69, v9
    s_waitcnt vmcnt(16) lgkmcnt(8)
    v_mfma_f32_16x16x32_bf16 v[64:67], v[160:163], v[200:203], v[64:67]
    ds_read_b64_tr_b16 v[184:185], v252 offset:8192
    ds_read_b64_tr_b16 v[186:187], v252 offset:9216
    v_mfma_f32_16x16x32_bf16 v[68:71], v[160:163], v[204:207], v[68:71]
    s_add_u32 s68, s68, 32768
    buffer_store_dwordx4 v[128:131], v242, s[12:15], s68 offen offset:0 sc1
    v_mul_f32 v10, s69, v10
    v_mul_f32 v11, s69, v11
    v_mul_f32 v24, s69, v24
    v_mul_f32 v25, s69, v25
    v_mfma_f32_16x16x32_bf16 v[72:75], v[164:167], v[200:203], v[72:75]
    ds_read_b64_tr_b16 v[188:189], v253 offset:8192
    ds_read_b64_tr_b16 v[190:191], v253 offset:9216
    v_mfma_f32_16x16x32_bf16 v[76:79], v[164:167], v[204:207], v[76:79]
    buffer_load_dwordx4 v[196:199], v255, s[12:15], s55 offen offset:256 sc1
    v_mul_f32 v26, s69, v26
    v_mul_f32 v27, s69, v27
    v_cvt_pk_bf16_f32 v8, v8, v9
    v_cvt_pk_bf16_f32 v9, v10, v11
    s_waitcnt lgkmcnt(8)
    v_mfma_f32_16x16x32_bf16 v[80:83], v[168:171], v[200:203], v[80:83]
    ds_read_b64_tr_b16 v[160:161], v246 offset:16384
    ds_read_b64_tr_b16 v[162:163], v246 offset:17408
    v_mfma_f32_16x16x32_bf16 v[84:87], v[168:171], v[204:207], v[84:87]
    s_add_u32 m0, s44, 105472
    s_add_u32 s49, s43, 3375104
    buffer_load_dwordx4 v244, s[8:11], s49 offen lds
    v_cvt_pk_bf16_f32 v10, v24, v25
    v_cvt_pk_bf16_f32 v11, v26, v27
    s_nop 1
    v_permlane32_swap_b32 v8, v10
    v_mfma_f32_16x16x32_bf16 v[88:91], v[172:175], v[200:203], v[88:91]
    ds_read_b64_tr_b16 v[164:165], v247 offset:16384
    ds_read_b64_tr_b16 v[166:167], v247 offset:17408
    v_mfma_f32_16x16x32_bf16 v[92:95], v[172:175], v[204:207], v[92:95]
    v_permlane32_swap_b32 v9, v11
    v_mul_f32 v12, s69, v12
    v_mul_f32 v13, s69, v13
    v_mul_f32 v14, s69, v14
    s_waitcnt lgkmcnt(8)
    v_mfma_f32_16x16x32_bf16 v[96:99], v[176:179], v[200:203], v[96:99]
    ds_read_b64_tr_b16 v[168:169], v248 offset:16384
    ds_read_b64_tr_b16 v[170:171], v248 offset:17408
    v_mfma_f32_16x16x32_bf16 v[100:103], v[176:179], v[204:207], v[100:103]
    v_mul_f32 v15, s69, v15
    v_mul_f32 v28, s69, v28
    v_mul_f32 v29, s69, v29
    v_mul_f32 v30, s69, v30
    v_mfma_f32_16x16x32_bf16 v[104:107], v[180:183], v[200:203], v[104:107]
    ds_read_b64_tr_b16 v[172:173], v249 offset:16384
    ds_read_b64_tr_b16 v[174:175], v249 offset:17408
    v_mfma_f32_16x16x32_bf16 v[108:111], v[180:183], v[204:207], v[108:111]
    v_mul_f32 v31, s69, v31
    v_cvt_pk_bf16_f32 v12, v12, v13
    v_cvt_pk_bf16_f32 v13, v14, v15
    v_cvt_pk_bf16_f32 v14, v28, v29
    s_waitcnt lgkmcnt(8)
    v_mfma_f32_16x16x32_bf16 v[112:115], v[184:187], v[200:203], v[112:115]
    ds_read_b64_tr_b16 v[176:177], v250 offset:16384
    ds_read_b64_tr_b16 v[178:179], v250 offset:17408
    v_mfma_f32_16x16x32_bf16 v[116:119], v[184:187], v[204:207], v[116:119]
    v_cvt_pk_bf16_f32 v15, v30, v31
    s_nop 1
    v_permlane32_swap_b32 v12, v14
    v_permlane32_swap_b32 v13, v15
    v_mfma_f32_16x16x32_bf16 v[120:123], v[188:191], v[200:203], v[120:123]
    ds_read_b64_tr_b16 v[180:181], v251 offset:16384
    ds_read_b64_tr_b16 v[182:183], v251 offset:17408
    v_mfma_f32_16x16x32_bf16 v[124:127], v[188:191], v[204:207], v[124:127]
    buffer_store_dwordx4 v[132:135], v242, s[12:15], s68 offen offset:1024 sc1
    v_mul_f32 v32, s69, v32
    v_mul_f32 v33, s69, v33
    v_mul_f32 v34, s69, v34
    v_mul_f32 v35, s69, v35
    s_waitcnt vmcnt(18) lgkmcnt(8)
    v_mfma_f32_16x16x32_bf16 v[64:67], v[160:163], v[208:211], v[64:67]
    ds_read_b64_tr_b16 v[184:185], v252 offset:16384
    ds_read_b64_tr_b16 v[186:187], v252 offset:17408
    v_mfma_f32_16x16x32_bf16 v[68:71], v[160:163], v[212:215], v[68:71]
    buffer_load_dwordx4 v[200:203], v255, s[12:15], s55 offen offset:2048 sc1
    v_mul_f32 v48, s69, v48
    v_mul_f32 v49, s69, v49
    v_mul_f32 v50, s69, v50
    v_mul_f32 v51, s69, v51
    v_mfma_f32_16x16x32_bf16 v[72:75], v[164:167], v[208:211], v[72:75]
    ds_read_b64_tr_b16 v[188:189], v253 offset:16384
    ds_read_b64_tr_b16 v[190:191], v253 offset:17408
    v_mfma_f32_16x16x32_bf16 v[76:79], v[164:167], v[212:215], v[76:79]
    buffer_load_dwordx4 v[204:207], v255, s[12:15], s55 offen offset:2304 sc1
    v_cvt_pk_bf16_f32 v16, v32, v33
    v_cvt_pk_bf16_f32 v17, v34, v35
    v_cvt_pk_bf16_f32 v18, v48, v49
    v_cvt_pk_bf16_f32 v19, v50, v51
    s_waitcnt lgkmcnt(8)
    v_mfma_f32_16x16x32_bf16 v[80:83], v[168:171], v[208:211], v[80:83]
    ds_read_b64_tr_b16 v[160:161], v246 offset:24576
    ds_read_b64_tr_b16 v[162:163], v246 offset:25600
    v_mfma_f32_16x16x32_bf16 v[84:87], v[168:171], v[212:215], v[84:87]
    s_nop 1
    v_permlane32_swap_b32 v16, v18
    v_permlane32_swap_b32 v17, v19
    v_mul_f32 v36, s69, v36
    v_mfma_f32_16x16x32_bf16 v[88:91], v[172:175], v[208:211], v[88:91]
    ds_read_b64_tr_b16 v[164:165], v247 offset:24576
    ds_read_b64_tr_b16 v[166:167], v247 offset:25600
    v_mfma_f32_16x16x32_bf16 v[92:95], v[172:175], v[212:215], v[92:95]
    v_mul_f32 v37, s69, v37
    v_mul_f32 v38, s69, v38
    v_mul_f32 v39, s69, v39
    v_mul_f32 v52, s69, v52
    s_waitcnt lgkmcnt(8)
    v_mfma_f32_16x16x32_bf16 v[96:99], v[176:179], v[208:211], v[96:99]
    ds_read_b64_tr_b16 v[168:169], v248 offset:24576
    ds_read_b64_tr_b16 v[170:171], v248 offset:25600
    v_mfma_f32_16x16x32_bf16 v[100:103], v[176:179], v[212:215], v[100:103]
    v_mul_f32 v53, s69, v53
    v_mul_f32 v54, s69, v54
    v_mul_f32 v55, s69, v55
    v_cvt_pk_bf16_f32 v20, v36, v37
    v_mfma_f32_16x16x32_bf16 v[104:107], v[180:183], v[208:211], v[104:107]
    ds_read_b64_tr_b16 v[172:173], v249 offset:24576
    ds_read_b64_tr_b16 v[174:175], v249 offset:25600
    v_mfma_f32_16x16x32_bf16 v[108:111], v[180:183], v[212:215], v[108:111]
    v_cvt_pk_bf16_f32 v21, v38, v39
    v_cvt_pk_bf16_f32 v22, v52, v53
    v_cvt_pk_bf16_f32 v23, v54, v55
    s_nop 1
    s_waitcnt lgkmcnt(8)
    v_mfma_f32_16x16x32_bf16 v[112:115], v[184:187], v[208:211], v[112:115]
    ds_read_b64_tr_b16 v[176:177], v250 offset:24576
    ds_read_b64_tr_b16 v[178:179], v250 offset:25600
    v_mfma_f32_16x16x32_bf16 v[116:119], v[184:187], v[212:215], v[116:119]
    buffer_store_dwordx4 v[136:139], v242, s[12:15], s68 offen offset:2048 sc1
    v_permlane32_swap_b32 v20, v22
    v_permlane32_swap_b32 v21, v23
    v_mul_f32 v40, s69, v40
    v_mul_f32 v41, s69, v41
    v_mfma_f32_16x16x32_bf16 v[120:123], v[188:191], v[208:211], v[120:123]
    ds_read_b64_tr_b16 v[180:181], v251 offset:24576
    ds_read_b64_tr_b16 v[182:183], v251 offset:25600
    v_mfma_f32_16x16x32_bf16 v[124:127], v[188:191], v[212:215], v[124:127]
    s_add_u32 s55, s55, 4096
    buffer_load_dwordx4 v[208:211], v255, s[12:15], s55 offen offset:0 sc1
    v_mul_f32 v42, s69, v42
    v_mul_f32 v43, s69, v43
    v_mul_f32 v56, s69, v56
    v_mul_f32 v57, s69, v57
    s_waitcnt vmcnt(20) lgkmcnt(8)
    v_mfma_f32_16x16x32_bf16 v[64:67], v[160:163], v[216:219], v[64:67]
    ds_read_b64_tr_b16 v[184:185], v252 offset:24576
    ds_read_b64_tr_b16 v[186:187], v252 offset:25600
    v_mfma_f32_16x16x32_bf16 v[68:71], v[160:163], v[220:223], v[68:71]
    buffer_load_dwordx4 v[212:215], v255, s[12:15], s55 offen offset:256 sc1
    v_mul_f32 v58, s69, v58
    v_mul_f32 v59, s69, v59
    v_cvt_pk_bf16_f32 v24, v40, v41
    v_cvt_pk_bf16_f32 v25, v42, v43
    v_mfma_f32_16x16x32_bf16 v[72:75], v[164:167], v[216:219], v[72:75]
    ds_read_b64_tr_b16 v[188:189], v253 offset:24576
    ds_read_b64_tr_b16 v[190:191], v253 offset:25600
    v_mfma_f32_16x16x32_bf16 v[76:79], v[164:167], v[220:223], v[76:79]
    v_cvt_pk_bf16_f32 v26, v56, v57
    v_cvt_pk_bf16_f32 v27, v58, v59
    s_nop 1
    v_permlane32_swap_b32 v24, v26
    s_waitcnt lgkmcnt(8)
    v_mfma_f32_16x16x32_bf16 v[80:83], v[168:171], v[216:219], v[80:83]
    s_waitcnt vmcnt(29)
    s_barrier
    ds_read_b64_tr_b16 v[160:161], v246 offset:32768
    ds_read_b64_tr_b16 v[162:163], v246 offset:33792
    v_mfma_f32_16x16x32_bf16 v[84:87], v[168:171], v[220:223], v[84:87]
    v_permlane32_swap_b32 v25, v27
    v_mul_f32 v44, s69, v44
    v_mul_f32 v45, s69, v45
    v_mul_f32 v46, s69, v46
    v_mfma_f32_16x16x32_bf16 v[88:91], v[172:175], v[216:219], v[88:91]
    ds_read_b64_tr_b16 v[164:165], v247 offset:32768
    ds_read_b64_tr_b16 v[166:167], v247 offset:33792
    v_mfma_f32_16x16x32_bf16 v[92:95], v[172:175], v[220:223], v[92:95]
    v_mul_f32 v47, s69, v47
    v_mul_f32 v60, s69, v60
    v_mul_f32 v61, s69, v61
    v_mul_f32 v62, s69, v62
    s_waitcnt lgkmcnt(8)
    v_mfma_f32_16x16x32_bf16 v[96:99], v[176:179], v[216:219], v[96:99]
    ds_read_b64_tr_b16 v[168:169], v248 offset:32768
    ds_read_b64_tr_b16 v[170:171], v248 offset:33792
    v_mfma_f32_16x16x32_bf16 v[100:103], v[176:179], v[220:223], v[100:103]
    v_mul_f32 v63, s69, v63
    v_cvt_pk_bf16_f32 v28, v44, v45
    v_cvt_pk_bf16_f32 v29, v46, v47
    v_cvt_pk_bf16_f32 v30, v60, v61
    v_mfma_f32_16x16x32_bf16 v[104:107], v[180:183], v[216:219], v[104:107]
    ds_read_b64_tr_b16 v[172:173], v249 offset:32768
    ds_read_b64_tr_b16 v[174:175], v249 offset:33792
    v_mfma_f32_16x16x32_bf16 v[108:111], v[180:183], v[220:223], v[108:111]
    buffer_store_dwordx4 v[140:143], v242, s[12:15], s68 offen offset:3072 sc1
    s_add_u32 s68, s68, 16384
    v_cvt_pk_bf16_f32 v31, v62, v63
    s_nop 1
    v_permlane32_swap_b32 v28, v30
    v_permlane32_swap_b32 v29, v31
    s_waitcnt lgkmcnt(8)
    v_mfma_f32_16x16x32_bf16 v[112:115], v[184:187], v[216:219], v[112:115]
    ds_read_b64_tr_b16 v[176:177], v250 offset:32768
    ds_read_b64_tr_b16 v[178:179], v250 offset:33792
    v_mfma_f32_16x16x32_bf16 v[116:119], v[184:187], v[220:223], v[116:119]
    v_mfma_f32_16x16x32_bf16 v[120:123], v[188:191], v[216:219], v[120:123]
    ds_read_b64_tr_b16 v[180:181], v251 offset:32768
    ds_read_b64_tr_b16 v[182:183], v251 offset:33792
    v_mfma_f32_16x16x32_bf16 v[124:127], v[188:191], v[220:223], v[124:127]
    buffer_load_dwordx4 v[216:219], v255, s[12:15], s55 offen offset:2048 sc1
    s_waitcnt vmcnt(21) lgkmcnt(8)
    v_mfma_f32_16x16x32_bf16 v[64:67], v[160:163], v[224:227], v[64:67]
    ds_read_b64_tr_b16 v[184:185], v252 offset:32768
    ds_read_b64_tr_b16 v[186:187], v252 offset:33792
    v_mfma_f32_16x16x32_bf16 v[68:71], v[160:163], v[228:231], v[68:71]
    buffer_load_dwordx4 v[220:223], v255, s[12:15], s55 offen offset:2304 sc1
    v_mfma_f32_16x16x32_bf16 v[72:75], v[164:167], v[224:227], v[72:75]
    ds_read_b64_tr_b16 v[188:189], v253 offset:32768
    ds_read_b64_tr_b16 v[190:191], v253 offset:33792
    v_mfma_f32_16x16x32_bf16 v[76:79], v[164:167], v[228:231], v[76:79]
    s_waitcnt lgkmcnt(8)
    v_mfma_f32_16x16x32_bf16 v[80:83], v[168:171], v[224:227], v[80:83]
    ds_read_b64_tr_b16 v[160:161], v246 offset:40960
    ds_read_b64_tr_b16 v[162:163], v246 offset:41984
    v_mfma_f32_16x16x32_bf16 v[84:87], v[168:171], v[228:231], v[84:87]
    v_mfma_f32_16x16x32_bf16 v[88:91], v[172:175], v[224:227], v[88:91]
    ds_read_b64_tr_b16 v[164:165], v247 offset:40960
    ds_read_b64_tr_b16 v[166:167], v247 offset:41984
    v_mfma_f32_16x16x32_bf16 v[92:95], v[172:175], v[228:231], v[92:95]
    s_waitcnt lgkmcnt(8)
    v_mfma_f32_16x16x32_bf16 v[96:99], v[176:179], v[224:227], v[96:99]
    ds_read_b64_tr_b16 v[168:169], v248 offset:40960
    ds_read_b64_tr_b16 v[170:171], v248 offset:41984
    v_mfma_f32_16x16x32_bf16 v[100:103], v[176:179], v[228:231], v[100:103]
    buffer_store_dwordx4 v[144:147], v242, s[12:15], s68 offen offset:0 sc1
    v_mfma_f32_16x16x32_bf16 v[104:107], v[180:183], v[224:227], v[104:107]
    ds_read_b64_tr_b16 v[172:173], v249 offset:40960
    ds_read_b64_tr_b16 v[174:175], v249 offset:41984
    v_mfma_f32_16x16x32_bf16 v[108:111], v[180:183], v[228:231], v[108:111]
    s_waitcnt lgkmcnt(8)
    v_mfma_f32_16x16x32_bf16 v[112:115], v[184:187], v[224:227], v[112:115]
    ds_read_b64_tr_b16 v[176:177], v250 offset:40960
    ds_read_b64_tr_b16 v[178:179], v250 offset:41984
    v_mfma_f32_16x16x32_bf16 v[116:119], v[184:187], v[228:231], v[116:119]
    v_mfma_f32_16x16x32_bf16 v[120:123], v[188:191], v[224:227], v[120:123]
    ds_read_b64_tr_b16 v[180:181], v251 offset:40960
    ds_read_b64_tr_b16 v[182:183], v251 offset:41984
    v_mfma_f32_16x16x32_bf16 v[124:127], v[188:191], v[228:231], v[124:127]
    s_add_u32 s55, s55, 4096
    buffer_load_dwordx4 v[224:227], v255, s[12:15], s55 offen offset:0 sc1
    s_waitcnt vmcnt(22) lgkmcnt(8)
    v_mfma_f32_16x16x32_bf16 v[64:67], v[160:163], v[232:235], v[64:67]
    ds_read_b64_tr_b16 v[184:185], v252 offset:40960
    ds_read_b64_tr_b16 v[186:187], v252 offset:41984
    v_mfma_f32_16x16x32_bf16 v[68:71], v[160:163], v[236:239], v[68:71]
    buffer_load_dwordx4 v[228:231], v255, s[12:15], s55 offen offset:256 sc1
    v_mfma_f32_16x16x32_bf16 v[72:75], v[164:167], v[232:235], v[72:75]
    ds_read_b64_tr_b16 v[188:189], v253 offset:40960
    ds_read_b64_tr_b16 v[190:191], v253 offset:41984
    v_mfma_f32_16x16x32_bf16 v[76:79], v[164:167], v[236:239], v[76:79]
    s_waitcnt lgkmcnt(8)
    v_mfma_f32_16x16x32_bf16 v[80:83], v[168:171], v[232:235], v[80:83]
    ds_read_b64_tr_b16 v[160:161], v246 offset:49152
    ds_read_b64_tr_b16 v[162:163], v246 offset:50176
    v_mfma_f32_16x16x32_bf16 v[84:87], v[168:171], v[236:239], v[84:87]
    v_mfma_f32_16x16x32_bf16 v[88:91], v[172:175], v[232:235], v[88:91]
    ds_read_b64_tr_b16 v[164:165], v247 offset:49152
    ds_read_b64_tr_b16 v[166:167], v247 offset:50176
    v_mfma_f32_16x16x32_bf16 v[92:95], v[172:175], v[236:239], v[92:95]
    buffer_store_dwordx4 v[148:151], v242, s[12:15], s68 offen offset:1024 sc1
    s_waitcnt lgkmcnt(8)
    v_mfma_f32_16x16x32_bf16 v[96:99], v[176:179], v[232:235], v[96:99]
    ds_read_b64_tr_b16 v[168:169], v248 offset:49152
    ds_read_b64_tr_b16 v[170:171], v248 offset:50176
    v_mfma_f32_16x16x32_bf16 v[100:103], v[176:179], v[236:239], v[100:103]
    v_mfma_f32_16x16x32_bf16 v[104:107], v[180:183], v[232:235], v[104:107]
    ds_read_b64_tr_b16 v[172:173], v249 offset:49152
    ds_read_b64_tr_b16 v[174:175], v249 offset:50176
    v_mfma_f32_16x16x32_bf16 v[108:111], v[180:183], v[236:239], v[108:111]
    s_waitcnt lgkmcnt(8)
    v_mfma_f32_16x16x32_bf16 v[112:115], v[184:187], v[232:235], v[112:115]
    ds_read_b64_tr_b16 v[176:177], v250 offset:49152
    ds_read_b64_tr_b16 v[178:179], v250 offset:50176
    v_mfma_f32_16x16x32_bf16 v[116:119], v[184:187], v[236:239], v[116:119]
    v_mfma_f32_16x16x32_bf16 v[120:123], v[188:191], v[232:235], v[120:123]
    ds_read_b64_tr_b16 v[180:181], v251 offset:49152
    ds_read_b64_tr_b16 v[182:183], v251 offset:50176
    v_mfma_f32_16x16x32_bf16 v[124:127], v[188:191], v[236:239], v[124:127]
    buffer_load_dwordx4 v[232:235], v255, s[12:15], s55 offen offset:2048 sc1
    s_waitcnt vmcnt(15) lgkmcnt(8)
    v_mfma_f32_16x16x32_bf16 v[64:67], v[160:163], v[192:195], v[64:67]
    ds_read_b64_tr_b16 v[184:185], v252 offset:49152
    ds_read_b64_tr_b16 v[186:187], v252 offset:50176
    v_mfma_f32_16x16x32_bf16 v[68:71], v[160:163], v[196:199], v[68:71]
    buffer_load_dwordx4 v[236:239], v255, s[12:15], s55 offen offset:2304 sc1
    v_mfma_f32_16x16x32_bf16 v[72:75], v[164:167], v[192:195], v[72:75]
    ds_read_b64_tr_b16 v[188:189], v253 offset:49152
    ds_read_b64_tr_b16 v[190:191], v253 offset:50176
    v_mfma_f32_16x16x32_bf16 v[76:79], v[164:167], v[196:199], v[76:79]
    s_waitcnt lgkmcnt(8)
    v_mfma_f32_16x16x32_bf16 v[80:83], v[168:171], v[192:195], v[80:83]
    ds_read_b64_tr_b16 v[160:161], v246 offset:57344
    ds_read_b64_tr_b16 v[162:163], v246 offset:58368
    v_mfma_f32_16x16x32_bf16 v[84:87], v[168:171], v[196:199], v[84:87]
    buffer_store_dwordx4 v[152:155], v242, s[12:15], s68 offen offset:2048 sc1
    v_mfma_f32_16x16x32_bf16 v[88:91], v[172:175], v[192:195], v[88:91]
    ds_read_b64_tr_b16 v[164:165], v247 offset:57344
    ds_read_b64_tr_b16 v[166:167], v247 offset:58368
    v_mfma_f32_16x16x32_bf16 v[92:95], v[172:175], v[196:199], v[92:95]
    s_waitcnt lgkmcnt(8)
    v_mfma_f32_16x16x32_bf16 v[96:99], v[176:179], v[192:195], v[96:99]
    ds_read_b64_tr_b16 v[168:169], v248 offset:57344
    ds_read_b64_tr_b16 v[170:171], v248 offset:58368
    v_mfma_f32_16x16x32_bf16 v[100:103], v[176:179], v[196:199], v[100:103]
    v_mfma_f32_16x16x32_bf16 v[104:107], v[180:183], v[192:195], v[104:107]
    ds_read_b64_tr_b16 v[172:173], v249 offset:57344
    ds_read_b64_tr_b16 v[174:175], v249 offset:58368
    v_mfma_f32_16x16x32_bf16 v[108:111], v[180:183], v[196:199], v[108:111]
    s_waitcnt lgkmcnt(8)
    v_mfma_f32_16x16x32_bf16 v[112:115], v[184:187], v[192:195], v[112:115]
    ds_read_b64_tr_b16 v[176:177], v250 offset:57344
    ds_read_b64_tr_b16 v[178:179], v250 offset:58368
    v_mfma_f32_16x16x32_bf16 v[116:119], v[184:187], v[196:199], v[116:119]
    v_mfma_f32_16x16x32_bf16 v[120:123], v[188:191], v[192:195], v[120:123]
    ds_read_b64_tr_b16 v[180:181], v251 offset:57344
    ds_read_b64_tr_b16 v[182:183], v251 offset:58368
    v_mfma_f32_16x16x32_bf16 v[124:127], v[188:191], v[196:199], v[124:127]
    s_add_u32 s55, s55, 4096
    buffer_load_dwordx4 v[192:195], v255, s[12:15], s55 offen offset:0 sc1
    s_waitcnt vmcnt(14) lgkmcnt(8)
    v_mfma_f32_16x16x32_bf16 v[64:67], v[160:163], v[200:203], v[64:67]
    ds_read_b64_tr_b16 v[184:185], v252 offset:57344
    ds_read_b64_tr_b16 v[186:187], v252 offset:58368
    v_mfma_f32_16x16x32_bf16 v[68:71], v[160:163], v[204:207], v[68:71]
    buffer_load_dwordx4 v[196:199], v255, s[12:15], s55 offen offset:256 sc1
    v_mfma_f32_16x16x32_bf16 v[72:75], v[164:167], v[200:203], v[72:75]
    ds_read_b64_tr_b16 v[188:189], v253 offset:57344
    ds_read_b64_tr_b16 v[190:191], v253 offset:58368
    v_mfma_f32_16x16x32_bf16 v[76:79], v[164:167], v[204:207], v[76:79]
    buffer_store_dwordx4 v[156:159], v242, s[12:15], s68 offen offset:3072 sc1
    s_sub_u32 s68, s68, 49152
    s_waitcnt lgkmcnt(8)
    v_mfma_f32_16x16x32_bf16 v[80:83], v[168:171], v[200:203], v[80:83]
    s_waitcnt vmcnt(46)
    s_barrier
    v_add_u32 v246, 0x10000, v246
    v_add_u32 v247, 0x10000, v247
    v_add_u32 v248, 0x10000, v248
    v_add_u32 v249, 0x10000, v249
    v_add_u32 v250, 0x10000, v250
    v_add_u32 v251, 0x10000, v251
    v_add_u32 v252, 0x10000, v252
    v_add_u32 v253, 0x10000, v253
    ds_read_b64_tr_b16 v[160:161], v246 offset:0
    ds_read_b64_tr_b16 v[162:163], v246 offset:1024
    v_mfma_f32_16x16x32_bf16 v[84:87], v[168:171], v[204:207], v[84:87]
    s_add_u32 m0, s44, 0
    s_add_u32 s49, s54, 4194304
    buffer_load_dwordx4 v245, s[8:11], s49 offen lds
    v_mfma_f32_16x16x32_bf16 v[88:91], v[172:175], v[200:203], v[88:91]
    ds_read_b64_tr_b16 v[164:165], v247 offset:0
    ds_read_b64_tr_b16 v[166:167], v247 offset:1024
    v_mfma_f32_16x16x32_bf16 v[92:95], v[172:175], v[204:207], v[92:95]
    s_add_u32 m0, s44, 1024
    s_add_u32 s49, s54, 4227072
    buffer_load_dwordx4 v245, s[8:11], s49 offen lds
    s_waitcnt lgkmcnt(8)
    v_mfma_f32_16x16x32_bf16 v[96:99], v[176:179], v[200:203], v[96:99]
    ds_read_b64_tr_b16 v[168:169], v248 offset:0
    ds_read_b64_tr_b16 v[170:171], v248 offset:1024
    v_mfma_f32_16x16x32_bf16 v[100:103], v[176:179], v[204:207], v[100:103]
    s_add_u32 m0, s44, 2048
    s_add_u32 s49, s54, 4259840
    buffer_load_dwordx4 v244, s[8:11], s49 offen lds
    v_mfma_f32_16x16x32_bf16 v[104:107], v[180:183], v[200:203], v[104:107]
    ds_read_b64_tr_b16 v[172:173], v249 offset:0
    ds_read_b64_tr_b16 v[174:175], v249 offset:1024
    v_mfma_f32_16x16x32_bf16 v[108:111], v[180:183], v[204:207], v[108:111]
    s_add_u32 m0, s44, 3072
    s_add_u32 s49, s54, 4292608
    buffer_load_dwordx4 v244, s[8:11], s49 offen lds
    s_waitcnt lgkmcnt(8)
    v_mfma_f32_16x16x32_bf16 v[112:115], v[184:187], v[200:203], v[112:115]
    ds_read_b64_tr_b16 v[176:177], v250 offset:0
    ds_read_b64_tr_b16 v[178:179], v250 offset:1024
    v_mfma_f32_16x16x32_bf16 v[116:119], v[184:187], v[204:207], v[116:119]
    s_add_u32 m0, s44, 4096
    s_add_u32 s49, s54, 4325376
    buffer_load_dwordx4 v245, s[8:11], s49 offen lds
    v_mfma_f32_16x16x32_bf16 v[120:123], v[188:191], v[200:203], v[120:123]
    ds_read_b64_tr_b16 v[180:181], v251 offset:0
    ds_read_b64_tr_b16 v[182:183], v251 offset:1024
    v_mfma_f32_16x16x32_bf16 v[124:127], v[188:191], v[204:207], v[124:127]
    buffer_load_dwordx4 v[200:203], v255, s[12:15], s55 offen offset:2048 sc1
    s_waitcnt vmcnt(19) lgkmcnt(8)
    v_mfma_f32_16x16x32_bf16 v[64:67], v[160:163], v[208:211], v[64:67]
    ds_read_b64_tr_b16 v[184:185], v252 offset:0
    ds_read_b64_tr_b16 v[186:187], v252 offset:1024
    v_mfma_f32_16x16x32_bf16 v[68:71], v[160:163], v[212:215], v[68:71]
    buffer_store_dwordx4 v[0:3], v242, s[12:15], s68 offen offset:0 sc1
    v_mfma_f32_16x16x32_bf16 v[72:75], v[164:167], v[208:211], v[72:75]
    ds_read_b64_tr_b16 v[188:189], v253 offset:0
    ds_read_b64_tr_b16 v[190:191], v253 offset:1024
    v_mfma_f32_16x16x32_bf16 v[76:79], v[164:167], v[212:215], v[76:79]
    buffer_load_dwordx4 v[204:207], v255, s[12:15], s55 offen offset:2304 sc1
    s_waitcnt lgkmcnt(8)
    v_mfma_f32_16x16x32_bf16 v[80:83], v[168:171], v[208:211], v[80:83]
    ds_read_b64_tr_b16 v[160:161], v246 offset:8192
    ds_read_b64_tr_b16 v[162:163], v246 offset:9216
    v_mfma_f32_16x16x32_bf16 v[84:87], v[168:171], v[212:215], v[84:87]
    s_add_u32 m0, s44, 5120
    s_add_u32 s49, s54, 4358144
    buffer_load_dwordx4 v245, s[8:11], s49 offen lds
    v_mfma_f32_16x16x32_bf16 v[88:91], v[172:175], v[208:211], v[88:91]
    ds_read_b64_tr_b16 v[164:165], v247 offset:8192
    ds_read_b64_tr_b16 v[166:167], v247 offset:9216
    v_mfma_f32_16x16x32_bf16 v[92:95], v[172:175], v[212:215], v[92:95]
    s_add_u32 m0, s44, 6144
    s_add_u32 s49, s54, 4390912
    buffer_load_dwordx4 v244, s[8:11], s49 offen lds
    s_waitcnt lgkmcnt(8)
    v_mfma_f32_16x16x32_bf16 v[96:99], v[176:179], v[208:211], v[96:99]
    ds_read_b64_tr_b16 v[168:169], v248 offset:8192
    ds_read_b64_tr_b16 v[170:171], v248 offset:9216
    v_mfma_f32_16x16x32_bf16 v[100:103], v[176:179], v[212:215], v[100:103]
    s_add_u32 m0, s44, 7168
    s_add_u32 s49, s54, 4423680
    buffer_load_dwordx4 v244, s[8:11], s49 offen lds
    v_mfma_f32_16x16x32_bf16 v[104:107], v[180:183], v[208:211], v[104:107]
    ds_read_b64_tr_b16 v[172:173], v249 offset:8192
    ds_read_b64_tr_b16 v[174:175], v249 offset:9216
    v_mfma_f32_16x16x32_bf16 v[108:111], v[180:183], v[212:215], v[108:111]
    s_waitcnt lgkmcnt(8)
    v_mfma_f32_16x16x32_bf16 v[112:115], v[184:187], v[208:211], v[112:115]
    ds_read_b64_tr_b16 v[176:177], v250 offset:8192
    ds_read_b64_tr_b16 v[178:179], v250 offset:9216
    v_mfma_f32_16x16x32_bf16 v[116:119], v[184:187], v[212:215], v[116:119]
    v_mfma_f32_16x16x32_bf16 v[120:123], v[188:191], v[208:211], v[120:123]
    ds_read_b64_tr_b16 v[180:181], v251 offset:8192
    ds_read_b64_tr_b16 v[182:183], v251 offset:9216
    v_mfma_f32_16x16x32_bf16 v[124:127], v[188:191], v[212:215], v[124:127]
    buffer_store_dwordx4 v[4:7], v242, s[12:15], s68 offen offset:1024 sc1
    s_waitcnt vmcnt(22) lgkmcnt(8)
    v_mfma_f32_16x16x32_bf16 v[64:67], v[160:163], v[216:219], v[64:67]
    ds_read_b64_tr_b16 v[184:185], v252 offset:8192
    ds_read_b64_tr_b16 v[186:187], v252 offset:9216
    v_mfma_f32_16x16x32_bf16 v[68:71], v[160:163], v[220:223], v[68:71]
    s_add_u32 s55, s55, 4096
    buffer_load_dwordx4 v[208:211], v255, s[12:15], s55 offen offset:0 sc1
    v_mfma_f32_16x16x32_bf16 v[72:75], v[164:167], v[216:219], v[72:75]
    ds_read_b64_tr_b16 v[188:189], v253 offset:8192
    ds_read_b64_tr_b16 v[190:191], v253 offset:9216
    v_mfma_f32_16x16x32_bf16 v[76:79], v[164:167], v[220:223], v[76:79]
    buffer_load_dwordx4 v[212:215], v255, s[12:15], s55 offen offset:256 sc1
    s_waitcnt lgkmcnt(8)
    v_mfma_f32_16x16x32_bf16 v[80:83], v[168:171], v[216:219], v[80:83]
    ds_read_b64_tr_b16 v[160:161], v246 offset:16384
    ds_read_b64_tr_b16 v[162:163], v246 offset:17408
    v_mfma_f32_16x16x32_bf16 v[84:87], v[168:171], v[220:223], v[84:87]
    v_mfma_f32_16x16x32_bf16 v[88:91], v[172:175], v[216:219], v[88:91]
    ds_read_b64_tr_b16 v[164:165], v247 offset:16384
    ds_read_b64_tr_b16 v[166:167], v247 offset:17408
    v_mfma_f32_16x16x32_bf16 v[92:95], v[172:175], v[220:223], v[92:95]
    s_waitcnt lgkmcnt(8)
    v_mfma_f32_16x16x32_bf16 v[96:99], v[176:179], v[216:219], v[96:99]
    ds_read_b64_tr_b16 v[168:169], v248 offset:16384
    ds_read_b64_tr_b16 v[170:171], v248 offset:17408
    v_mfma_f32_16x16x32_bf16 v[100:103], v[176:179], v[220:223], v[100:103]
    v_mfma_f32_16x16x32_bf16 v[104:107], v[180:183], v[216:219], v[104:107]
    ds_read_b64_tr_b16 v[172:173], v249 offset:16384
    ds_read_b64_tr_b16 v[174:175], v249 offset:17408
    v_mfma_f32_16x16x32_bf16 v[108:111], v[180:183], v[220:223], v[108:111]
    s_waitcnt lgkmcnt(8)
    v_mfma_f32_16x16x32_bf16 v[112:115], v[184:187], v[216:219], v[112:115]
    ds_read_b64_tr_b16 v[176:177], v250 offset:16384
    ds_read_b64_tr_b16 v[178:179], v250 offset:17408
    v_mfma_f32_16x16x32_bf16 v[116:119], v[184:187], v[220:223], v[116:119]
    buffer_store_dwordx4 v[8:11], v242, s[12:15], s68 offen offset:2048 sc1
    v_mfma_f32_16x16x32_bf16 v[120:123], v[188:191], v[216:219], v[120:123]
    ds_read_b64_tr_b16 v[180:181], v251 offset:16384
    ds_read_b64_tr_b16 v[182:183], v251 offset:17408
    v_mfma_f32_16x16x32_bf16 v[124:127], v[188:191], v[220:223], v[124:127]
    buffer_load_dwordx4 v[216:219], v255, s[12:15], s55 offen offset:2048 sc1
    s_waitcnt vmcnt(23) lgkmcnt(8)
    v_mfma_f32_16x16x32_bf16 v[64:67], v[160:163], v[224:227], v[64:67]
    ds_read_b64_tr_b16 v[184:185], v252 offset:16384
    ds_read_b64_tr_b16 v[186:187], v252 offset:17408
    v_mfma_f32_16x16x32_bf16 v[68:71], v[160:163], v[228:231], v[68:71]
    buffer_load_dwordx4 v[220:223], v255, s[12:15], s55 offen offset:2304 sc1
    v_mfma_f32_16x16x32_bf16 v[72:75], v[164:167], v[224:227], v[72:75]
    ds_read_b64_tr_b16 v[188:189], v253 offset:16384
    ds_read_b64_tr_b16 v[190:191], v253 offset:17408
    v_mfma_f32_16x16x32_bf16 v[76:79], v[164:167], v[228:231], v[76:79]
    s_waitcnt lgkmcnt(8)
    v_mfma_f32_16x16x32_bf16 v[80:83], v[168:171], v[224:227], v[80:83]
    ds_read_b64_tr_b16 v[160:161], v246 offset:24576
    ds_read_b64_tr_b16 v[162:163], v246 offset:25600
    v_mfma_f32_16x16x32_bf16 v[84:87], v[168:171], v[228:231], v[84:87]
    v_mfma_f32_16x16x32_bf16 v[88:91], v[172:175], v[224:227], v[88:91]
    ds_read_b64_tr_b16 v[164:165], v247 offset:24576
    ds_read_b64_tr_b16 v[166:167], v247 offset:25600
    v_mfma_f32_16x16x32_bf16 v[92:95], v[172:175], v[228:231], v[92:95]
    s_waitcnt lgkmcnt(8)
    v_mfma_f32_16x16x32_bf16 v[96:99], v[176:179], v[224:227], v[96:99]
    ds_read_b64_tr_b16 v[168:169], v248 offset:24576
    ds_read_b64_tr_b16 v[170:171], v248 offset:25600
    v_mfma_f32_16x16x32_bf16 v[100:103], v[176:179], v[228:231], v[100:103]
    v_mfma_f32_16x16x32_bf16 v[104:107], v[180:183], v[224:227], v[104:107]
    ds_read_b64_tr_b16 v[172:173], v249 offset:24576
    ds_read_b64_tr_b16 v[174:175], v249 offset:25600
    v_mfma_f32_16x16x32_bf16 v[108:111], v[180:183], v[228:231], v[108:111]
    buffer_store_dwordx4 v[12:15], v242, s[12:15], s68 offen offset:3072 sc1
    s_add_u32 s68, s68, 16384
    s_waitcnt lgkmcnt(8)
    v_mfma_f32_16x16x32_bf16 v[112:115], v[184:187], v[224:227], v[112:115]
    ds_read_b64_tr_b16 v[176:177], v250 offset:24576
    ds_read_b64_tr_b16 v[178:179], v250 offset:25600
    v_mfma_f32_16x16x32_bf16 v[116:119], v[184:187], v[228:231], v[116:119]
    v_mfma_f32_16x16x32_bf16 v[120:123], v[188:191], v[224:227], v[120:123]
    ds_read_b64_tr_b16 v[180:181], v251 offset:24576
    ds_read_b64_tr_b16 v[182:183], v251 offset:25600
    v_mfma_f32_16x16x32_bf16 v[124:127], v[188:191], v[228:231], v[124:127]
    s_add_u32 s55, s55, 4096
    buffer_load_dwordx4 v[224:227], v255, s[12:15], s55 offen offset:0 sc1
    s_waitcnt vmcnt(23) lgkmcnt(8)
    v_mfma_f32_16x16x32_bf16 v[64:67], v[160:163], v[232:235], v[64:67]
    ds_read_b64_tr_b16 v[184:185], v252 offset:24576
    ds_read_b64_tr_b16 v[186:187], v252 offset:25600
    v_mfma_f32_16x16x32_bf16 v[68:71], v[160:163], v[236:239], v[68:71]
    buffer_load_dwordx4 v[228:231], v255, s[12:15], s55 offen offset:256 sc1
    v_mfma_f32_16x16x32_bf16 v[72:75], v[164:167], v[232:235], v[72:75]
    ds_read_b64_tr_b16 v[188:189], v253 offset:24576
    ds_read_b64_tr_b16 v[190:191], v253 offset:25600
    v_mfma_f32_16x16x32_bf16 v[76:79], v[164:167], v[236:239], v[76:79]
    s_waitcnt lgkmcnt(8)
    v_mfma_f32_16x16x32_bf16 v[80:83], v[168:171], v[232:235], v[80:83]
    s_waitcnt vmcnt(39)
    s_barrier
    ds_read_b64_tr_b16 v[160:161], v246 offset:32768
    ds_read_b64_tr_b16 v[162:163], v246 offset:33792
    v_mfma_f32_16x16x32_bf16 v[84:87], v[168:171], v[236:239], v[84:87]
    v_mfma_f32_16x16x32_bf16 v[88:91], v[172:175], v[232:235], v[88:91]
    ds_read_b64_tr_b16 v[164:165], v247 offset:32768
    ds_read_b64_tr_b16 v[166:167], v247 offset:33792
    v_mfma_f32_16x16x32_bf16 v[92:95], v[172:175], v[236:239], v[92:95]
    s_waitcnt lgkmcnt(8)
    v_mfma_f32_16x16x32_bf16 v[96:99], v[176:179], v[232:235], v[96:99]
    ds_read_b64_tr_b16 v[168:169], v248 offset:32768
    ds_read_b64_tr_b16 v[170:171], v248 offset:33792
    v_mfma_f32_16x16x32_bf16 v[100:103], v[176:179], v[236:239], v[100:103]
    buffer_store_dwordx4 v[16:19], v242, s[12:15], s68 offen offset:0 sc1
    v_mfma_f32_16x16x32_bf16 v[104:107], v[180:183], v[232:235], v[104:107]
    ds_read_b64_tr_b16 v[172:173], v249 offset:32768
    ds_read_b64_tr_b16 v[174:175], v249 offset:33792
    v_mfma_f32_16x16x32_bf16 v[108:111], v[180:183], v[236:239], v[108:111]
    s_waitcnt lgkmcnt(8)
    v_mfma_f32_16x16x32_bf16 v[112:115], v[184:187], v[232:235], v[112:115]
    ds_read_b64_tr_b16 v[176:177], v250 offset:32768
    ds_read_b64_tr_b16 v[178:179], v250 offset:33792
    v_mfma_f32_16x16x32_bf16 v[116:119], v[184:187], v[236:239], v[116:119]
    v_mfma_f32_16x16x32_bf16 v[120:123], v[188:191], v[232:235], v[120:123]
    ds_read_b64_tr_b16 v[180:181], v251 offset:32768
    ds_read_b64_tr_b16 v[182:183], v251 offset:33792
    v_mfma_f32_16x16x32_bf16 v[124:127], v[188:191], v[236:239], v[124:127]
    buffer_load_dwordx4 v[232:235], v255, s[12:15], s55 offen offset:2048 sc1
    s_waitcnt vmcnt(23) lgkmcnt(8)
    v_mfma_f32_16x16x32_bf16 v[64:67], v[160:163], v[192:195], v[64:67]
    ds_read_b64_tr_b16 v[184:185], v252 offset:32768
    ds_read_b64_tr_b16 v[186:187], v252 offset:33792
    v_mfma_f32_16x16x32_bf16 v[68:71], v[160:163], v[196:199], v[68:71]
    buffer_load_dwordx4 v[236:239], v255, s[12:15], s55 offen offset:2304 sc1
    v_mfma_f32_16x16x32_bf16 v[72:75], v[164:167], v[192:195], v[72:75]
    ds_read_b64_tr_b16 v[188:189], v253 offset:32768
    ds_read_b64_tr_b16 v[190:191], v253 offset:33792
    v_mfma_f32_16x16x32_bf16 v[76:79], v[164:167], v[196:199], v[76:79]
    s_waitcnt lgkmcnt(8)
    v_mfma_f32_16x16x32_bf16 v[80:83], v[168:171], v[192:195], v[80:83]
    ds_read_b64_tr_b16 v[160:161], v246 offset:40960
    ds_read_b64_tr_b16 v[162:163], v246 offset:41984
    v_mfma_f32_16x16x32_bf16 v[84:87], v[168:171], v[196:199], v[84:87]
    v_mfma_f32_16x16x32_bf16 v[88:91], v[172:175], v[192:195], v[88:91]
    ds_read_b64_tr_b16 v[164:165], v247 offset:40960
    ds_read_b64_tr_b16 v[166:167], v247 offset:41984
    v_mfma_f32_16x16x32_bf16 v[92:95], v[172:175], v[196:199], v[92:95]
    buffer_store_dwordx4 v[20:23], v242, s[12:15], s68 offen offset:1024 sc1
    s_waitcnt lgkmcnt(8)
    v_mfma_f32_16x16x32_bf16 v[96:99], v[176:179], v[192:195], v[96:99]
    ds_read_b64_tr_b16 v[168:169], v248 offset:40960
    ds_read_b64_tr_b16 v[170:171], v248 offset:41984
    v_mfma_f32_16x16x32_bf16 v[100:103], v[176:179], v[196:199], v[100:103]
    v_mfma_f32_16x16x32_bf16 v[104:107], v[180:183], v[192:195], v[104:107]
    ds_read_b64_tr_b16 v[172:173], v249 offset:40960
    ds_read_b64_tr_b16 v[174:175], v249 offset:41984
    v_mfma_f32_16x16x32_bf16 v[108:111], v[180:183], v[196:199], v[108:111]
    s_waitcnt lgkmcnt(8)
    v_mfma_f32_16x16x32_bf16 v[112:115], v[184:187], v[192:195], v[112:115]
    ds_read_b64_tr_b16 v[176:177], v250 offset:40960
    ds_read_b64_tr_b16 v[178:179], v250 offset:41984
    v_mfma_f32_16x16x32_bf16 v[116:119], v[184:187], v[196:199], v[116:119]
    v_mfma_f32_16x16x32_bf16 v[120:123], v[188:191], v[192:195], v[120:123]
    ds_read_b64_tr_b16 v[180:181], v251 offset:40960
    ds_read_b64_tr_b16 v[182:183], v251 offset:41984
    v_mfma_f32_16x16x32_bf16 v[124:127], v[188:191], v[196:199], v[124:127]
    s_waitcnt vmcnt(16) lgkmcnt(8)
    v_mfma_f32_16x16x32_bf16 v[64:67], v[160:163], v[200:203], v[64:67]
    ds_read_b64_tr_b16 v[184:185], v252 offset:40960
    ds_read_b64_tr_b16 v[186:187], v252 offset:41984
    v_mfma_f32_16x16x32_bf16 v[68:71], v[160:163], v[204:207], v[68:71]
    v_mfma_f32_16x16x32_bf16 v[72:75], v[164:167], v[200:203], v[72:75]
    ds_read_b64_tr_b16 v[188:189], v253 offset:40960
    ds_read_b64_tr_b16 v[190:191], v253 offset:41984
    v_mfma_f32_16x16x32_bf16 v[76:79], v[164:167], v[204:207], v[76:79]
    s_waitcnt lgkmcnt(8)
    v_mfma_f32_16x16x32_bf16 v[80:83], v[168:171], v[200:203], v[80:83]
    ds_read_b64_tr_b16 v[160:161], v246 offset:49152
    ds_read_b64_tr_b16 v[162:163], v246 offset:50176
    v_mfma_f32_16x16x32_bf16 v[84:87], v[168:171], v[204:207], v[84:87]
    buffer_store_dwordx4 v[24:27], v242, s[12:15], s68 offen offset:2048 sc1
    v_mfma_f32_16x16x32_bf16 v[88:91], v[172:175], v[200:203], v[88:91]
    ds_read_b64_tr_b16 v[164:165], v247 offset:49152
    ds_read_b64_tr_b16 v[166:167], v247 offset:50176
    v_mfma_f32_16x16x32_bf16 v[92:95], v[172:175], v[204:207], v[92:95]
    s_waitcnt lgkmcnt(8)
    v_mfma_f32_16x16x32_bf16 v[96:99], v[176:179], v[200:203], v[96:99]
    ds_read_b64_tr_b16 v[168:169], v248 offset:49152
    ds_read_b64_tr_b16 v[170:171], v248 offset:50176
    v_mfma_f32_16x16x32_bf16 v[100:103], v[176:179], v[204:207], v[100:103]
    v_mfma_f32_16x16x32_bf16 v[104:107], v[180:183], v[200:203], v[104:107]
    ds_read_b64_tr_b16 v[172:173], v249 offset:49152
    ds_read_b64_tr_b16 v[174:175], v249 offset:50176
    v_mfma_f32_16x16x32_bf16 v[108:111], v[180:183], v[204:207], v[108:111]
    s_waitcnt lgkmcnt(8)
    v_mfma_f32_16x16x32_bf16 v[112:115], v[184:187], v[200:203], v[112:115]
    ds_read_b64_tr_b16 v[176:177], v250 offset:49152
    ds_read_b64_tr_b16 v[178:179], v250 offset:50176
    v_mfma_f32_16x16x32_bf16 v[116:119], v[184:187], v[204:207], v[116:119]
    v_mfma_f32_16x16x32_bf16 v[120:123], v[188:191], v[200:203], v[120:123]
    ds_read_b64_tr_b16 v[180:181], v251 offset:49152
    ds_read_b64_tr_b16 v[182:183], v251 offset:50176
    v_mfma_f32_16x16x32_bf16 v[124:127], v[188:191], v[204:207], v[124:127]
    s_waitcnt vmcnt(11) lgkmcnt(8)
    v_mfma_f32_16x16x32_bf16 v[64:67], v[160:163], v[208:211], v[64:67]
    ds_read_b64_tr_b16 v[184:185], v252 offset:49152
    ds_read_b64_tr_b16 v[186:187], v252 offset:50176
    v_mfma_f32_16x16x32_bf16 v[68:71], v[160:163], v[212:215], v[68:71]
    v_lshlrev_b32 v255, 3, v243
    v_mov_b32 v254, 0x40000000
    v_cmp_gt_u32 vcc, 160, v243
    s_nop 1
    v_cndmask_b32 v255, v254, v255, vcc
    v_mfma_f32_16x16x32_bf16 v[72:75], v[164:167], v[208:211], v[72:75]
    ds_read_b64_tr_b16 v[188:189], v253 offset:49152
    ds_read_b64_tr_b16 v[190:191], v253 offset:50176
    v_mfma_f32_16x16x32_bf16 v[76:79], v[164:167], v[212:215], v[76:79]
    buffer_store_dwordx4 v[28:31], v242, s[12:15], s68 offen offset:3072 sc1
    s_add_u32 s68, s68, 16384
    s_waitcnt lgkmcnt(8)
    v_mfma_f32_16x16x32_bf16 v[80:83], v[168:171], v[208:211], v[80:83]
    ds_read_b64_tr_b16 v[160:161], v246 offset:57344
    ds_read_b64_tr_b16 v[162:163], v246 offset:58368
    v_mfma_f32_16x16x32_bf16 v[84:87], v[168:171], v[212:215], v[84:87]
    v_mfma_f32_16x16x32_bf16 v[88:91], v[172:175], v[208:211], v[88:91]
    ds_read_b64_tr_b16 v[164:165], v247 offset:57344
    ds_read_b64_tr_b16 v[166:167], v247 offset:58368
    v_mfma_f32_16x16x32_bf16 v[92:95], v[172:175], v[212:215], v[92:95]
    s_waitcnt lgkmcnt(8)
    v_mfma_f32_16x16x32_bf16 v[96:99], v[176:179], v[208:211], v[96:99]
    ds_read_b64_tr_b16 v[168:169], v248 offset:57344
    ds_read_b64_tr_b16 v[170:171], v248 offset:58368
    v_mfma_f32_16x16x32_bf16 v[100:103], v[176:179], v[212:215], v[100:103]
    v_bfe_u32 v196, v243, 4, 2
    v_lshlrev_b32 v196, 6, v196
    buffer_load_dword v192, v196, s[12:15], s70 offen sc1
    v_mfma_f32_16x16x32_bf16 v[104:107], v[180:183], v[208:211], v[104:107]
    ds_read_b64_tr_b16 v[172:173], v249 offset:57344
    ds_read_b64_tr_b16 v[174:175], v249 offset:58368
    v_mfma_f32_16x16x32_bf16 v[108:111], v[180:183], v[212:215], v[108:111]
    s_waitcnt lgkmcnt(8)
    v_mfma_f32_16x16x32_bf16 v[112:115], v[184:187], v[208:211], v[112:115]
    ds_read_b64_tr_b16 v[176:177], v250 offset:57344
    ds_read_b64_tr_b16 v[178:179], v250 offset:58368
    v_mfma_f32_16x16x32_bf16 v[116:119], v[184:187], v[212:215], v[116:119]
    v_mfma_f32_16x16x32_bf16 v[120:123], v[188:191], v[208:211], v[120:123]
    ds_read_b64_tr_b16 v[180:181], v251 offset:57344
    ds_read_b64_tr_b16 v[182:183], v251 offset:58368
    v_mfma_f32_16x16x32_bf16 v[124:127], v[188:191], v[212:215], v[124:127]
    s_waitcnt vmcnt(10) lgkmcnt(8)
    v_mfma_f32_16x16x32_bf16 v[64:67], v[160:163], v[216:219], v[64:67]
    ds_read_b64_tr_b16 v[184:185], v252 offset:57344
    ds_read_b64_tr_b16 v[186:187], v252 offset:58368
    v_mfma_f32_16x16x32_bf16 v[68:71], v[160:163], v[220:223], v[68:71]
    v_mov_b32 v0, 0
    v_mov_b32 v1, 0
    v_mov_b32 v2, 0
    v_mov_b32 v3, 0
    v_mfma_f32_16x16x32_bf16 v[72:75], v[164:167], v[216:219], v[72:75]
    ds_read_b64_tr_b16 v[188:189], v253 offset:57344
    ds_read_b64_tr_b16 v[190:191], v253 offset:58368
    v_mfma_f32_16x16x32_bf16 v[76:79], v[164:167], v[220:223], v[76:79]
    v_mov_b32 v4, 0
    v_mov_b32 v5, 0
    v_mov_b32 v6, 0
    v_mov_b32 v7, 0
    s_waitcnt lgkmcnt(8)
    v_mfma_f32_16x16x32_bf16 v[80:83], v[168:171], v[216:219], v[80:83]
    s_waitcnt vmcnt(16)
    s_barrier
    v_subrev_u32 v246, 0x10000, v246
    v_subrev_u32 v247, 0x10000, v247
    v_subrev_u32 v248, 0x10000, v248
    v_subrev_u32 v249, 0x10000, v249
    v_subrev_u32 v250, 0x10000, v250
    v_subrev_u32 v251, 0x10000, v251
    v_subrev_u32 v252, 0x10000, v252
    v_subrev_u32 v253, 0x10000, v253
    ds_read_b64_tr_b16 v[160:161], v246 offset:0
    ds_read_b64_tr_b16 v[162:163], v246 offset:1024
    v_mfma_f32_16x16x32_bf16 v[84:87], v[168:171], v[220:223], v[84:87]
    v_mov_b32 v8, 0
    v_mov_b32 v9, 0
    v_mov_b32 v10, 0
    v_mov_b32 v11, 0
    v_mfma_f32_16x16x32_bf16 v[88:91], v[172:175], v[216:219], v[88:91]
    ds_read_b64_tr_b16 v[164:165], v247 offset:0
    ds_read_b64_tr_b16 v[166:167], v247 offset:1024
    v_mfma_f32_16x16x32_bf16 v[92:95], v[172:175], v[220:223], v[92:95]
    v_mov_b32 v12, 0
    v_mov_b32 v13, 0
    v_mov_b32 v14, 0
    v_mov_b32 v15, 0
    s_waitcnt lgkmcnt(8)
    v_mfma_f32_16x16x32_bf16 v[96:99], v[176:179], v[216:219], v[96:99]
    ds_read_b64_tr_b16 v[168:169], v248 offset:0
    ds_read_b64_tr_b16 v[170:171], v248 offset:1024
    v_mfma_f32_16x16x32_bf16 v[100:103], v[176:179], v[220:223], v[100:103]
    v_mov_b32 v16, 0
    v_mov_b32 v17, 0
    v_mov_b32 v18, 0
    v_mov_b32 v19, 0
    v_mfma_f32_16x16x32_bf16 v[104:107], v[180:183], v[216:219], v[104:107]
    ds_read_b64_tr_b16 v[172:173], v249 offset:0
    ds_read_b64_tr_b16 v[174:175], v249 offset:1024
    v_mfma_f32_16x16x32_bf16 v[108:111], v[180:183], v[220:223], v[108:111]
    v_mov_b32 v20, 0
    v_mov_b32 v21, 0
    v_mov_b32 v22, 0
    v_mov_b32 v23, 0
    s_waitcnt lgkmcnt(8)
    v_mfma_f32_16x16x32_bf16 v[112:115], v[184:187], v[216:219], v[112:115]
    ds_read_b64_tr_b16 v[176:177], v250 offset:0
    ds_read_b64_tr_b16 v[178:179], v250 offset:1024
    v_mfma_f32_16x16x32_bf16 v[116:119], v[184:187], v[220:223], v[116:119]
    v_mov_b32 v24, 0
    v_mov_b32 v25, 0
    v_mov_b32 v26, 0
    v_mov_b32 v27, 0
    s_waitcnt vmcnt(0)
    s_mov_b32 s35, 0x40000
parallel_sum__compressed_kv_cla__moe_arch_mod__prompt_kernel_chk_kv0slow:
    v_xor_b32 v192, s87, v192
    v_cmp_ne_u32 s[84:85], 0, v192
    s_nop 1
    s_cmp_eq_u64 s[84:85], 0
    s_cbranch_scc1 parallel_sum__compressed_kv_cla__moe_arch_mod__prompt_kernel_chk_kv0slow_ok
    s_sub_u32 s35, s35, 1
    s_cbranch_scc1 parallel_sum__compressed_kv_cla__moe_arch_mod__prompt_kernel_chk_kv0slow_ok
    s_sleep 1
    buffer_load_dword v192, v196, s[12:15], s70 offen sc1
    s_waitcnt vmcnt(0)
    s_branch parallel_sum__compressed_kv_cla__moe_arch_mod__prompt_kernel_chk_kv0slow
parallel_sum__compressed_kv_cla__moe_arch_mod__prompt_kernel_chk_kv0slow_ok:
    v_mfma_f32_16x16x32_bf16 v[120:123], v[188:191], v[216:219], v[120:123]
    ds_read_b64_tr_b16 v[180:181], v251 offset:0
    ds_read_b64_tr_b16 v[182:183], v251 offset:1024
    v_mfma_f32_16x16x32_bf16 v[124:127], v[188:191], v[220:223], v[124:127]
    s_mul_i32 s47, s36, 16384
    s_add_u32 s48, s47, 4294893568
    s_cmp_lt_u32 s36, 2
    s_cselect_b32 s43, s47, s48
    s_add_u32 s44, s44, 32768
    s_mov_b32 m0, s44
    s_max_i32 s53, s43, 0
    s_add_u32 s49, s53, 4096
    buffer_load_dwordx4 v243, s[16:19], s53 offen offset:0 sc1 lds
    v_mov_b32 v28, 0
    v_mov_b32 v29, 0
    v_mov_b32 v30, 0
    v_mov_b32 v31, 0
    s_waitcnt vmcnt(8) lgkmcnt(8)
    v_mfma_f32_16x16x32_bf16 v[64:67], v[160:163], v[224:227], v[64:67]
    ds_read_b64_tr_b16 v[184:185], v252 offset:0
    ds_read_b64_tr_b16 v[186:187], v252 offset:1024
    v_mfma_f32_16x16x32_bf16 v[68:71], v[160:163], v[228:231], v[68:71]
    buffer_load_dwordx4 v243, s[16:19], s53 offen offset:1024 sc1 lds
    v_mov_b32 v32, 0
    v_mov_b32 v33, 0
    v_mov_b32 v34, 0
    v_mov_b32 v35, 0
    v_mfma_f32_16x16x32_bf16 v[72:75], v[164:167], v[224:227], v[72:75]
    ds_read_b64_tr_b16 v[188:189], v253 offset:0
    ds_read_b64_tr_b16 v[190:191], v253 offset:1024
    v_mfma_f32_16x16x32_bf16 v[76:79], v[164:167], v[228:231], v[76:79]
    buffer_load_dwordx4 v243, s[16:19], s53 offen offset:2048 sc1 lds
    v_mov_b32 v36, 0
    v_mov_b32 v37, 0
    v_mov_b32 v38, 0
    v_mov_b32 v39, 0
    s_waitcnt lgkmcnt(8)
    v_mfma_f32_16x16x32_bf16 v[80:83], v[168:171], v[224:227], v[80:83]
    ds_read_b64_tr_b16 v[160:161], v246 offset:8192
    ds_read_b64_tr_b16 v[162:163], v246 offset:9216
    v_mfma_f32_16x16x32_bf16 v[84:87], v[168:171], v[228:231], v[84:87]
    buffer_load_dwordx4 v243, s[16:19], s53 offen offset:3072 sc1 lds
    v_mov_b32 v40, 0
    v_mov_b32 v41, 0
    v_mov_b32 v42, 0
    v_mov_b32 v43, 0
    v_mfma_f32_16x16x32_bf16 v[88:91], v[172:175], v[224:227], v[88:91]
    ds_read_b64_tr_b16 v[164:165], v247 offset:8192
    ds_read_b64_tr_b16 v[166:167], v247 offset:9216
    v_mfma_f32_16x16x32_bf16 v[92:95], v[172:175], v[228:231], v[92:95]
    s_add_u32 m0, s44, 4096
    s_add_u32 s44, s44, 32768
    buffer_load_dwordx4 v243, s[16:19], s49 offen offset:0 sc1 lds
    v_mov_b32 v44, 0
    v_mov_b32 v45, 0
    v_mov_b32 v46, 0
    v_mov_b32 v47, 0
    s_waitcnt lgkmcnt(8)
    v_mfma_f32_16x16x32_bf16 v[96:99], v[176:179], v[224:227], v[96:99]
    ds_read_b64_tr_b16 v[168:169], v248 offset:8192
    ds_read_b64_tr_b16 v[170:171], v248 offset:9216
    v_mfma_f32_16x16x32_bf16 v[100:103], v[176:179], v[228:231], v[100:103]
    buffer_load_dwordx4 v243, s[16:19], s49 offen offset:1024 sc1 lds
    v_mov_b32 v48, 0
    v_mov_b32 v49, 0
    v_mov_b32 v50, 0
    v_mov_b32 v51, 0
    v_mfma_f32_16x16x32_bf16 v[104:107], v[180:183], v[224:227], v[104:107]
    ds_read_b64_tr_b16 v[172:173], v249 offset:8192
    ds_read_b64_tr_b16 v[174:175], v249 offset:9216
    v_mfma_f32_16x16x32_bf16 v[108:111], v[180:183], v[228:231], v[108:111]
    buffer_load_dwordx4 v243, s[16:19], s49 offen offset:2048 sc1 lds
    v_mov_b32 v52, 0
    v_mov_b32 v53, 0
    v_mov_b32 v54, 0
    v_mov_b32 v55, 0
    s_waitcnt lgkmcnt(8)
    v_mfma_f32_16x16x32_bf16 v[112:115], v[184:187], v[224:227], v[112:115]
    ds_read_b64_tr_b16 v[176:177], v250 offset:8192
    ds_read_b64_tr_b16 v[178:179], v250 offset:9216
    v_mfma_f32_16x16x32_bf16 v[116:119], v[184:187], v[228:231], v[116:119]
    buffer_load_dwordx4 v243, s[16:19], s49 offen offset:3072 sc1 lds
    s_add_u32 s43, s43, 32768
    s_and_b32 s44, s44, 0x1ffff
    v_mov_b32 v56, 0
    v_mov_b32 v57, 0
    v_mov_b32 v58, 0
    v_mov_b32 v59, 0
    v_mfma_f32_16x16x32_bf16 v[120:123], v[188:191], v[224:227], v[120:123]
    ds_read_b64_tr_b16 v[180:181], v251 offset:8192
    ds_read_b64_tr_b16 v[182:183], v251 offset:9216
    v_mfma_f32_16x16x32_bf16 v[124:127], v[188:191], v[228:231], v[124:127]
    s_mov_b32 m0, s44
    s_max_i32 s53, s43, 0
    s_add_u32 s49, s53, 4096
    buffer_load_dwordx4 v243, s[16:19], s53 offen offset:0 sc1 lds
    v_mov_b32 v60, 0
    v_mov_b32 v61, 0
    v_mov_b32 v62, 0
    v_mov_b32 v63, 0
    s_waitcnt vmcnt(13) lgkmcnt(8)
    v_mfma_f32_16x16x32_bf16 v[64:67], v[160:163], v[232:235], v[64:67]
    ds_read_b64_tr_b16 v[184:185], v252 offset:8192
    ds_read_b64_tr_b16 v[186:187], v252 offset:9216
    v_mfma_f32_16x16x32_bf16 v[68:71], v[160:163], v[236:239], v[68:71]
    buffer_load_dwordx4 v243, s[16:19], s53 offen offset:1024 sc1 lds
    v_mfma_f32_16x16x32_bf16 v[72:75], v[164:167], v[232:235], v[72:75]
    ds_read_b64_tr_b16 v[188:189], v253 offset:8192
    ds_read_b64_tr_b16 v[190:191], v253 offset:9216
    v_mfma_f32_16x16x32_bf16 v[76:79], v[164:167], v[236:239], v[76:79]
    buffer_load_dwordx4 v243, s[16:19], s53 offen offset:2048 sc1 lds
    s_waitcnt lgkmcnt(8)
    v_mfma_f32_16x16x32_bf16 v[80:83], v[168:171], v[232:235], v[80:83]
    v_mfma_f32_16x16x32_bf16 v[84:87], v[168:171], v[236:239], v[84:87]
    buffer_load_dwordx4 v243, s[16:19], s53 offen offset:3072 sc1 lds
    v_mfma_f32_16x16x32_bf16 v[88:91], v[172:175], v[232:235], v[88:91]
    v_mfma_f32_16x16x32_bf16 v[92:95], v[172:175], v[236:239], v[92:95]
    s_add_u32 m0, s44, 4096
    s_add_u32 s44, s44, 32768
    buffer_load_dwordx4 v243, s[16:19], s49 offen offset:0 sc1 lds
    s_waitcnt lgkmcnt(4)
    v_mfma_f32_16x16x32_bf16 v[96:99], v[176:179], v[232:235], v[96:99]
    v_mfma_f32_16x16x32_bf16 v[100:103], v[176:179], v[236:239], v[100:103]
    buffer_load_dwordx4 v243, s[16:19], s49 offen offset:1024 sc1 lds
    v_mfma_f32_16x16x32_bf16 v[104:107], v[180:183], v[232:235], v[104:107]
    v_mfma_f32_16x16x32_bf16 v[108:111], v[180:183], v[236:239], v[108:111]
    buffer_load_dwordx4 v243, s[16:19], s49 offen offset:2048 sc1 lds
    s_waitcnt lgkmcnt(0)
    v_mfma_f32_16x16x32_bf16 v[112:115], v[184:187], v[232:235], v[112:115]
    v_mfma_f32_16x16x32_bf16 v[116:119], v[184:187], v[236:239], v[116:119]
    buffer_load_dwordx4 v243, s[16:19], s49 offen offset:3072 sc1 lds
    s_add_u32 s43, s43, 32768
    s_and_b32 s44, s44, 0x1ffff
    v_mfma_f32_16x16x32_bf16 v[120:123], v[188:191], v[232:235], v[120:123]
    v_mfma_f32_16x16x32_bf16 v[124:127], v[188:191], v[236:239], v[124:127]
    buffer_load_dword v254, v255, s[20:23], s32 offen
    s_add_u32 s32, s32, 1280
    v_cvt_pk_bf16_f32 v128, v64, v65
    v_cvt_pk_bf16_f32 v129, v66, v67
    v_cvt_pk_bf16_f32 v130, v68, v69
    v_cvt_pk_bf16_f32 v131, v70, v71
    v_cvt_pk_bf16_f32 v132, v72, v73
    v_cvt_pk_bf16_f32 v133, v74, v75
    v_cvt_pk_bf16_f32 v134, v76, v77
    v_cvt_pk_bf16_f32 v135, v78, v79
    v_cvt_pk_bf16_f32 v136, v80, v81
    v_cvt_pk_bf16_f32 v137, v82, v83
    v_cvt_pk_bf16_f32 v138, v84, v85
    v_cvt_pk_bf16_f32 v139, v86, v87
    v_cvt_pk_bf16_f32 v140, v88, v89
    v_cvt_pk_bf16_f32 v141, v90, v91
    v_cvt_pk_bf16_f32 v142, v92, v93
    v_cvt_pk_bf16_f32 v143, v94, v95
    v_cvt_pk_bf16_f32 v144, v96, v97
    v_cvt_pk_bf16_f32 v145, v98, v99
    v_cvt_pk_bf16_f32 v146, v100, v101
    v_cvt_pk_bf16_f32 v147, v102, v103
    v_cvt_pk_bf16_f32 v148, v104, v105
    v_cvt_pk_bf16_f32 v149, v106, v107
    v_cvt_pk_bf16_f32 v150, v108, v109
    v_cvt_pk_bf16_f32 v151, v110, v111
    v_cvt_pk_bf16_f32 v152, v112, v113
    v_cvt_pk_bf16_f32 v153, v114, v115
    v_cvt_pk_bf16_f32 v154, v116, v117
    v_cvt_pk_bf16_f32 v155, v118, v119
    v_cvt_pk_bf16_f32 v156, v120, v121
    v_cvt_pk_bf16_f32 v157, v122, v123
    v_cvt_pk_bf16_f32 v158, v124, v125
    v_cvt_pk_bf16_f32 v159, v126, v127
    v_mov_b32 v246, 0xff800000
    v_bfe_u32 v244, v243, 4, 5
    v_lshrrev_b32 v247, 9, v243
    v_lshlrev_b32 v247, 2, v247
    v_sub_u32 v244, v244, v247
    s_nop 1
    v_permlane16_swap_b32 v128, v130
    v_permlane16_swap_b32 v129, v131
    v_permlane16_swap_b32 v132, v134
    v_permlane16_swap_b32 v133, v135
    v_permlane16_swap_b32 v136, v138
    v_permlane16_swap_b32 v137, v139
    v_permlane16_swap_b32 v140, v142
    v_permlane16_swap_b32 v141, v143
    v_permlane16_swap_b32 v144, v146
    v_permlane16_swap_b32 v145, v147
    v_permlane16_swap_b32 v148, v150
    v_permlane16_swap_b32 v149, v151
    v_permlane16_swap_b32 v152, v154
    v_permlane16_swap_b32 v153, v155
    v_permlane16_swap_b32 v156, v158
    v_permlane16_swap_b32 v157, v159
    s_nop 1
    v_permlane32_swap_b32 v128, v130
    v_permlane32_swap_b32 v129, v131
    v_permlane32_swap_b32 v132, v134
    v_permlane32_swap_b32 v133, v135
    v_permlane32_swap_b32 v136, v138
    v_permlane32_swap_b32 v137, v139
    v_permlane32_swap_b32 v140, v142
    v_permlane32_swap_b32 v141, v143
    v_permlane32_swap_b32 v144, v146
    v_permlane32_swap_b32 v145, v147
    v_permlane32_swap_b32 v148, v150
    v_permlane32_swap_b32 v149, v151
    v_permlane32_swap_b32 v152, v154
    v_permlane32_swap_b32 v153, v155
    v_permlane32_swap_b32 v156, v158
    v_permlane32_swap_b32 v157, v159
    v_mov_b32 v120, 0
    v_mov_b32 v121, 0
    v_mov_b32 v122, 0
    v_mov_b32 v123, 0
    v_mov_b32 v124, 0
    v_mov_b32 v125, 0
    v_mov_b32 v126, 0
    v_mov_b32 v127, 0
    v_mov_b32 v96, 0
    v_mov_b32 v97, 0
    v_mov_b32 v98, 0
    v_mov_b32 v99, 0
    v_mov_b32 v100, 0
    v_mov_b32 v101, 0
    v_mov_b32 v102, 0
    v_mov_b32 v103, 0
    v_mov_b32 v104, 0
    v_mov_b32 v105, 0
    v_mov_b32 v106, 0
    v_mov_b32 v107, 0
    v_mov_b32 v108, 0
    v_mov_b32 v109, 0
    v_mov_b32 v110, 0
    v_mov_b32 v111, 0
    s_waitcnt vmcnt(9)
parallel_sum__compressed_kv_cla__moe_arch_mod__prompt_kernel_A_qdone:
    s_barrier
    s_cmp_eq_u32 s36, 0
    s_cbranch_scc0 parallel_sum__compressed_kv_cla__moe_arch_mod__prompt_kernel_A_nopub2
    s_cmp_lt_u32 s77, 2
    s_cbranch_scc1 parallel_sum__compressed_kv_cla__moe_arch_mod__prompt_kernel_A_nopub2
    v_mov_b32 v253, s87
    s_mov_b64 exec, 1
    buffer_store_dword v253, off, s[12:15], s66 sc1
    s_mov_b64 exec, -1
parallel_sum__compressed_kv_cla__moe_arch_mod__prompt_kernel_A_nopub2:
    s_mov_b32 s86, 6
    s_mov_b32 s42, 65536
    v_add_u32 v242, 32768, v243
    ds_read_b128 v[160:163], v242 offset:0
    ds_read_b128 v[164:167], v242 offset:1024
    ds_read_b128 v[168:171], v242 offset:2048
    ds_read_b128 v[172:175], v242 offset:3072
    ds_read_b128 v[176:179], v242 offset:4096
    ds_read_b128 v[180:183], v242 offset:5120
    ds_read_b128 v[184:187], v242 offset:6144
    ds_read_b128 v[188:191], v242 offset:7168
    v_mov_b32 v240, 0
    s_lshr_b32 s41, s40, 1
    s_cmp_eq_u32 s40, 1
    s_cbranch_scc0 parallel_sum__compressed_kv_cla__moe_arch_mod__prompt_kernel_A_nomask0
    v_cmp_le_i32 vcc, 0, v244
    s_nop 1
    v_cndmask_b32 v96, v246, v96, vcc
    v_cmp_le_i32 vcc, 1, v244
    s_nop 1
    v_cndmask_b32 v97, v246, v97, vcc
    v_cmp_le_i32 vcc, 2, v244
    s_nop 1
    v_cndmask_b32 v98, v246, v98, vcc
    v_cmp_le_i32 vcc, 3, v244
    s_nop 1
    v_cndmask_b32 v99, v246, v99, vcc
    v_cmp_le_i32 vcc, 8, v244
    s_nop 1
    v_cndmask_b32 v100, v246, v100, vcc
    v_cmp_le_i32 vcc, 9, v244
    s_nop 1
    v_cndmask_b32 v101, v246, v101, vcc
    v_cmp_le_i32 vcc, 10, v244
    s_nop 1
    v_cndmask_b32 v102, v246, v102, vcc
    v_cmp_le_i32 vcc, 11, v244
    s_nop 1
    v_cndmask_b32 v103, v246, v103, vcc
    v_cmp_le_i32 vcc, 16, v244
    s_nop 1
    v_cndmask_b32 v104, v246, v104, vcc
    v_cmp_le_i32 vcc, 17, v244
    s_nop 1
    v_cndmask_b32 v105, v246, v105, vcc
    v_cmp_le_i32 vcc, 18, v244
    s_nop 1
    v_cndmask_b32 v106, v246, v106, vcc
    v_cmp_le_i32 vcc, 19, v244
    s_nop 1
    v_cndmask_b32 v107, v246, v107, vcc
    v_cmp_le_i32 vcc, 24, v244
    s_nop 1
    v_cndmask_b32 v108, v246, v108, vcc
    v_cmp_le_i32 vcc, 25, v244
    s_nop 1
    v_cndmask_b32 v109, v246, v109, vcc
    v_cmp_le_i32 vcc, 26, v244
    s_nop 1
    v_cndmask_b32 v110, v246, v110, vcc
    v_cmp_le_i32 vcc, 27, v244
    s_nop 1
    v_cndmask_b32 v111, v246, v111, vcc
    s_nop 1
parallel_sum__compressed_kv_cla__moe_arch_mod__prompt_kernel_A_nomask0:
    s_waitcnt lgkmcnt(4)
    v_mfma_f32_32x32x16_bf16 v[64:79], v[160:163], v[128:131], v[96:111]
    ds_read_b128 v[160:163], v242 offset:8192
    s_sub_u32 s86, s86, 1
    s_cmp_lt_u32 s86, 2
    s_cbranch_scc1 parallel_sum__compressed_kv_cla__moe_arch_mod__prompt_kernel_trg_1
parallel_sum__compressed_kv_cla__moe_arch_mod__prompt_kernel_trg_1_back:
    s_mov_b32 m0, s44
    s_max_i32 s53, s43, 0
    s_add_u32 s49, s53, 4096
    buffer_load_dwordx4 v243, s[16:19], s53 offen offset:0 sc1 lds
    v_mfma_f32_32x32x16_bf16 v[64:79], v[164:167], v[132:135], v[64:79]
    ds_read_b128 v[164:167], v242 offset:9216
    buffer_load_dwordx4 v243, s[16:19], s53 offen offset:1024 sc1 lds
    v_mfma_f32_32x32x16_bf16 v[64:79], v[168:171], v[136:139], v[64:79]
    ds_read_b128 v[168:171], v242 offset:10240
    buffer_load_dwordx4 v243, s[16:19], s53 offen offset:2048 sc1 lds
    v_mfma_f32_32x32x16_bf16 v[64:79], v[172:175], v[140:143], v[64:79]
    ds_read_b128 v[172:175], v242 offset:11264
    buffer_load_dwordx4 v243, s[16:19], s53 offen offset:3072 sc1 lds
    s_waitcnt lgkmcnt(4)
    v_mfma_f32_32x32x16_bf16 v[64:79], v[176:179], v[144:147], v[64:79]
    ds_read_b128 v[176:179], v242 offset:12288
    s_add_u32 m0, s44, 4096
    s_add_u32 s44, s44, 32768
    buffer_load_dwordx4 v243, s[16:19], s49 offen offset:0 sc1 lds
    v_mfma_f32_32x32x16_bf16 v[64:79], v[180:183], v[148:151], v[64:79]
    ds_read_b128 v[180:183], v242 offset:13312
    buffer_load_dwordx4 v243, s[16:19], s49 offen offset:1024 sc1 lds
    v_mfma_f32_32x32x16_bf16 v[64:79], v[184:187], v[152:155], v[64:79]
    ds_read_b128 v[184:187], v242 offset:14336
    buffer_load_dwordx4 v243, s[16:19], s49 offen offset:2048 sc1 lds
    v_mfma_f32_32x32x16_bf16 v[64:79], v[188:191], v[156:159], v[64:79]
    ds_read_b128 v[188:191], v242 offset:15360
    buffer_load_dwordx4 v243, s[16:19], s49 offen offset:3072 sc1 lds
    s_add_u32 s43, s43, 32768
    s_and_b32 s44, s44, 0x1ffff
    buffer_load_dword v254, v255, s[20:23], s32 offen
    s_add_u32 s32, s32, 1280
    s_nop 15
    v_max3_f32 v247, v64, v65, v66
    v_max3_f32 v247, v247, v67, v68
    v_max3_f32 v247, v247, v69, v70
    v_max3_f32 v247, v247, v71, v72
    v_max3_f32 v247, v247, v73, v74
    v_max3_f32 v247, v247, v75, v76
    v_max3_f32 v247, v247, v77, v78
    v_max_f32 v247, v247, v79
    v_mov_b32 v252, v247
    s_nop 1
    v_permlane32_swap_b32 v247, v252
    s_nop 1
    v_max_f32 v247, v247, v252
    v_sub_f32 v96, 0, v247
    v_sub_f32 v97, 0, v247
    v_sub_f32 v98, 0, v247
    v_sub_f32 v99, 0, v247
    v_sub_f32 v100, 0, v247
    v_sub_f32 v101, 0, v247
    v_sub_f32 v102, 0, v247
    v_sub_f32 v103, 0, v247
    v_sub_f32 v104, 0, v247
    v_sub_f32 v105, 0, v247
    v_sub_f32 v106, 0, v247
    v_sub_f32 v107, 0, v247
    v_sub_f32 v108, 0, v247
    v_sub_f32 v109, 0, v247
    v_sub_f32 v110, 0, v247
    v_sub_f32 v111, 0, v247
    v_sub_f32 v64, v64, v247
    v_sub_f32 v65, v65, v247
    v_sub_f32 v66, v66, v247
    v_sub_f32 v67, v67, v247
    v_sub_f32 v68, v68, v247
    v_sub_f32 v69, v69, v247
    v_sub_f32 v70, v70, v247
    v_sub_f32 v71, v71, v247
    v_sub_f32 v72, v72, v247
    v_sub_f32 v73, v73, v247
    v_sub_f32 v74, v74, v247
    v_sub_f32 v75, v75, v247
    v_sub_f32 v76, v76, v247
    v_sub_f32 v77, v77, v247
    v_sub_f32 v78, v78, v247
    v_sub_f32 v79, v79, v247
    s_mov_b32 s46, s41
    s_cmp_eq_u32 s41, 0
    s_cbranch_scc1 parallel_sum__compressed_kv_cla__moe_arch_mod__prompt_kernel_A_seqO2
    s_sub_u32 s41, s41, 1
    s_cmp_eq_u32 s41, 0
    s_cbranch_scc1 parallel_sum__compressed_kv_cla__moe_arch_mod__prompt_kernel_A_endseq
    s_branch parallel_sum__compressed_kv_cla__moe_arch_mod__prompt_kernel_A_h0
.p2align 6
parallel_sum__compressed_kv_cla__moe_arch_mod__prompt_kernel_A_rot:
    ds_read_b128 v[180:183], v242 offset:13312
    v_cvt_pk_bf16_f32 v127, v198, v199
    v_add_f32 v241, v241, v199
    v_mfma_f32_32x32x16_bf16 v[32:47], v[184:187], v[116:119], v[32:47]
    ds_read_b128 v[184:187], v242 offset:14336
    v_cmp_nge_f32 vcc, s52, v241
    v_mfma_f32_32x32x16_bf16 v[48:63], v[188:191], v[116:119], v[48:63]
    s_cbranch_vccnz parallel_sum__compressed_kv_cla__moe_arch_mod__prompt_kernel_chk_4_slow
parallel_sum__compressed_kv_cla__moe_arch_mod__prompt_kernel_chk_4_back:
    ds_read_b128 v[188:191], v242 offset:15360
    v_add_f32 v240, v240, v241
parallel_sum__compressed_kv_cla__moe_arch_mod__prompt_kernel_A_h0:
    s_waitcnt vmcnt(10) lgkmcnt(4)
    v_mfma_f32_32x32x16_bf16 v[80:95], v[160:163], v[128:131], v[96:111]
    s_barrier
    v_add_u32 v242, s42, v243
    ds_read_b128 v[160:163], v242 offset:16384
    v_exp_f32 v192, v64
    v_mfma_f32_32x32x16_bf16 v[80:95], v[164:167], v[132:135], v[80:95]
    ds_read_b128 v[164:167], v242 offset:18432
    v_exp_f32 v193, v65
    s_sub_u32 s86, s86, 1
    s_cmp_lt_u32 s86, 2
    s_cbranch_scc1 parallel_sum__compressed_kv_cla__moe_arch_mod__prompt_kernel_trg_2
parallel_sum__compressed_kv_cla__moe_arch_mod__prompt_kernel_trg_2_back:
    s_mov_b32 m0, s44
    s_max_i32 s53, s43, 0
    s_add_u32 s49, s53, 4096
    buffer_load_dwordx4 v243, s[16:19], s53 offen offset:0 sc1 lds
    v_mfma_f32_32x32x16_bf16 v[80:95], v[168:171], v[136:139], v[80:95]
    ds_read_b128 v[168:171], v242 offset:20480
    v_exp_f32 v194, v66
    v_exp_f32 v195, v67
    v_cvt_pk_bf16_f32 v112, v192, v193
    v_add_f32 v241, v192, v193
    buffer_load_dwordx4 v243, s[16:19], s53 offen offset:1024 sc1 lds
    v_mfma_f32_32x32x16_bf16 v[80:95], v[172:175], v[140:143], v[80:95]
    ds_read_b128 v[172:175], v242 offset:22528
    v_exp_f32 v196, v68
    v_cvt_pk_bf16_f32 v113, v194, v195
    v_add_f32 v241, v241, v194
    v_add_f32 v241, v241, v195
    buffer_load_dwordx4 v243, s[16:19], s53 offen offset:2048 sc1 lds
    s_waitcnt lgkmcnt(4)
    v_mfma_f32_32x32x16_bf16 v[80:95], v[176:179], v[144:147], v[80:95]
    ds_read_b128 v[176:179], v242 offset:17408
    v_exp_f32 v197, v69
    v_exp_f32 v198, v70
    v_add_f32 v241, v241, v196
    buffer_load_dwordx4 v243, s[16:19], s53 offen offset:3072 sc1 lds
    v_mfma_f32_32x32x16_bf16 v[80:95], v[180:183], v[148:151], v[80:95]
    ds_read_b128 v[180:183], v242 offset:19456
    v_exp_f32 v199, v71
    v_cvt_pk_bf16_f32 v114, v196, v197
    v_add_f32 v241, v241, v197
    v_add_f32 v241, v241, v198
    s_add_u32 m0, s44, 4096
    s_add_u32 s44, s44, 32768
    buffer_load_dwordx4 v243, s[16:19], s49 offen offset:0 sc1 lds
    v_mfma_f32_32x32x16_bf16 v[80:95], v[184:187], v[152:155], v[80:95]
    ds_read_b128 v[184:187], v242 offset:21504
    v_exp_f32 v192, v72
    v_exp_f32 v193, v73
    v_cvt_pk_bf16_f32 v115, v198, v199
    v_add_f32 v241, v241, v199
    buffer_load_dwordx4 v243, s[16:19], s49 offen offset:1024 sc1 lds
    v_mfma_f32_32x32x16_bf16 v[80:95], v[188:191], v[156:159], v[80:95]
    ds_read_b128 v[188:191], v242 offset:23552
    v_exp_f32 v194, v74
    v_cvt_pk_bf16_f32 v116, v192, v193
    v_add_f32 v241, v241, v192
    v_add_f32 v241, v241, v193
    buffer_load_dwordx4 v243, s[16:19], s49 offen offset:2048 sc1 lds
    s_waitcnt lgkmcnt(4)
    v_mfma_f32_32x32x16_bf16 v[0:15], v[160:163], v[120:123], v[0:15]
    ds_read_b128 v[160:163], v242 offset:0
    v_exp_f32 v195, v75
    v_add_f32 v241, v241, v194
    buffer_load_dwordx4 v243, s[16:19], s49 offen offset:3072 sc1 lds
    s_add_u32 s43, s43, 32768
    s_and_b32 s44, s44, 0x1ffff
    v_mfma_f32_32x32x16_bf16 v[16:31], v[164:167], v[120:123], v[16:31]
    ds_read_b128 v[164:167], v242 offset:1024
    v_exp_f32 v196, v76
    v_cvt_pk_bf16_f32 v117, v194, v195
    v_add_f32 v241, v241, v195
    buffer_load_dword v254, v255, s[20:23], s32 offen
    s_add_u32 s32, s32, 1280
    v_mfma_f32_32x32x16_bf16 v[32:47], v[168:171], v[120:123], v[32:47]
    ds_read_b128 v[168:171], v242 offset:2048
    v_exp_f32 v197, v77
    v_add_f32 v241, v241, v196
    v_mfma_f32_32x32x16_bf16 v[48:63], v[172:175], v[120:123], v[48:63]
    ds_read_b128 v[172:175], v242 offset:3072
    v_exp_f32 v198, v78
    v_cvt_pk_bf16_f32 v118, v196, v197
    v_add_f32 v241, v241, v197
    s_waitcnt lgkmcnt(4)
    v_mfma_f32_32x32x16_bf16 v[0:15], v[176:179], v[124:127], v[0:15]
    ds_read_b128 v[176:179], v242 offset:4096
    v_exp_f32 v199, v79
    v_add_f32 v241, v241, v198
    v_mfma_f32_32x32x16_bf16 v[16:31], v[180:183], v[124:127], v[16:31]
    ds_read_b128 v[180:183], v242 offset:5120
    v_cvt_pk_bf16_f32 v119, v198, v199
    v_add_f32 v241, v241, v199
    v_mfma_f32_32x32x16_bf16 v[32:47], v[184:187], v[124:127], v[32:47]
    ds_read_b128 v[184:187], v242 offset:6144
    v_cmp_nge_f32 vcc, s52, v241
    v_mfma_f32_32x32x16_bf16 v[48:63], v[188:191], v[124:127], v[48:63]
    s_cbranch_vccnz parallel_sum__compressed_kv_cla__moe_arch_mod__prompt_kernel_chk_3_slow
parallel_sum__compressed_kv_cla__moe_arch_mod__prompt_kernel_chk_3_back:
    ds_read_b128 v[188:191], v242 offset:7168
    v_add_f32 v240, v240, v241
    s_waitcnt lgkmcnt(4)
    v_mfma_f32_32x32x16_bf16 v[64:79], v[160:163], v[128:131], v[96:111]
    ds_read_b128 v[160:163], v242 offset:24576
    v_exp_f32 v192, v80
    v_exp_f32 v193, v81
    v_mfma_f32_32x32x16_bf16 v[64:79], v[164:167], v[132:135], v[64:79]
    ds_read_b128 v[164:167], v242 offset:26624
    v_exp_f32 v194, v82
    v_cvt_pk_bf16_f32 v120, v192, v193
    v_add_f32 v241, v192, v193
    v_mfma_f32_32x32x16_bf16 v[64:79], v[168:171], v[136:139], v[64:79]
    ds_read_b128 v[168:171], v242 offset:28672
    v_exp_f32 v195, v83
    v_exp_f32 v196, v84
    v_add_f32 v241, v241, v194
    v_mfma_f32_32x32x16_bf16 v[64:79], v[172:175], v[140:143], v[64:79]
    ds_read_b128 v[172:175], v242 offset:30720
    v_exp_f32 v197, v85
    v_cvt_pk_bf16_f32 v121, v194, v195
    v_add_f32 v241, v241, v195
    v_add_f32 v241, v241, v196
    s_waitcnt lgkmcnt(4)
    v_mfma_f32_32x32x16_bf16 v[64:79], v[176:179], v[144:147], v[64:79]
    ds_read_b128 v[176:179], v242 offset:25600
    v_exp_f32 v198, v86
    v_cvt_pk_bf16_f32 v122, v196, v197
    v_add_f32 v241, v241, v197
    v_mfma_f32_32x32x16_bf16 v[64:79], v[180:183], v[148:151], v[64:79]
    ds_read_b128 v[180:183], v242 offset:27648
    v_exp_f32 v199, v87
    v_add_f32 v241, v241, v198
    v_mfma_f32_32x32x16_bf16 v[64:79], v[184:187], v[152:155], v[64:79]
    ds_read_b128 v[184:187], v242 offset:29696
    v_exp_f32 v192, v88
    v_exp_f32 v193, v89
    v_cvt_pk_bf16_f32 v123, v198, v199
    v_add_f32 v241, v241, v199
    v_mfma_f32_32x32x16_bf16 v[64:79], v[188:191], v[156:159], v[64:79]
    ds_read_b128 v[188:191], v242 offset:31744
    v_exp_f32 v194, v90
    v_cvt_pk_bf16_f32 v124, v192, v193
    v_add_f32 v241, v241, v192
    v_add_f32 v241, v241, v193
    s_waitcnt lgkmcnt(4)
    v_mfma_f32_32x32x16_bf16 v[0:15], v[160:163], v[112:115], v[0:15]
    ds_read_b128 v[160:163], v242 offset:8192
    v_exp_f32 v195, v91
    v_add_f32 v241, v241, v194
    v_mfma_f32_32x32x16_bf16 v[16:31], v[164:167], v[112:115], v[16:31]
    s_sub_u32 s41, s41, 1
    ds_read_b128 v[164:167], v242 offset:9216
    v_exp_f32 v196, v92
    v_cvt_pk_bf16_f32 v125, v194, v195
    v_add_f32 v241, v241, v195
    v_mfma_f32_32x32x16_bf16 v[32:47], v[168:171], v[112:115], v[32:47]
    ds_read_b128 v[168:171], v242 offset:10240
    v_exp_f32 v197, v93
    v_add_f32 v241, v241, v196
    v_mfma_f32_32x32x16_bf16 v[48:63], v[172:175], v[112:115], v[48:63]
    ds_read_b128 v[172:175], v242 offset:11264
    v_exp_f32 v198, v94
    v_cvt_pk_bf16_f32 v126, v196, v197
    v_add_f32 v241, v241, v197
    s_add_u32 s42, s42, 32768
    s_and_b32 s42, s42, 0x1ffff
    s_waitcnt lgkmcnt(4)
    v_mfma_f32_32x32x16_bf16 v[0:15], v[176:179], v[116:119], v[0:15]
    ds_read_b128 v[176:179], v242 offset:12288
    v_exp_f32 v199, v95
    v_add_f32 v241, v241, v198
    s_cmp_lg_u32 s41, 0
    v_mfma_f32_32x32x16_bf16 v[16:31], v[180:183], v[116:119], v[16:31]
    s_cbranch_scc1 parallel_sum__compressed_kv_cla__moe_arch_mod__prompt_kernel_A_rot
    ds_read_b128 v[180:183], v242 offset:13312
    v_cvt_pk_bf16_f32 v127, v198, v199
    v_add_f32 v241, v241, v199
    v_mfma_f32_32x32x16_bf16 v[32:47], v[184:187], v[116:119], v[32:47]
    ds_read_b128 v[184:187], v242 offset:14336
    v_cmp_nge_f32 vcc, s52, v241
    v_mfma_f32_32x32x16_bf16 v[48:63], v[188:191], v[116:119], v[48:63]
    s_cbranch_vccnz parallel_sum__compressed_kv_cla__moe_arch_mod__prompt_kernel_chk_7_slow
parallel_sum__compressed_kv_cla__moe_arch_mod__prompt_kernel_chk_7_back:
    ds_read_b128 v[188:191], v242 offset:15360
    v_add_f32 v240, v240, v241
parallel_sum__compressed_kv_cla__moe_arch_mod__prompt_kernel_A_endseq:
    s_bitcmp1_b32 s40, 0
    s_cbranch_scc1 parallel_sum__compressed_kv_cla__moe_arch_mod__prompt_kernel_A_seqO
    v_cmp_le_i32 vcc, 0, v244
    s_nop 1
    v_cndmask_b32 v96, v246, v96, vcc
    v_cmp_le_i32 vcc, 1, v244
    s_nop 1
    v_cndmask_b32 v97, v246, v97, vcc
    v_cmp_le_i32 vcc, 2, v244
    s_nop 1
    v_cndmask_b32 v98, v246, v98, vcc
    v_cmp_le_i32 vcc, 3, v244
    s_nop 1
    v_cndmask_b32 v99, v246, v99, vcc
    v_cmp_le_i32 vcc, 8, v244
    s_nop 1
    v_cndmask_b32 v100, v246, v100, vcc
    v_cmp_le_i32 vcc, 9, v244
    s_nop 1
    v_cndmask_b32 v101, v246, v101, vcc
    v_cmp_le_i32 vcc, 10, v244
    s_nop 1
    v_cndmask_b32 v102, v246, v102, vcc
    v_cmp_le_i32 vcc, 11, v244
    s_nop 1
    v_cndmask_b32 v103, v246, v103, vcc
    v_cmp_le_i32 vcc, 16, v244
    s_nop 1
    v_cndmask_b32 v104, v246, v104, vcc
    v_cmp_le_i32 vcc, 17, v244
    s_nop 1
    v_cndmask_b32 v105, v246, v105, vcc
    v_cmp_le_i32 vcc, 18, v244
    s_nop 1
    v_cndmask_b32 v106, v246, v106, vcc
    v_cmp_le_i32 vcc, 19, v244
    s_nop 1
    v_cndmask_b32 v107, v246, v107, vcc
    v_cmp_le_i32 vcc, 24, v244
    s_nop 1
    v_cndmask_b32 v108, v246, v108, vcc
    v_cmp_le_i32 vcc, 25, v244
    s_nop 1
    v_cndmask_b32 v109, v246, v109, vcc
    v_cmp_le_i32 vcc, 26, v244
    s_nop 1
    v_cndmask_b32 v110, v246, v110, vcc
    v_cmp_le_i32 vcc, 27, v244
    s_nop 1
    v_cndmask_b32 v111, v246, v111, vcc
    s_nop 1
    s_waitcnt vmcnt(10) lgkmcnt(4)
    v_mfma_f32_32x32x16_bf16 v[80:95], v[160:163], v[128:131], v[96:111]
    s_barrier
    v_add_u32 v242, s42, v243
    ds_read_b128 v[160:163], v242 offset:16384
    v_exp_f32 v192, v64
    v_mfma_f32_32x32x16_bf16 v[80:95], v[164:167], v[132:135], v[80:95]
    ds_read_b128 v[164:167], v242 offset:18432
    v_exp_f32 v193, v65
    s_sub_u32 s86, s86, 1
    s_cmp_lt_u32 s86, 2
    s_cbranch_scc1 parallel_sum__compressed_kv_cla__moe_arch_mod__prompt_kernel_trg_8
parallel_sum__compressed_kv_cla__moe_arch_mod__prompt_kernel_trg_8_back:
    s_mov_b32 m0, s44
    s_max_i32 s53, s43, 0
    s_add_u32 s49, s53, 4096
    buffer_load_dwordx4 v243, s[16:19], s53 offen offset:0 sc1 lds
    v_mfma_f32_32x32x16_bf16 v[80:95], v[168:171], v[136:139], v[80:95]
    ds_read_b128 v[168:171], v242 offset:20480
    v_exp_f32 v194, v66
    v_exp_f32 v195, v67
    v_cvt_pk_bf16_f32 v112, v192, v193
    v_add_f32 v241, v192, v193
    buffer_load_dwordx4 v243, s[16:19], s53 offen offset:1024 sc1 lds
    v_mfma_f32_32x32x16_bf16 v[80:95], v[172:175], v[140:143], v[80:95]
    ds_read_b128 v[172:175], v242 offset:22528
    v_exp_f32 v196, v68
    v_cvt_pk_bf16_f32 v113, v194, v195
    v_add_f32 v241, v241, v194
    v_add_f32 v241, v241, v195
    buffer_load_dwordx4 v243, s[16:19], s53 offen offset:2048 sc1 lds
    s_waitcnt lgkmcnt(4)
    v_mfma_f32_32x32x16_bf16 v[80:95], v[176:179], v[144:147], v[80:95]
    ds_read_b128 v[176:179], v242 offset:17408
    v_exp_f32 v197, v69
    v_exp_f32 v198, v70
    v_add_f32 v241, v241, v196
    buffer_load_dwordx4 v243, s[16:19], s53 offen offset:3072 sc1 lds
    v_mfma_f32_32x32x16_bf16 v[80:95], v[180:183], v[148:151], v[80:95]
    ds_read_b128 v[180:183], v242 offset:19456
    v_exp_f32 v199, v71
    v_cvt_pk_bf16_f32 v114, v196, v197
    v_add_f32 v241, v241, v197
    v_add_f32 v241, v241, v198
    s_add_u32 m0, s44, 4096
    s_add_u32 s44, s44, 32768
    buffer_load_dwordx4 v243, s[16:19], s49 offen offset:0 sc1 lds
    v_mfma_f32_32x32x16_bf16 v[80:95], v[184:187], v[152:155], v[80:95]
    ds_read_b128 v[184:187], v242 offset:21504
    v_exp_f32 v192, v72
    v_exp_f32 v193, v73
    v_cvt_pk_bf16_f32 v115, v198, v199
    v_add_f32 v241, v241, v199
    buffer_load_dwordx4 v243, s[16:19], s49 offen offset:1024 sc1 lds
    v_mfma_f32_32x32x16_bf16 v[80:95], v[188:191], v[156:159], v[80:95]
    ds_read_b128 v[188:191], v242 offset:23552
    v_exp_f32 v194, v74
    v_cvt_pk_bf16_f32 v116, v192, v193
    v_add_f32 v241, v241, v192
    v_add_f32 v241, v241, v193
    buffer_load_dwordx4 v243, s[16:19], s49 offen offset:2048 sc1 lds
    s_waitcnt lgkmcnt(4)
    v_mfma_f32_32x32x16_bf16 v[0:15], v[160:163], v[120:123], v[0:15]
    ds_read_b128 v[160:163], v242 offset:0
    v_exp_f32 v195, v75
    v_add_f32 v241, v241, v194
    buffer_load_dwordx4 v243, s[16:19], s49 offen offset:3072 sc1 lds
    s_add_u32 s43, s43, 32768
    s_and_b32 s44, s44, 0x1ffff
    v_mfma_f32_32x32x16_bf16 v[16:31], v[164:167], v[120:123], v[16:31]
    ds_read_b128 v[164:167], v242 offset:1024
    v_exp_f32 v196, v76
    v_cvt_pk_bf16_f32 v117, v194, v195
    v_add_f32 v241, v241, v195
    buffer_load_dword v254, v255, s[20:23], s32 offen
    s_add_u32 s32, s32, 1280
    v_mfma_f32_32x32x16_bf16 v[32:47], v[168:171], v[120:123], v[32:47]
    ds_read_b128 v[168:171], v242 offset:2048
    v_exp_f32 v197, v77
    v_add_f32 v241, v241, v196
    v_mfma_f32_32x32x16_bf16 v[48:63], v[172:175], v[120:123], v[48:63]
    ds_read_b128 v[172:175], v242 offset:3072
    v_exp_f32 v198, v78
    v_cvt_pk_bf16_f32 v118, v196, v197
    v_add_f32 v241, v241, v197
    s_waitcnt lgkmcnt(4)
    v_mfma_f32_32x32x16_bf16 v[0:15], v[176:179], v[124:127], v[0:15]
    ds_read_b128 v[176:179], v242 offset:4096
    v_exp_f32 v199, v79
    v_add_f32 v241, v241, v198
    v_mfma_f32_32x32x16_bf16 v[16:31], v[180:183], v[124:127], v[16:31]
    ds_read_b128 v[180:183], v242 offset:5120
    v_cvt_pk_bf16_f32 v119, v198, v199
    v_add_f32 v241, v241, v199
    v_mfma_f32_32x32x16_bf16 v[32:47], v[184:187], v[124:127], v[32:47]
    ds_read_b128 v[184:187], v242 offset:6144
    v_cmp_nge_f32 vcc, s52, v241
    v_mfma_f32_32x32x16_bf16 v[48:63], v[188:191], v[124:127], v[48:63]
    s_cbranch_vccnz parallel_sum__compressed_kv_cla__moe_arch_mod__prompt_kernel_chk_9_slow
parallel_sum__compressed_kv_cla__moe_arch_mod__prompt_kernel_chk_9_back:
    ds_read_b128 v[188:191], v242 offset:7168
    v_add_f32 v240, v240, v241
    ds_read_b128 v[160:163], v242 offset:24576
    ds_read_b128 v[164:167], v242 offset:26624
    ds_read_b128 v[168:171], v242 offset:28672
    ds_read_b128 v[172:175], v242 offset:30720
    ds_read_b128 v[176:179], v242 offset:25600
    ds_read_b128 v[180:183], v242 offset:27648
    ds_read_b128 v[184:187], v242 offset:29696
    ds_read_b128 v[188:191], v242 offset:31744
    v_exp_f32 v192, v80
    v_exp_f32 v193, v81
    v_exp_f32 v194, v82
    v_cvt_pk_bf16_f32 v120, v192, v193
    v_add_f32 v241, v192, v193
    v_exp_f32 v195, v83
    v_exp_f32 v196, v84
    v_add_f32 v241, v241, v194
    v_exp_f32 v197, v85
    v_cvt_pk_bf16_f32 v121, v194, v195
    v_add_f32 v241, v241, v195
    v_add_f32 v241, v241, v196
    v_exp_f32 v198, v86
    v_cvt_pk_bf16_f32 v122, v196, v197
    v_add_f32 v241, v241, v197
    v_exp_f32 v199, v87
    v_add_f32 v241, v241, v198
    v_exp_f32 v192, v88
    v_exp_f32 v193, v89
    v_cvt_pk_bf16_f32 v123, v198, v199
    v_add_f32 v241, v241, v199
    v_exp_f32 v194, v90
    v_cvt_pk_bf16_f32 v124, v192, v193
    v_add_f32 v241, v241, v192
    v_add_f32 v241, v241, v193
    s_waitcnt lgkmcnt(4)
    v_mfma_f32_32x32x16_bf16 v[0:15], v[160:163], v[112:115], v[0:15]
    v_exp_f32 v195, v91
    v_add_f32 v241, v241, v194
    v_mfma_f32_32x32x16_bf16 v[16:31], v[164:167], v[112:115], v[16:31]
    v_exp_f32 v196, v92
    v_cvt_pk_bf16_f32 v125, v194, v195
    v_add_f32 v241, v241, v195
    v_mfma_f32_32x32x16_bf16 v[32:47], v[168:171], v[112:115], v[32:47]
    v_exp_f32 v197, v93
    v_add_f32 v241, v241, v196
    v_mfma_f32_32x32x16_bf16 v[48:63], v[172:175], v[112:115], v[48:63]
    v_exp_f32 v198, v94
    v_cvt_pk_bf16_f32 v126, v196, v197
    v_add_f32 v241, v241, v197
    s_waitcnt lgkmcnt(0)
    v_mfma_f32_32x32x16_bf16 v[0:15], v[176:179], v[116:119], v[0:15]
    v_exp_f32 v199, v95
    v_add_f32 v241, v241, v198
    v_mfma_f32_32x32x16_bf16 v[16:31], v[180:183], v[116:119], v[16:31]
    v_cvt_pk_bf16_f32 v127, v198, v199
    v_add_f32 v241, v241, v199
    v_mfma_f32_32x32x16_bf16 v[32:47], v[184:187], v[116:119], v[32:47]
    v_cmp_nge_f32 vcc, s52, v241
    v_mfma_f32_32x32x16_bf16 v[48:63], v[188:191], v[116:119], v[48:63]
    s_cbranch_vccnz parallel_sum__compressed_kv_cla__moe_arch_mod__prompt_kernel_chk_10_slow
parallel_sum__compressed_kv_cla__moe_arch_mod__prompt_kernel_chk_10_back:
    v_add_f32 v240, v240, v241
    s_add_u32 s42, s42, 32768
    s_and_b32 s42, s42, 0x1ffff
    s_waitcnt vmcnt(10)
    s_barrier
    v_add_u32 v242, s42, v243
    s_sub_u32 s86, s86, 1
    s_cmp_lt_u32 s86, 2
    s_cbranch_scc1 parallel_sum__compressed_kv_cla__moe_arch_mod__prompt_kernel_trg_11
parallel_sum__compressed_kv_cla__moe_arch_mod__prompt_kernel_trg_11_back:
    s_mov_b32 m0, s44
    s_max_i32 s53, s43, 0
    s_add_u32 s49, s53, 4096
    buffer_load_dwordx4 v243, s[16:19], s53 offen offset:0 sc1 lds
    buffer_load_dwordx4 v243, s[16:19], s53 offen offset:1024 sc1 lds
    buffer_load_dwordx4 v243, s[16:19], s53 offen offset:2048 sc1 lds
    buffer_load_dwordx4 v243, s[16:19], s53 offen offset:3072 sc1 lds
    s_add_u32 m0, s44, 4096
    s_add_u32 s44, s44, 32768
    buffer_load_dwordx4 v243, s[16:19], s49 offen offset:0 sc1 lds
    buffer_load_dwordx4 v243, s[16:19], s49 offen offset:1024 sc1 lds
    buffer_load_dwordx4 v243, s[16:19], s49 offen offset:2048 sc1 lds
    buffer_load_dwordx4 v243, s[16:19], s49 offen offset:3072 sc1 lds
    s_add_u32 s43, s43, 32768
    s_and_b32 s44, s44, 0x1ffff
    buffer_load_dword v254, v255, s[20:23], s32 offen
    s_add_u32 s32, s32, 1280
    ds_read_b128 v[160:163], v242 offset:16384
    ds_read_b128 v[164:167], v242 offset:18432
    ds_read_b128 v[168:171], v242 offset:20480
    ds_read_b128 v[172:175], v242 offset:22528
    ds_read_b128 v[176:179], v242 offset:17408
    ds_read_b128 v[180:183], v242 offset:19456
    ds_read_b128 v[184:187], v242 offset:21504
    ds_read_b128 v[188:191], v242 offset:23552
    s_waitcnt lgkmcnt(6)
    v_mfma_f32_32x32x16_bf16 v[0:15], v[160:163], v[120:123], v[0:15]
    v_mfma_f32_32x32x16_bf16 v[16:31], v[164:167], v[120:123], v[16:31]
    s_waitcnt lgkmcnt(4)
    v_mfma_f32_32x32x16_bf16 v[32:47], v[168:171], v[120:123], v[32:47]
    v_mfma_f32_32x32x16_bf16 v[48:63], v[172:175], v[120:123], v[48:63]
    s_waitcnt lgkmcnt(2)
    v_mfma_f32_32x32x16_bf16 v[0:15], v[176:179], v[124:127], v[0:15]
    v_mfma_f32_32x32x16_bf16 v[16:31], v[180:183], v[124:127], v[16:31]
    s_waitcnt lgkmcnt(0)
    v_mfma_f32_32x32x16_bf16 v[32:47], v[184:187], v[124:127], v[32:47]
    v_mfma_f32_32x32x16_bf16 v[48:63], v[188:191], v[124:127], v[48:63]
    s_branch parallel_sum__compressed_kv_cla__moe_arch_mod__prompt_kernel_A_epi
parallel_sum__compressed_kv_cla__moe_arch_mod__prompt_kernel_A_seqO:
    s_waitcnt vmcnt(10) lgkmcnt(4)
    v_mfma_f32_32x32x16_bf16 v[80:95], v[160:163], v[128:131], v[96:111]
    s_barrier
    v_add_u32 v242, s42, v243
    ds_read_b128 v[160:163], v242 offset:16384
    v_exp_f32 v192, v64
    v_mfma_f32_32x32x16_bf16 v[80:95], v[164:167], v[132:135], v[80:95]
    ds_read_b128 v[164:167], v242 offset:18432
    v_exp_f32 v193, v65
    s_sub_u32 s86, s86, 1
    s_cmp_lt_u32 s86, 2
    s_cbranch_scc1 parallel_sum__compressed_kv_cla__moe_arch_mod__prompt_kernel_trg_12
parallel_sum__compressed_kv_cla__moe_arch_mod__prompt_kernel_trg_12_back:
    s_mov_b32 m0, s44
    s_max_i32 s53, s43, 0
    s_add_u32 s49, s53, 4096
    buffer_load_dwordx4 v243, s[16:19], s53 offen offset:0 sc1 lds
    v_mfma_f32_32x32x16_bf16 v[80:95], v[168:171], v[136:139], v[80:95]
    ds_read_b128 v[168:171], v242 offset:20480
    v_exp_f32 v194, v66
    v_exp_f32 v195, v67
    v_cvt_pk_bf16_f32 v112, v192, v193
    v_add_f32 v241, v192, v193
    buffer_load_dwordx4 v243, s[16:19], s53 offen offset:1024 sc1 lds
    v_mfma_f32_32x32x16_bf16 v[80:95], v[172:175], v[140:143], v[80:95]
    ds_read_b128 v[172:175], v242 offset:22528
    v_exp_f32 v196, v68
    v_cvt_pk_bf16_f32 v113, v194, v195
    v_add_f32 v241, v241, v194
    v_add_f32 v241, v241, v195
    buffer_load_dwordx4 v243, s[16:19], s53 offen offset:2048 sc1 lds
    s_waitcnt lgkmcnt(4)
    v_mfma_f32_32x32x16_bf16 v[80:95], v[176:179], v[144:147], v[80:95]
    ds_read_b128 v[176:179], v242 offset:17408
    v_exp_f32 v197, v69
    v_exp_f32 v198, v70
    v_add_f32 v241, v241, v196
    buffer_load_dwordx4 v243, s[16:19], s53 offen offset:3072 sc1 lds
    v_mfma_f32_32x32x16_bf16 v[80:95], v[180:183], v[148:151], v[80:95]
    ds_read_b128 v[180:183], v242 offset:19456
    v_exp_f32 v199, v71
    v_cvt_pk_bf16_f32 v114, v196, v197
    v_add_f32 v241, v241, v197
    v_add_f32 v241, v241, v198
    s_add_u32 m0, s44, 4096
    s_add_u32 s44, s44, 32768
    buffer_load_dwordx4 v243, s[16:19], s49 offen offset:0 sc1 lds
    v_mfma_f32_32x32x16_bf16 v[80:95], v[184:187], v[152:155], v[80:95]
    ds_read_b128 v[184:187], v242 offset:21504
    v_exp_f32 v192, v72
    v_exp_f32 v193, v73
    v_cvt_pk_bf16_f32 v115, v198, v199
    v_add_f32 v241, v241, v199
    buffer_load_dwordx4 v243, s[16:19], s49 offen offset:1024 sc1 lds
    v_mfma_f32_32x32x16_bf16 v[80:95], v[188:191], v[156:159], v[80:95]
    ds_read_b128 v[188:191], v242 offset:23552
    v_exp_f32 v194, v74
    v_cvt_pk_bf16_f32 v116, v192, v193
    v_add_f32 v241, v241, v192
    v_add_f32 v241, v241, v193
    buffer_load_dwordx4 v243, s[16:19], s49 offen offset:2048 sc1 lds
    s_waitcnt lgkmcnt(4)
    v_mfma_f32_32x32x16_bf16 v[0:15], v[160:163], v[120:123], v[0:15]
    ds_read_b128 v[160:163], v242 offset:0
    v_exp_f32 v195, v75
    v_add_f32 v241, v241, v194
    buffer_load_dwordx4 v243, s[16:19], s49 offen offset:3072 sc1 lds
    s_add_u32 s43, s43, 32768
    s_and_b32 s44, s44, 0x1ffff
    v_mfma_f32_32x32x16_bf16 v[16:31], v[164:167], v[120:123], v[16:31]
    ds_read_b128 v[164:167], v242 offset:1024
    v_exp_f32 v196, v76
    v_cvt_pk_bf16_f32 v117, v194, v195
    v_add_f32 v241, v241, v195
    buffer_load_dword v254, v255, s[20:23], s32 offen
    s_add_u32 s32, s32, 1280
    v_mfma_f32_32x32x16_bf16 v[32:47], v[168:171], v[120:123], v[32:47]
    ds_read_b128 v[168:171], v242 offset:2048
    v_exp_f32 v197, v77
    v_add_f32 v241, v241, v196
    v_mfma_f32_32x32x16_bf16 v[48:63], v[172:175], v[120:123], v[48:63]
    ds_read_b128 v[172:175], v242 offset:3072
    v_exp_f32 v198, v78
    v_cvt_pk_bf16_f32 v118, v196, v197
    v_add_f32 v241, v241, v197
    s_waitcnt lgkmcnt(4)
    v_mfma_f32_32x32x16_bf16 v[0:15], v[176:179], v[124:127], v[0:15]
    ds_read_b128 v[176:179], v242 offset:4096
    v_exp_f32 v199, v79
    v_add_f32 v241, v241, v198
    v_mfma_f32_32x32x16_bf16 v[16:31], v[180:183], v[124:127], v[16:31]
    ds_read_b128 v[180:183], v242 offset:5120
    v_cvt_pk_bf16_f32 v119, v198, v199
    v_add_f32 v241, v241, v199
    v_mfma_f32_32x32x16_bf16 v[32:47], v[184:187], v[124:127], v[32:47]
    ds_read_b128 v[184:187], v242 offset:6144
    v_cmp_nge_f32 vcc, s52, v241
    v_mfma_f32_32x32x16_bf16 v[48:63], v[188:191], v[124:127], v[48:63]
    s_cbranch_vccnz parallel_sum__compressed_kv_cla__moe_arch_mod__prompt_kernel_chk_13_slow
parallel_sum__compressed_kv_cla__moe_arch_mod__prompt_kernel_chk_13_back:
    ds_read_b128 v[188:191], v242 offset:7168
    v_add_f32 v240, v240, v241
    v_cmp_le_i32 vcc, 0, v244
    s_nop 1
    v_cndmask_b32 v96, v246, v96, vcc
    v_cmp_le_i32 vcc, 1, v244
    s_nop 1
    v_cndmask_b32 v97, v246, v97, vcc
    v_cmp_le_i32 vcc, 2, v244
    s_nop 1
    v_cndmask_b32 v98, v246, v98, vcc
    v_cmp_le_i32 vcc, 3, v244
    s_nop 1
    v_cndmask_b32 v99, v246, v99, vcc
    v_cmp_le_i32 vcc, 8, v244
    s_nop 1
    v_cndmask_b32 v100, v246, v100, vcc
    v_cmp_le_i32 vcc, 9, v244
    s_nop 1
    v_cndmask_b32 v101, v246, v101, vcc
    v_cmp_le_i32 vcc, 10, v244
    s_nop 1
    v_cndmask_b32 v102, v246, v102, vcc
    v_cmp_le_i32 vcc, 11, v244
    s_nop 1
    v_cndmask_b32 v103, v246, v103, vcc
    v_cmp_le_i32 vcc, 16, v244
    s_nop 1
    v_cndmask_b32 v104, v246, v104, vcc
    v_cmp_le_i32 vcc, 17, v244
    s_nop 1
    v_cndmask_b32 v105, v246, v105, vcc
    v_cmp_le_i32 vcc, 18, v244
    s_nop 1
    v_cndmask_b32 v106, v246, v106, vcc
    v_cmp_le_i32 vcc, 19, v244
    s_nop 1
    v_cndmask_b32 v107, v246, v107, vcc
    v_cmp_le_i32 vcc, 24, v244
    s_nop 1
    v_cndmask_b32 v108, v246, v108, vcc
    v_cmp_le_i32 vcc, 25, v244
    s_nop 1
    v_cndmask_b32 v109, v246, v109, vcc
    v_cmp_le_i32 vcc, 26, v244
    s_nop 1
    v_cndmask_b32 v110, v246, v110, vcc
    v_cmp_le_i32 vcc, 27, v244
    s_nop 1
    v_cndmask_b32 v111, v246, v111, vcc
    s_nop 1
    s_waitcnt lgkmcnt(4)
    v_mfma_f32_32x32x16_bf16 v[64:79], v[160:163], v[128:131], v[96:111]
    ds_read_b128 v[160:163], v242 offset:24576
    v_exp_f32 v192, v80
    v_exp_f32 v193, v81
    v_mfma_f32_32x32x16_bf16 v[64:79], v[164:167], v[132:135], v[64:79]
    ds_read_b128 v[164:167], v242 offset:26624
    v_exp_f32 v194, v82
    v_cvt_pk_bf16_f32 v120, v192, v193
    v_add_f32 v241, v192, v193
    v_mfma_f32_32x32x16_bf16 v[64:79], v[168:171], v[136:139], v[64:79]
    ds_read_b128 v[168:171], v242 offset:28672
    v_exp_f32 v195, v83
    v_exp_f32 v196, v84
    v_add_f32 v241, v241, v194
    v_mfma_f32_32x32x16_bf16 v[64:79], v[172:175], v[140:143], v[64:79]
    ds_read_b128 v[172:175], v242 offset:30720
    v_exp_f32 v197, v85
    v_cvt_pk_bf16_f32 v121, v194, v195
    v_add_f32 v241, v241, v195
    v_add_f32 v241, v241, v196
    s_waitcnt lgkmcnt(4)
    v_mfma_f32_32x32x16_bf16 v[64:79], v[176:179], v[144:147], v[64:79]
    ds_read_b128 v[176:179], v242 offset:25600
    v_exp_f32 v198, v86
    v_cvt_pk_bf16_f32 v122, v196, v197
    v_add_f32 v241, v241, v197
    v_mfma_f32_32x32x16_bf16 v[64:79], v[180:183], v[148:151], v[64:79]
    ds_read_b128 v[180:183], v242 offset:27648
    v_exp_f32 v199, v87
    v_add_f32 v241, v241, v198
    v_mfma_f32_32x32x16_bf16 v[64:79], v[184:187], v[152:155], v[64:79]
    ds_read_b128 v[184:187], v242 offset:29696
    v_exp_f32 v192, v88
    v_exp_f32 v193, v89
    v_cvt_pk_bf16_f32 v123, v198, v199
    v_add_f32 v241, v241, v199
    v_mfma_f32_32x32x16_bf16 v[64:79], v[188:191], v[156:159], v[64:79]
    ds_read_b128 v[188:191], v242 offset:31744
    v_exp_f32 v194, v90
    v_cvt_pk_bf16_f32 v124, v192, v193
    v_add_f32 v241, v241, v192
    v_add_f32 v241, v241, v193
    s_waitcnt lgkmcnt(4)
    v_mfma_f32_32x32x16_bf16 v[0:15], v[160:163], v[112:115], v[0:15]
    ds_read_b128 v[160:163], v242 offset:8192
    v_exp_f32 v195, v91
    v_add_f32 v241, v241, v194
    v_mfma_f32_32x32x16_bf16 v[16:31], v[164:167], v[112:115], v[16:31]
    ds_read_b128 v[164:167], v242 offset:9216
    v_exp_f32 v196, v92
    v_cvt_pk_bf16_f32 v125, v194, v195
    v_add_f32 v241, v241, v195
    v_mfma_f32_32x32x16_bf16 v[32:47], v[168:171], v[112:115], v[32:47]
    ds_read_b128 v[168:171], v242 offset:10240
    v_exp_f32 v197, v93
    v_add_f32 v241, v241, v196
    v_mfma_f32_32x32x16_bf16 v[48:63], v[172:175], v[112:115], v[48:63]
    ds_read_b128 v[172:175], v242 offset:11264
    v_exp_f32 v198, v94
    v_cvt_pk_bf16_f32 v126, v196, v197
    v_add_f32 v241, v241, v197
    s_add_u32 s42, s42, 32768
    s_and_b32 s42, s42, 0x1ffff
    s_waitcnt lgkmcnt(4)
    v_mfma_f32_32x32x16_bf16 v[0:15], v[176:179], v[116:119], v[0:15]
    ds_read_b128 v[176:179], v242 offset:12288
    v_exp_f32 v199, v95
    v_add_f32 v241, v241, v198
    v_mfma_f32_32x32x16_bf16 v[16:31], v[180:183], v[116:119], v[16:31]
    ds_read_b128 v[180:183], v242 offset:13312
    v_cvt_pk_bf16_f32 v127, v198, v199
    v_add_f32 v241, v241, v199
    v_mfma_f32_32x32x16_bf16 v[32:47], v[184:187], v[116:119], v[32:47]
    ds_read_b128 v[184:187], v242 offset:14336
    v_cmp_nge_f32 vcc, s52, v241
    v_mfma_f32_32x32x16_bf16 v[48:63], v[188:191], v[116:119], v[48:63]
    s_cbranch_vccnz parallel_sum__compressed_kv_cla__moe_arch_mod__prompt_kernel_chk_14_slow
parallel_sum__compressed_kv_cla__moe_arch_mod__prompt_kernel_chk_14_back:
    ds_read_b128 v[188:191], v242 offset:15360
    v_add_f32 v240, v240, v241
parallel_sum__compressed_kv_cla__moe_arch_mod__prompt_kernel_A_seqO2:
    s_waitcnt vmcnt(10)
    s_barrier
    v_add_u32 v242, s42, v243
    s_sub_u32 s86, s86, 1
    s_cmp_lt_u32 s86, 2
    s_cbranch_scc1 parallel_sum__compressed_kv_cla__moe_arch_mod__prompt_kernel_trg_15
parallel_sum__compressed_kv_cla__moe_arch_mod__prompt_kernel_trg_15_back:
    s_mov_b32 m0, s44
    s_max_i32 s53, s43, 0
    s_add_u32 s49, s53, 4096
    buffer_load_dwordx4 v243, s[16:19], s53 offen offset:0 sc1 lds
    buffer_load_dwordx4 v243, s[16:19], s53 offen offset:1024 sc1 lds
    buffer_load_dwordx4 v243, s[16:19], s53 offen offset:2048 sc1 lds
    buffer_load_dwordx4 v243, s[16:19], s53 offen offset:3072 sc1 lds
    s_add_u32 m0, s44, 4096
    s_add_u32 s44, s44, 32768
    buffer_load_dwordx4 v243, s[16:19], s49 offen offset:0 sc1 lds
    buffer_load_dwordx4 v243, s[16:19], s49 offen offset:1024 sc1 lds
    buffer_load_dwordx4 v243, s[16:19], s49 offen offset:2048 sc1 lds
    buffer_load_dwordx4 v243, s[16:19], s49 offen offset:3072 sc1 lds
    s_add_u32 s43, s43, 32768
    s_and_b32 s44, s44, 0x1ffff
    buffer_load_dword v254, v255, s[20:23], s32 offen
    s_add_u32 s32, s32, 1280
    ds_read_b128 v[160:163], v242 offset:16384
    ds_read_b128 v[164:167], v242 offset:18432
    ds_read_b128 v[168:171], v242 offset:20480
    ds_read_b128 v[172:175], v242 offset:22528
    ds_read_b128 v[176:179], v242 offset:17408
    ds_read_b128 v[180:183], v242 offset:19456
    ds_read_b128 v[184:187], v242 offset:21504
    ds_read_b128 v[188:191], v242 offset:23552
    v_exp_f32 v192, v64
    v_exp_f32 v193, v65
    v_exp_f32 v194, v66
    v_exp_f32 v195, v67
    v_cvt_pk_bf16_f32 v112, v192, v193
    v_add_f32 v241, v192, v193
    v_exp_f32 v196, v68
    v_cvt_pk_bf16_f32 v113, v194, v195
    v_add_f32 v241, v241, v194
    v_add_f32 v241, v241, v195
    v_exp_f32 v197, v69
    v_exp_f32 v198, v70
    v_add_f32 v241, v241, v196
    v_exp_f32 v199, v71
    v_cvt_pk_bf16_f32 v114, v196, v197
    v_add_f32 v241, v241, v197
    v_add_f32 v241, v241, v198
    v_exp_f32 v192, v72
    v_exp_f32 v193, v73
    v_cvt_pk_bf16_f32 v115, v198, v199
    v_add_f32 v241, v241, v199
    v_exp_f32 v194, v74
    v_cvt_pk_bf16_f32 v116, v192, v193
    v_add_f32 v241, v241, v192
    v_add_f32 v241, v241, v193
    s_waitcnt lgkmcnt(4)
    v_mfma_f32_32x32x16_bf16 v[0:15], v[160:163], v[120:123], v[0:15]
    v_exp_f32 v195, v75
    v_add_f32 v241, v241, v194
    v_mfma_f32_32x32x16_bf16 v[16:31], v[164:167], v[120:123], v[16:31]
    v_exp_f32 v196, v76
    v_cvt_pk_bf16_f32 v117, v194, v195
    v_add_f32 v241, v241, v195
    v_mfma_f32_32x32x16_bf16 v[32:47], v[168:171], v[120:123], v[32:47]
    v_exp_f32 v197, v77
    v_add_f32 v241, v241, v196
    v_mfma_f32_32x32x16_bf16 v[48:63], v[172:175], v[120:123], v[48:63]
    v_exp_f32 v198, v78
    v_cvt_pk_bf16_f32 v118, v196, v197
    v_add_f32 v241, v241, v197
    s_waitcnt lgkmcnt(0)
    v_mfma_f32_32x32x16_bf16 v[0:15], v[176:179], v[124:127], v[0:15]
    v_exp_f32 v199, v79
    v_add_f32 v241, v241, v198
    v_mfma_f32_32x32x16_bf16 v[16:31], v[180:183], v[124:127], v[16:31]
    v_cvt_pk_bf16_f32 v119, v198, v199
    v_add_f32 v241, v241, v199
    v_mfma_f32_32x32x16_bf16 v[32:47], v[184:187], v[124:127], v[32:47]
    v_cmp_nge_f32 vcc, s52, v241
    v_mfma_f32_32x32x16_bf16 v[48:63], v[188:191], v[124:127], v[48:63]
    s_cbranch_vccnz parallel_sum__compressed_kv_cla__moe_arch_mod__prompt_kernel_chk_16_slow
parallel_sum__compressed_kv_cla__moe_arch_mod__prompt_kernel_chk_16_back:
    v_add_f32 v240, v240, v241
    ds_read_b128 v[160:163], v242 offset:24576
    ds_read_b128 v[164:167], v242 offset:26624
    ds_read_b128 v[168:171], v242 offset:28672
    ds_read_b128 v[172:175], v242 offset:30720
    ds_read_b128 v[176:179], v242 offset:25600
    ds_read_b128 v[180:183], v242 offset:27648
    ds_read_b128 v[184:187], v242 offset:29696
    ds_read_b128 v[188:191], v242 offset:31744
    s_waitcnt lgkmcnt(6)
    v_mfma_f32_32x32x16_bf16 v[0:15], v[160:163], v[112:115], v[0:15]
    v_mfma_f32_32x32x16_bf16 v[16:31], v[164:167], v[112:115], v[16:31]
    s_waitcnt lgkmcnt(4)
    v_mfma_f32_32x32x16_bf16 v[32:47], v[168:171], v[112:115], v[32:47]
    v_mfma_f32_32x32x16_bf16 v[48:63], v[172:175], v[112:115], v[48:63]
    s_waitcnt lgkmcnt(2)
    v_mfma_f32_32x32x16_bf16 v[0:15], v[176:179], v[116:119], v[0:15]
    v_mfma_f32_32x32x16_bf16 v[16:31], v[180:183], v[116:119], v[16:31]
    s_waitcnt lgkmcnt(0)
    v_mfma_f32_32x32x16_bf16 v[32:47], v[184:187], v[116:119], v[32:47]
    v_mfma_f32_32x32x16_bf16 v[48:63], v[188:191], v[116:119], v[48:63]
parallel_sum__compressed_kv_cla__moe_arch_mod__prompt_kernel_A_epi:
    v_mov_b32 v252, v240
    s_nop 1
    v_permlane32_swap_b32 v240, v252
    s_lshl_b32 s47, s39, 5
    s_add_u32 s47, s47, s37
    v_add_f32 v240, v240, v252
    v_rcp_f32 v240, v240
    s_lshl_b32 s71, s47, 6
    s_add_u32 s71, s71, 0x788000
    s_lshl_b32 s47, s47, 13
    s_add_u32 s47, s47, 0x2800000
    s_add_u32 s48, s47, 4096
    s_nop 7
    v_mul_f32 v0, v0, v240
    v_mul_f32 v1, v1, v240
    v_mul_f32 v2, v2, v240
    v_mul_f32 v3, v3, v240
    v_mul_f32 v4, v4, v240
    v_mul_f32 v5, v5, v240
    v_mul_f32 v6, v6, v240
    v_mul_f32 v7, v7, v240
    v_cvt_pk_bf16_f32 v64, v0, v1
    v_cvt_pk_bf16_f32 v65, v2, v3
    v_cvt_pk_bf16_f32 v66, v4, v5
    v_cvt_pk_bf16_f32 v67, v6, v7
    buffer_store_dwordx4 v[64:67], v243, s[12:15], s47 offen offset:0 sc1
    v_mul_f32 v8, v8, v240
    v_mul_f32 v9, v9, v240
    v_mul_f32 v10, v10, v240
    v_mul_f32 v11, v11, v240
    v_mul_f32 v12, v12, v240
    v_mul_f32 v13, v13, v240
    v_mul_f32 v14, v14, v240
    v_mul_f32 v15, v15, v240
    v_cvt_pk_bf16_f32 v68, v8, v9
    v_cvt_pk_bf16_f32 v69, v10, v11
    v_cvt_pk_bf16_f32 v70, v12, v13
    v_cvt_pk_bf16_f32 v71, v14, v15
    buffer_store_dwordx4 v[68:71], v243, s[12:15], s47 offen offset:1024 sc1
    v_mul_f32 v16, v16, v240
    v_mul_f32 v17, v17, v240
    v_mul_f32 v18, v18, v240
    v_mul_f32 v19, v19, v240
    v_mul_f32 v20, v20, v240
    v_mul_f32 v21, v21, v240
    v_mul_f32 v22, v22, v240
    v_mul_f32 v23, v23, v240
    v_cvt_pk_bf16_f32 v72, v16, v17
    v_cvt_pk_bf16_f32 v73, v18, v19
    v_cvt_pk_bf16_f32 v74, v20, v21
    v_cvt_pk_bf16_f32 v75, v22, v23
    buffer_store_dwordx4 v[72:75], v243, s[12:15], s47 offen offset:2048 sc1
    v_mul_f32 v24, v24, v240
    v_mul_f32 v25, v25, v240
    v_mul_f32 v26, v26, v240
    v_mul_f32 v27, v27, v240
    v_mul_f32 v28, v28, v240
    v_mul_f32 v29, v29, v240
    v_mul_f32 v30, v30, v240
    v_mul_f32 v31, v31, v240
    v_cvt_pk_bf16_f32 v76, v24, v25
    v_cvt_pk_bf16_f32 v77, v26, v27
    v_cvt_pk_bf16_f32 v78, v28, v29
    v_cvt_pk_bf16_f32 v79, v30, v31
    buffer_store_dwordx4 v[76:79], v243, s[12:15], s47 offen offset:3072 sc1
    v_mul_f32 v32, v32, v240
    v_mul_f32 v33, v33, v240
    v_mul_f32 v34, v34, v240
    v_mul_f32 v35, v35, v240
    v_mul_f32 v36, v36, v240
    v_mul_f32 v37, v37, v240
    v_mul_f32 v38, v38, v240
    v_mul_f32 v39, v39, v240
    v_cvt_pk_bf16_f32 v80, v32, v33
    v_cvt_pk_bf16_f32 v81, v34, v35
    v_cvt_pk_bf16_f32 v82, v36, v37
    v_cvt_pk_bf16_f32 v83, v38, v39
    buffer_store_dwordx4 v[80:83], v243, s[12:15], s48 offen offset:0 sc1
    v_mul_f32 v40, v40, v240
    v_mul_f32 v41, v41, v240
    v_mul_f32 v42, v42, v240
    v_mul_f32 v43, v43, v240
    v_mul_f32 v44, v44, v240
    v_mul_f32 v45, v45, v240
    v_mul_f32 v46, v46, v240
    v_mul_f32 v47, v47, v240
    v_cvt_pk_bf16_f32 v84, v40, v41
    v_cvt_pk_bf16_f32 v85, v42, v43
    v_cvt_pk_bf16_f32 v86, v44, v45
    v_cvt_pk_bf16_f32 v87, v46, v47
    buffer_store_dwordx4 v[84:87], v243, s[12:15], s48 offen offset:1024 sc1
    v_mul_f32 v48, v48, v240
    v_mul_f32 v49, v49, v240
    v_mul_f32 v50, v50, v240
    v_mul_f32 v51, v51, v240
    v_mul_f32 v52, v52, v240
    v_mul_f32 v53, v53, v240
    v_mul_f32 v54, v54, v240
    v_mul_f32 v55, v55, v240
    v_cvt_pk_bf16_f32 v88, v48, v49
    v_cvt_pk_bf16_f32 v89, v50, v51
    v_cvt_pk_bf16_f32 v90, v52, v53
    v_cvt_pk_bf16_f32 v91, v54, v55
    buffer_store_dwordx4 v[88:91], v243, s[12:15], s48 offen offset:2048 sc1
    v_mul_f32 v56, v56, v240
    v_mul_f32 v57, v57, v240
    v_mul_f32 v58, v58, v240
    v_mul_f32 v59, v59, v240
    v_mul_f32 v60, v60, v240
    v_mul_f32 v61, v61, v240
    v_mul_f32 v62, v62, v240
    v_mul_f32 v63, v63, v240
    v_cvt_pk_bf16_f32 v92, v56, v57
    v_cvt_pk_bf16_f32 v93, v58, v59
    v_cvt_pk_bf16_f32 v94, v60, v61
    v_cvt_pk_bf16_f32 v95, v62, v63
    buffer_store_dwordx4 v[92:95], v243, s[12:15], s48 offen offset:3072 sc1
    s_sub_u32 s47, s2, 128
    s_cmp_lt_u32 s47, 48
    s_cselect_b32 s34, 13, -1
    v_bfe_u32 v242, v243, 4, 3
    v_lshlrev_b32 v242, 3, v242
    s_mov_b32 s67, 0x4e0000
    buffer_load_dwordx2 v[240:241], v242, s[12:15], s67 offen sc1
    s_or_b32 s47, s2, s36
    s_cmp_eq_u32 s47, 0
    s_cbranch_scc1 parallel_sum__compressed_kv_cla__moe_arch_mod__prompt_kernel_A_top8
    s_waitcnt vmcnt(18)
    s_branch parallel_sum__compressed_kv_cla__moe_arch_mod__prompt_kernel_A_ld_in
parallel_sum__compressed_kv_cla__moe_arch_mod__prompt_kernel_A_ld:
    s_cmp_eq_u32 s46, s34
    s_cbranch_scc1 parallel_sum__compressed_kv_cla__moe_arch_mod__prompt_kernel_A_moe
    s_waitcnt vmcnt(10)
    s_cmp_eq_u32 s71, 0
    s_cbranch_scc1 parallel_sum__compressed_kv_cla__moe_arch_mod__prompt_kernel_A_cf0
    s_waitcnt vmcnt(9)
    v_mov_b32 v0, s87
    s_mov_b64 exec, 1
    buffer_store_dword v0, off, s[12:15], s71 sc1
    s_mov_b64 exec, -1
    s_mov_b32 s71, 0
parallel_sum__compressed_kv_cla__moe_arch_mod__prompt_kernel_A_cf0:
parallel_sum__compressed_kv_cla__moe_arch_mod__prompt_kernel_A_ld_in:
    s_barrier
    s_add_u32 s46, s46, 1
    s_add_u32 s47, s46, 2
    s_cmp_gt_u32 s47, s45
    s_cbranch_scc1 parallel_sum__compressed_kv_cla__moe_arch_mod__prompt_kernel_A_ld_drain
    s_sub_u32 s86, s86, 1
    s_cmp_lt_u32 s86, 2
    s_cbranch_scc1 parallel_sum__compressed_kv_cla__moe_arch_mod__prompt_kernel_trg_17
parallel_sum__compressed_kv_cla__moe_arch_mod__prompt_kernel_trg_17_back:
    s_mov_b32 m0, s44
    s_max_i32 s53, s43, 0
    s_add_u32 s49, s53, 4096
    buffer_load_dwordx4 v243, s[16:19], s53 offen offset:0 sc1 lds
    buffer_load_dwordx4 v243, s[16:19], s53 offen offset:1024 sc1 lds
    buffer_load_dwordx4 v243, s[16:19], s53 offen offset:2048 sc1 lds
    buffer_load_dwordx4 v243, s[16:19], s53 offen offset:3072 sc1 lds
    s_add_u32 m0, s44, 4096
    s_add_u32 s44, s44, 32768
    buffer_load_dwordx4 v243, s[16:19], s49 offen offset:0 sc1 lds
    buffer_load_dwordx4 v243, s[16:19], s49 offen offset:1024 sc1 lds
    buffer_load_dwordx4 v243, s[16:19], s49 offen offset:2048 sc1 lds
    buffer_load_dwordx4 v243, s[16:19], s49 offen offset:3072 sc1 lds
    s_add_u32 s43, s43, 32768
    s_and_b32 s44, s44, 0x1ffff
    buffer_load_dword v254, v255, s[20:23], s32 offen
    s_add_u32 s32, s32, 1280
    s_branch parallel_sum__compressed_kv_cla__moe_arch_mod__prompt_kernel_A_ld
parallel_sum__compressed_kv_cla__moe_arch_mod__prompt_kernel_A_ld_drain:
    s_cmp_ge_u32 s46, s45
    s_cbranch_scc1 parallel_sum__compressed_kv_cla__moe_arch_mod__prompt_kernel_A_done
    s_waitcnt vmcnt(0)
    s_cmp_eq_u32 s71, 0
    s_cbranch_scc1 parallel_sum__compressed_kv_cla__moe_arch_mod__prompt_kernel_A_cf1
    s_waitcnt vmcnt(9)
    v_mov_b32 v0, s87
    s_mov_b64 exec, 1
    buffer_store_dword v0, off, s[12:15], s71 sc1
    s_mov_b64 exec, -1
    s_mov_b32 s71, 0
parallel_sum__compressed_kv_cla__moe_arch_mod__prompt_kernel_A_cf1:
    s_barrier
    s_branch parallel_sum__compressed_kv_cla__moe_arch_mod__prompt_kernel_A_done
parallel_sum__compressed_kv_cla__moe_arch_mod__prompt_kernel_A_top8:
    s_waitcnt vmcnt(19)
    s_barrier
    s_sub_u32 s86, s86, 1
    s_cmp_lt_u32 s86, 2
    s_cbranch_scc1 parallel_sum__compressed_kv_cla__moe_arch_mod__prompt_kernel_trg_18
parallel_sum__compressed_kv_cla__moe_arch_mod__prompt_kernel_trg_18_back:
    s_mov_b32 m0, s44
    s_max_i32 s53, s43, 0
    s_add_u32 s49, s53, 4096
    buffer_load_dwordx4 v243, s[16:19], s53 offen offset:0 sc1 lds
    buffer_load_dwordx4 v243, s[16:19], s53 offen offset:1024 sc1 lds
    buffer_load_dwordx4 v243, s[16:19], s53 offen offset:2048 sc1 lds
    buffer_load_dwordx4 v243, s[16:19], s53 offen offset:3072 sc1 lds
    s_add_u32 m0, s44, 4096
    s_add_u32 s44, s44, 32768
    buffer_load_dwordx4 v243, s[16:19], s49 offen offset:0 sc1 lds
    buffer_load_dwordx4 v243, s[16:19], s49 offen offset:1024 sc1 lds
    buffer_load_dwordx4 v243, s[16:19], s49 offen offset:2048 sc1 lds
    buffer_load_dwordx4 v243, s[16:19], s49 offen offset:3072 sc1 lds
    s_add_u32 s43, s43, 32768
    s_and_b32 s44, s44, 0x1ffff
    buffer_load_dword v254, v255, s[20:23], s32 offen
    s_add_u32 s32, s32, 1280
    s_mov_b32 s47, 0x240000
    s_add_u32 s48, s47, 4096
    buffer_load_dwordx4 v[0:3], v243, s[12:15], s47 offen offset:0 sc1
    buffer_load_dwordx4 v[4:7], v243, s[12:15], s47 offen offset:1024 sc1
    buffer_load_dwordx4 v[8:11], v243, s[12:15], s47 offen offset:2048 sc1
    buffer_load_dwordx4 v[12:15], v243, s[12:15], s47 offen offset:3072 sc1
    buffer_load_dwordx4 v[16:19], v243, s[12:15], s48 offen offset:0 sc1
    buffer_load_dwordx4 v[20:23], v243, s[12:15], s48 offen offset:1024 sc1
    buffer_load_dwordx4 v[24:27], v243, s[12:15], s48 offen offset:2048 sc1
    buffer_load_dwordx4 v[28:31], v243, s[12:15], s48 offen offset:3072 sc1
    s_waitcnt vmcnt(27)
    s_barrier
    s_sub_u32 s86, s86, 1
    s_cmp_lt_u32 s86, 2
    s_cbranch_scc1 parallel_sum__compressed_kv_cla__moe_arch_mod__prompt_kernel_trg_19
parallel_sum__compressed_kv_cla__moe_arch_mod__prompt_kernel_trg_19_back:
    s_mov_b32 m0, s44
    s_max_i32 s53, s43, 0
    s_add_u32 s49, s53, 4096
    buffer_load_dwordx4 v243, s[16:19], s53 offen offset:0 sc1 lds
    buffer_load_dwordx4 v243, s[16:19], s53 offen offset:1024 sc1 lds
    buffer_load_dwordx4 v243, s[16:19], s53 offen offset:2048 sc1 lds
    buffer_load_dwordx4 v243, s[16:19], s53 offen offset:3072 sc1 lds
    s_add_u32 m0, s44, 4096
    s_add_u32 s44, s44, 32768
    buffer_load_dwordx4 v243, s[16:19], s49 offen offset:0 sc1 lds
    buffer_load_dwordx4 v243, s[16:19], s49 offen offset:1024 sc1 lds
    buffer_load_dwordx4 v243, s[16:19], s49 offen offset:2048 sc1 lds
    buffer_load_dwordx4 v243, s[16:19], s49 offen offset:3072 sc1 lds
    s_add_u32 s43, s43, 32768
    s_and_b32 s44, s44, 0x1ffff
    buffer_load_dword v254, v255, s[20:23], s32 offen
    s_add_u32 s32, s32, 1280
    s_waitcnt vmcnt(9)
    v_mov_b32 v40, s87
    s_mov_b64 exec, 1
    buffer_store_dword v40, off, s[12:15], s71 sc1
    s_mov_b64 exec, -1
    s_mov_b32 s71, 0
    v_mov_b32 v40, 0
    v_max3_u32 v41, v0, v1, v2
    v_max3_u32 v41, v41, v3, v4
    v_max3_u32 v41, v41, v5, v6
    v_max3_u32 v41, v41, v7, v8
    v_max3_u32 v41, v41, v9, v10
    v_max3_u32 v41, v41, v11, v12
    v_max3_u32 v41, v41, v13, v14
    v_max3_u32 v41, v41, v15, v16
    v_max3_u32 v41, v41, v17, v18
    v_max3_u32 v41, v41, v19, v20
    v_max3_u32 v41, v41, v21, v22
    v_max3_u32 v41, v41, v23, v24
    v_max3_u32 v41, v41, v25, v26
    v_max3_u32 v41, v41, v27, v28
    v_max3_u32 v41, v41, v29, v30
    v_max_u32 v41, v41, v31
    s_nop 1
    v_max_u32_dpp v41, v41, v41 row_shr:1 row_mask:0xf bank_mask:0xf
    s_nop 1
    v_max_u32_dpp v41, v41, v41 row_shr:2 row_mask:0xf bank_mask:0xf
    s_nop 1
    v_max_u32_dpp v41, v41, v41 row_shr:4 row_mask:0xf bank_mask:0xf
    s_nop 1
    v_max_u32_dpp v41, v41, v41 row_shr:8 row_mask:0xf bank_mask:0xf
    s_nop 1
    v_max_u32_dpp v41, v41, v41 row_bcast:15 row_mask:0xa bank_mask:0xf
    s_nop 1
    v_max_u32_dpp v41, v41, v41 row_bcast:31 row_mask:0xc bank_mask:0xf
    s_nop 1
    v_readlane_b32 s47, v41, 63
    s_nop 3
    s_mov_b32 s48, s47
    v_writelane_b32 v40, s48, 0
    v_subrev_u32 v0, s47, v0
    v_subrev_u32 v1, s47, v1
    v_subrev_u32 v2, s47, v2
    v_subrev_u32 v3, s47, v3
    v_subrev_u32 v4, s47, v4
    v_subrev_u32 v5, s47, v5
    v_subrev_u32 v6, s47, v6
    v_subrev_u32 v7, s47, v7
    v_subrev_u32 v8, s47, v8
    v_subrev_u32 v9, s47, v9
    v_subrev_u32 v10, s47, v10
    v_subrev_u32 v11, s47, v11
    v_subrev_u32 v12, s47, v12
    v_subrev_u32 v13, s47, v13
    v_subrev_u32 v14, s47, v14
    v_subrev_u32 v15, s47, v15
    v_subrev_u32 v16, s47, v16
    v_subrev_u32 v17, s47, v17
    v_subrev_u32 v18, s47, v18
    v_subrev_u32 v19, s47, v19
    v_subrev_u32 v20, s47, v20
    v_subrev_u32 v21, s47, v21
    v_subrev_u32 v22, s47, v22
    v_subrev_u32 v23, s47, v23
    v_subrev_u32 v24, s47, v24
    v_subrev_u32 v25, s47, v25
    v_subrev_u32 v26, s47, v26
    v_subrev_u32 v27, s47, v27
    v_subrev_u32 v28, s47, v28
    v_subrev_u32 v29, s47, v29
    v_subrev_u32 v30, s47, v30
    v_subrev_u32 v31, s47, v31
    v_max3_u32 v41, v0, v1, v2
    v_max3_u32 v41, v41, v3, v4
    v_max3_u32 v41, v41, v5, v6
    v_max3_u32 v41, v41, v7, v8
    v_max3_u32 v41, v41, v9, v10
    v_max3_u32 v41, v41, v11, v12
    v_max3_u32 v41, v41, v13, v14
    v_max3_u32 v41, v41, v15, v16
    v_max3_u32 v41, v41, v17, v18
    v_max3_u32 v41, v41, v19, v20
    v_max3_u32 v41, v41, v21, v22
    v_max3_u32 v41, v41, v23, v24
    v_max3_u32 v41, v41, v25, v26
    v_max3_u32 v41, v41, v27, v28
    v_max3_u32 v41, v41, v29, v30
    v_max_u32 v41, v41, v31
    s_nop 1
    v_max_u32_dpp v41, v41, v41 row_shr:1 row_mask:0xf bank_mask:0xf
    s_nop 1
    v_max_u32_dpp v41, v41, v41 row_shr:2 row_mask:0xf bank_mask:0xf
    s_nop 1
    v_max_u32_dpp v41, v41, v41 row_shr:4 row_mask:0xf bank_mask:0xf
    s_nop 1
    v_max_u32_dpp v41, v41, v41 row_shr:8 row_mask:0xf bank_mask:0xf
    s_nop 1
    v_max_u32_dpp v41, v41, v41 row_bcast:15 row_mask:0xa bank_mask:0xf
    s_nop 1
    v_max_u32_dpp v41, v41, v41 row_bcast:31 row_mask:0xc bank_mask:0xf
    s_nop 1
    v_readlane_b32 s47, v41, 63
    s_nop 3
    s_add_u32 s48, s48, s47
    v_writelane_b32 v40, s48, 1
    s_waitcnt vmcnt(19)
    s_barrier
    s_sub_u32 s86, s86, 1
    s_cmp_lt_u32 s86, 2
    s_cbranch_scc1 parallel_sum__compressed_kv_cla__moe_arch_mod__prompt_kernel_trg_20
parallel_sum__compressed_kv_cla__moe_arch_mod__prompt_kernel_trg_20_back:
    s_mov_b32 m0, s44
    s_max_i32 s53, s43, 0
    s_add_u32 s49, s53, 4096
    buffer_load_dwordx4 v243, s[16:19], s53 offen offset:0 sc1 lds
    buffer_load_dwordx4 v243, s[16:19], s53 offen offset:1024 sc1 lds
    buffer_load_dwordx4 v243, s[16:19], s53 offen offset:2048 sc1 lds
    buffer_load_dwordx4 v243, s[16:19], s53 offen offset:3072 sc1 lds
    s_add_u32 m0, s44, 4096
    s_add_u32 s44, s44, 32768
    buffer_load_dwordx4 v243, s[16:19], s49 offen offset:0 sc1 lds
    buffer_load_dwordx4 v243, s[16:19], s49 offen offset:1024 sc1 lds
    buffer_load_dwordx4 v243, s[16:19], s49 offen offset:2048 sc1 lds
    buffer_load_dwordx4 v243, s[16:19], s49 offen offset:3072 sc1 lds
    s_add_u32 s43, s43, 32768
    s_and_b32 s44, s44, 0x1ffff
    buffer_load_dword v254, v255, s[20:23], s32 offen
    s_add_u32 s32, s32, 1280
    v_subrev_u32 v0, s47, v0
    v_subrev_u32 v1, s47, v1
    v_subrev_u32 v2, s47, v2
    v_subrev_u32 v3, s47, v3
    v_subrev_u32 v4, s47, v4
    v_subrev_u32 v5, s47, v5
    v_subrev_u32 v6, s47, v6
    v_subrev_u32 v7, s47, v7
    v_subrev_u32 v8, s47, v8
    v_subrev_u32 v9, s47, v9
    v_subrev_u32 v10, s47, v10
    v_subrev_u32 v11, s47, v11
    v_subrev_u32 v12, s47, v12
    v_subrev_u32 v13, s47, v13
    v_subrev_u32 v14, s47, v14
    v_subrev_u32 v15, s47, v15
    v_subrev_u32 v16, s47, v16
    v_subrev_u32 v17, s47, v17
    v_subrev_u32 v18, s47, v18
    v_subrev_u32 v19, s47, v19
    v_subrev_u32 v20, s47, v20
    v_subrev_u32 v21, s47, v21
    v_subrev_u32 v22, s47, v22
    v_subrev_u32 v23, s47, v23
    v_subrev_u32 v24, s47, v24
    v_subrev_u32 v25, s47, v25
    v_subrev_u32 v26, s47, v26
    v_subrev_u32 v27, s47, v27
    v_subrev_u32 v28, s47, v28
    v_subrev_u32 v29, s47, v29
    v_subrev_u32 v30, s47, v30
    v_subrev_u32 v31, s47, v31
    v_max3_u32 v41, v0, v1, v2
    v_max3_u32 v41, v41, v3, v4
    v_max3_u32 v41, v41, v5, v6
    v_max3_u32 v41, v41, v7, v8
    v_max3_u32 v41, v41, v9, v10
    v_max3_u32 v41, v41, v11, v12
    v_max3_u32 v41, v41, v13, v14
    v_max3_u32 v41, v41, v15, v16
    v_max3_u32 v41, v41, v17, v18
    v_max3_u32 v41, v41, v19, v20
    v_max3_u32 v41, v41, v21, v22
    v_max3_u32 v41, v41, v23, v24
    v_max3_u32 v41, v41, v25, v26
    v_max3_u32 v41, v41, v27, v28
    v_max3_u32 v41, v41, v29, v30
    v_max_u32 v41, v41, v31
    s_nop 1
    v_max_u32_dpp v41, v41, v41 row_shr:1 row_mask:0xf bank_mask:0xf
    s_nop 1
    v_max_u32_dpp v41, v41, v41 row_shr:2 row_mask:0xf bank_mask:0xf
    s_nop 1
    v_max_u32_dpp v41, v41, v41 row_shr:4 row_mask:0xf bank_mask:0xf
    s_nop 1
    v_max_u32_dpp v41, v41, v41 row_shr:8 row_mask:0xf bank_mask:0xf
    s_nop 1
    v_max_u32_dpp v41, v41, v41 row_bcast:15 row_mask:0xa bank_mask:0xf
    s_nop 1
    v_max_u32_dpp v41, v41, v41 row_bcast:31 row_mask:0xc bank_mask:0xf
    s_nop 1
    v_readlane_b32 s47, v41, 63
    s_nop 3
    s_add_u32 s48, s48, s47
    v_writelane_b32 v40, s48, 2
    v_subrev_u32 v0, s47, v0
    v_subrev_u32 v1, s47, v1
    v_subrev_u32 v2, s47, v2
    v_subrev_u32 v3, s47, v3
    v_subrev_u32 v4, s47, v4
    v_subrev_u32 v5, s47, v5
    v_subrev_u32 v6, s47, v6
    v_subrev_u32 v7, s47, v7
    v_subrev_u32 v8, s47, v8
    v_subrev_u32 v9, s47, v9
    v_subrev_u32 v10, s47, v10
    v_subrev_u32 v11, s47, v11
    v_subrev_u32 v12, s47, v12
    v_subrev_u32 v13, s47, v13
    v_subrev_u32 v14, s47, v14
    v_subrev_u32 v15, s47, v15
    v_subrev_u32 v16, s47, v16
    v_subrev_u32 v17, s47, v17
    v_subrev_u32 v18, s47, v18
    v_subrev_u32 v19, s47, v19
    v_subrev_u32 v20, s47, v20
    v_subrev_u32 v21, s47, v21
    v_subrev_u32 v22, s47, v22
    v_subrev_u32 v23, s47, v23
    v_subrev_u32 v24, s47, v24
    v_subrev_u32 v25, s47, v25
    v_subrev_u32 v26, s47, v26
    v_subrev_u32 v27, s47, v27
    v_subrev_u32 v28, s47, v28
    v_subrev_u32 v29, s47, v29
    v_subrev_u32 v30, s47, v30
    v_subrev_u32 v31, s47, v31
    v_max3_u32 v41, v0, v1, v2
    v_max3_u32 v41, v41, v3, v4
    v_max3_u32 v41, v41, v5, v6
    v_max3_u32 v41, v41, v7, v8
    v_max3_u32 v41, v41, v9, v10
    v_max3_u32 v41, v41, v11, v12
    v_max3_u32 v41, v41, v13, v14
    v_max3_u32 v41, v41, v15, v16
    v_max3_u32 v41, v41, v17, v18
    v_max3_u32 v41, v41, v19, v20
    v_max3_u32 v41, v41, v21, v22
    v_max3_u32 v41, v41, v23, v24
    v_max3_u32 v41, v41, v25, v26
    v_max3_u32 v41, v41, v27, v28
    v_max3_u32 v41, v41, v29, v30
    v_max_u32 v41, v41, v31
    s_nop 1
    v_max_u32_dpp v41, v41, v41 row_shr:1 row_mask:0xf bank_mask:0xf
    s_nop 1
    v_max_u32_dpp v41, v41, v41 row_shr:2 row_mask:0xf bank_mask:0xf
    s_nop 1
    v_max_u32_dpp v41, v41, v41 row_shr:4 row_mask:0xf bank_mask:0xf
    s_nop 1
    v_max_u32_dpp v41, v41, v41 row_shr:8 row_mask:0xf bank_mask:0xf
    s_nop 1
    v_max_u32_dpp v41, v41, v41 row_bcast:15 row_mask:0xa bank_mask:0xf
    s_nop 1
    v_max_u32_dpp v41, v41, v41 row_bcast:31 row_mask:0xc bank_mask:0xf
    s_nop 1
    v_readlane_b32 s47, v41, 63
    s_nop 3
    s_add_u32 s48, s48, s47
    v_writelane_b32 v40, s48, 3
    s_waitcnt vmcnt(11)
    s_barrier
    s_sub_u32 s86, s86, 1
    s_cmp_lt_u32 s86, 2
    s_cbranch_scc1 parallel_sum__compressed_kv_cla__moe_arch_mod__prompt_kernel_trg_21
parallel_sum__compressed_kv_cla__moe_arch_mod__prompt_kernel_trg_21_back:
    s_mov_b32 m0, s44
    s_max_i32 s53, s43, 0
    s_add_u32 s49, s53, 4096
    buffer_load_dwordx4 v243, s[16:19], s53 offen offset:0 sc1 lds
    buffer_load_dwordx4 v243, s[16:19], s53 offen offset:1024 sc1 lds
    buffer_load_dwordx4 v243, s[16:19], s53 offen offset:2048 sc1 lds
    buffer_load_dwordx4 v243, s[16:19], s53 offen offset:3072 sc1 lds
    s_add_u32 m0, s44, 4096
    s_add_u32 s44, s44, 32768
    buffer_load_dwordx4 v243, s[16:19], s49 offen offset:0 sc1 lds
    buffer_load_dwordx4 v243, s[16:19], s49 offen offset:1024 sc1 lds
    buffer_load_dwordx4 v243, s[16:19], s49 offen offset:2048 sc1 lds
    buffer_load_dwordx4 v243, s[16:19], s49 offen offset:3072 sc1 lds
    s_add_u32 s43, s43, 32768
    s_and_b32 s44, s44, 0x1ffff
    buffer_load_dword v254, v255, s[20:23], s32 offen
    s_add_u32 s32, s32, 1280
    v_subrev_u32 v0, s47, v0
    v_subrev_u32 v1, s47, v1
    v_subrev_u32 v2, s47, v2
    v_subrev_u32 v3, s47, v3
    v_subrev_u32 v4, s47, v4
    v_subrev_u32 v5, s47, v5
    v_subrev_u32 v6, s47, v6
    v_subrev_u32 v7, s47, v7
    v_subrev_u32 v8, s47, v8
    v_subrev_u32 v9, s47, v9
    v_subrev_u32 v10, s47, v10
    v_subrev_u32 v11, s47, v11
    v_subrev_u32 v12, s47, v12
    v_subrev_u32 v13, s47, v13
    v_subrev_u32 v14, s47, v14
    v_subrev_u32 v15, s47, v15
    v_subrev_u32 v16, s47, v16
    v_subrev_u32 v17, s47, v17
    v_subrev_u32 v18, s47, v18
    v_subrev_u32 v19, s47, v19
    v_subrev_u32 v20, s47, v20
    v_subrev_u32 v21, s47, v21
    v_subrev_u32 v22, s47, v22
    v_subrev_u32 v23, s47, v23
    v_subrev_u32 v24, s47, v24
    v_subrev_u32 v25, s47, v25
    v_subrev_u32 v26, s47, v26
    v_subrev_u32 v27, s47, v27
    v_subrev_u32 v28, s47, v28
    v_subrev_u32 v29, s47, v29
    v_subrev_u32 v30, s47, v30
    v_subrev_u32 v31, s47, v31
    v_max3_u32 v41, v0, v1, v2
    v_max3_u32 v41, v41, v3, v4
    v_max3_u32 v41, v41, v5, v6
    v_max3_u32 v41, v41, v7, v8
    v_max3_u32 v41, v41, v9, v10
    v_max3_u32 v41, v41, v11, v12
    v_max3_u32 v41, v41, v13, v14
    v_max3_u32 v41, v41, v15, v16
    v_max3_u32 v41, v41, v17, v18
    v_max3_u32 v41, v41, v19, v20
    v_max3_u32 v41, v41, v21, v22
    v_max3_u32 v41, v41, v23, v24
    v_max3_u32 v41, v41, v25, v26
    v_max3_u32 v41, v41, v27, v28
    v_max3_u32 v41, v41, v29, v30
    v_max_u32 v41, v41, v31
    s_nop 1
    v_max_u32_dpp v41, v41, v41 row_shr:1 row_mask:0xf bank_mask:0xf
    s_nop 1
    v_max_u32_dpp v41, v41, v41 row_shr:2 row_mask:0xf bank_mask:0xf
    s_nop 1
    v_max_u32_dpp v41, v41, v41 row_shr:4 row_mask:0xf bank_mask:0xf
    s_nop 1
    v_max_u32_dpp v41, v41, v41 row_shr:8 row_mask:0xf bank_mask:0xf
    s_nop 1
    v_max_u32_dpp v41, v41, v41 row_bcast:15 row_mask:0xa bank_mask:0xf
    s_nop 1
    v_max_u32_dpp v41, v41, v41 row_bcast:31 row_mask:0xc bank_mask:0xf
    s_nop 1
    v_readlane_b32 s47, v41, 63
    s_nop 3
    s_add_u32 s48, s48, s47
    v_writelane_b32 v40, s48, 4
    v_subrev_u32 v0, s47, v0
    v_subrev_u32 v1, s47, v1
    v_subrev_u32 v2, s47, v2
    v_subrev_u32 v3, s47, v3
    v_subrev_u32 v4, s47, v4
    v_subrev_u32 v5, s47, v5
    v_subrev_u32 v6, s47, v6
    v_subrev_u32 v7, s47, v7
    v_subrev_u32 v8, s47, v8
    v_subrev_u32 v9, s47, v9
    v_subrev_u32 v10, s47, v10
    v_subrev_u32 v11, s47, v11
    v_subrev_u32 v12, s47, v12
    v_subrev_u32 v13, s47, v13
    v_subrev_u32 v14, s47, v14
    v_subrev_u32 v15, s47, v15
    v_subrev_u32 v16, s47, v16
    v_subrev_u32 v17, s47, v17
    v_subrev_u32 v18, s47, v18
    v_subrev_u32 v19, s47, v19
    v_subrev_u32 v20, s47, v20
    v_subrev_u32 v21, s47, v21
    v_subrev_u32 v22, s47, v22
    v_subrev_u32 v23, s47, v23
    v_subrev_u32 v24, s47, v24
    v_subrev_u32 v25, s47, v25
    v_subrev_u32 v26, s47, v26
    v_subrev_u32 v27, s47, v27
    v_subrev_u32 v28, s47, v28
    v_subrev_u32 v29, s47, v29
    v_subrev_u32 v30, s47, v30
    v_subrev_u32 v31, s47, v31
    v_max3_u32 v41, v0, v1, v2
    v_max3_u32 v41, v41, v3, v4
    v_max3_u32 v41, v41, v5, v6
    v_max3_u32 v41, v41, v7, v8
    v_max3_u32 v41, v41, v9, v10
    v_max3_u32 v41, v41, v11, v12
    v_max3_u32 v41, v41, v13, v14
    v_max3_u32 v41, v41, v15, v16
    v_max3_u32 v41, v41, v17, v18
    v_max3_u32 v41, v41, v19, v20
    v_max3_u32 v41, v41, v21, v22
    v_max3_u32 v41, v41, v23, v24
    v_max3_u32 v41, v41, v25, v26
    v_max3_u32 v41, v41, v27, v28
    v_max3_u32 v41, v41, v29, v30
    v_max_u32 v41, v41, v31
    s_nop 1
    v_max_u32_dpp v41, v41, v41 row_shr:1 row_mask:0xf bank_mask:0xf
    s_nop 1
    v_max_u32_dpp v41, v41, v41 row_shr:2 row_mask:0xf bank_mask:0xf
    s_nop 1
    v_max_u32_dpp v41, v41, v41 row_shr:4 row_mask:0xf bank_mask:0xf
    s_nop 1
    v_max_u32_dpp v41, v41, v41 row_shr:8 row_mask:0xf bank_mask:0xf
    s_nop 1
    v_max_u32_dpp v41, v41, v41 row_bcast:15 row_mask:0xa bank_mask:0xf
    s_nop 1
    v_max_u32_dpp v41, v41, v41 row_bcast:31 row_mask:0xc bank_mask:0xf
    s_nop 1
    v_readlane_b32 s47, v41, 63
    s_nop 3
    s_add_u32 s48, s48, s47
    v_writelane_b32 v40, s48, 5
    s_waitcnt vmcnt(10)
    s_barrier
    s_sub_u32 s86, s86, 1
    s_cmp_lt_u32 s86, 2
    s_cbranch_scc1 parallel_sum__compressed_kv_cla__moe_arch_mod__prompt_kernel_trg_22
parallel_sum__compressed_kv_cla__moe_arch_mod__prompt_kernel_trg_22_back:
    s_mov_b32 m0, s44
    s_max_i32 s53, s43, 0
    s_add_u32 s49, s53, 4096
    buffer_load_dwordx4 v243, s[16:19], s53 offen offset:0 sc1 lds
    buffer_load_dwordx4 v243, s[16:19], s53 offen offset:1024 sc1 lds
    buffer_load_dwordx4 v243, s[16:19], s53 offen offset:2048 sc1 lds
    buffer_load_dwordx4 v243, s[16:19], s53 offen offset:3072 sc1 lds
    s_add_u32 m0, s44, 4096
    s_add_u32 s44, s44, 32768
    buffer_load_dwordx4 v243, s[16:19], s49 offen offset:0 sc1 lds
    buffer_load_dwordx4 v243, s[16:19], s49 offen offset:1024 sc1 lds
    buffer_load_dwordx4 v243, s[16:19], s49 offen offset:2048 sc1 lds
    buffer_load_dwordx4 v243, s[16:19], s49 offen offset:3072 sc1 lds
    s_add_u32 s43, s43, 32768
    s_and_b32 s44, s44, 0x1ffff
    buffer_load_dword v254, v255, s[20:23], s32 offen
    s_add_u32 s32, s32, 1280
    v_subrev_u32 v0, s47, v0
    v_subrev_u32 v1, s47, v1
    v_subrev_u32 v2, s47, v2
    v_subrev_u32 v3, s47, v3
    v_subrev_u32 v4, s47, v4
    v_subrev_u32 v5, s47, v5
    v_subrev_u32 v6, s47, v6
    v_subrev_u32 v7, s47, v7
    v_subrev_u32 v8, s47, v8
    v_subrev_u32 v9, s47, v9
    v_subrev_u32 v10, s47, v10
    v_subrev_u32 v11, s47, v11
    v_subrev_u32 v12, s47, v12
    v_subrev_u32 v13, s47, v13
    v_subrev_u32 v14, s47, v14
    v_subrev_u32 v15, s47, v15
    v_subrev_u32 v16, s47, v16
    v_subrev_u32 v17, s47, v17
    v_subrev_u32 v18, s47, v18
    v_subrev_u32 v19, s47, v19
    v_subrev_u32 v20, s47, v20
    v_subrev_u32 v21, s47, v21
    v_subrev_u32 v22, s47, v22
    v_subrev_u32 v23, s47, v23
    v_subrev_u32 v24, s47, v24
    v_subrev_u32 v25, s47, v25
    v_subrev_u32 v26, s47, v26
    v_subrev_u32 v27, s47, v27
    v_subrev_u32 v28, s47, v28
    v_subrev_u32 v29, s47, v29
    v_subrev_u32 v30, s47, v30
    v_subrev_u32 v31, s47, v31
    v_max3_u32 v41, v0, v1, v2
    v_max3_u32 v41, v41, v3, v4
    v_max3_u32 v41, v41, v5, v6
    v_max3_u32 v41, v41, v7, v8
    v_max3_u32 v41, v41, v9, v10
    v_max3_u32 v41, v41, v11, v12
    v_max3_u32 v41, v41, v13, v14
    v_max3_u32 v41, v41, v15, v16
    v_max3_u32 v41, v41, v17, v18
    v_max3_u32 v41, v41, v19, v20
    v_max3_u32 v41, v41, v21, v22
    v_max3_u32 v41, v41, v23, v24
    v_max3_u32 v41, v41, v25, v26
    v_max3_u32 v41, v41, v27, v28
    v_max3_u32 v41, v41, v29, v30
    v_max_u32 v41, v41, v31
    s_nop 1
    v_max_u32_dpp v41, v41, v41 row_shr:1 row_mask:0xf bank_mask:0xf
    s_nop 1
    v_max_u32_dpp v41, v41, v41 row_shr:2 row_mask:0xf bank_mask:0xf
    s_nop 1
    v_max_u32_dpp v41, v41, v41 row_shr:4 row_mask:0xf bank_mask:0xf
    s_nop 1
    v_max_u32_dpp v41, v41, v41 row_shr:8 row_mask:0xf bank_mask:0xf
    s_nop 1
    v_max_u32_dpp v41, v41, v41 row_bcast:15 row_mask:0xa bank_mask:0xf
    s_nop 1
    v_max_u32_dpp v41, v41, v41 row_bcast:31 row_mask:0xc bank_mask:0xf
    s_nop 1
    v_readlane_b32 s47, v41, 63
    s_nop 3
    s_add_u32 s48, s48, s47
    v_writelane_b32 v40, s48, 6
    v_subrev_u32 v0, s47, v0
    v_subrev_u32 v1, s47, v1
    v_subrev_u32 v2, s47, v2
    v_subrev_u32 v3, s47, v3
    v_subrev_u32 v4, s47, v4
    v_subrev_u32 v5, s47, v5
    v_subrev_u32 v6, s47, v6
    v_subrev_u32 v7, s47, v7
    v_subrev_u32 v8, s47, v8
    v_subrev_u32 v9, s47, v9
    v_subrev_u32 v10, s47, v10
    v_subrev_u32 v11, s47, v11
    v_subrev_u32 v12, s47, v12
    v_subrev_u32 v13, s47, v13
    v_subrev_u32 v14, s47, v14
    v_subrev_u32 v15, s47, v15
    v_subrev_u32 v16, s47, v16
    v_subrev_u32 v17, s47, v17
    v_subrev_u32 v18, s47, v18
    v_subrev_u32 v19, s47, v19
    v_subrev_u32 v20, s47, v20
    v_subrev_u32 v21, s47, v21
    v_subrev_u32 v22, s47, v22
    v_subrev_u32 v23, s47, v23
    v_subrev_u32 v24, s47, v24
    v_subrev_u32 v25, s47, v25
    v_subrev_u32 v26, s47, v26
    v_subrev_u32 v27, s47, v27
    v_subrev_u32 v28, s47, v28
    v_subrev_u32 v29, s47, v29
    v_subrev_u32 v30, s47, v30
    v_subrev_u32 v31, s47, v31
    v_max3_u32 v41, v0, v1, v2
    v_max3_u32 v41, v41, v3, v4
    v_max3_u32 v41, v41, v5, v6
    v_max3_u32 v41, v41, v7, v8
    v_max3_u32 v41, v41, v9, v10
    v_max3_u32 v41, v41, v11, v12
    v_max3_u32 v41, v41, v13, v14
    v_max3_u32 v41, v41, v15, v16
    v_max3_u32 v41, v41, v17, v18
    v_max3_u32 v41, v41, v19, v20
    v_max3_u32 v41, v41, v21, v22
    v_max3_u32 v41, v41, v23, v24
    v_max3_u32 v41, v41, v25, v26
    v_max3_u32 v41, v41, v27, v28
    v_max3_u32 v41, v41, v29, v30
    v_max_u32 v41, v41, v31
    s_nop 1
    v_max_u32_dpp v41, v41, v41 row_shr:1 row_mask:0xf bank_mask:0xf
    s_nop 1
    v_max_u32_dpp v41, v41, v41 row_shr:2 row_mask:0xf bank_mask:0xf
    s_nop 1
    v_max_u32_dpp v41, v41, v41 row_shr:4 row_mask:0xf bank_mask:0xf
    s_nop 1
    v_max_u32_dpp v41, v41, v41 row_shr:8 row_mask:0xf bank_mask:0xf
    s_nop 1
    v_max_u32_dpp v41, v41, v41 row_bcast:15 row_mask:0xa bank_mask:0xf
    s_nop 1
    v_max_u32_dpp v41, v41, v41 row_bcast:31 row_mask:0xc bank_mask:0xf
    s_nop 1
    v_readlane_b32 s47, v41, 63
    s_nop 3
    s_add_u32 s48, s48, s47
    v_writelane_b32 v40, s48, 7
    s_waitcnt vmcnt(10)
    s_barrier
    s_sub_u32 s86, s86, 1
    s_cmp_lt_u32 s86, 2
    s_cbranch_scc1 parallel_sum__compressed_kv_cla__moe_arch_mod__prompt_kernel_trg_23
parallel_sum__compressed_kv_cla__moe_arch_mod__prompt_kernel_trg_23_back:
    s_mov_b32 m0, s44
    s_max_i32 s53, s43, 0
    s_add_u32 s49, s53, 4096
    buffer_load_dwordx4 v243, s[16:19], s53 offen offset:0 sc1 lds
    buffer_load_dwordx4 v243, s[16:19], s53 offen offset:1024 sc1 lds
    buffer_load_dwordx4 v243, s[16:19], s53 offen offset:2048 sc1 lds
    buffer_load_dwordx4 v243, s[16:19], s53 offen offset:3072 sc1 lds
    s_add_u32 m0, s44, 4096
    s_add_u32 s44, s44, 32768
    buffer_load_dwordx4 v243, s[16:19], s49 offen offset:0 sc1 lds
    buffer_load_dwordx4 v243, s[16:19], s49 offen offset:1024 sc1 lds
    buffer_load_dwordx4 v243, s[16:19], s49 offen offset:2048 sc1 lds
    buffer_load_dwordx4 v243, s[16:19], s49 offen offset:3072 sc1 lds
    s_add_u32 s43, s43, 32768
    s_and_b32 s44, s44, 0x1ffff
    buffer_load_dword v254, v255, s[20:23], s32 offen
    s_add_u32 s32, s32, 1280
    v_and_b32 v42, 0xffff, v40
    v_sub_u32 v42, 2047, v42
    v_lshrrev_b32 v43, 16, v40
    v_and_b32 v44, 0x7fff, v43
    v_xor_b32 v45, 0xffff, v43
    v_cmp_lt_u32 vcc, 0x7fff, v43
    s_nop 1
    v_cndmask_b32 v43, v45, v44, vcc
    v_lshlrev_b32 v43, 16, v43
    v_mul_f32 v43, 0xbfb8aa3b, v43
    v_exp_f32 v43, v43
    v_lshrrev_b32 v44, 2, v243
    v_add_f32 v43, 1.0, v43
    v_rcp_f32 v43, v43
    v_mov_b32 v45, 0x40000000
    v_cvt_pk_bf16_f32 v43, v43, v43
    v_and_b32 v43, 0xffff0000, v43
    v_or_b32 v42, v42, v43
    v_mov_b32 v43, s87
    v_cmp_gt_u32 vcc, 32, v44
    v_lshlrev_b32 v44, 1, v44
    s_mov_b32 s47, 0x4e0000
    v_cndmask_b32 v44, v45, v44, vcc
    buffer_store_dwordx2 v[42:43], v44, s[12:15], s47 offen sc1
    s_mov_b32 s46, 6
    s_waitcnt vmcnt(11)
    s_branch parallel_sum__compressed_kv_cla__moe_arch_mod__prompt_kernel_A_ld_in
parallel_sum__compressed_kv_cla__moe_arch_mod__prompt_kernel_A_moe:
    s_cmp_eq_u32 s71, 0
    s_cbranch_scc1 parallel_sum__compressed_kv_cla__moe_arch_mod__prompt_kernel_A_cf2
    s_waitcnt vmcnt(9)
    v_mov_b32 v0, s87
    s_mov_b64 exec, 1
    buffer_store_dword v0, off, s[12:15], s71 sc1
    s_mov_b64 exec, -1
    s_mov_b32 s71, 0
parallel_sum__compressed_kv_cla__moe_arch_mod__prompt_kernel_A_cf2:
    s_mov_b32 s35, 0x40000
parallel_sum__compressed_kv_cla__moe_arch_mod__prompt_kernel_chk_sel0:
    v_xor_b32 v241, s87, v241
    v_cmp_ne_u32 s[84:85], 0, v241
    s_nop 1
    s_cmp_eq_u64 s[84:85], 0
    s_cbranch_scc1 parallel_sum__compressed_kv_cla__moe_arch_mod__prompt_kernel_chk_sel0_ok
    s_sub_u32 s35, s35, 1
    s_cbranch_scc1 parallel_sum__compressed_kv_cla__moe_arch_mod__prompt_kernel_chk_sel0_ok
    s_sleep 1
    buffer_load_dwordx2 v[240:241], v242, s[12:15], s67 offen sc1
    s_waitcnt vmcnt(0)
    s_branch parallel_sum__compressed_kv_cla__moe_arch_mod__prompt_kernel_chk_sel0
parallel_sum__compressed_kv_cla__moe_arch_mod__prompt_kernel_chk_sel0_ok:
    v_and_b32 v241, 0xffff0000, v240
    v_and_b32 v240, 0xffff, v240
    s_waitcnt vmcnt(10) lgkmcnt(0)
    s_barrier
    s_sub_u32 s86, s86, 1
    s_cmp_lt_u32 s86, 2
    s_cbranch_scc1 parallel_sum__compressed_kv_cla__moe_arch_mod__prompt_kernel_trg_24
parallel_sum__compressed_kv_cla__moe_arch_mod__prompt_kernel_trg_24_back:
    s_mov_b32 m0, s44
    s_max_i32 s53, s43, 0
    s_add_u32 s49, s53, 4096
    buffer_load_dwordx4 v243, s[16:19], s53 offen offset:0 sc1 lds
    buffer_load_dwordx4 v243, s[16:19], s53 offen offset:1024 sc1 lds
    buffer_load_dwordx4 v243, s[16:19], s53 offen offset:2048 sc1 lds
    buffer_load_dwordx4 v243, s[16:19], s53 offen offset:3072 sc1 lds
    s_add_u32 m0, s44, 4096
    s_add_u32 s44, s44, 32768
    buffer_load_dwordx4 v243, s[16:19], s49 offen offset:0 sc1 lds
    buffer_load_dwordx4 v243, s[16:19], s49 offen offset:1024 sc1 lds
    buffer_load_dwordx4 v243, s[16:19], s49 offen offset:2048 sc1 lds
    buffer_load_dwordx4 v243, s[16:19], s49 offen offset:3072 sc1 lds
    s_add_u32 s43, s43, 32768
    s_and_b32 s44, s44, 0x1ffff
    buffer_load_dword v254, v255, s[20:23], s32 offen
    s_add_u32 s32, s32, 1280
    v_lshrrev_b32 v2, 4, v243
    v_lshrrev_b32 v4, 2, v2
    v_mul_u32_u24 v4, 9216, v4
    v_and_b32 v5, 3, v2
    v_lshl_add_u32 v4, v5, 4, v4
    v_and_b32 v11, 7, v2
    v_lshlrev_b32 v12, 2, v11
    ds_bpermute_b32 v13, v12, v240
    s_mul_i32 s68, s36, 1327104
    s_sub_u32 s69, s2, 128
    s_mul_i32 s69, s69, 192
    s_add_u32 s68, s68, s69
    s_mul_i32 s69, s36, 9216
    s_mov_b32 s72, s28
    s_mov_b32 s73, s29
    s_mov_b32 s74, 0x510000
    s_mov_b32 s75, 0x20000
    s_mov_b32 s76, s30
    s_mov_b32 s77, s31
    s_mov_b32 s78, 0x510000
    s_mov_b32 s79, 0x20000
    s_waitcnt lgkmcnt(0)
    v_lshrrev_b32 v14, 5, v13
    v_mul_u32_u24 v14, 36864, v14
    v_and_b32 v15, 31, v13
    v_lshl_add_u32 v14, v15, 4, v14
    v_lshrrev_b32 v15, 5, v2
    v_lshl_add_u32 v14, v15, 9, v14
    s_add_u32 s70, s69, 0x0
    buffer_load_dwordx4 v[204:207], v14, s[12:15], s70 offen sc1
    s_add_u32 s70, s70, 1024
    buffer_load_dwordx4 v[208:211], v14, s[12:15], s70 offen sc1
    s_add_u32 s70, s70, 1024
    buffer_load_dwordx4 v[212:215], v14, s[12:15], s70 offen sc1
    s_add_u32 s70, s70, 1024
    buffer_load_dwordx4 v[216:219], v14, s[12:15], s70 offen sc1
    s_add_u32 s70, s70, 1024
    buffer_load_dwordx4 v[220:223], v14, s[12:15], s70 offen sc1
    s_add_u32 s70, s70, 1024
    buffer_load_dwordx4 v[224:227], v14, s[12:15], s70 offen sc1
    s_add_u32 s70, s70, 1024
    buffer_load_dwordx4 v[228:231], v14, s[12:15], s70 offen sc1
    s_add_u32 s70, s70, 1024
    buffer_load_dwordx4 v[232:235], v14, s[12:15], s70 offen sc1
    s_add_u32 s70, s70, 1024
    buffer_load_dwordx4 v[236:239], v14, s[12:15], s70 offen sc1
    s_add_u32 s70, s70, 1024
    s_waitcnt vmcnt(19) lgkmcnt(0)
    s_barrier
    s_sub_u32 s86, s86, 1
    s_cmp_lt_u32 s86, 2
    s_cbranch_scc1 parallel_sum__compressed_kv_cla__moe_arch_mod__prompt_kernel_trg_25
parallel_sum__compressed_kv_cla__moe_arch_mod__prompt_kernel_trg_25_back:
    s_mov_b32 m0, s44
    s_max_i32 s53, s43, 0
    s_add_u32 s49, s53, 4096
    buffer_load_dwordx4 v243, s[16:19], s53 offen offset:0 sc1 lds
    buffer_load_dwordx4 v243, s[16:19], s53 offen offset:1024 sc1 lds
    buffer_load_dwordx4 v243, s[16:19], s53 offen offset:2048 sc1 lds
    buffer_load_dwordx4 v243, s[16:19], s53 offen offset:3072 sc1 lds
    s_add_u32 m0, s44, 4096
    s_add_u32 s44, s44, 32768
    buffer_load_dwordx4 v243, s[16:19], s49 offen offset:0 sc1 lds
    buffer_load_dwordx4 v243, s[16:19], s49 offen offset:1024 sc1 lds
    buffer_load_dwordx4 v243, s[16:19], s49 offen offset:2048 sc1 lds
    buffer_load_dwordx4 v243, s[16:19], s49 offen offset:3072 sc1 lds
    s_add_u32 s43, s43, 32768
    s_and_b32 s44, s44, 0x1ffff
    buffer_load_dword v254, v255, s[20:23], s32 offen
    s_add_u32 s32, s32, 1280
    s_add_u32 s70, s68, 0
    buffer_load_dwordx4 v[60:63], v4, s[72:75], s70 offen
    buffer_load_dwordx4 v[64:67], v4, s[76:79], s70 offen
    s_add_u32 s70, s68, 147456
    buffer_load_dwordx4 v[68:71], v4, s[72:75], s70 offen
    buffer_load_dwordx4 v[72:75], v4, s[76:79], s70 offen
    s_add_u32 s70, s68, 294912
    buffer_load_dwordx4 v[76:79], v4, s[72:75], s70 offen
    buffer_load_dwordx4 v[80:83], v4, s[76:79], s70 offen
    s_waitcnt vmcnt(25) lgkmcnt(0)
    s_barrier
    s_sub_u32 s86, s86, 1
    s_cmp_lt_u32 s86, 2
    s_cbranch_scc1 parallel_sum__compressed_kv_cla__moe_arch_mod__prompt_kernel_trg_26
parallel_sum__compressed_kv_cla__moe_arch_mod__prompt_kernel_trg_26_back:
    s_mov_b32 m0, s44
    s_max_i32 s53, s43, 0
    s_add_u32 s49, s53, 4096
    buffer_load_dwordx4 v243, s[16:19], s53 offen offset:0 sc1 lds
    buffer_load_dwordx4 v243, s[16:19], s53 offen offset:1024 sc1 lds
    buffer_load_dwordx4 v243, s[16:19], s53 offen offset:2048 sc1 lds
    buffer_load_dwordx4 v243, s[16:19], s53 offen offset:3072 sc1 lds
    s_add_u32 m0, s44, 4096
    s_add_u32 s44, s44, 32768
    buffer_load_dwordx4 v243, s[16:19], s49 offen offset:0 sc1 lds
    buffer_load_dwordx4 v243, s[16:19], s49 offen offset:1024 sc1 lds
    buffer_load_dwordx4 v243, s[16:19], s49 offen offset:2048 sc1 lds
    buffer_load_dwordx4 v243, s[16:19], s49 offen offset:3072 sc1 lds
    s_add_u32 s43, s43, 32768
    s_and_b32 s44, s44, 0x1ffff
    buffer_load_dword v254, v255, s[20:23], s32 offen
    s_add_u32 s32, s32, 1280
    s_add_u32 s70, s68, 442368
    buffer_load_dwordx4 v[84:87], v4, s[72:75], s70 offen
    buffer_load_dwordx4 v[88:91], v4, s[76:79], s70 offen
    s_add_u32 s70, s68, 589824
    buffer_load_dwordx4 v[92:95], v4, s[72:75], s70 offen
    buffer_load_dwordx4 v[96:99], v4, s[76:79], s70 offen
    s_add_u32 s70, s68, 737280
    buffer_load_dwordx4 v[100:103], v4, s[72:75], s70 offen
    buffer_load_dwordx4 v[104:107], v4, s[76:79], s70 offen
    s_waitcnt vmcnt(22) lgkmcnt(0)
    s_barrier
    s_sub_u32 s86, s86, 1
    s_cmp_lt_u32 s86, 2
    s_cbranch_scc1 parallel_sum__compressed_kv_cla__moe_arch_mod__prompt_kernel_trg_27
parallel_sum__compressed_kv_cla__moe_arch_mod__prompt_kernel_trg_27_back:
    s_mov_b32 m0, s44
    s_max_i32 s53, s43, 0
    s_add_u32 s49, s53, 4096
    buffer_load_dwordx4 v243, s[16:19], s53 offen offset:0 sc1 lds
    buffer_load_dwordx4 v243, s[16:19], s53 offen offset:1024 sc1 lds
    buffer_load_dwordx4 v243, s[16:19], s53 offen offset:2048 sc1 lds
    buffer_load_dwordx4 v243, s[16:19], s53 offen offset:3072 sc1 lds
    s_add_u32 m0, s44, 4096
    s_add_u32 s44, s44, 32768
    buffer_load_dwordx4 v243, s[16:19], s49 offen offset:0 sc1 lds
    buffer_load_dwordx4 v243, s[16:19], s49 offen offset:1024 sc1 lds
    buffer_load_dwordx4 v243, s[16:19], s49 offen offset:2048 sc1 lds
    buffer_load_dwordx4 v243, s[16:19], s49 offen offset:3072 sc1 lds
    s_add_u32 s43, s43, 32768
    s_and_b32 s44, s44, 0x1ffff
    buffer_load_dword v254, v255, s[20:23], s32 offen
    s_add_u32 s32, s32, 1280
    s_add_u32 s70, s68, 884736
    buffer_load_dwordx4 v[108:111], v4, s[72:75], s70 offen
    buffer_load_dwordx4 v[112:115], v4, s[76:79], s70 offen
    s_add_u32 s70, s68, 1032192
    buffer_load_dwordx4 v[116:119], v4, s[72:75], s70 offen
    buffer_load_dwordx4 v[120:123], v4, s[76:79], s70 offen
    s_add_u32 s70, s68, 1179648
    buffer_load_dwordx4 v[124:127], v4, s[72:75], s70 offen
    buffer_load_dwordx4 v[128:131], v4, s[76:79], s70 offen
    s_waitcnt vmcnt(22) lgkmcnt(0)
    s_barrier
    s_sub_u32 s86, s86, 1
    s_cmp_lt_u32 s86, 2
    s_cbranch_scc1 parallel_sum__compressed_kv_cla__moe_arch_mod__prompt_kernel_trg_28
parallel_sum__compressed_kv_cla__moe_arch_mod__prompt_kernel_trg_28_back:
    s_mov_b32 m0, s44
    s_max_i32 s53, s43, 0
    s_add_u32 s49, s53, 4096
    buffer_load_dwordx4 v243, s[16:19], s53 offen offset:0 sc1 lds
    buffer_load_dwordx4 v243, s[16:19], s53 offen offset:1024 sc1 lds
    buffer_load_dwordx4 v243, s[16:19], s53 offen offset:2048 sc1 lds
    buffer_load_dwordx4 v243, s[16:19], s53 offen offset:3072 sc1 lds
    s_add_u32 m0, s44, 4096
    s_add_u32 s44, s44, 32768
    buffer_load_dwordx4 v243, s[16:19], s49 offen offset:0 sc1 lds
    buffer_load_dwordx4 v243, s[16:19], s49 offen offset:1024 sc1 lds
    buffer_load_dwordx4 v243, s[16:19], s49 offen offset:2048 sc1 lds
    buffer_load_dwordx4 v243, s[16:19], s49 offen offset:3072 sc1 lds
    s_add_u32 s43, s43, 32768
    s_and_b32 s44, s44, 0x1ffff
    buffer_load_dword v254, v255, s[20:23], s32 offen
    s_add_u32 s32, s32, 1280
    s_add_u32 s70, s68, 64
    buffer_load_dwordx4 v[132:135], v4, s[72:75], s70 offen
    buffer_load_dwordx4 v[136:139], v4, s[76:79], s70 offen
    s_add_u32 s70, s68, 147520
    buffer_load_dwordx4 v[140:143], v4, s[72:75], s70 offen
    buffer_load_dwordx4 v[144:147], v4, s[76:79], s70 offen
    s_add_u32 s70, s68, 294976
    buffer_load_dwordx4 v[148:151], v4, s[72:75], s70 offen
    buffer_load_dwordx4 v[152:155], v4, s[76:79], s70 offen
    s_waitcnt vmcnt(22) lgkmcnt(0)
    s_barrier
    s_sub_u32 s86, s86, 1
    s_cmp_lt_u32 s86, 2
    s_cbranch_scc1 parallel_sum__compressed_kv_cla__moe_arch_mod__prompt_kernel_trg_29
parallel_sum__compressed_kv_cla__moe_arch_mod__prompt_kernel_trg_29_back:
    s_mov_b32 m0, s44
    s_max_i32 s53, s43, 0
    s_add_u32 s49, s53, 4096
    buffer_load_dwordx4 v243, s[16:19], s53 offen offset:0 sc1 lds
    buffer_load_dwordx4 v243, s[16:19], s53 offen offset:1024 sc1 lds
    buffer_load_dwordx4 v243, s[16:19], s53 offen offset:2048 sc1 lds
    buffer_load_dwordx4 v243, s[16:19], s53 offen offset:3072 sc1 lds
    s_add_u32 m0, s44, 4096
    s_add_u32 s44, s44, 32768
    buffer_load_dwordx4 v243, s[16:19], s49 offen offset:0 sc1 lds
    buffer_load_dwordx4 v243, s[16:19], s49 offen offset:1024 sc1 lds
    buffer_load_dwordx4 v243, s[16:19], s49 offen offset:2048 sc1 lds
    buffer_load_dwordx4 v243, s[16:19], s49 offen offset:3072 sc1 lds
    s_add_u32 s43, s43, 32768
    s_and_b32 s44, s44, 0x1ffff
    buffer_load_dword v254, v255, s[20:23], s32 offen
    s_add_u32 s32, s32, 1280
    s_add_u32 s70, s68, 442432
    buffer_load_dwordx4 v[156:159], v4, s[72:75], s70 offen
    buffer_load_dwordx4 v[160:163], v4, s[76:79], s70 offen
    s_add_u32 s70, s68, 589888
    buffer_load_dwordx4 v[164:167], v4, s[72:75], s70 offen
    buffer_load_dwordx4 v[168:171], v4, s[76:79], s70 offen
    s_add_u32 s70, s68, 737344
    buffer_load_dwordx4 v[172:175], v4, s[72:75], s70 offen
    buffer_load_dwordx4 v[176:179], v4, s[76:79], s70 offen
    s_waitcnt vmcnt(22) lgkmcnt(0)
    s_barrier
    s_sub_u32 s86, s86, 1
    s_cmp_lt_u32 s86, 2
    s_cbranch_scc1 parallel_sum__compressed_kv_cla__moe_arch_mod__prompt_kernel_trg_30
parallel_sum__compressed_kv_cla__moe_arch_mod__prompt_kernel_trg_30_back:
    s_mov_b32 m0, s44
    s_max_i32 s53, s43, 0
    s_add_u32 s49, s53, 4096
    buffer_load_dwordx4 v243, s[16:19], s53 offen offset:0 sc1 lds
    buffer_load_dwordx4 v243, s[16:19], s53 offen offset:1024 sc1 lds
    buffer_load_dwordx4 v243, s[16:19], s53 offen offset:2048 sc1 lds
    buffer_load_dwordx4 v243, s[16:19], s53 offen offset:3072 sc1 lds
    s_add_u32 m0, s44, 4096
    s_add_u32 s44, s44, 32768
    buffer_load_dwordx4 v243, s[16:19], s49 offen offset:0 sc1 lds
    buffer_load_dwordx4 v243, s[16:19], s49 offen offset:1024 sc1 lds
    buffer_load_dwordx4 v243, s[16:19], s49 offen offset:2048 sc1 lds
    buffer_load_dwordx4 v243, s[16:19], s49 offen offset:3072 sc1 lds
    s_add_u32 s43, s43, 32768
    s_and_b32 s44, s44, 0x1ffff
    buffer_load_dword v254, v255, s[20:23], s32 offen
    s_add_u32 s32, s32, 1280
    s_add_u32 s70, s68, 884800
    buffer_load_dwordx4 v[180:183], v4, s[72:75], s70 offen
    buffer_load_dwordx4 v[184:187], v4, s[76:79], s70 offen
    s_add_u32 s70, s68, 1032256
    buffer_load_dwordx4 v[188:191], v4, s[72:75], s70 offen
    buffer_load_dwordx4 v[192:195], v4, s[76:79], s70 offen
    s_add_u32 s70, s68, 1179712
    buffer_load_dwordx4 v[196:199], v4, s[72:75], s70 offen
    buffer_load_dwordx4 v[200:203], v4, s[76:79], s70 offen
    s_add_u32 s46, s46, 7
    s_waitcnt vmcnt(22)
    s_branch parallel_sum__compressed_kv_cla__moe_arch_mod__prompt_kernel_A_ld_in
parallel_sum__compressed_kv_cla__moe_arch_mod__prompt_kernel_A_done:
    s_sub_u32 s47, s2, 128
    s_cmp_lt_u32 s47, 48
    s_cbranch_scc1 parallel_sum__compressed_kv_cla__moe_arch_mod__prompt_kernel_p3moe
    s_cmp_ge_u32 s2, 240
    s_cbranch_scc1 parallel_sum__compressed_kv_cla__moe_arch_mod__prompt_kernel_p3end
    s_mov_b32 s35, 0x40000
parallel_sum__compressed_kv_cla__moe_arch_mod__prompt_kernel_chk_sel1:
    v_xor_b32 v241, s87, v241
    v_cmp_ne_u32 s[84:85], 0, v241
    s_nop 1
    s_cmp_eq_u64 s[84:85], 0
    s_cbranch_scc1 parallel_sum__compressed_kv_cla__moe_arch_mod__prompt_kernel_chk_sel1_ok
    s_sub_u32 s35, s35, 1
    s_cbranch_scc1 parallel_sum__compressed_kv_cla__moe_arch_mod__prompt_kernel_chk_sel1_ok
    s_sleep 1
    buffer_load_dwordx2 v[240:241], v242, s[12:15], s67 offen sc1
    s_waitcnt vmcnt(0)
    s_branch parallel_sum__compressed_kv_cla__moe_arch_mod__prompt_kernel_chk_sel1
parallel_sum__compressed_kv_cla__moe_arch_mod__prompt_kernel_chk_sel1_ok:
    v_and_b32 v241, 0xffff0000, v240
    v_and_b32 v240, 0xffff, v240
    s_load_dwordx2 s[16:17], s[0:1], 0
    s_load_dwordx2 s[20:21], s[0:1], 88
    v_lshrrev_b32 v2, 4, v243
    v_mov_b32 v148, v2
    s_and_b32 s39, s2, 3
    s_lshr_b32 s46, s2, 3
    s_sub_u32 s47, s46, 6
    s_cmp_lt_u32 s2, 128
    s_cselect_b32 s46, s46, s47
    s_mul_i32 s47, s46, 86
    s_lshr_b32 s47, s47, 8
    s_and_b32 s37, s2, 4
    s_lshl_b32 s37, s37, 1
    s_add_u32 s37, s37, s47
    s_mul_i32 s47, s47, 3
    s_sub_u32 s38, s46, s47
    v_add_u32 v3, 0, v2
    v_mul_u32_u24 v4, 0xaab, v3
    v_lshrrev_b32 v4, 16, v4
    v_mul_u32_u24 v5, 24, v4
    v_sub_u32 v5, v3, v5
    v_bfe_u32 v6, v4, 1, 1
    v_lshlrev_b32 v6, 2, v6
    v_xor_b32 v5, v5, v6
    v_mul_u32_u24 v4, 1152, v4
    v_lshl_add_u32 v4, v5, 4, v4
    v_subrev_u32 v137, 0, v4
    v_add_u32 v3, 64, v2
    v_mul_u32_u24 v4, 0xaab, v3
    v_lshrrev_b32 v4, 16, v4
    v_mul_u32_u24 v5, 24, v4
    v_sub_u32 v5, v3, v5
    v_bfe_u32 v6, v4, 1, 1
    v_lshlrev_b32 v6, 2, v6
    v_xor_b32 v5, v5, v6
    v_mul_u32_u24 v4, 1152, v4
    v_lshl_add_u32 v4, v5, 4, v4
    v_subrev_u32 v138, 1024, v4
    v_add_u32 v3, 128, v2
    v_mul_u32_u24 v4, 0xaab, v3
    v_lshrrev_b32 v4, 16, v4
    v_mul_u32_u24 v5, 24, v4
    v_sub_u32 v5, v3, v5
    v_bfe_u32 v6, v4, 1, 1
    v_lshlrev_b32 v6, 2, v6
    v_xor_b32 v5, v5, v6
    v_mul_u32_u24 v4, 1152, v4
    v_lshl_add_u32 v4, v5, 4, v4
    v_subrev_u32 v139, 2048, v4
    s_lshl_b32 s40, s37, 2
    s_add_u32 s40, s40, s36
    s_lshl_b32 s40, s40, 18
    s_lshl_b32 s45, s39, 16
    s_add_u32 s40, s40, s45
    s_add_u32 s40, s40, 0x2800000
    s_lshl_b32 s41, s39, 10
    s_lshl_b32 s45, s36, 4
    s_add_u32 s41, s41, s45
    s_mul_i32 s41, s41, 1152
    s_mul_i32 s45, s38, 384
    s_add_u32 s41, s41, s45
    s_add_u32 s42, s41, 9216
    s_lshl_b32 s43, s36, 12
    s_mul_i32 s44, s36, 6144
    s_add_u32 s44, s44, 16384
    s_mov_b32 s8, s24
    s_mov_b32 s9, s25
    s_mov_b32 s10, 0x480000
    s_mov_b32 s11, 0x20000
    v_and_b32 v150, 7, v2
    v_lshlrev_b32 v150, 6, v150
    s_lshl_b32 s48, s37, 2
    s_add_u32 s48, s48, s36
    s_lshl_b32 s48, s48, 5
    s_lshl_b32 s45, s39, 3
    s_add_u32 s48, s48, s45
    s_lshl_b32 s48, s48, 6
    s_add_u32 s48, s48, 0x788000
    v_readlane_b32 s56, v240, 0
    v_readlane_b32 s57, v240, 1
    v_readlane_b32 s58, v240, 2
    v_readlane_b32 s59, v240, 3
    v_readlane_b32 s60, v240, 4
    v_readlane_b32 s61, v240, 5
    v_readlane_b32 s62, v240, 6
    v_readlane_b32 s63, v240, 7
    s_barrier
    buffer_load_dword v149, v150, s[12:15], s48 offen sc1
    s_add_u32 m0, s44, 0
    s_nop 0
    buffer_load_dwordx4 v137, s[8:11], s41 offen offset:0 lds
    buffer_load_dwordx4 v138, s[8:11], s41 offen offset:1024 lds
    buffer_load_dwordx4 v139, s[8:11], s41 offen offset:2048 lds
    s_add_u32 s41, s41, 73728
    s_add_u32 m0, s44, 3072
    s_nop 0
    buffer_load_dwordx4 v137, s[8:11], s42 offen offset:0 lds
    buffer_load_dwordx4 v138, s[8:11], s42 offen offset:1024 lds
    buffer_load_dwordx4 v139, s[8:11], s42 offen offset:2048 lds
    s_add_u32 s42, s42, 73728
    s_add_u32 m0, s44, 40960
    s_nop 0
    buffer_load_dwordx4 v137, s[8:11], s41 offen offset:0 lds
    buffer_load_dwordx4 v138, s[8:11], s41 offen offset:1024 lds
    buffer_load_dwordx4 v139, s[8:11], s41 offen offset:2048 lds
    s_add_u32 s41, s41, 73728
    s_add_u32 m0, s44, 44032
    s_nop 0
    buffer_load_dwordx4 v137, s[8:11], s42 offen offset:0 lds
    buffer_load_dwordx4 v138, s[8:11], s42 offen offset:1024 lds
    buffer_load_dwordx4 v139, s[8:11], s42 offen offset:2048 lds
    s_add_u32 s42, s42, 73728
    s_add_u32 m0, s44, 81920
    s_nop 0
    buffer_load_dwordx4 v137, s[8:11], s41 offen offset:0 lds
    buffer_load_dwordx4 v138, s[8:11], s41 offen offset:1024 lds
    buffer_load_dwordx4 v139, s[8:11], s41 offen offset:2048 lds
    s_add_u32 s41, s41, 73728
    s_add_u32 m0, s44, 84992
    s_nop 0
    buffer_load_dwordx4 v137, s[8:11], s42 offen offset:0 lds
    buffer_load_dwordx4 v138, s[8:11], s42 offen offset:1024 lds
    buffer_load_dwordx4 v139, s[8:11], s42 offen offset:2048 lds
    s_add_u32 s42, s42, 73728
    s_add_u32 m0, s44, 122880
    s_nop 0
    buffer_load_dwordx4 v137, s[8:11], s41 offen offset:0 lds
    buffer_load_dwordx4 v138, s[8:11], s41 offen offset:1024 lds
    buffer_load_dwordx4 v139, s[8:11], s41 offen offset:2048 lds
    s_add_u32 s41, s41, 73728
    s_add_u32 m0, s44, 125952
    s_nop 0
    buffer_load_dwordx4 v137, s[8:11], s42 offen offset:0 lds
    buffer_load_dwordx4 v138, s[8:11], s42 offen offset:1024 lds
    buffer_load_dwordx4 v139, s[8:11], s42 offen offset:2048 lds
    s_add_u32 s42, s42, 73728
    s_and_b32 s45, s36, 1
    s_lshl_b32 s45, s45, 13
    v_add_u32 v140, s45, v243
    v_add_u32 v141, 81920, v140
    v_bfe_u32 v4, v2, 2, 2
    v_lshrrev_b32 v5, 5, v2
    v_lshl_add_u32 v5, v5, 2, v4
    v_mul_u32_u24 v5, 384, v5
    v_bfe_u32 v6, v2, 4, 1
    v_lshl_add_u32 v5, v6, 5, v5
    v_and_b32 v6, 3, v2
    v_lshl_add_u32 v5, v6, 3, v5
    v_add_u32 v5, 16384, v5
    v_lshrrev_b32 v4, 1, v4
    s_lshr_b32 s45, s36, 1
    s_mul_i32 s45, s45, 3
    s_add_u32 s46, s45, 0
    v_xor_b32 v6, s46, v4
    v_lshl_add_u32 v142, v6, 6, v5
    v_add_u32 v145, 81920, v142
    s_add_u32 s46, s45, 1
    v_xor_b32 v6, s46, v4
    v_lshl_add_u32 v143, v6, 6, v5
    v_add_u32 v146, 81920, v143
    s_add_u32 s46, s45, 2
    v_xor_b32 v6, s46, v4
    v_lshl_add_u32 v144, v6, 6, v5
    v_add_u32 v147, 81920, v144
    s_waitcnt vmcnt(24) lgkmcnt(0)
    s_mov_b32 s35, 0x40000
parallel_sum__compressed_kv_cla__moe_arch_mod__prompt_kernel_chk_ctx:
    v_xor_b32 v149, s87, v149
    v_cmp_ne_u32 s[84:85], 0, v149
    s_nop 1
    s_cmp_eq_u64 s[84:85], 0
    s_cbranch_scc1 parallel_sum__compressed_kv_cla__moe_arch_mod__prompt_kernel_chk_ctx_ok
    s_sub_u32 s35, s35, 1
    s_cbranch_scc1 parallel_sum__compressed_kv_cla__moe_arch_mod__prompt_kernel_chk_ctx_ok
    s_sleep 1
    buffer_load_dword v149, v150, s[12:15], s48 offen sc1
    s_waitcnt vmcnt(0)
    s_branch parallel_sum__compressed_kv_cla__moe_arch_mod__prompt_kernel_chk_ctx
parallel_sum__compressed_kv_cla__moe_arch_mod__prompt_kernel_chk_ctx_ok:
    s_add_u32 m0, s43, 0
    s_nop 0
    buffer_load_dwordx4 v243, s[12:15], s40 offen offset:0 sc1 lds
    buffer_load_dwordx4 v243, s[12:15], s40 offen offset:1024 sc1 lds
    buffer_load_dwordx4 v243, s[12:15], s40 offen offset:2048 sc1 lds
    buffer_load_dwordx4 v243, s[12:15], s40 offen offset:3072 sc1 lds
    s_add_u32 s40, s40, 4096
    s_add_u32 m0, s43, 40960
    s_nop 0
    buffer_load_dwordx4 v243, s[12:15], s40 offen offset:0 sc1 lds
    buffer_load_dwordx4 v243, s[12:15], s40 offen offset:1024 sc1 lds
    buffer_load_dwordx4 v243, s[12:15], s40 offen offset:2048 sc1 lds
    buffer_load_dwordx4 v243, s[12:15], s40 offen offset:3072 sc1 lds
    s_add_u32 s40, s40, 4096
    s_add_u32 m0, s43, 81920
    s_nop 0
    buffer_load_dwordx4 v243, s[12:15], s40 offen offset:0 sc1 lds
    buffer_load_dwordx4 v243, s[12:15], s40 offen offset:1024 sc1 lds
    buffer_load_dwordx4 v243, s[12:15], s40 offen offset:2048 sc1 lds
    buffer_load_dwordx4 v243, s[12:15], s40 offen offset:3072 sc1 lds
    s_add_u32 s40, s40, 4096
    s_waitcnt vmcnt(8)
    s_barrier
    ds_read_b64_tr_b16 v[104:105], v142 offset:0
    ds_read_b64_tr_b16 v[106:107], v142 offset:3072
    ds_read_b128 v[96:99], v140 offset:0
    ds_read_b128 v[100:103], v140 offset:4096
    ds_read_b64_tr_b16 v[108:109], v143 offset:0
    ds_read_b64_tr_b16 v[110:111], v143 offset:3072
    ds_read_b64_tr_b16 v[112:113], v144 offset:0
    ds_read_b64_tr_b16 v[114:115], v144 offset:3072
    ds_read_b64_tr_b16 v[124:125], v142 offset:6144
    ds_read_b64_tr_b16 v[126:127], v142 offset:9216
    ds_read_b128 v[116:119], v140 offset:1024
    ds_read_b128 v[120:123], v140 offset:5120
    ds_read_b64_tr_b16 v[128:129], v143 offset:6144
    ds_read_b64_tr_b16 v[130:131], v143 offset:9216
    ds_read_b64_tr_b16 v[132:133], v144 offset:6144
    ds_read_b64_tr_b16 v[134:135], v144 offset:9216
    s_waitcnt lgkmcnt(8)
    v_mfma_f32_32x32x16_bf16 v[0:15], v[104:107], v[96:99], 0
    ds_read_b64_tr_b16 v[160:161], v142 offset:12288
    ds_read_b64_tr_b16 v[162:163], v142 offset:15360
    s_add_u32 m0, s43, 122880
    s_nop 0
    buffer_load_dwordx4 v243, s[12:15], s40 offen offset:0 sc1 lds
    v_mfma_f32_32x32x16_bf16 v[16:31], v[104:107], v[100:103], 0
    ds_read_b128 v[152:155], v140 offset:2048
    ds_read_b128 v[156:159], v140 offset:6144
    buffer_load_dwordx4 v243, s[12:15], s40 offen offset:1024 sc1 lds
    v_mfma_f32_32x32x16_bf16 v[32:47], v[108:111], v[96:99], 0
    ds_read_b64_tr_b16 v[164:165], v143 offset:12288
    ds_read_b64_tr_b16 v[166:167], v143 offset:15360
    buffer_load_dwordx4 v243, s[12:15], s40 offen offset:2048 sc1 lds
    v_mfma_f32_32x32x16_bf16 v[48:63], v[108:111], v[100:103], 0
    ds_read_b64_tr_b16 v[168:169], v144 offset:12288
    ds_read_b64_tr_b16 v[170:171], v144 offset:15360
    buffer_load_dwordx4 v243, s[12:15], s40 offen offset:3072 sc1 lds
    s_add_u32 s40, s40, 4096
    v_mfma_f32_32x32x16_bf16 v[64:79], v[112:115], v[96:99], 0
    v_mfma_f32_32x32x16_bf16 v[80:95], v[112:115], v[100:103], 0
    s_waitcnt lgkmcnt(8)
    v_mfma_f32_32x32x16_bf16 v[0:15], v[124:127], v[116:119], v[0:15]
    ds_read_b64_tr_b16 v[104:105], v142 offset:18432
    ds_read_b64_tr_b16 v[106:107], v142 offset:21504
    v_mfma_f32_32x32x16_bf16 v[16:31], v[124:127], v[120:123], v[16:31]
    ds_read_b128 v[96:99], v140 offset:3072
    ds_read_b128 v[100:103], v140 offset:7168
    v_mfma_f32_32x32x16_bf16 v[32:47], v[128:131], v[116:119], v[32:47]
    ds_read_b64_tr_b16 v[108:109], v143 offset:18432
    ds_read_b64_tr_b16 v[110:111], v143 offset:21504
    v_mfma_f32_32x32x16_bf16 v[48:63], v[128:131], v[120:123], v[48:63]
    ds_read_b64_tr_b16 v[112:113], v144 offset:18432
    ds_read_b64_tr_b16 v[114:115], v144 offset:21504
    v_mfma_f32_32x32x16_bf16 v[64:79], v[132:135], v[116:119], v[64:79]
    v_mfma_f32_32x32x16_bf16 v[80:95], v[132:135], v[120:123], v[80:95]
    s_waitcnt lgkmcnt(8)
    v_mfma_f32_32x32x16_bf16 v[0:15], v[160:163], v[152:155], v[0:15]
    s_waitcnt vmcnt(8) lgkmcnt(0)
    s_barrier
    ds_read_b64_tr_b16 v[124:125], v142 offset:40960
    ds_read_b64_tr_b16 v[126:127], v142 offset:44032
    s_add_u32 m0, s43, 0
    s_nop 0
    buffer_load_dwordx4 v243, s[12:15], s40 offen offset:0 sc1 lds
    v_mfma_f32_32x32x16_bf16 v[16:31], v[160:163], v[156:159], v[16:31]
    ds_read_b128 v[116:119], v140 offset:40960
    ds_read_b128 v[120:123], v140 offset:45056
    buffer_load_dwordx4 v243, s[12:15], s40 offen offset:1024 sc1 lds
    v_mfma_f32_32x32x16_bf16 v[32:47], v[164:167], v[152:155], v[32:47]
    ds_read_b64_tr_b16 v[128:129], v143 offset:40960
    ds_read_b64_tr_b16 v[130:131], v143 offset:44032
    buffer_load_dwordx4 v243, s[12:15], s40 offen offset:2048 sc1 lds
    v_mfma_f32_32x32x16_bf16 v[48:63], v[164:167], v[156:159], v[48:63]
    ds_read_b64_tr_b16 v[132:133], v144 offset:40960
    ds_read_b64_tr_b16 v[134:135], v144 offset:44032
    buffer_load_dwordx4 v243, s[12:15], s40 offen offset:3072 sc1 lds
    s_add_u32 s40, s40, 4096
    v_mfma_f32_32x32x16_bf16 v[64:79], v[168:171], v[152:155], v[64:79]
    s_add_u32 m0, s44, 0
    s_nop 0
    buffer_load_dwordx4 v137, s[8:11], s41 offen offset:0 lds
    v_mfma_f32_32x32x16_bf16 v[80:95], v[168:171], v[156:159], v[80:95]
    buffer_load_dwordx4 v138, s[8:11], s41 offen offset:1024 lds
    s_waitcnt lgkmcnt(8)
    v_mfma_f32_32x32x16_bf16 v[0:15], v[104:107], v[96:99], v[0:15]
    ds_read_b64_tr_b16 v[160:161], v142 offset:47104
    ds_read_b64_tr_b16 v[162:163], v142 offset:50176
    buffer_load_dwordx4 v139, s[8:11], s41 offen offset:2048 lds
    s_add_u32 s41, s41, 73728
    v_mfma_f32_32x32x16_bf16 v[16:31], v[104:107], v[100:103], v[16:31]
    ds_read_b128 v[152:155], v140 offset:41984
    ds_read_b128 v[156:159], v140 offset:46080
    s_add_u32 m0, s44, 3072
    s_nop 0
    buffer_load_dwordx4 v137, s[8:11], s42 offen offset:0 lds
    v_mfma_f32_32x32x16_bf16 v[32:47], v[108:111], v[96:99], v[32:47]
    ds_read_b64_tr_b16 v[164:165], v143 offset:47104
    ds_read_b64_tr_b16 v[166:167], v143 offset:50176
    buffer_load_dwordx4 v138, s[8:11], s42 offen offset:1024 lds
    v_mfma_f32_32x32x16_bf16 v[48:63], v[108:111], v[100:103], v[48:63]
    ds_read_b64_tr_b16 v[168:169], v144 offset:47104
    ds_read_b64_tr_b16 v[170:171], v144 offset:50176
    buffer_load_dwordx4 v139, s[8:11], s42 offen offset:2048 lds
    s_add_u32 s42, s42, 73728
    v_mfma_f32_32x32x16_bf16 v[64:79], v[112:115], v[96:99], v[64:79]
    v_mfma_f32_32x32x16_bf16 v[80:95], v[112:115], v[100:103], v[80:95]
    s_waitcnt lgkmcnt(8)
    v_mfma_f32_32x32x16_bf16 v[0:15], v[124:127], v[116:119], v[0:15]
    ds_read_b64_tr_b16 v[104:105], v142 offset:53248
    ds_read_b64_tr_b16 v[106:107], v142 offset:56320
    v_mfma_f32_32x32x16_bf16 v[16:31], v[124:127], v[120:123], v[16:31]
    ds_read_b128 v[96:99], v140 offset:43008
    ds_read_b128 v[100:103], v140 offset:47104
    v_mfma_f32_32x32x16_bf16 v[32:47], v[128:131], v[116:119], v[32:47]
    ds_read_b64_tr_b16 v[108:109], v143 offset:53248
    ds_read_b64_tr_b16 v[110:111], v143 offset:56320
    v_mfma_f32_32x32x16_bf16 v[48:63], v[128:131], v[120:123], v[48:63]
    ds_read_b64_tr_b16 v[112:113], v144 offset:53248
    ds_read_b64_tr_b16 v[114:115], v144 offset:56320
    v_mfma_f32_32x32x16_bf16 v[64:79], v[132:135], v[116:119], v[64:79]
    v_mfma_f32_32x32x16_bf16 v[80:95], v[132:135], v[120:123], v[80:95]
    s_waitcnt lgkmcnt(8)
    v_mfma_f32_32x32x16_bf16 v[0:15], v[160:163], v[152:155], v[0:15]
    ds_read_b64_tr_b16 v[124:125], v142 offset:59392
    ds_read_b64_tr_b16 v[126:127], v142 offset:62464
    v_mfma_f32_32x32x16_bf16 v[16:31], v[160:163], v[156:159], v[16:31]
    ds_read_b128 v[116:119], v140 offset:44032
    ds_read_b128 v[120:123], v140 offset:48128
    v_mfma_f32_32x32x16_bf16 v[32:47], v[164:167], v[152:155], v[32:47]
    ds_read_b64_tr_b16 v[128:129], v143 offset:59392
    ds_read_b64_tr_b16 v[130:131], v143 offset:62464
    v_mfma_f32_32x32x16_bf16 v[48:63], v[164:167], v[156:159], v[48:63]
    ds_read_b64_tr_b16 v[132:133], v144 offset:59392
    ds_read_b64_tr_b16 v[134:135], v144 offset:62464
    v_mfma_f32_32x32x16_bf16 v[64:79], v[168:171], v[152:155], v[64:79]
    v_mfma_f32_32x32x16_bf16 v[80:95], v[168:171], v[156:159], v[80:95]
    s_waitcnt lgkmcnt(8)
    v_mfma_f32_32x32x16_bf16 v[0:15], v[104:107], v[96:99], v[0:15]
    s_waitcnt vmcnt(14) lgkmcnt(0)
    s_barrier
    ds_read_b64_tr_b16 v[160:161], v145 offset:0
    ds_read_b64_tr_b16 v[162:163], v145 offset:3072
    v_mfma_f32_32x32x16_bf16 v[16:31], v[104:107], v[100:103], v[16:31]
    ds_read_b128 v[152:155], v141 offset:0
    ds_read_b128 v[156:159], v141 offset:4096
    s_add_u32 m0, s43, 40960
    s_nop 0
    buffer_load_dwordx4 v243, s[12:15], s40 offen offset:0 sc1 lds
    v_mfma_f32_32x32x16_bf16 v[32:47], v[108:111], v[96:99], v[32:47]
    ds_read_b64_tr_b16 v[164:165], v146 offset:0
    ds_read_b64_tr_b16 v[166:167], v146 offset:3072
    v_mfma_f32_32x32x16_bf16 v[48:63], v[108:111], v[100:103], v[48:63]
    ds_read_b64_tr_b16 v[168:169], v147 offset:0
    ds_read_b64_tr_b16 v[170:171], v147 offset:3072
    v_mfma_f32_32x32x16_bf16 v[64:79], v[112:115], v[96:99], v[64:79]
    buffer_load_dwordx4 v243, s[12:15], s40 offen offset:1024 sc1 lds
    v_mfma_f32_32x32x16_bf16 v[80:95], v[112:115], v[100:103], v[80:95]
    buffer_load_dwordx4 v243, s[12:15], s40 offen offset:2048 sc1 lds
    s_waitcnt lgkmcnt(8)
    v_mfma_f32_32x32x16_bf16 v[0:15], v[124:127], v[116:119], v[0:15]
    ds_read_b64_tr_b16 v[104:105], v145 offset:6144
    ds_read_b64_tr_b16 v[106:107], v145 offset:9216
    v_mfma_f32_32x32x16_bf16 v[16:31], v[124:127], v[120:123], v[16:31]
    ds_read_b128 v[96:99], v141 offset:1024
    ds_read_b128 v[100:103], v141 offset:5120
    buffer_load_dwordx4 v243, s[12:15], s40 offen offset:3072 sc1 lds
    s_add_u32 s40, s40, 4096
    v_mfma_f32_32x32x16_bf16 v[32:47], v[128:131], v[116:119], v[32:47]
    ds_read_b64_tr_b16 v[108:109], v146 offset:6144
    ds_read_b64_tr_b16 v[110:111], v146 offset:9216
    v_mfma_f32_32x32x16_bf16 v[48:63], v[128:131], v[120:123], v[48:63]
    ds_read_b64_tr_b16 v[112:113], v147 offset:6144
    ds_read_b64_tr_b16 v[114:115], v147 offset:9216
    v_mfma_f32_32x32x16_bf16 v[64:79], v[132:135], v[116:119], v[64:79]
    s_add_u32 m0, s44, 40960
    s_nop 0
    buffer_load_dwordx4 v137, s[8:11], s41 offen offset:0 lds
    v_mfma_f32_32x32x16_bf16 v[80:95], v[132:135], v[120:123], v[80:95]
    buffer_load_dwordx4 v138, s[8:11], s41 offen offset:1024 lds
    s_waitcnt lgkmcnt(8)
    v_mfma_f32_32x32x16_bf16 v[0:15], v[160:163], v[152:155], v[0:15]
    ds_read_b64_tr_b16 v[124:125], v145 offset:12288
    ds_read_b64_tr_b16 v[126:127], v145 offset:15360
    v_mfma_f32_32x32x16_bf16 v[16:31], v[160:163], v[156:159], v[16:31]
    ds_read_b128 v[116:119], v141 offset:2048
    ds_read_b128 v[120:123], v141 offset:6144
    buffer_load_dwordx4 v139, s[8:11], s41 offen offset:2048 lds
    s_add_u32 s41, s41, 73728
    v_mfma_f32_32x32x16_bf16 v[32:47], v[164:167], v[152:155], v[32:47]
    ds_read_b64_tr_b16 v[128:129], v146 offset:12288
    ds_read_b64_tr_b16 v[130:131], v146 offset:15360
    v_mfma_f32_32x32x16_bf16 v[48:63], v[164:167], v[156:159], v[48:63]
    ds_read_b64_tr_b16 v[132:133], v147 offset:12288
    ds_read_b64_tr_b16 v[134:135], v147 offset:15360
    v_mfma_f32_32x32x16_bf16 v[64:79], v[168:171], v[152:155], v[64:79]
    s_add_u32 m0, s44, 44032
    s_nop 0
    buffer_load_dwordx4 v137, s[8:11], s42 offen offset:0 lds
    v_mfma_f32_32x32x16_bf16 v[80:95], v[168:171], v[156:159], v[80:95]
    buffer_load_dwordx4 v138, s[8:11], s42 offen offset:1024 lds
    s_waitcnt lgkmcnt(8)
    v_mfma_f32_32x32x16_bf16 v[0:15], v[104:107], v[96:99], v[0:15]
    ds_read_b64_tr_b16 v[160:161], v145 offset:18432
    ds_read_b64_tr_b16 v[162:163], v145 offset:21504
    v_mfma_f32_32x32x16_bf16 v[16:31], v[104:107], v[100:103], v[16:31]
    ds_read_b128 v[152:155], v141 offset:3072
    ds_read_b128 v[156:159], v141 offset:7168
    buffer_load_dwordx4 v139, s[8:11], s42 offen offset:2048 lds
    s_add_u32 s42, s42, 73728
    v_mfma_f32_32x32x16_bf16 v[32:47], v[108:111], v[96:99], v[32:47]
    ds_read_b64_tr_b16 v[164:165], v146 offset:18432
    ds_read_b64_tr_b16 v[166:167], v146 offset:21504
    v_mfma_f32_32x32x16_bf16 v[48:63], v[108:111], v[100:103], v[48:63]
    ds_read_b64_tr_b16 v[168:169], v147 offset:18432
    ds_read_b64_tr_b16 v[170:171], v147 offset:21504
    v_mfma_f32_32x32x16_bf16 v[64:79], v[112:115], v[96:99], v[64:79]
    v_mfma_f32_32x32x16_bf16 v[80:95], v[112:115], v[100:103], v[80:95]
    s_waitcnt lgkmcnt(8)
    v_mfma_f32_32x32x16_bf16 v[0:15], v[124:127], v[116:119], v[0:15]
    s_waitcnt vmcnt(20) lgkmcnt(0)
    s_barrier
    ds_read_b64_tr_b16 v[104:105], v145 offset:40960
    ds_read_b64_tr_b16 v[106:107], v145 offset:44032
    v_mfma_f32_32x32x16_bf16 v[16:31], v[124:127], v[120:123], v[16:31]
    ds_read_b128 v[96:99], v141 offset:40960
    ds_read_b128 v[100:103], v141 offset:45056
    s_add_u32 m0, s43, 81920
    s_nop 0
    buffer_load_dwordx4 v243, s[12:15], s40 offen offset:0 sc1 lds
    v_mfma_f32_32x32x16_bf16 v[32:47], v[128:131], v[116:119], v[32:47]
    ds_read_b64_tr_b16 v[108:109], v146 offset:40960
    ds_read_b64_tr_b16 v[110:111], v146 offset:44032
    v_mfma_f32_32x32x16_bf16 v[48:63], v[128:131], v[120:123], v[48:63]
    ds_read_b64_tr_b16 v[112:113], v147 offset:40960
    ds_read_b64_tr_b16 v[114:115], v147 offset:44032
    v_mfma_f32_32x32x16_bf16 v[64:79], v[132:135], v[116:119], v[64:79]
    buffer_load_dwordx4 v243, s[12:15], s40 offen offset:1024 sc1 lds
    v_mfma_f32_32x32x16_bf16 v[80:95], v[132:135], v[120:123], v[80:95]
    buffer_load_dwordx4 v243, s[12:15], s40 offen offset:2048 sc1 lds
    s_waitcnt lgkmcnt(8)
    v_mfma_f32_32x32x16_bf16 v[0:15], v[160:163], v[152:155], v[0:15]
    ds_read_b64_tr_b16 v[124:125], v145 offset:47104
    ds_read_b64_tr_b16 v[126:127], v145 offset:50176
    v_mfma_f32_32x32x16_bf16 v[16:31], v[160:163], v[156:159], v[16:31]
    ds_read_b128 v[116:119], v141 offset:41984
    ds_read_b128 v[120:123], v141 offset:46080
    buffer_load_dwordx4 v243, s[12:15], s40 offen offset:3072 sc1 lds
    s_add_u32 s40, s40, 4096
    v_mfma_f32_32x32x16_bf16 v[32:47], v[164:167], v[152:155], v[32:47]
    ds_read_b64_tr_b16 v[128:129], v146 offset:47104
    ds_read_b64_tr_b16 v[130:131], v146 offset:50176
    v_mfma_f32_32x32x16_bf16 v[48:63], v[164:167], v[156:159], v[48:63]
    ds_read_b64_tr_b16 v[132:133], v147 offset:47104
    ds_read_b64_tr_b16 v[134:135], v147 offset:50176
    v_mfma_f32_32x32x16_bf16 v[64:79], v[168:171], v[152:155], v[64:79]
    s_add_u32 m0, s44, 81920
    s_nop 0
    buffer_load_dwordx4 v137, s[8:11], s41 offen offset:0 lds
    v_mfma_f32_32x32x16_bf16 v[80:95], v[168:171], v[156:159], v[80:95]
    buffer_load_dwordx4 v138, s[8:11], s41 offen offset:1024 lds
    s_waitcnt lgkmcnt(8)
    v_mfma_f32_32x32x16_bf16 v[0:15], v[104:107], v[96:99], v[0:15]
    ds_read_b64_tr_b16 v[160:161], v145 offset:53248
    ds_read_b64_tr_b16 v[162:163], v145 offset:56320
    v_mfma_f32_32x32x16_bf16 v[16:31], v[104:107], v[100:103], v[16:31]
    ds_read_b128 v[152:155], v141 offset:43008
    ds_read_b128 v[156:159], v141 offset:47104
    buffer_load_dwordx4 v139, s[8:11], s41 offen offset:2048 lds
    s_add_u32 s41, s41, 73728
    v_mfma_f32_32x32x16_bf16 v[32:47], v[108:111], v[96:99], v[32:47]
    ds_read_b64_tr_b16 v[164:165], v146 offset:53248
    ds_read_b64_tr_b16 v[166:167], v146 offset:56320
    v_mfma_f32_32x32x16_bf16 v[48:63], v[108:111], v[100:103], v[48:63]
    ds_read_b64_tr_b16 v[168:169], v147 offset:53248
    ds_read_b64_tr_b16 v[170:171], v147 offset:56320
    v_mfma_f32_32x32x16_bf16 v[64:79], v[112:115], v[96:99], v[64:79]
    s_add_u32 m0, s44, 84992
    s_nop 0
    buffer_load_dwordx4 v137, s[8:11], s42 offen offset:0 lds
    v_mfma_f32_32x32x16_bf16 v[80:95], v[112:115], v[100:103], v[80:95]
    buffer_load_dwordx4 v138, s[8:11], s42 offen offset:1024 lds
    s_waitcnt lgkmcnt(8)
    v_mfma_f32_32x32x16_bf16 v[0:15], v[124:127], v[116:119], v[0:15]
    ds_read_b64_tr_b16 v[104:105], v145 offset:59392
    ds_read_b64_tr_b16 v[106:107], v145 offset:62464
    v_mfma_f32_32x32x16_bf16 v[16:31], v[124:127], v[120:123], v[16:31]
    ds_read_b128 v[96:99], v141 offset:44032
    ds_read_b128 v[100:103], v141 offset:48128
    buffer_load_dwordx4 v139, s[8:11], s42 offen offset:2048 lds
    s_add_u32 s42, s42, 73728
    v_mfma_f32_32x32x16_bf16 v[32:47], v[128:131], v[116:119], v[32:47]
    ds_read_b64_tr_b16 v[108:109], v146 offset:59392
    ds_read_b64_tr_b16 v[110:111], v146 offset:62464
    v_mfma_f32_32x32x16_bf16 v[48:63], v[128:131], v[120:123], v[48:63]
    ds_read_b64_tr_b16 v[112:113], v147 offset:59392
    ds_read_b64_tr_b16 v[114:115], v147 offset:62464
    v_mfma_f32_32x32x16_bf16 v[64:79], v[132:135], v[116:119], v[64:79]
    v_mfma_f32_32x32x16_bf16 v[80:95], v[132:135], v[120:123], v[80:95]
    s_waitcnt lgkmcnt(8)
    v_mfma_f32_32x32x16_bf16 v[0:15], v[160:163], v[152:155], v[0:15]
    s_waitcnt vmcnt(20) lgkmcnt(0)
    s_barrier
    ds_read_b64_tr_b16 v[124:125], v142 offset:0
    ds_read_b64_tr_b16 v[126:127], v142 offset:3072
    v_mfma_f32_32x32x16_bf16 v[16:31], v[160:163], v[156:159], v[16:31]
    ds_read_b128 v[116:119], v140 offset:0
    ds_read_b128 v[120:123], v140 offset:4096
    s_add_u32 m0, s43, 122880
    s_nop 0
    buffer_load_dwordx4 v243, s[12:15], s40 offen offset:0 sc1 lds
    v_mfma_f32_32x32x16_bf16 v[32:47], v[164:167], v[152:155], v[32:47]
    ds_read_b64_tr_b16 v[128:129], v143 offset:0
    ds_read_b64_tr_b16 v[130:131], v143 offset:3072
    v_mfma_f32_32x32x16_bf16 v[48:63], v[164:167], v[156:159], v[48:63]
    ds_read_b64_tr_b16 v[132:133], v144 offset:0
    ds_read_b64_tr_b16 v[134:135], v144 offset:3072
    v_mfma_f32_32x32x16_bf16 v[64:79], v[168:171], v[152:155], v[64:79]
    buffer_load_dwordx4 v243, s[12:15], s40 offen offset:1024 sc1 lds
    v_mfma_f32_32x32x16_bf16 v[80:95], v[168:171], v[156:159], v[80:95]
    buffer_load_dwordx4 v243, s[12:15], s40 offen offset:2048 sc1 lds
    s_waitcnt lgkmcnt(8)
    v_mfma_f32_32x32x16_bf16 v[0:15], v[104:107], v[96:99], v[0:15]
    ds_read_b64_tr_b16 v[160:161], v142 offset:6144
    ds_read_b64_tr_b16 v[162:163], v142 offset:9216
    v_mfma_f32_32x32x16_bf16 v[16:31], v[104:107], v[100:103], v[16:31]
    ds_read_b128 v[152:155], v140 offset:1024
    ds_read_b128 v[156:159], v140 offset:5120
    buffer_load_dwordx4 v243, s[12:15], s40 offen offset:3072 sc1 lds
    s_add_u32 s40, s40, 4096
    v_mfma_f32_32x32x16_bf16 v[32:47], v[108:111], v[96:99], v[32:47]
    ds_read_b64_tr_b16 v[164:165], v143 offset:6144
    ds_read_b64_tr_b16 v[166:167], v143 offset:9216
    v_mfma_f32_32x32x16_bf16 v[48:63], v[108:111], v[100:103], v[48:63]
    ds_read_b64_tr_b16 v[168:169], v144 offset:6144
    ds_read_b64_tr_b16 v[170:171], v144 offset:9216
    v_mfma_f32_32x32x16_bf16 v[64:79], v[112:115], v[96:99], v[64:79]
    s_add_u32 m0, s44, 122880
    s_nop 0
    buffer_load_dwordx4 v137, s[8:11], s41 offen offset:0 lds
    v_mfma_f32_32x32x16_bf16 v[80:95], v[112:115], v[100:103], v[80:95]
    buffer_load_dwordx4 v138, s[8:11], s41 offen offset:1024 lds
    s_waitcnt lgkmcnt(8)
    v_mfma_f32_32x32x16_bf16 v[0:15], v[124:127], v[116:119], v[0:15]
    ds_read_b64_tr_b16 v[104:105], v142 offset:12288
    ds_read_b64_tr_b16 v[106:107], v142 offset:15360
    v_mfma_f32_32x32x16_bf16 v[16:31], v[124:127], v[120:123], v[16:31]
    ds_read_b128 v[96:99], v140 offset:2048
    ds_read_b128 v[100:103], v140 offset:6144
    buffer_load_dwordx4 v139, s[8:11], s41 offen offset:2048 lds
    s_add_u32 s41, s41, 73728
    v_mfma_f32_32x32x16_bf16 v[32:47], v[128:131], v[116:119], v[32:47]
    ds_read_b64_tr_b16 v[108:109], v143 offset:12288
    ds_read_b64_tr_b16 v[110:111], v143 offset:15360
    v_mfma_f32_32x32x16_bf16 v[48:63], v[128:131], v[120:123], v[48:63]
    ds_read_b64_tr_b16 v[112:113], v144 offset:12288
    ds_read_b64_tr_b16 v[114:115], v144 offset:15360
    v_mfma_f32_32x32x16_bf16 v[64:79], v[132:135], v[116:119], v[64:79]
    s_add_u32 m0, s44, 125952
    s_nop 0
    buffer_load_dwordx4 v137, s[8:11], s42 offen offset:0 lds
    v_mfma_f32_32x32x16_bf16 v[80:95], v[132:135], v[120:123], v[80:95]
    buffer_load_dwordx4 v138, s[8:11], s42 offen offset:1024 lds
    s_waitcnt lgkmcnt(8)
    v_mfma_f32_32x32x16_bf16 v[0:15], v[160:163], v[152:155], v[0:15]
    ds_read_b64_tr_b16 v[124:125], v142 offset:18432
    ds_read_b64_tr_b16 v[126:127], v142 offset:21504
    v_mfma_f32_32x32x16_bf16 v[16:31], v[160:163], v[156:159], v[16:31]
    ds_read_b128 v[116:119], v140 offset:3072
    ds_read_b128 v[120:123], v140 offset:7168
    buffer_load_dwordx4 v139, s[8:11], s42 offen offset:2048 lds
    s_add_u32 s42, s42, 73728
    v_mfma_f32_32x32x16_bf16 v[32:47], v[164:167], v[152:155], v[32:47]
    ds_read_b64_tr_b16 v[128:129], v143 offset:18432
    ds_read_b64_tr_b16 v[130:131], v143 offset:21504
    v_mfma_f32_32x32x16_bf16 v[48:63], v[164:167], v[156:159], v[48:63]
    ds_read_b64_tr_b16 v[132:133], v144 offset:18432
    ds_read_b64_tr_b16 v[134:135], v144 offset:21504
    v_mfma_f32_32x32x16_bf16 v[64:79], v[168:171], v[152:155], v[64:79]
    v_mfma_f32_32x32x16_bf16 v[80:95], v[168:171], v[156:159], v[80:95]
    s_waitcnt lgkmcnt(8)
    v_mfma_f32_32x32x16_bf16 v[0:15], v[104:107], v[96:99], v[0:15]
    s_waitcnt vmcnt(20) lgkmcnt(0)
    s_barrier
    ds_read_b64_tr_b16 v[160:161], v142 offset:40960
    ds_read_b64_tr_b16 v[162:163], v142 offset:44032
    v_mfma_f32_32x32x16_bf16 v[16:31], v[104:107], v[100:103], v[16:31]
    ds_read_b128 v[152:155], v140 offset:40960
    ds_read_b128 v[156:159], v140 offset:45056
    s_add_u32 m0, s43, 0
    s_nop 0
    buffer_load_dwordx4 v243, s[12:15], s40 offen offset:0 sc1 lds
    v_mfma_f32_32x32x16_bf16 v[32:47], v[108:111], v[96:99], v[32:47]
    ds_read_b64_tr_b16 v[164:165], v143 offset:40960
    ds_read_b64_tr_b16 v[166:167], v143 offset:44032
    v_mfma_f32_32x32x16_bf16 v[48:63], v[108:111], v[100:103], v[48:63]
    ds_read_b64_tr_b16 v[168:169], v144 offset:40960
    ds_read_b64_tr_b16 v[170:171], v144 offset:44032
    v_mfma_f32_32x32x16_bf16 v[64:79], v[112:115], v[96:99], v[64:79]
    buffer_load_dwordx4 v243, s[12:15], s40 offen offset:1024 sc1 lds
    v_mfma_f32_32x32x16_bf16 v[80:95], v[112:115], v[100:103], v[80:95]
    buffer_load_dwordx4 v243, s[12:15], s40 offen offset:2048 sc1 lds
    s_waitcnt lgkmcnt(8)
    v_mfma_f32_32x32x16_bf16 v[0:15], v[124:127], v[116:119], v[0:15]
    ds_read_b64_tr_b16 v[104:105], v142 offset:47104
    ds_read_b64_tr_b16 v[106:107], v142 offset:50176
    v_mfma_f32_32x32x16_bf16 v[16:31], v[124:127], v[120:123], v[16:31]
    ds_read_b128 v[96:99], v140 offset:41984
    ds_read_b128 v[100:103], v140 offset:46080
    buffer_load_dwordx4 v243, s[12:15], s40 offen offset:3072 sc1 lds
    s_add_u32 s40, s40, 4096
    v_mfma_f32_32x32x16_bf16 v[32:47], v[128:131], v[116:119], v[32:47]
    ds_read_b64_tr_b16 v[108:109], v143 offset:47104
    ds_read_b64_tr_b16 v[110:111], v143 offset:50176
    v_mfma_f32_32x32x16_bf16 v[48:63], v[128:131], v[120:123], v[48:63]
    ds_read_b64_tr_b16 v[112:113], v144 offset:47104
    ds_read_b64_tr_b16 v[114:115], v144 offset:50176
    v_mfma_f32_32x32x16_bf16 v[64:79], v[132:135], v[116:119], v[64:79]
    s_add_u32 m0, s44, 0
    s_nop 0
    buffer_load_dwordx4 v137, s[8:11], s41 offen offset:0 lds
    v_mfma_f32_32x32x16_bf16 v[80:95], v[132:135], v[120:123], v[80:95]
    buffer_load_dwordx4 v138, s[8:11], s41 offen offset:1024 lds
    s_waitcnt lgkmcnt(8)
    v_mfma_f32_32x32x16_bf16 v[0:15], v[160:163], v[152:155], v[0:15]
    ds_read_b64_tr_b16 v[124:125], v142 offset:53248
    ds_read_b64_tr_b16 v[126:127], v142 offset:56320
    v_mfma_f32_32x32x16_bf16 v[16:31], v[160:163], v[156:159], v[16:31]
    ds_read_b128 v[116:119], v140 offset:43008
    ds_read_b128 v[120:123], v140 offset:47104
    buffer_load_dwordx4 v139, s[8:11], s41 offen offset:2048 lds
    s_add_u32 s41, s41, 73728
    v_mfma_f32_32x32x16_bf16 v[32:47], v[164:167], v[152:155], v[32:47]
    ds_read_b64_tr_b16 v[128:129], v143 offset:53248
    ds_read_b64_tr_b16 v[130:131], v143 offset:56320
    v_mfma_f32_32x32x16_bf16 v[48:63], v[164:167], v[156:159], v[48:63]
    ds_read_b64_tr_b16 v[132:133], v144 offset:53248
    ds_read_b64_tr_b16 v[134:135], v144 offset:56320
    v_mfma_f32_32x32x16_bf16 v[64:79], v[168:171], v[152:155], v[64:79]
    s_add_u32 m0, s44, 3072
    s_nop 0
    buffer_load_dwordx4 v137, s[8:11], s42 offen offset:0 lds
    v_mfma_f32_32x32x16_bf16 v[80:95], v[168:171], v[156:159], v[80:95]
    buffer_load_dwordx4 v138, s[8:11], s42 offen offset:1024 lds
    s_waitcnt lgkmcnt(8)
    v_mfma_f32_32x32x16_bf16 v[0:15], v[104:107], v[96:99], v[0:15]
    ds_read_b64_tr_b16 v[160:161], v142 offset:59392
    ds_read_b64_tr_b16 v[162:163], v142 offset:62464
    v_mfma_f32_32x32x16_bf16 v[16:31], v[104:107], v[100:103], v[16:31]
    ds_read_b128 v[152:155], v140 offset:44032
    ds_read_b128 v[156:159], v140 offset:48128
    buffer_load_dwordx4 v139, s[8:11], s42 offen offset:2048 lds
    s_add_u32 s42, s42, 73728
    v_mfma_f32_32x32x16_bf16 v[32:47], v[108:111], v[96:99], v[32:47]
    ds_read_b64_tr_b16 v[164:165], v143 offset:59392
    ds_read_b64_tr_b16 v[166:167], v143 offset:62464
    v_mfma_f32_32x32x16_bf16 v[48:63], v[108:111], v[100:103], v[48:63]
    ds_read_b64_tr_b16 v[168:169], v144 offset:59392
    ds_read_b64_tr_b16 v[170:171], v144 offset:62464
    v_mfma_f32_32x32x16_bf16 v[64:79], v[112:115], v[96:99], v[64:79]
    v_mfma_f32_32x32x16_bf16 v[80:95], v[112:115], v[100:103], v[80:95]
    s_waitcnt lgkmcnt(8)
    v_mfma_f32_32x32x16_bf16 v[0:15], v[124:127], v[116:119], v[0:15]
    s_waitcnt vmcnt(20) lgkmcnt(0)
    s_barrier
    ds_read_b64_tr_b16 v[104:105], v145 offset:0
    ds_read_b64_tr_b16 v[106:107], v145 offset:3072
    v_mfma_f32_32x32x16_bf16 v[16:31], v[124:127], v[120:123], v[16:31]
    ds_read_b128 v[96:99], v141 offset:0
    ds_read_b128 v[100:103], v141 offset:4096
    s_add_u32 m0, s43, 40960
    s_nop 0
    buffer_load_dwordx4 v243, s[12:15], s40 offen offset:0 sc1 lds
    v_mfma_f32_32x32x16_bf16 v[32:47], v[128:131], v[116:119], v[32:47]
    ds_read_b64_tr_b16 v[108:109], v146 offset:0
    ds_read_b64_tr_b16 v[110:111], v146 offset:3072
    v_mfma_f32_32x32x16_bf16 v[48:63], v[128:131], v[120:123], v[48:63]
    ds_read_b64_tr_b16 v[112:113], v147 offset:0
    ds_read_b64_tr_b16 v[114:115], v147 offset:3072
    v_mfma_f32_32x32x16_bf16 v[64:79], v[132:135], v[116:119], v[64:79]
    buffer_load_dwordx4 v243, s[12:15], s40 offen offset:1024 sc1 lds
    v_mfma_f32_32x32x16_bf16 v[80:95], v[132:135], v[120:123], v[80:95]
    buffer_load_dwordx4 v243, s[12:15], s40 offen offset:2048 sc1 lds
    s_waitcnt lgkmcnt(8)
    v_mfma_f32_32x32x16_bf16 v[0:15], v[160:163], v[152:155], v[0:15]
    ds_read_b64_tr_b16 v[124:125], v145 offset:6144
    ds_read_b64_tr_b16 v[126:127], v145 offset:9216
    v_mfma_f32_32x32x16_bf16 v[16:31], v[160:163], v[156:159], v[16:31]
    ds_read_b128 v[116:119], v141 offset:1024
    ds_read_b128 v[120:123], v141 offset:5120
    buffer_load_dwordx4 v243, s[12:15], s40 offen offset:3072 sc1 lds
    s_add_u32 s40, s40, 4096
    v_mfma_f32_32x32x16_bf16 v[32:47], v[164:167], v[152:155], v[32:47]
    ds_read_b64_tr_b16 v[128:129], v146 offset:6144
    ds_read_b64_tr_b16 v[130:131], v146 offset:9216
    v_mfma_f32_32x32x16_bf16 v[48:63], v[164:167], v[156:159], v[48:63]
    ds_read_b64_tr_b16 v[132:133], v147 offset:6144
    ds_read_b64_tr_b16 v[134:135], v147 offset:9216
    v_mfma_f32_32x32x16_bf16 v[64:79], v[168:171], v[152:155], v[64:79]
    s_add_u32 m0, s44, 40960
    s_nop 0
    buffer_load_dwordx4 v137, s[8:11], s41 offen offset:0 lds
    v_mfma_f32_32x32x16_bf16 v[80:95], v[168:171], v[156:159], v[80:95]
    buffer_load_dwordx4 v138, s[8:11], s41 offen offset:1024 lds
    s_waitcnt lgkmcnt(8)
    v_mfma_f32_32x32x16_bf16 v[0:15], v[104:107], v[96:99], v[0:15]
    ds_read_b64_tr_b16 v[160:161], v145 offset:12288
    ds_read_b64_tr_b16 v[162:163], v145 offset:15360
    v_mfma_f32_32x32x16_bf16 v[16:31], v[104:107], v[100:103], v[16:31]
    ds_read_b128 v[152:155], v141 offset:2048
    ds_read_b128 v[156:159], v141 offset:6144
    buffer_load_dwordx4 v139, s[8:11], s41 offen offset:2048 lds
    s_add_u32 s41, s41, 73728
    v_mfma_f32_32x32x16_bf16 v[32:47], v[108:111], v[96:99], v[32:47]
    ds_read_b64_tr_b16 v[164:165], v146 offset:12288
    ds_read_b64_tr_b16 v[166:167], v146 offset:15360
    v_mfma_f32_32x32x16_bf16 v[48:63], v[108:111], v[100:103], v[48:63]
    ds_read_b64_tr_b16 v[168:169], v147 offset:12288
    ds_read_b64_tr_b16 v[170:171], v147 offset:15360
    v_mfma_f32_32x32x16_bf16 v[64:79], v[112:115], v[96:99], v[64:79]
    s_add_u32 m0, s44, 44032
    s_nop 0
    buffer_load_dwordx4 v137, s[8:11], s42 offen offset:0 lds
    v_mfma_f32_32x32x16_bf16 v[80:95], v[112:115], v[100:103], v[80:95]
    buffer_load_dwordx4 v138, s[8:11], s42 offen offset:1024 lds
    s_waitcnt lgkmcnt(8)
    v_mfma_f32_32x32x16_bf16 v[0:15], v[124:127], v[116:119], v[0:15]
    ds_read_b64_tr_b16 v[104:105], v145 offset:18432
    ds_read_b64_tr_b16 v[106:107], v145 offset:21504
    v_mfma_f32_32x32x16_bf16 v[16:31], v[124:127], v[120:123], v[16:31]
    ds_read_b128 v[96:99], v141 offset:3072
    ds_read_b128 v[100:103], v141 offset:7168
    buffer_load_dwordx4 v139, s[8:11], s42 offen offset:2048 lds
    s_add_u32 s42, s42, 73728
    v_mfma_f32_32x32x16_bf16 v[32:47], v[128:131], v[116:119], v[32:47]
    ds_read_b64_tr_b16 v[108:109], v146 offset:18432
    ds_read_b64_tr_b16 v[110:111], v146 offset:21504
    v_mfma_f32_32x32x16_bf16 v[48:63], v[128:131], v[120:123], v[48:63]
    ds_read_b64_tr_b16 v[112:113], v147 offset:18432
    ds_read_b64_tr_b16 v[114:115], v147 offset:21504
    v_mfma_f32_32x32x16_bf16 v[64:79], v[132:135], v[116:119], v[64:79]
    v_mfma_f32_32x32x16_bf16 v[80:95], v[132:135], v[120:123], v[80:95]
    s_waitcnt lgkmcnt(8)
    v_mfma_f32_32x32x16_bf16 v[0:15], v[160:163], v[152:155], v[0:15]
    s_waitcnt vmcnt(20) lgkmcnt(0)
    s_barrier
    ds_read_b64_tr_b16 v[124:125], v145 offset:40960
    ds_read_b64_tr_b16 v[126:127], v145 offset:44032
    v_mfma_f32_32x32x16_bf16 v[16:31], v[160:163], v[156:159], v[16:31]
    ds_read_b128 v[116:119], v141 offset:40960
    ds_read_b128 v[120:123], v141 offset:45056
    s_add_u32 m0, s43, 81920
    s_nop 0
    buffer_load_dwordx4 v243, s[12:15], s40 offen offset:0 sc1 lds
    v_mfma_f32_32x32x16_bf16 v[32:47], v[164:167], v[152:155], v[32:47]
    ds_read_b64_tr_b16 v[128:129], v146 offset:40960
    ds_read_b64_tr_b16 v[130:131], v146 offset:44032
    v_mfma_f32_32x32x16_bf16 v[48:63], v[164:167], v[156:159], v[48:63]
    ds_read_b64_tr_b16 v[132:133], v147 offset:40960
    ds_read_b64_tr_b16 v[134:135], v147 offset:44032
    v_mfma_f32_32x32x16_bf16 v[64:79], v[168:171], v[152:155], v[64:79]
    buffer_load_dwordx4 v243, s[12:15], s40 offen offset:1024 sc1 lds
    v_mfma_f32_32x32x16_bf16 v[80:95], v[168:171], v[156:159], v[80:95]
    buffer_load_dwordx4 v243, s[12:15], s40 offen offset:2048 sc1 lds
    s_waitcnt lgkmcnt(8)
    v_mfma_f32_32x32x16_bf16 v[0:15], v[104:107], v[96:99], v[0:15]
    ds_read_b64_tr_b16 v[160:161], v145 offset:47104
    ds_read_b64_tr_b16 v[162:163], v145 offset:50176
    v_mfma_f32_32x32x16_bf16 v[16:31], v[104:107], v[100:103], v[16:31]
    ds_read_b128 v[152:155], v141 offset:41984
    ds_read_b128 v[156:159], v141 offset:46080
    buffer_load_dwordx4 v243, s[12:15], s40 offen offset:3072 sc1 lds
    s_add_u32 s40, s40, 4096
    v_mfma_f32_32x32x16_bf16 v[32:47], v[108:111], v[96:99], v[32:47]
    ds_read_b64_tr_b16 v[164:165], v146 offset:47104
    ds_read_b64_tr_b16 v[166:167], v146 offset:50176
    v_mfma_f32_32x32x16_bf16 v[48:63], v[108:111], v[100:103], v[48:63]
    ds_read_b64_tr_b16 v[168:169], v147 offset:47104
    ds_read_b64_tr_b16 v[170:171], v147 offset:50176
    v_mfma_f32_32x32x16_bf16 v[64:79], v[112:115], v[96:99], v[64:79]
    s_add_u32 m0, s44, 81920
    s_nop 0
    buffer_load_dwordx4 v137, s[8:11], s41 offen offset:0 lds
    v_mfma_f32_32x32x16_bf16 v[80:95], v[112:115], v[100:103], v[80:95]
    buffer_load_dwordx4 v138, s[8:11], s41 offen offset:1024 lds
    s_waitcnt lgkmcnt(8)
    v_mfma_f32_32x32x16_bf16 v[0:15], v[124:127], v[116:119], v[0:15]
    ds_read_b64_tr_b16 v[104:105], v145 offset:53248
    ds_read_b64_tr_b16 v[106:107], v145 offset:56320
    v_mfma_f32_32x32x16_bf16 v[16:31], v[124:127], v[120:123], v[16:31]
    ds_read_b128 v[96:99], v141 offset:43008
    ds_read_b128 v[100:103], v141 offset:47104
    buffer_load_dwordx4 v139, s[8:11], s41 offen offset:2048 lds
    s_add_u32 s41, s41, 73728
    v_mfma_f32_32x32x16_bf16 v[32:47], v[128:131], v[116:119], v[32:47]
    ds_read_b64_tr_b16 v[108:109], v146 offset:53248
    ds_read_b64_tr_b16 v[110:111], v146 offset:56320
    v_mfma_f32_32x32x16_bf16 v[48:63], v[128:131], v[120:123], v[48:63]
    ds_read_b64_tr_b16 v[112:113], v147 offset:53248
    ds_read_b64_tr_b16 v[114:115], v147 offset:56320
    v_mfma_f32_32x32x16_bf16 v[64:79], v[132:135], v[116:119], v[64:79]
    s_add_u32 m0, s44, 84992
    s_nop 0
    buffer_load_dwordx4 v137, s[8:11], s42 offen offset:0 lds
    v_mfma_f32_32x32x16_bf16 v[80:95], v[132:135], v[120:123], v[80:95]
    buffer_load_dwordx4 v138, s[8:11], s42 offen offset:1024 lds
    s_waitcnt lgkmcnt(8)
    v_mfma_f32_32x32x16_bf16 v[0:15], v[160:163], v[152:155], v[0:15]
    ds_read_b64_tr_b16 v[124:125], v145 offset:59392
    ds_read_b64_tr_b16 v[126:127], v145 offset:62464
    v_mfma_f32_32x32x16_bf16 v[16:31], v[160:163], v[156:159], v[16:31]
    ds_read_b128 v[116:119], v141 offset:44032
    ds_read_b128 v[120:123], v141 offset:48128
    buffer_load_dwordx4 v139, s[8:11], s42 offen offset:2048 lds
    s_add_u32 s42, s42, 73728
    v_mfma_f32_32x32x16_bf16 v[32:47], v[164:167], v[152:155], v[32:47]
    ds_read_b64_tr_b16 v[128:129], v146 offset:59392
    ds_read_b64_tr_b16 v[130:131], v146 offset:62464
    v_mfma_f32_32x32x16_bf16 v[48:63], v[164:167], v[156:159], v[48:63]
    ds_read_b64_tr_b16 v[132:133], v147 offset:59392
    ds_read_b64_tr_b16 v[134:135], v147 offset:62464
    v_mfma_f32_32x32x16_bf16 v[64:79], v[168:171], v[152:155], v[64:79]
    v_mfma_f32_32x32x16_bf16 v[80:95], v[168:171], v[156:159], v[80:95]
    s_waitcnt lgkmcnt(8)
    v_mfma_f32_32x32x16_bf16 v[0:15], v[104:107], v[96:99], v[0:15]
    s_waitcnt vmcnt(20) lgkmcnt(0)
    s_barrier
    ds_read_b64_tr_b16 v[160:161], v142 offset:0
    ds_read_b64_tr_b16 v[162:163], v142 offset:3072
    v_mfma_f32_32x32x16_bf16 v[16:31], v[104:107], v[100:103], v[16:31]
    ds_read_b128 v[152:155], v140 offset:0
    ds_read_b128 v[156:159], v140 offset:4096
    s_add_u32 m0, s43, 122880
    s_nop 0
    buffer_load_dwordx4 v243, s[12:15], s40 offen offset:0 sc1 lds
    v_mfma_f32_32x32x16_bf16 v[32:47], v[108:111], v[96:99], v[32:47]
    ds_read_b64_tr_b16 v[164:165], v143 offset:0
    ds_read_b64_tr_b16 v[166:167], v143 offset:3072
    v_mfma_f32_32x32x16_bf16 v[48:63], v[108:111], v[100:103], v[48:63]
    ds_read_b64_tr_b16 v[168:169], v144 offset:0
    ds_read_b64_tr_b16 v[170:171], v144 offset:3072
    v_mfma_f32_32x32x16_bf16 v[64:79], v[112:115], v[96:99], v[64:79]
    buffer_load_dwordx4 v243, s[12:15], s40 offen offset:1024 sc1 lds
    v_mfma_f32_32x32x16_bf16 v[80:95], v[112:115], v[100:103], v[80:95]
    buffer_load_dwordx4 v243, s[12:15], s40 offen offset:2048 sc1 lds
    s_waitcnt lgkmcnt(8)
    v_mfma_f32_32x32x16_bf16 v[0:15], v[124:127], v[116:119], v[0:15]
    ds_read_b64_tr_b16 v[104:105], v142 offset:6144
    ds_read_b64_tr_b16 v[106:107], v142 offset:9216
    v_mfma_f32_32x32x16_bf16 v[16:31], v[124:127], v[120:123], v[16:31]
    ds_read_b128 v[96:99], v140 offset:1024
    ds_read_b128 v[100:103], v140 offset:5120
    buffer_load_dwordx4 v243, s[12:15], s40 offen offset:3072 sc1 lds
    s_add_u32 s40, s40, 4096
    v_mfma_f32_32x32x16_bf16 v[32:47], v[128:131], v[116:119], v[32:47]
    ds_read_b64_tr_b16 v[108:109], v143 offset:6144
    ds_read_b64_tr_b16 v[110:111], v143 offset:9216
    v_mfma_f32_32x32x16_bf16 v[48:63], v[128:131], v[120:123], v[48:63]
    ds_read_b64_tr_b16 v[112:113], v144 offset:6144
    ds_read_b64_tr_b16 v[114:115], v144 offset:9216
    v_mfma_f32_32x32x16_bf16 v[64:79], v[132:135], v[116:119], v[64:79]
    s_add_u32 m0, s44, 122880
    s_nop 0
    buffer_load_dwordx4 v137, s[8:11], s41 offen offset:0 lds
    v_mfma_f32_32x32x16_bf16 v[80:95], v[132:135], v[120:123], v[80:95]
    buffer_load_dwordx4 v138, s[8:11], s41 offen offset:1024 lds
    s_waitcnt lgkmcnt(8)
    v_mfma_f32_32x32x16_bf16 v[0:15], v[160:163], v[152:155], v[0:15]
    ds_read_b64_tr_b16 v[124:125], v142 offset:12288
    ds_read_b64_tr_b16 v[126:127], v142 offset:15360
    v_mfma_f32_32x32x16_bf16 v[16:31], v[160:163], v[156:159], v[16:31]
    ds_read_b128 v[116:119], v140 offset:2048
    ds_read_b128 v[120:123], v140 offset:6144
    buffer_load_dwordx4 v139, s[8:11], s41 offen offset:2048 lds
    s_add_u32 s41, s41, 73728
    v_mfma_f32_32x32x16_bf16 v[32:47], v[164:167], v[152:155], v[32:47]
    ds_read_b64_tr_b16 v[128:129], v143 offset:12288
    ds_read_b64_tr_b16 v[130:131], v143 offset:15360
    v_mfma_f32_32x32x16_bf16 v[48:63], v[164:167], v[156:159], v[48:63]
    ds_read_b64_tr_b16 v[132:133], v144 offset:12288
    ds_read_b64_tr_b16 v[134:135], v144 offset:15360
    v_mfma_f32_32x32x16_bf16 v[64:79], v[168:171], v[152:155], v[64:79]
    s_add_u32 m0, s44, 125952
    s_nop 0
    buffer_load_dwordx4 v137, s[8:11], s42 offen offset:0 lds
    v_mfma_f32_32x32x16_bf16 v[80:95], v[168:171], v[156:159], v[80:95]
    buffer_load_dwordx4 v138, s[8:11], s42 offen offset:1024 lds
    s_waitcnt lgkmcnt(8)
    v_mfma_f32_32x32x16_bf16 v[0:15], v[104:107], v[96:99], v[0:15]
    ds_read_b64_tr_b16 v[160:161], v142 offset:18432
    ds_read_b64_tr_b16 v[162:163], v142 offset:21504
    v_mfma_f32_32x32x16_bf16 v[16:31], v[104:107], v[100:103], v[16:31]
    ds_read_b128 v[152:155], v140 offset:3072
    ds_read_b128 v[156:159], v140 offset:7168
    buffer_load_dwordx4 v139, s[8:11], s42 offen offset:2048 lds
    s_add_u32 s42, s42, 73728
    v_mfma_f32_32x32x16_bf16 v[32:47], v[108:111], v[96:99], v[32:47]
    ds_read_b64_tr_b16 v[164:165], v143 offset:18432
    ds_read_b64_tr_b16 v[166:167], v143 offset:21504
    v_mfma_f32_32x32x16_bf16 v[48:63], v[108:111], v[100:103], v[48:63]
    ds_read_b64_tr_b16 v[168:169], v144 offset:18432
    ds_read_b64_tr_b16 v[170:171], v144 offset:21504
    v_mfma_f32_32x32x16_bf16 v[64:79], v[112:115], v[96:99], v[64:79]
    v_mfma_f32_32x32x16_bf16 v[80:95], v[112:115], v[100:103], v[80:95]
    s_waitcnt lgkmcnt(8)
    v_mfma_f32_32x32x16_bf16 v[0:15], v[124:127], v[116:119], v[0:15]
    s_waitcnt vmcnt(20) lgkmcnt(0)
    s_barrier
    ds_read_b64_tr_b16 v[104:105], v142 offset:40960
    ds_read_b64_tr_b16 v[106:107], v142 offset:44032
    v_mfma_f32_32x32x16_bf16 v[16:31], v[124:127], v[120:123], v[16:31]
    ds_read_b128 v[96:99], v140 offset:40960
    ds_read_b128 v[100:103], v140 offset:45056
    s_add_u32 m0, s43, 0
    s_nop 0
    buffer_load_dwordx4 v243, s[12:15], s40 offen offset:0 sc1 lds
    v_mfma_f32_32x32x16_bf16 v[32:47], v[128:131], v[116:119], v[32:47]
    ds_read_b64_tr_b16 v[108:109], v143 offset:40960
    ds_read_b64_tr_b16 v[110:111], v143 offset:44032
    v_mfma_f32_32x32x16_bf16 v[48:63], v[128:131], v[120:123], v[48:63]
    ds_read_b64_tr_b16 v[112:113], v144 offset:40960
    ds_read_b64_tr_b16 v[114:115], v144 offset:44032
    v_mfma_f32_32x32x16_bf16 v[64:79], v[132:135], v[116:119], v[64:79]
    buffer_load_dwordx4 v243, s[12:15], s40 offen offset:1024 sc1 lds
    v_mfma_f32_32x32x16_bf16 v[80:95], v[132:135], v[120:123], v[80:95]
    buffer_load_dwordx4 v243, s[12:15], s40 offen offset:2048 sc1 lds
    s_waitcnt lgkmcnt(8)
    v_mfma_f32_32x32x16_bf16 v[0:15], v[160:163], v[152:155], v[0:15]
    ds_read_b64_tr_b16 v[124:125], v142 offset:47104
    ds_read_b64_tr_b16 v[126:127], v142 offset:50176
    v_mfma_f32_32x32x16_bf16 v[16:31], v[160:163], v[156:159], v[16:31]
    ds_read_b128 v[116:119], v140 offset:41984
    ds_read_b128 v[120:123], v140 offset:46080
    buffer_load_dwordx4 v243, s[12:15], s40 offen offset:3072 sc1 lds
    s_add_u32 s40, s40, 4096
    v_mfma_f32_32x32x16_bf16 v[32:47], v[164:167], v[152:155], v[32:47]
    ds_read_b64_tr_b16 v[128:129], v143 offset:47104
    ds_read_b64_tr_b16 v[130:131], v143 offset:50176
    v_mfma_f32_32x32x16_bf16 v[48:63], v[164:167], v[156:159], v[48:63]
    ds_read_b64_tr_b16 v[132:133], v144 offset:47104
    ds_read_b64_tr_b16 v[134:135], v144 offset:50176
    v_mfma_f32_32x32x16_bf16 v[64:79], v[168:171], v[152:155], v[64:79]
    s_add_u32 m0, s44, 0
    s_nop 0
    buffer_load_dwordx4 v137, s[8:11], s41 offen offset:0 lds
    v_mfma_f32_32x32x16_bf16 v[80:95], v[168:171], v[156:159], v[80:95]
    buffer_load_dwordx4 v138, s[8:11], s41 offen offset:1024 lds
    s_waitcnt lgkmcnt(8)
    v_mfma_f32_32x32x16_bf16 v[0:15], v[104:107], v[96:99], v[0:15]
    ds_read_b64_tr_b16 v[160:161], v142 offset:53248
    ds_read_b64_tr_b16 v[162:163], v142 offset:56320
    v_mfma_f32_32x32x16_bf16 v[16:31], v[104:107], v[100:103], v[16:31]
    ds_read_b128 v[152:155], v140 offset:43008
    ds_read_b128 v[156:159], v140 offset:47104
    buffer_load_dwordx4 v139, s[8:11], s41 offen offset:2048 lds
    s_add_u32 s41, s41, 73728
    v_mfma_f32_32x32x16_bf16 v[32:47], v[108:111], v[96:99], v[32:47]
    ds_read_b64_tr_b16 v[164:165], v143 offset:53248
    ds_read_b64_tr_b16 v[166:167], v143 offset:56320
    v_mfma_f32_32x32x16_bf16 v[48:63], v[108:111], v[100:103], v[48:63]
    ds_read_b64_tr_b16 v[168:169], v144 offset:53248
    ds_read_b64_tr_b16 v[170:171], v144 offset:56320
    v_mfma_f32_32x32x16_bf16 v[64:79], v[112:115], v[96:99], v[64:79]
    s_add_u32 m0, s44, 3072
    s_nop 0
    buffer_load_dwordx4 v137, s[8:11], s42 offen offset:0 lds
    v_mfma_f32_32x32x16_bf16 v[80:95], v[112:115], v[100:103], v[80:95]
    buffer_load_dwordx4 v138, s[8:11], s42 offen offset:1024 lds
    s_waitcnt lgkmcnt(8)
    v_mfma_f32_32x32x16_bf16 v[0:15], v[124:127], v[116:119], v[0:15]
    ds_read_b64_tr_b16 v[104:105], v142 offset:59392
    ds_read_b64_tr_b16 v[106:107], v142 offset:62464
    v_mfma_f32_32x32x16_bf16 v[16:31], v[124:127], v[120:123], v[16:31]
    ds_read_b128 v[96:99], v140 offset:44032
    ds_read_b128 v[100:103], v140 offset:48128
    buffer_load_dwordx4 v139, s[8:11], s42 offen offset:2048 lds
    s_add_u32 s42, s42, 73728
    v_mfma_f32_32x32x16_bf16 v[32:47], v[128:131], v[116:119], v[32:47]
    ds_read_b64_tr_b16 v[108:109], v143 offset:59392
    ds_read_b64_tr_b16 v[110:111], v143 offset:62464
    v_mfma_f32_32x32x16_bf16 v[48:63], v[128:131], v[120:123], v[48:63]
    ds_read_b64_tr_b16 v[112:113], v144 offset:59392
    ds_read_b64_tr_b16 v[114:115], v144 offset:62464
    v_mfma_f32_32x32x16_bf16 v[64:79], v[132:135], v[116:119], v[64:79]
    v_mfma_f32_32x32x16_bf16 v[80:95], v[132:135], v[120:123], v[80:95]
    s_waitcnt lgkmcnt(8)
    v_mfma_f32_32x32x16_bf16 v[0:15], v[160:163], v[152:155], v[0:15]
    s_waitcnt vmcnt(20) lgkmcnt(0)
    s_barrier
    ds_read_b64_tr_b16 v[124:125], v145 offset:0
    ds_read_b64_tr_b16 v[126:127], v145 offset:3072
    v_mfma_f32_32x32x16_bf16 v[16:31], v[160:163], v[156:159], v[16:31]
    ds_read_b128 v[116:119], v141 offset:0
    ds_read_b128 v[120:123], v141 offset:4096
    s_add_u32 m0, s43, 40960
    s_nop 0
    buffer_load_dwordx4 v243, s[12:15], s40 offen offset:0 sc1 lds
    v_mfma_f32_32x32x16_bf16 v[32:47], v[164:167], v[152:155], v[32:47]
    ds_read_b64_tr_b16 v[128:129], v146 offset:0
    ds_read_b64_tr_b16 v[130:131], v146 offset:3072
    v_mfma_f32_32x32x16_bf16 v[48:63], v[164:167], v[156:159], v[48:63]
    ds_read_b64_tr_b16 v[132:133], v147 offset:0
    ds_read_b64_tr_b16 v[134:135], v147 offset:3072
    v_mfma_f32_32x32x16_bf16 v[64:79], v[168:171], v[152:155], v[64:79]
    buffer_load_dwordx4 v243, s[12:15], s40 offen offset:1024 sc1 lds
    v_mfma_f32_32x32x16_bf16 v[80:95], v[168:171], v[156:159], v[80:95]
    buffer_load_dwordx4 v243, s[12:15], s40 offen offset:2048 sc1 lds
    s_waitcnt lgkmcnt(8)
    v_mfma_f32_32x32x16_bf16 v[0:15], v[104:107], v[96:99], v[0:15]
    ds_read_b64_tr_b16 v[160:161], v145 offset:6144
    ds_read_b64_tr_b16 v[162:163], v145 offset:9216
    v_mfma_f32_32x32x16_bf16 v[16:31], v[104:107], v[100:103], v[16:31]
    ds_read_b128 v[152:155], v141 offset:1024
    ds_read_b128 v[156:159], v141 offset:5120
    buffer_load_dwordx4 v243, s[12:15], s40 offen offset:3072 sc1 lds
    s_add_u32 s40, s40, 4096
    v_mfma_f32_32x32x16_bf16 v[32:47], v[108:111], v[96:99], v[32:47]
    ds_read_b64_tr_b16 v[164:165], v146 offset:6144
    ds_read_b64_tr_b16 v[166:167], v146 offset:9216
    v_mfma_f32_32x32x16_bf16 v[48:63], v[108:111], v[100:103], v[48:63]
    ds_read_b64_tr_b16 v[168:169], v147 offset:6144
    ds_read_b64_tr_b16 v[170:171], v147 offset:9216
    v_mfma_f32_32x32x16_bf16 v[64:79], v[112:115], v[96:99], v[64:79]
    s_add_u32 m0, s44, 40960
    s_nop 0
    buffer_load_dwordx4 v137, s[8:11], s41 offen offset:0 lds
    v_mfma_f32_32x32x16_bf16 v[80:95], v[112:115], v[100:103], v[80:95]
    buffer_load_dwordx4 v138, s[8:11], s41 offen offset:1024 lds
    s_waitcnt lgkmcnt(8)
    v_mfma_f32_32x32x16_bf16 v[0:15], v[124:127], v[116:119], v[0:15]
    ds_read_b64_tr_b16 v[104:105], v145 offset:12288
    ds_read_b64_tr_b16 v[106:107], v145 offset:15360
    v_mfma_f32_32x32x16_bf16 v[16:31], v[124:127], v[120:123], v[16:31]
    ds_read_b128 v[96:99], v141 offset:2048
    ds_read_b128 v[100:103], v141 offset:6144
    buffer_load_dwordx4 v139, s[8:11], s41 offen offset:2048 lds
    s_add_u32 s41, s41, 73728
    v_mfma_f32_32x32x16_bf16 v[32:47], v[128:131], v[116:119], v[32:47]
    ds_read_b64_tr_b16 v[108:109], v146 offset:12288
    ds_read_b64_tr_b16 v[110:111], v146 offset:15360
    v_mfma_f32_32x32x16_bf16 v[48:63], v[128:131], v[120:123], v[48:63]
    ds_read_b64_tr_b16 v[112:113], v147 offset:12288
    ds_read_b64_tr_b16 v[114:115], v147 offset:15360
    v_mfma_f32_32x32x16_bf16 v[64:79], v[132:135], v[116:119], v[64:79]
    s_add_u32 m0, s44, 44032
    s_nop 0
    buffer_load_dwordx4 v137, s[8:11], s42 offen offset:0 lds
    v_mfma_f32_32x32x16_bf16 v[80:95], v[132:135], v[120:123], v[80:95]
    buffer_load_dwordx4 v138, s[8:11], s42 offen offset:1024 lds
    s_waitcnt lgkmcnt(8)
    v_mfma_f32_32x32x16_bf16 v[0:15], v[160:163], v[152:155], v[0:15]
    ds_read_b64_tr_b16 v[124:125], v145 offset:18432
    ds_read_b64_tr_b16 v[126:127], v145 offset:21504
    v_mfma_f32_32x32x16_bf16 v[16:31], v[160:163], v[156:159], v[16:31]
    ds_read_b128 v[116:119], v141 offset:3072
    ds_read_b128 v[120:123], v141 offset:7168
    buffer_load_dwordx4 v139, s[8:11], s42 offen offset:2048 lds
    s_add_u32 s42, s42, 73728
    v_mfma_f32_32x32x16_bf16 v[32:47], v[164:167], v[152:155], v[32:47]
    ds_read_b64_tr_b16 v[128:129], v146 offset:18432
    ds_read_b64_tr_b16 v[130:131], v146 offset:21504
    v_mfma_f32_32x32x16_bf16 v[48:63], v[164:167], v[156:159], v[48:63]
    ds_read_b64_tr_b16 v[132:133], v147 offset:18432
    ds_read_b64_tr_b16 v[134:135], v147 offset:21504
    v_mfma_f32_32x32x16_bf16 v[64:79], v[168:171], v[152:155], v[64:79]
    v_mfma_f32_32x32x16_bf16 v[80:95], v[168:171], v[156:159], v[80:95]
    s_waitcnt lgkmcnt(8)
    v_mfma_f32_32x32x16_bf16 v[0:15], v[104:107], v[96:99], v[0:15]
    s_waitcnt vmcnt(20) lgkmcnt(0)
    s_barrier
    ds_read_b64_tr_b16 v[160:161], v145 offset:40960
    ds_read_b64_tr_b16 v[162:163], v145 offset:44032
    v_mfma_f32_32x32x16_bf16 v[16:31], v[104:107], v[100:103], v[16:31]
    ds_read_b128 v[152:155], v141 offset:40960
    ds_read_b128 v[156:159], v141 offset:45056
    s_add_u32 m0, s43, 81920
    s_nop 0
    buffer_load_dwordx4 v243, s[12:15], s40 offen offset:0 sc1 lds
    v_mfma_f32_32x32x16_bf16 v[32:47], v[108:111], v[96:99], v[32:47]
    ds_read_b64_tr_b16 v[164:165], v146 offset:40960
    ds_read_b64_tr_b16 v[166:167], v146 offset:44032
    v_mfma_f32_32x32x16_bf16 v[48:63], v[108:111], v[100:103], v[48:63]
    ds_read_b64_tr_b16 v[168:169], v147 offset:40960
    ds_read_b64_tr_b16 v[170:171], v147 offset:44032
    v_mfma_f32_32x32x16_bf16 v[64:79], v[112:115], v[96:99], v[64:79]
    buffer_load_dwordx4 v243, s[12:15], s40 offen offset:1024 sc1 lds
    v_mfma_f32_32x32x16_bf16 v[80:95], v[112:115], v[100:103], v[80:95]
    buffer_load_dwordx4 v243, s[12:15], s40 offen offset:2048 sc1 lds
    s_waitcnt lgkmcnt(8)
    v_mfma_f32_32x32x16_bf16 v[0:15], v[124:127], v[116:119], v[0:15]
    ds_read_b64_tr_b16 v[104:105], v145 offset:47104
    ds_read_b64_tr_b16 v[106:107], v145 offset:50176
    v_mfma_f32_32x32x16_bf16 v[16:31], v[124:127], v[120:123], v[16:31]
    ds_read_b128 v[96:99], v141 offset:41984
    ds_read_b128 v[100:103], v141 offset:46080
    buffer_load_dwordx4 v243, s[12:15], s40 offen offset:3072 sc1 lds
    s_add_u32 s40, s40, 4096
    v_mfma_f32_32x32x16_bf16 v[32:47], v[128:131], v[116:119], v[32:47]
    ds_read_b64_tr_b16 v[108:109], v146 offset:47104
    ds_read_b64_tr_b16 v[110:111], v146 offset:50176
    v_mfma_f32_32x32x16_bf16 v[48:63], v[128:131], v[120:123], v[48:63]
    ds_read_b64_tr_b16 v[112:113], v147 offset:47104
    ds_read_b64_tr_b16 v[114:115], v147 offset:50176
    v_mfma_f32_32x32x16_bf16 v[64:79], v[132:135], v[116:119], v[64:79]
    s_add_u32 m0, s44, 81920
    s_nop 0
    buffer_load_dwordx4 v137, s[8:11], s41 offen offset:0 lds
    v_mfma_f32_32x32x16_bf16 v[80:95], v[132:135], v[120:123], v[80:95]
    buffer_load_dwordx4 v138, s[8:11], s41 offen offset:1024 lds
    s_waitcnt lgkmcnt(8)
    v_mfma_f32_32x32x16_bf16 v[0:15], v[160:163], v[152:155], v[0:15]
    ds_read_b64_tr_b16 v[124:125], v145 offset:53248
    ds_read_b64_tr_b16 v[126:127], v145 offset:56320
    v_mfma_f32_32x32x16_bf16 v[16:31], v[160:163], v[156:159], v[16:31]
    ds_read_b128 v[116:119], v141 offset:43008
    ds_read_b128 v[120:123], v141 offset:47104
    buffer_load_dwordx4 v139, s[8:11], s41 offen offset:2048 lds
    s_add_u32 s41, s41, 73728
    v_mfma_f32_32x32x16_bf16 v[32:47], v[164:167], v[152:155], v[32:47]
    ds_read_b64_tr_b16 v[128:129], v146 offset:53248
    ds_read_b64_tr_b16 v[130:131], v146 offset:56320
    v_mfma_f32_32x32x16_bf16 v[48:63], v[164:167], v[156:159], v[48:63]
    ds_read_b64_tr_b16 v[132:133], v147 offset:53248
    ds_read_b64_tr_b16 v[134:135], v147 offset:56320
    v_mfma_f32_32x32x16_bf16 v[64:79], v[168:171], v[152:155], v[64:79]
    s_add_u32 m0, s44, 84992
    s_nop 0
    buffer_load_dwordx4 v137, s[8:11], s42 offen offset:0 lds
    v_mfma_f32_32x32x16_bf16 v[80:95], v[168:171], v[156:159], v[80:95]
    buffer_load_dwordx4 v138, s[8:11], s42 offen offset:1024 lds
    s_waitcnt lgkmcnt(8)
    v_mfma_f32_32x32x16_bf16 v[0:15], v[104:107], v[96:99], v[0:15]
    ds_read_b64_tr_b16 v[160:161], v145 offset:59392
    ds_read_b64_tr_b16 v[162:163], v145 offset:62464
    v_mfma_f32_32x32x16_bf16 v[16:31], v[104:107], v[100:103], v[16:31]
    ds_read_b128 v[152:155], v141 offset:44032
    ds_read_b128 v[156:159], v141 offset:48128
    buffer_load_dwordx4 v139, s[8:11], s42 offen offset:2048 lds
    s_add_u32 s42, s42, 73728
    v_mfma_f32_32x32x16_bf16 v[32:47], v[108:111], v[96:99], v[32:47]
    ds_read_b64_tr_b16 v[164:165], v146 offset:59392
    ds_read_b64_tr_b16 v[166:167], v146 offset:62464
    v_mfma_f32_32x32x16_bf16 v[48:63], v[108:111], v[100:103], v[48:63]
    ds_read_b64_tr_b16 v[168:169], v147 offset:59392
    ds_read_b64_tr_b16 v[170:171], v147 offset:62464
    v_mfma_f32_32x32x16_bf16 v[64:79], v[112:115], v[96:99], v[64:79]
    v_mfma_f32_32x32x16_bf16 v[80:95], v[112:115], v[100:103], v[80:95]
    s_waitcnt lgkmcnt(8)
    v_mfma_f32_32x32x16_bf16 v[0:15], v[124:127], v[116:119], v[0:15]
    s_waitcnt vmcnt(20) lgkmcnt(0)
    s_barrier
    ds_read_b64_tr_b16 v[104:105], v142 offset:0
    ds_read_b64_tr_b16 v[106:107], v142 offset:3072
    v_mfma_f32_32x32x16_bf16 v[16:31], v[124:127], v[120:123], v[16:31]
    ds_read_b128 v[96:99], v140 offset:0
    ds_read_b128 v[100:103], v140 offset:4096
    s_add_u32 m0, s43, 122880
    s_nop 0
    buffer_load_dwordx4 v243, s[12:15], s40 offen offset:0 sc1 lds
    v_mfma_f32_32x32x16_bf16 v[32:47], v[128:131], v[116:119], v[32:47]
    ds_read_b64_tr_b16 v[108:109], v143 offset:0
    ds_read_b64_tr_b16 v[110:111], v143 offset:3072
    v_mfma_f32_32x32x16_bf16 v[48:63], v[128:131], v[120:123], v[48:63]
    ds_read_b64_tr_b16 v[112:113], v144 offset:0
    ds_read_b64_tr_b16 v[114:115], v144 offset:3072
    v_mfma_f32_32x32x16_bf16 v[64:79], v[132:135], v[116:119], v[64:79]
    buffer_load_dwordx4 v243, s[12:15], s40 offen offset:1024 sc1 lds
    v_mfma_f32_32x32x16_bf16 v[80:95], v[132:135], v[120:123], v[80:95]
    buffer_load_dwordx4 v243, s[12:15], s40 offen offset:2048 sc1 lds
    s_waitcnt lgkmcnt(8)
    v_mfma_f32_32x32x16_bf16 v[0:15], v[160:163], v[152:155], v[0:15]
    ds_read_b64_tr_b16 v[124:125], v142 offset:6144
    ds_read_b64_tr_b16 v[126:127], v142 offset:9216
    v_mfma_f32_32x32x16_bf16 v[16:31], v[160:163], v[156:159], v[16:31]
    ds_read_b128 v[116:119], v140 offset:1024
    ds_read_b128 v[120:123], v140 offset:5120
    buffer_load_dwordx4 v243, s[12:15], s40 offen offset:3072 sc1 lds
    s_add_u32 s40, s40, 4096
    v_mfma_f32_32x32x16_bf16 v[32:47], v[164:167], v[152:155], v[32:47]
    ds_read_b64_tr_b16 v[128:129], v143 offset:6144
    ds_read_b64_tr_b16 v[130:131], v143 offset:9216
    v_mfma_f32_32x32x16_bf16 v[48:63], v[164:167], v[156:159], v[48:63]
    ds_read_b64_tr_b16 v[132:133], v144 offset:6144
    ds_read_b64_tr_b16 v[134:135], v144 offset:9216
    v_mfma_f32_32x32x16_bf16 v[64:79], v[168:171], v[152:155], v[64:79]
    s_add_u32 m0, s44, 122880
    s_nop 0
    buffer_load_dwordx4 v137, s[8:11], s41 offen offset:0 lds
    v_mfma_f32_32x32x16_bf16 v[80:95], v[168:171], v[156:159], v[80:95]
    buffer_load_dwordx4 v138, s[8:11], s41 offen offset:1024 lds
    s_waitcnt lgkmcnt(8)
    v_mfma_f32_32x32x16_bf16 v[0:15], v[104:107], v[96:99], v[0:15]
    ds_read_b64_tr_b16 v[160:161], v142 offset:12288
    ds_read_b64_tr_b16 v[162:163], v142 offset:15360
    v_mfma_f32_32x32x16_bf16 v[16:31], v[104:107], v[100:103], v[16:31]
    ds_read_b128 v[152:155], v140 offset:2048
    ds_read_b128 v[156:159], v140 offset:6144
    buffer_load_dwordx4 v139, s[8:11], s41 offen offset:2048 lds
    s_add_u32 s41, s41, 73728
    v_mfma_f32_32x32x16_bf16 v[32:47], v[108:111], v[96:99], v[32:47]
    ds_read_b64_tr_b16 v[164:165], v143 offset:12288
    ds_read_b64_tr_b16 v[166:167], v143 offset:15360
    v_mfma_f32_32x32x16_bf16 v[48:63], v[108:111], v[100:103], v[48:63]
    ds_read_b64_tr_b16 v[168:169], v144 offset:12288
    ds_read_b64_tr_b16 v[170:171], v144 offset:15360
    v_mfma_f32_32x32x16_bf16 v[64:79], v[112:115], v[96:99], v[64:79]
    s_add_u32 m0, s44, 125952
    s_nop 0
    buffer_load_dwordx4 v137, s[8:11], s42 offen offset:0 lds
    v_mfma_f32_32x32x16_bf16 v[80:95], v[112:115], v[100:103], v[80:95]
    buffer_load_dwordx4 v138, s[8:11], s42 offen offset:1024 lds
    s_waitcnt lgkmcnt(8)
    v_mfma_f32_32x32x16_bf16 v[0:15], v[124:127], v[116:119], v[0:15]
    ds_read_b64_tr_b16 v[104:105], v142 offset:18432
    ds_read_b64_tr_b16 v[106:107], v142 offset:21504
    v_mfma_f32_32x32x16_bf16 v[16:31], v[124:127], v[120:123], v[16:31]
    ds_read_b128 v[96:99], v140 offset:3072
    ds_read_b128 v[100:103], v140 offset:7168
    buffer_load_dwordx4 v139, s[8:11], s42 offen offset:2048 lds
    s_add_u32 s42, s42, 73728
    v_mfma_f32_32x32x16_bf16 v[32:47], v[128:131], v[116:119], v[32:47]
    ds_read_b64_tr_b16 v[108:109], v143 offset:18432
    ds_read_b64_tr_b16 v[110:111], v143 offset:21504
    v_mfma_f32_32x32x16_bf16 v[48:63], v[128:131], v[120:123], v[48:63]
    ds_read_b64_tr_b16 v[112:113], v144 offset:18432
    ds_read_b64_tr_b16 v[114:115], v144 offset:21504
    v_mfma_f32_32x32x16_bf16 v[64:79], v[132:135], v[116:119], v[64:79]
    v_mfma_f32_32x32x16_bf16 v[80:95], v[132:135], v[120:123], v[80:95]
    s_waitcnt lgkmcnt(8)
    v_mfma_f32_32x32x16_bf16 v[0:15], v[160:163], v[152:155], v[0:15]
    s_waitcnt vmcnt(20) lgkmcnt(0)
    s_barrier
    ds_read_b64_tr_b16 v[124:125], v142 offset:40960
    ds_read_b64_tr_b16 v[126:127], v142 offset:44032
    v_mfma_f32_32x32x16_bf16 v[16:31], v[160:163], v[156:159], v[16:31]
    ds_read_b128 v[116:119], v140 offset:40960
    ds_read_b128 v[120:123], v140 offset:45056
    v_mfma_f32_32x32x16_bf16 v[32:47], v[164:167], v[152:155], v[32:47]
    ds_read_b64_tr_b16 v[128:129], v143 offset:40960
    ds_read_b64_tr_b16 v[130:131], v143 offset:44032
    v_mfma_f32_32x32x16_bf16 v[48:63], v[164:167], v[156:159], v[48:63]
    ds_read_b64_tr_b16 v[132:133], v144 offset:40960
    ds_read_b64_tr_b16 v[134:135], v144 offset:44032
    v_mfma_f32_32x32x16_bf16 v[64:79], v[168:171], v[152:155], v[64:79]
    v_mfma_f32_32x32x16_bf16 v[80:95], v[168:171], v[156:159], v[80:95]
    s_waitcnt lgkmcnt(8)
    v_mfma_f32_32x32x16_bf16 v[0:15], v[104:107], v[96:99], v[0:15]
    ds_read_b64_tr_b16 v[160:161], v142 offset:47104
    ds_read_b64_tr_b16 v[162:163], v142 offset:50176
    v_mfma_f32_32x32x16_bf16 v[16:31], v[104:107], v[100:103], v[16:31]
    ds_read_b128 v[152:155], v140 offset:41984
    ds_read_b128 v[156:159], v140 offset:46080
    v_mfma_f32_32x32x16_bf16 v[32:47], v[108:111], v[96:99], v[32:47]
    ds_read_b64_tr_b16 v[164:165], v143 offset:47104
    ds_read_b64_tr_b16 v[166:167], v143 offset:50176
    v_mfma_f32_32x32x16_bf16 v[48:63], v[108:111], v[100:103], v[48:63]
    ds_read_b64_tr_b16 v[168:169], v144 offset:47104
    ds_read_b64_tr_b16 v[170:171], v144 offset:50176
    v_mfma_f32_32x32x16_bf16 v[64:79], v[112:115], v[96:99], v[64:79]
    v_mfma_f32_32x32x16_bf16 v[80:95], v[112:115], v[100:103], v[80:95]
    s_waitcnt lgkmcnt(8)
    v_mfma_f32_32x32x16_bf16 v[0:15], v[124:127], v[116:119], v[0:15]
    ds_read_b64_tr_b16 v[104:105], v142 offset:53248
    ds_read_b64_tr_b16 v[106:107], v142 offset:56320
    v_mfma_f32_32x32x16_bf16 v[16:31], v[124:127], v[120:123], v[16:31]
    ds_read_b128 v[96:99], v140 offset:43008
    ds_read_b128 v[100:103], v140 offset:47104
    v_mfma_f32_32x32x16_bf16 v[32:47], v[128:131], v[116:119], v[32:47]
    ds_read_b64_tr_b16 v[108:109], v143 offset:53248
    ds_read_b64_tr_b16 v[110:111], v143 offset:56320
    v_mfma_f32_32x32x16_bf16 v[48:63], v[128:131], v[120:123], v[48:63]
    ds_read_b64_tr_b16 v[112:113], v144 offset:53248
    ds_read_b64_tr_b16 v[114:115], v144 offset:56320
    v_mfma_f32_32x32x16_bf16 v[64:79], v[132:135], v[116:119], v[64:79]
    v_mfma_f32_32x32x16_bf16 v[80:95], v[132:135], v[120:123], v[80:95]
    s_waitcnt lgkmcnt(8)
    v_mfma_f32_32x32x16_bf16 v[0:15], v[160:163], v[152:155], v[0:15]
    ds_read_b64_tr_b16 v[124:125], v142 offset:59392
    ds_read_b64_tr_b16 v[126:127], v142 offset:62464
    v_mfma_f32_32x32x16_bf16 v[16:31], v[160:163], v[156:159], v[16:31]
    ds_read_b128 v[116:119], v140 offset:44032
    ds_read_b128 v[120:123], v140 offset:48128
    v_mfma_f32_32x32x16_bf16 v[32:47], v[164:167], v[152:155], v[32:47]
    ds_read_b64_tr_b16 v[128:129], v143 offset:59392
    ds_read_b64_tr_b16 v[130:131], v143 offset:62464
    v_mfma_f32_32x32x16_bf16 v[48:63], v[164:167], v[156:159], v[48:63]
    ds_read_b64_tr_b16 v[132:133], v144 offset:59392
    ds_read_b64_tr_b16 v[134:135], v144 offset:62464
    v_mfma_f32_32x32x16_bf16 v[64:79], v[168:171], v[152:155], v[64:79]
    v_mfma_f32_32x32x16_bf16 v[80:95], v[168:171], v[156:159], v[80:95]
    s_waitcnt lgkmcnt(8)
    v_mfma_f32_32x32x16_bf16 v[0:15], v[104:107], v[96:99], v[0:15]
    s_waitcnt vmcnt(10) lgkmcnt(0)
    s_barrier
    ds_read_b64_tr_b16 v[160:161], v145 offset:0
    ds_read_b64_tr_b16 v[162:163], v145 offset:3072
    v_mfma_f32_32x32x16_bf16 v[16:31], v[104:107], v[100:103], v[16:31]
    ds_read_b128 v[152:155], v141 offset:0
    ds_read_b128 v[156:159], v141 offset:4096
    v_mfma_f32_32x32x16_bf16 v[32:47], v[108:111], v[96:99], v[32:47]
    ds_read_b64_tr_b16 v[164:165], v146 offset:0
    ds_read_b64_tr_b16 v[166:167], v146 offset:3072
    v_mfma_f32_32x32x16_bf16 v[48:63], v[108:111], v[100:103], v[48:63]
    ds_read_b64_tr_b16 v[168:169], v147 offset:0
    ds_read_b64_tr_b16 v[170:171], v147 offset:3072
    v_mfma_f32_32x32x16_bf16 v[64:79], v[112:115], v[96:99], v[64:79]
    v_mfma_f32_32x32x16_bf16 v[80:95], v[112:115], v[100:103], v[80:95]
    s_waitcnt lgkmcnt(8)
    v_mfma_f32_32x32x16_bf16 v[0:15], v[124:127], v[116:119], v[0:15]
    ds_read_b64_tr_b16 v[104:105], v145 offset:6144
    ds_read_b64_tr_b16 v[106:107], v145 offset:9216
    v_mfma_f32_32x32x16_bf16 v[16:31], v[124:127], v[120:123], v[16:31]
    ds_read_b128 v[96:99], v141 offset:1024
    ds_read_b128 v[100:103], v141 offset:5120
    v_mfma_f32_32x32x16_bf16 v[32:47], v[128:131], v[116:119], v[32:47]
    ds_read_b64_tr_b16 v[108:109], v146 offset:6144
    ds_read_b64_tr_b16 v[110:111], v146 offset:9216
    v_mfma_f32_32x32x16_bf16 v[48:63], v[128:131], v[120:123], v[48:63]
    ds_read_b64_tr_b16 v[112:113], v147 offset:6144
    ds_read_b64_tr_b16 v[114:115], v147 offset:9216
    v_mfma_f32_32x32x16_bf16 v[64:79], v[132:135], v[116:119], v[64:79]
    v_mfma_f32_32x32x16_bf16 v[80:95], v[132:135], v[120:123], v[80:95]
    s_waitcnt lgkmcnt(8)
    v_mfma_f32_32x32x16_bf16 v[0:15], v[160:163], v[152:155], v[0:15]
    ds_read_b64_tr_b16 v[124:125], v145 offset:12288
    ds_read_b64_tr_b16 v[126:127], v145 offset:15360
    v_mfma_f32_32x32x16_bf16 v[16:31], v[160:163], v[156:159], v[16:31]
    ds_read_b128 v[116:119], v141 offset:2048
    ds_read_b128 v[120:123], v141 offset:6144
    v_mfma_f32_32x32x16_bf16 v[32:47], v[164:167], v[152:155], v[32:47]
    ds_read_b64_tr_b16 v[128:129], v146 offset:12288
    ds_read_b64_tr_b16 v[130:131], v146 offset:15360
    v_mfma_f32_32x32x16_bf16 v[48:63], v[164:167], v[156:159], v[48:63]
    ds_read_b64_tr_b16 v[132:133], v147 offset:12288
    ds_read_b64_tr_b16 v[134:135], v147 offset:15360
    v_mfma_f32_32x32x16_bf16 v[64:79], v[168:171], v[152:155], v[64:79]
    v_mfma_f32_32x32x16_bf16 v[80:95], v[168:171], v[156:159], v[80:95]
    s_waitcnt lgkmcnt(8)
    v_mfma_f32_32x32x16_bf16 v[0:15], v[104:107], v[96:99], v[0:15]
    ds_read_b64_tr_b16 v[160:161], v145 offset:18432
    ds_read_b64_tr_b16 v[162:163], v145 offset:21504
    v_mfma_f32_32x32x16_bf16 v[16:31], v[104:107], v[100:103], v[16:31]
    ds_read_b128 v[152:155], v141 offset:3072
    ds_read_b128 v[156:159], v141 offset:7168
    v_mfma_f32_32x32x16_bf16 v[32:47], v[108:111], v[96:99], v[32:47]
    ds_read_b64_tr_b16 v[164:165], v146 offset:18432
    ds_read_b64_tr_b16 v[166:167], v146 offset:21504
    v_mfma_f32_32x32x16_bf16 v[48:63], v[108:111], v[100:103], v[48:63]
    ds_read_b64_tr_b16 v[168:169], v147 offset:18432
    ds_read_b64_tr_b16 v[170:171], v147 offset:21504
    v_mfma_f32_32x32x16_bf16 v[64:79], v[112:115], v[96:99], v[64:79]
    v_mfma_f32_32x32x16_bf16 v[80:95], v[112:115], v[100:103], v[80:95]
    s_waitcnt lgkmcnt(8)
    v_mfma_f32_32x32x16_bf16 v[0:15], v[124:127], v[116:119], v[0:15]
    s_waitcnt vmcnt(0) lgkmcnt(0)
    s_barrier
    ds_read_b64_tr_b16 v[104:105], v145 offset:40960
    ds_read_b64_tr_b16 v[106:107], v145 offset:44032
    v_mfma_f32_32x32x16_bf16 v[16:31], v[124:127], v[120:123], v[16:31]
    ds_read_b128 v[96:99], v141 offset:40960
    ds_read_b128 v[100:103], v141 offset:45056
    v_mfma_f32_32x32x16_bf16 v[32:47], v[128:131], v[116:119], v[32:47]
    ds_read_b64_tr_b16 v[108:109], v146 offset:40960
    ds_read_b64_tr_b16 v[110:111], v146 offset:44032
    v_mfma_f32_32x32x16_bf16 v[48:63], v[128:131], v[120:123], v[48:63]
    ds_read_b64_tr_b16 v[112:113], v147 offset:40960
    ds_read_b64_tr_b16 v[114:115], v147 offset:44032
    v_mfma_f32_32x32x16_bf16 v[64:79], v[132:135], v[116:119], v[64:79]
    v_mfma_f32_32x32x16_bf16 v[80:95], v[132:135], v[120:123], v[80:95]
    s_waitcnt lgkmcnt(8)
    v_mfma_f32_32x32x16_bf16 v[0:15], v[160:163], v[152:155], v[0:15]
    ds_read_b64_tr_b16 v[124:125], v145 offset:47104
    ds_read_b64_tr_b16 v[126:127], v145 offset:50176
    v_mfma_f32_32x32x16_bf16 v[16:31], v[160:163], v[156:159], v[16:31]
    ds_read_b128 v[116:119], v141 offset:41984
    ds_read_b128 v[120:123], v141 offset:46080
    v_mfma_f32_32x32x16_bf16 v[32:47], v[164:167], v[152:155], v[32:47]
    ds_read_b64_tr_b16 v[128:129], v146 offset:47104
    ds_read_b64_tr_b16 v[130:131], v146 offset:50176
    v_mfma_f32_32x32x16_bf16 v[48:63], v[164:167], v[156:159], v[48:63]
    ds_read_b64_tr_b16 v[132:133], v147 offset:47104
    ds_read_b64_tr_b16 v[134:135], v147 offset:50176
    v_mfma_f32_32x32x16_bf16 v[64:79], v[168:171], v[152:155], v[64:79]
    v_mfma_f32_32x32x16_bf16 v[80:95], v[168:171], v[156:159], v[80:95]
    s_waitcnt lgkmcnt(8)
    v_mfma_f32_32x32x16_bf16 v[0:15], v[104:107], v[96:99], v[0:15]
    ds_read_b64_tr_b16 v[160:161], v145 offset:53248
    ds_read_b64_tr_b16 v[162:163], v145 offset:56320
    v_mfma_f32_32x32x16_bf16 v[16:31], v[104:107], v[100:103], v[16:31]
    ds_read_b128 v[152:155], v141 offset:43008
    ds_read_b128 v[156:159], v141 offset:47104
    v_mfma_f32_32x32x16_bf16 v[32:47], v[108:111], v[96:99], v[32:47]
    ds_read_b64_tr_b16 v[164:165], v146 offset:53248
    ds_read_b64_tr_b16 v[166:167], v146 offset:56320
    v_mfma_f32_32x32x16_bf16 v[48:63], v[108:111], v[100:103], v[48:63]
    ds_read_b64_tr_b16 v[168:169], v147 offset:53248
    ds_read_b64_tr_b16 v[170:171], v147 offset:56320
    v_mfma_f32_32x32x16_bf16 v[64:79], v[112:115], v[96:99], v[64:79]
    v_mfma_f32_32x32x16_bf16 v[80:95], v[112:115], v[100:103], v[80:95]
    s_waitcnt lgkmcnt(8)
    v_mfma_f32_32x32x16_bf16 v[0:15], v[124:127], v[116:119], v[0:15]
    ds_read_b64_tr_b16 v[104:105], v145 offset:59392
    ds_read_b64_tr_b16 v[106:107], v145 offset:62464
    v_mfma_f32_32x32x16_bf16 v[16:31], v[124:127], v[120:123], v[16:31]
    ds_read_b128 v[96:99], v141 offset:44032
    ds_read_b128 v[100:103], v141 offset:48128
    v_mfma_f32_32x32x16_bf16 v[32:47], v[128:131], v[116:119], v[32:47]
    ds_read_b64_tr_b16 v[108:109], v146 offset:59392
    ds_read_b64_tr_b16 v[110:111], v146 offset:62464
    v_mfma_f32_32x32x16_bf16 v[48:63], v[128:131], v[120:123], v[48:63]
    ds_read_b64_tr_b16 v[112:113], v147 offset:59392
    ds_read_b64_tr_b16 v[114:115], v147 offset:62464
    v_mfma_f32_32x32x16_bf16 v[64:79], v[132:135], v[116:119], v[64:79]
    v_mfma_f32_32x32x16_bf16 v[80:95], v[132:135], v[120:123], v[80:95]
    s_waitcnt lgkmcnt(8)
    v_mfma_f32_32x32x16_bf16 v[0:15], v[160:163], v[152:155], v[0:15]
    v_mfma_f32_32x32x16_bf16 v[16:31], v[160:163], v[156:159], v[16:31]
    v_mfma_f32_32x32x16_bf16 v[32:47], v[164:167], v[152:155], v[32:47]
    v_mfma_f32_32x32x16_bf16 v[48:63], v[164:167], v[156:159], v[48:63]
    v_mfma_f32_32x32x16_bf16 v[64:79], v[168:171], v[152:155], v[64:79]
    v_mfma_f32_32x32x16_bf16 v[80:95], v[168:171], v[156:159], v[80:95]
    s_waitcnt lgkmcnt(0)
    v_mfma_f32_32x32x16_bf16 v[0:15], v[104:107], v[96:99], v[0:15]
    v_mfma_f32_32x32x16_bf16 v[16:31], v[104:107], v[100:103], v[16:31]
    v_mfma_f32_32x32x16_bf16 v[32:47], v[108:111], v[96:99], v[32:47]
    v_mfma_f32_32x32x16_bf16 v[48:63], v[108:111], v[100:103], v[48:63]
    v_mfma_f32_32x32x16_bf16 v[64:79], v[112:115], v[96:99], v[64:79]
    v_mfma_f32_32x32x16_bf16 v[80:95], v[112:115], v[100:103], v[80:95]
    s_lshl_b32 s45, s39, 6
    s_lshl_b32 s46, s37, 2
    s_add_u32 s45, s45, s46
    s_and_b32 s47, s36, 1
    s_lshl_b32 s47, s47, 1
    s_add_u32 s45, s45, s47
    s_mul_i32 s45, s45, 18
    s_mul_i32 s46, s38, 6
    s_add_u32 s45, s45, s46
    s_lshr_b32 s46, s36, 1
    s_mul_i32 s46, s46, 3
    s_add_u32 s45, s45, s46
    s_lshl_b32 s45, s45, 11
    s_add_u32 s45, s45, 0x3800000
    s_lshl_b32 s46, s46, 12
    v_add_u32 v100, s46, v243
    s_sub_u32 s47, s39, s47
    s_cmp_eq_u32 s47, 0
    s_cbranch_scc1 parallel_sum__compressed_kv_cla__moe_arch_mod__prompt_kernel_own0
    v_cvt_pk_bf16_f32 v104, v0, v1
    v_cvt_pk_bf16_f32 v105, v2, v3
    v_cvt_pk_bf16_f32 v106, v4, v5
    v_cvt_pk_bf16_f32 v107, v6, v7
    v_cvt_pk_bf16_f32 v108, v8, v9
    v_cvt_pk_bf16_f32 v109, v10, v11
    v_cvt_pk_bf16_f32 v110, v12, v13
    v_cvt_pk_bf16_f32 v111, v14, v15
    s_add_u32 s46, s45, 0
    buffer_store_dwordx4 v[104:107], v243, s[12:15], s46 offen offset:0 sc1
    buffer_store_dwordx4 v[108:111], v243, s[12:15], s46 offen offset:1024 sc1
    v_cvt_pk_bf16_f32 v112, v32, v33
    v_cvt_pk_bf16_f32 v113, v34, v35
    v_cvt_pk_bf16_f32 v114, v36, v37
    v_cvt_pk_bf16_f32 v115, v38, v39
    v_cvt_pk_bf16_f32 v116, v40, v41
    v_cvt_pk_bf16_f32 v117, v42, v43
    v_cvt_pk_bf16_f32 v118, v44, v45
    v_cvt_pk_bf16_f32 v119, v46, v47
    s_add_u32 s46, s45, 2048
    buffer_store_dwordx4 v[112:115], v243, s[12:15], s46 offen offset:0 sc1
    buffer_store_dwordx4 v[116:119], v243, s[12:15], s46 offen offset:1024 sc1
    v_cvt_pk_bf16_f32 v120, v64, v65
    v_cvt_pk_bf16_f32 v121, v66, v67
    v_cvt_pk_bf16_f32 v122, v68, v69
    v_cvt_pk_bf16_f32 v123, v70, v71
    v_cvt_pk_bf16_f32 v124, v72, v73
    v_cvt_pk_bf16_f32 v125, v74, v75
    v_cvt_pk_bf16_f32 v126, v76, v77
    v_cvt_pk_bf16_f32 v127, v78, v79
    s_add_u32 s46, s45, 4096
    buffer_store_dwordx4 v[120:123], v243, s[12:15], s46 offen offset:0 sc1
    buffer_store_dwordx4 v[124:127], v243, s[12:15], s46 offen offset:1024 sc1
    s_branch parallel_sum__compressed_kv_cla__moe_arch_mod__prompt_kernel_nx0
parallel_sum__compressed_kv_cla__moe_arch_mod__prompt_kernel_own0:
    ds_write_b128 v100, v[0:3] offset:0
    ds_write_b128 v100, v[4:7] offset:1024
    ds_write_b128 v100, v[8:11] offset:2048
    ds_write_b128 v100, v[12:15] offset:3072
    ds_write_b128 v100, v[32:35] offset:4096
    ds_write_b128 v100, v[36:39] offset:5120
    ds_write_b128 v100, v[40:43] offset:6144
    ds_write_b128 v100, v[44:47] offset:7168
    ds_write_b128 v100, v[64:67] offset:8192
    ds_write_b128 v100, v[68:71] offset:9216
    ds_write_b128 v100, v[72:75] offset:10240
    ds_write_b128 v100, v[76:79] offset:11264
parallel_sum__compressed_kv_cla__moe_arch_mod__prompt_kernel_nx0:
    s_cmp_eq_u32 s47, 1
    s_cbranch_scc1 parallel_sum__compressed_kv_cla__moe_arch_mod__prompt_kernel_own1
    v_cvt_pk_bf16_f32 v104, v16, v17
    v_cvt_pk_bf16_f32 v105, v18, v19
    v_cvt_pk_bf16_f32 v106, v20, v21
    v_cvt_pk_bf16_f32 v107, v22, v23
    v_cvt_pk_bf16_f32 v108, v24, v25
    v_cvt_pk_bf16_f32 v109, v26, v27
    v_cvt_pk_bf16_f32 v110, v28, v29
    v_cvt_pk_bf16_f32 v111, v30, v31
    s_add_u32 s46, s45, 36864
    buffer_store_dwordx4 v[104:107], v243, s[12:15], s46 offen offset:0 sc1
    buffer_store_dwordx4 v[108:111], v243, s[12:15], s46 offen offset:1024 sc1
    v_cvt_pk_bf16_f32 v112, v48, v49
    v_cvt_pk_bf16_f32 v113, v50, v51
    v_cvt_pk_bf16_f32 v114, v52, v53
    v_cvt_pk_bf16_f32 v115, v54, v55
    v_cvt_pk_bf16_f32 v116, v56, v57
    v_cvt_pk_bf16_f32 v117, v58, v59
    v_cvt_pk_bf16_f32 v118, v60, v61
    v_cvt_pk_bf16_f32 v119, v62, v63
    s_add_u32 s46, s45, 38912
    buffer_store_dwordx4 v[112:115], v243, s[12:15], s46 offen offset:0 sc1
    buffer_store_dwordx4 v[116:119], v243, s[12:15], s46 offen offset:1024 sc1
    v_cvt_pk_bf16_f32 v120, v80, v81
    v_cvt_pk_bf16_f32 v121, v82, v83
    v_cvt_pk_bf16_f32 v122, v84, v85
    v_cvt_pk_bf16_f32 v123, v86, v87
    v_cvt_pk_bf16_f32 v124, v88, v89
    v_cvt_pk_bf16_f32 v125, v90, v91
    v_cvt_pk_bf16_f32 v126, v92, v93
    v_cvt_pk_bf16_f32 v127, v94, v95
    s_add_u32 s46, s45, 40960
    buffer_store_dwordx4 v[120:123], v243, s[12:15], s46 offen offset:0 sc1
    buffer_store_dwordx4 v[124:127], v243, s[12:15], s46 offen offset:1024 sc1
    s_branch parallel_sum__compressed_kv_cla__moe_arch_mod__prompt_kernel_nx1
parallel_sum__compressed_kv_cla__moe_arch_mod__prompt_kernel_own1:
    ds_write_b128 v100, v[16:19] offset:0
    ds_write_b128 v100, v[20:23] offset:1024
    ds_write_b128 v100, v[24:27] offset:2048
    ds_write_b128 v100, v[28:31] offset:3072
    ds_write_b128 v100, v[48:51] offset:4096
    ds_write_b128 v100, v[52:55] offset:5120
    ds_write_b128 v100, v[56:59] offset:6144
    ds_write_b128 v100, v[60:63] offset:7168
    ds_write_b128 v100, v[80:83] offset:8192
    ds_write_b128 v100, v[84:87] offset:9216
    ds_write_b128 v100, v[88:91] offset:10240
    ds_write_b128 v100, v[92:95] offset:11264
parallel_sum__compressed_kv_cla__moe_arch_mod__prompt_kernel_nx1:
    s_mov_b32 s18, 0x240000
    s_mov_b32 s19, 0x20000
    s_mov_b32 s22, 0x240000
    s_mov_b32 s23, 0x20000
    s_lshl_b32 s40, s37, 2
    s_add_u32 s40, s40, s39
    s_mul_i32 s41, s37, 3
    s_add_u32 s41, s41, s38
    s_lshl_b32 s41, s41, 8
    s_add_u32 s41, s41, 0x7a8000
    v_and_b32 v99, 31, v148
    v_lshrrev_b32 v101, 5, v148
    v_mul_u32_u24 v96, 1152, v99
    v_lshl_add_u32 v96, v101, 4, v96
    v_and_b32 v150, 3, v148
    v_lshlrev_b32 v150, 6, v150
    v_add_u32 v150, s41, v150
    v_mov_b32 v160, 0
    v_mov_b32 v161, 0
    v_mov_b32 v162, 0
    v_mov_b32 v163, 0
    v_mov_b32 v164, 0
    v_mov_b32 v165, 0
    v_mov_b32 v166, 0
    v_mov_b32 v167, 0
    v_mov_b32 v168, 0
    v_mov_b32 v169, 0
    v_mov_b32 v170, 0
    v_mov_b32 v171, 0
    v_mov_b32 v172, 0
    v_mov_b32 v173, 0
    v_mov_b32 v174, 0
    v_mov_b32 v175, 0
    v_mov_b32 v176, 0
    v_mov_b32 v177, 0
    v_mov_b32 v178, 0
    v_mov_b32 v179, 0
    v_mov_b32 v180, 0
    v_mov_b32 v181, 0
    v_mov_b32 v182, 0
    v_mov_b32 v183, 0
    s_mul_i32 s45, s36, 3
    s_mul_i32 s46, s38, 12
    s_add_u32 s45, s45, s46
    s_add_u32 s45, s45, 0
    s_mul_i32 s46, s40, 36864
    s_lshl_b32 s47, s45, 5
    s_add_u32 s42, s46, s47
    s_mul_i32 s46, s40, 36
    s_add_u32 s46, s46, s45
    s_lshl_b32 s48, s46, 10
    buffer_load_dwordx4 v[208:211], v96, s[16:19], s42 offen
    buffer_load_dwordx4 v[212:215], v243, s[12:15], s48 offen sc1
    s_mul_i32 s45, s36, 3
    s_mul_i32 s46, s38, 12
    s_add_u32 s45, s45, s46
    s_add_u32 s45, s45, 1
    s_mul_i32 s46, s40, 36864
    s_lshl_b32 s47, s45, 5
    s_add_u32 s43, s46, s47
    s_mul_i32 s46, s40, 36
    s_add_u32 s46, s46, s45
    s_lshl_b32 s49, s46, 10
    buffer_load_dwordx4 v[216:219], v96, s[16:19], s43 offen
    buffer_load_dwordx4 v[220:223], v243, s[12:15], s49 offen sc1
    s_mul_i32 s45, s36, 3
    s_mul_i32 s46, s38, 12
    s_add_u32 s45, s45, s46
    s_add_u32 s45, s45, 2
    s_mul_i32 s46, s40, 36864
    s_lshl_b32 s47, s45, 5
    s_add_u32 s44, s46, s47
    s_mul_i32 s46, s40, 36
    s_add_u32 s46, s46, s45
    s_lshl_b32 s50, s46, 10
    buffer_load_dwordx4 v[224:227], v96, s[16:19], s44 offen
    buffer_load_dwordx4 v[228:231], v243, s[12:15], s50 offen sc1
    s_add_u32 s51, s39, 1
    s_and_b32 s51, s51, 3
    s_mul_i32 s51, s51, 2359296
    s_add_u32 s51, s51, 0x3800000
    s_add_u32 s52, s39, 2
    s_and_b32 s52, s52, 3
    s_mul_i32 s52, s52, 2359296
    s_add_u32 s52, s52, 0x3800000
    s_add_u32 s53, s39, 3
    s_and_b32 s53, s53, 3
    s_mul_i32 s53, s53, 2359296
    s_add_u32 s53, s53, 0x3800000
    s_mul_i32 s45, s36, 6144
    v_add_u32 v102, s45, v243
    s_lshl_b32 s45, s39, 6
    s_add_u32 s45, s45, s41
    s_waitcnt vmcnt(6) lgkmcnt(0)
    s_barrier
    s_cmp_eq_u32 s36, 0
    s_cbranch_scc0 parallel_sum__compressed_kv_cla__moe_arch_mod__prompt_kernel_nosig
    v_mov_b32 v103, s87
    s_mov_b64 exec, 1
    buffer_store_dword v103, off, s[12:15], s45 sc1
    s_mov_b64 exec, -1
parallel_sum__compressed_kv_cla__moe_arch_mod__prompt_kernel_nosig:
    ds_read_b128 v[0:3], v102 offset:0
    ds_read_b128 v[4:7], v102 offset:1024
    ds_read_b128 v[32:35], v102 offset:2048
    ds_read_b128 v[36:39], v102 offset:3072
    ds_read_b128 v[64:67], v102 offset:4096
    ds_read_b128 v[68:71], v102 offset:5120
    s_mov_b32 s33, 0
    s_lshl_b32 s47, s40, 5
    s_sub_u32 s45, s56, s47
    s_cmp_lt_u32 s45, 32
    s_cbranch_scc0 parallel_sum__compressed_kv_cla__moe_arch_mod__prompt_kernel_m0
    s_mov_b32 s64, 0
    s_call_b64 s[66:67], parallel_sum__compressed_kv_cla__moe_arch_mod__prompt_kernel_addy
parallel_sum__compressed_kv_cla__moe_arch_mod__prompt_kernel_m0:
    s_sub_u32 s45, s57, s47
    s_cmp_lt_u32 s45, 32
    s_cbranch_scc0 parallel_sum__compressed_kv_cla__moe_arch_mod__prompt_kernel_m1
    s_mov_b32 s64, 1
    s_call_b64 s[66:67], parallel_sum__compressed_kv_cla__moe_arch_mod__prompt_kernel_addy
parallel_sum__compressed_kv_cla__moe_arch_mod__prompt_kernel_m1:
    s_sub_u32 s45, s58, s47
    s_cmp_lt_u32 s45, 32
    s_cbranch_scc0 parallel_sum__compressed_kv_cla__moe_arch_mod__prompt_kernel_m2
    s_mov_b32 s64, 2
    s_call_b64 s[66:67], parallel_sum__compressed_kv_cla__moe_arch_mod__prompt_kernel_addy
parallel_sum__compressed_kv_cla__moe_arch_mod__prompt_kernel_m2:
    s_sub_u32 s45, s59, s47
    s_cmp_lt_u32 s45, 32
    s_cbranch_scc0 parallel_sum__compressed_kv_cla__moe_arch_mod__prompt_kernel_m3
    s_mov_b32 s64, 3
    s_call_b64 s[66:67], parallel_sum__compressed_kv_cla__moe_arch_mod__prompt_kernel_addy
parallel_sum__compressed_kv_cla__moe_arch_mod__prompt_kernel_m3:
    s_sub_u32 s45, s60, s47
    s_cmp_lt_u32 s45, 32
    s_cbranch_scc0 parallel_sum__compressed_kv_cla__moe_arch_mod__prompt_kernel_m4
    s_mov_b32 s64, 4
    s_call_b64 s[66:67], parallel_sum__compressed_kv_cla__moe_arch_mod__prompt_kernel_addy
parallel_sum__compressed_kv_cla__moe_arch_mod__prompt_kernel_m4:
    s_sub_u32 s45, s61, s47
    s_cmp_lt_u32 s45, 32
    s_cbranch_scc0 parallel_sum__compressed_kv_cla__moe_arch_mod__prompt_kernel_m5
    s_mov_b32 s64, 5
    s_call_b64 s[66:67], parallel_sum__compressed_kv_cla__moe_arch_mod__prompt_kernel_addy
parallel_sum__compressed_kv_cla__moe_arch_mod__prompt_kernel_m5:
    s_sub_u32 s45, s62, s47
    s_cmp_lt_u32 s45, 32
    s_cbranch_scc0 parallel_sum__compressed_kv_cla__moe_arch_mod__prompt_kernel_m6
    s_mov_b32 s64, 6
    s_call_b64 s[66:67], parallel_sum__compressed_kv_cla__moe_arch_mod__prompt_kernel_addy
parallel_sum__compressed_kv_cla__moe_arch_mod__prompt_kernel_m6:
    s_sub_u32 s45, s63, s47
    s_cmp_lt_u32 s45, 32
    s_cbranch_scc0 parallel_sum__compressed_kv_cla__moe_arch_mod__prompt_kernel_m7
    s_mov_b32 s64, 7
    s_call_b64 s[66:67], parallel_sum__compressed_kv_cla__moe_arch_mod__prompt_kernel_addy
parallel_sum__compressed_kv_cla__moe_arch_mod__prompt_kernel_m7:
    buffer_load_dword v149, v150, s[12:15], 0 offen sc1
    s_waitcnt vmcnt(0)
    s_mov_b32 s35, 0x40000
parallel_sum__compressed_kv_cla__moe_arch_mod__prompt_kernel_chk_tile:
    v_xor_b32 v149, s87, v149
    v_cmp_ne_u32 s[84:85], 0, v149
    s_nop 1
    s_cmp_eq_u64 s[84:85], 0
    s_cbranch_scc1 parallel_sum__compressed_kv_cla__moe_arch_mod__prompt_kernel_chk_tile_ok
    s_sub_u32 s35, s35, 1
    s_cbranch_scc1 parallel_sum__compressed_kv_cla__moe_arch_mod__prompt_kernel_chk_tile_ok
    s_sleep 1
    buffer_load_dword v149, v150, s[12:15], 0 offen sc1
    s_waitcnt vmcnt(0)
    s_branch parallel_sum__compressed_kv_cla__moe_arch_mod__prompt_kernel_chk_tile
parallel_sum__compressed_kv_cla__moe_arch_mod__prompt_kernel_chk_tile_ok:
    s_add_u32 s45, s48, s51
    buffer_load_dwordx4 v[8:11], v243, s[12:15], s45 offen sc1
    s_add_u32 s45, s48, s52
    buffer_load_dwordx4 v[12:15], v243, s[12:15], s45 offen sc1
    s_add_u32 s45, s48, s53
    buffer_load_dwordx4 v[16:19], v243, s[12:15], s45 offen sc1
    s_add_u32 s45, s49, s51
    buffer_load_dwordx4 v[40:43], v243, s[12:15], s45 offen sc1
    s_add_u32 s45, s49, s52
    buffer_load_dwordx4 v[44:47], v243, s[12:15], s45 offen sc1
    s_add_u32 s45, s49, s53
    buffer_load_dwordx4 v[48:51], v243, s[12:15], s45 offen sc1
    s_add_u32 s45, s50, s51
    buffer_load_dwordx4 v[72:75], v243, s[12:15], s45 offen sc1
    s_add_u32 s45, s50, s52
    buffer_load_dwordx4 v[76:79], v243, s[12:15], s45 offen sc1
    s_add_u32 s45, s50, s53
    buffer_load_dwordx4 v[80:83], v243, s[12:15], s45 offen sc1
    s_waitcnt lgkmcnt(0)
    v_add_f32 v0, v0, v160
    v_add_f32 v1, v1, v161
    v_add_f32 v2, v2, v162
    v_add_f32 v3, v3, v163
    v_add_f32 v4, v4, v164
    v_add_f32 v5, v5, v165
    v_add_f32 v6, v6, v166
    v_add_f32 v7, v7, v167
    v_add_f32 v32, v32, v168
    v_add_f32 v33, v33, v169
    v_add_f32 v34, v34, v170
    v_add_f32 v35, v35, v171
    v_add_f32 v36, v36, v172
    v_add_f32 v37, v37, v173
    v_add_f32 v38, v38, v174
    v_add_f32 v39, v39, v175
    v_add_f32 v64, v64, v176
    v_add_f32 v65, v65, v177
    v_add_f32 v66, v66, v178
    v_add_f32 v67, v67, v179
    v_add_f32 v68, v68, v180
    v_add_f32 v69, v69, v181
    v_add_f32 v70, v70, v182
    v_add_f32 v71, v71, v183
    s_waitcnt vmcnt(6)
    v_lshlrev_b32 v104, 16, v8
    v_and_b32 v105, 0xffff0000, v8
    v_add_f32 v0, v0, v104
    v_add_f32 v1, v1, v105
    v_lshlrev_b32 v104, 16, v9
    v_and_b32 v105, 0xffff0000, v9
    v_add_f32 v2, v2, v104
    v_add_f32 v3, v3, v105
    v_lshlrev_b32 v104, 16, v10
    v_and_b32 v105, 0xffff0000, v10
    v_add_f32 v4, v4, v104
    v_add_f32 v5, v5, v105
    v_lshlrev_b32 v104, 16, v11
    v_and_b32 v105, 0xffff0000, v11
    v_add_f32 v6, v6, v104
    v_add_f32 v7, v7, v105
    v_lshlrev_b32 v104, 16, v12
    v_and_b32 v105, 0xffff0000, v12
    v_add_f32 v0, v0, v104
    v_add_f32 v1, v1, v105
    v_lshlrev_b32 v104, 16, v13
    v_and_b32 v105, 0xffff0000, v13
    v_add_f32 v2, v2, v104
    v_add_f32 v3, v3, v105
    v_lshlrev_b32 v104, 16, v14
    v_and_b32 v105, 0xffff0000, v14
    v_add_f32 v4, v4, v104
    v_add_f32 v5, v5, v105
    v_lshlrev_b32 v104, 16, v15
    v_and_b32 v105, 0xffff0000, v15
    v_add_f32 v6, v6, v104
    v_add_f32 v7, v7, v105
    v_lshlrev_b32 v104, 16, v16
    v_and_b32 v105, 0xffff0000, v16
    v_add_f32 v0, v0, v104
    v_add_f32 v1, v1, v105
    v_lshlrev_b32 v104, 16, v17
    v_and_b32 v105, 0xffff0000, v17
    v_add_f32 v2, v2, v104
    v_add_f32 v3, v3, v105
    v_lshlrev_b32 v104, 16, v18
    v_and_b32 v105, 0xffff0000, v18
    v_add_f32 v4, v4, v104
    v_add_f32 v5, v5, v105
    v_lshlrev_b32 v104, 16, v19
    v_and_b32 v105, 0xffff0000, v19
    v_add_f32 v6, v6, v104
    v_add_f32 v7, v7, v105
    s_nop 1
    v_permlane32_swap_b32 v0, v4
    v_permlane32_swap_b32 v1, v5
    v_permlane32_swap_b32 v2, v6
    v_permlane32_swap_b32 v3, v7
    v_lshlrev_b32 v104, 16, v208
    v_and_b32 v105, 0xffff0000, v208
    v_add_f32 v0, v0, v104
    v_add_f32 v1, v1, v105
    v_lshlrev_b32 v104, 16, v212
    v_and_b32 v105, 0xffff0000, v212
    v_add_f32 v0, v0, v104
    v_add_f32 v1, v1, v105
    v_lshlrev_b32 v104, 16, v209
    v_and_b32 v105, 0xffff0000, v209
    v_add_f32 v2, v2, v104
    v_add_f32 v3, v3, v105
    v_lshlrev_b32 v104, 16, v213
    v_and_b32 v105, 0xffff0000, v213
    v_add_f32 v2, v2, v104
    v_add_f32 v3, v3, v105
    v_lshlrev_b32 v104, 16, v210
    v_and_b32 v105, 0xffff0000, v210
    v_add_f32 v4, v4, v104
    v_add_f32 v5, v5, v105
    v_lshlrev_b32 v104, 16, v214
    v_and_b32 v105, 0xffff0000, v214
    v_add_f32 v4, v4, v104
    v_add_f32 v5, v5, v105
    v_lshlrev_b32 v104, 16, v211
    v_and_b32 v105, 0xffff0000, v211
    v_add_f32 v6, v6, v104
    v_add_f32 v7, v7, v105
    v_lshlrev_b32 v104, 16, v215
    v_and_b32 v105, 0xffff0000, v215
    v_add_f32 v6, v6, v104
    v_add_f32 v7, v7, v105
    v_cvt_pk_bf16_f32 v8, v0, v1
    v_cvt_pk_bf16_f32 v9, v2, v3
    v_cvt_pk_bf16_f32 v10, v4, v5
    v_cvt_pk_bf16_f32 v11, v6, v7
    buffer_store_dwordx4 v[8:11], v96, s[20:23], s42 offen nt
    s_waitcnt vmcnt(4)
    v_lshlrev_b32 v104, 16, v40
    v_and_b32 v105, 0xffff0000, v40
    v_add_f32 v32, v32, v104
    v_add_f32 v33, v33, v105
    v_lshlrev_b32 v104, 16, v41
    v_and_b32 v105, 0xffff0000, v41
    v_add_f32 v34, v34, v104
    v_add_f32 v35, v35, v105
    v_lshlrev_b32 v104, 16, v42
    v_and_b32 v105, 0xffff0000, v42
    v_add_f32 v36, v36, v104
    v_add_f32 v37, v37, v105
    v_lshlrev_b32 v104, 16, v43
    v_and_b32 v105, 0xffff0000, v43
    v_add_f32 v38, v38, v104
    v_add_f32 v39, v39, v105
    v_lshlrev_b32 v104, 16, v44
    v_and_b32 v105, 0xffff0000, v44
    v_add_f32 v32, v32, v104
    v_add_f32 v33, v33, v105
    v_lshlrev_b32 v104, 16, v45
    v_and_b32 v105, 0xffff0000, v45
    v_add_f32 v34, v34, v104
    v_add_f32 v35, v35, v105
    v_lshlrev_b32 v104, 16, v46
    v_and_b32 v105, 0xffff0000, v46
    v_add_f32 v36, v36, v104
    v_add_f32 v37, v37, v105
    v_lshlrev_b32 v104, 16, v47
    v_and_b32 v105, 0xffff0000, v47
    v_add_f32 v38, v38, v104
    v_add_f32 v39, v39, v105
    v_lshlrev_b32 v104, 16, v48
    v_and_b32 v105, 0xffff0000, v48
    v_add_f32 v32, v32, v104
    v_add_f32 v33, v33, v105
    v_lshlrev_b32 v104, 16, v49
    v_and_b32 v105, 0xffff0000, v49
    v_add_f32 v34, v34, v104
    v_add_f32 v35, v35, v105
    v_lshlrev_b32 v104, 16, v50
    v_and_b32 v105, 0xffff0000, v50
    v_add_f32 v36, v36, v104
    v_add_f32 v37, v37, v105
    v_lshlrev_b32 v104, 16, v51
    v_and_b32 v105, 0xffff0000, v51
    v_add_f32 v38, v38, v104
    v_add_f32 v39, v39, v105
    s_nop 1
    v_permlane32_swap_b32 v32, v36
    v_permlane32_swap_b32 v33, v37
    v_permlane32_swap_b32 v34, v38
    v_permlane32_swap_b32 v35, v39
    v_lshlrev_b32 v104, 16, v216
    v_and_b32 v105, 0xffff0000, v216
    v_add_f32 v32, v32, v104
    v_add_f32 v33, v33, v105
    v_lshlrev_b32 v104, 16, v220
    v_and_b32 v105, 0xffff0000, v220
    v_add_f32 v32, v32, v104
    v_add_f32 v33, v33, v105
    v_lshlrev_b32 v104, 16, v217
    v_and_b32 v105, 0xffff0000, v217
    v_add_f32 v34, v34, v104
    v_add_f32 v35, v35, v105
    v_lshlrev_b32 v104, 16, v221
    v_and_b32 v105, 0xffff0000, v221
    v_add_f32 v34, v34, v104
    v_add_f32 v35, v35, v105
    v_lshlrev_b32 v104, 16, v218
    v_and_b32 v105, 0xffff0000, v218
    v_add_f32 v36, v36, v104
    v_add_f32 v37, v37, v105
    v_lshlrev_b32 v104, 16, v222
    v_and_b32 v105, 0xffff0000, v222
    v_add_f32 v36, v36, v104
    v_add_f32 v37, v37, v105
    v_lshlrev_b32 v104, 16, v219
    v_and_b32 v105, 0xffff0000, v219
    v_add_f32 v38, v38, v104
    v_add_f32 v39, v39, v105
    v_lshlrev_b32 v104, 16, v223
    v_and_b32 v105, 0xffff0000, v223
    v_add_f32 v38, v38, v104
    v_add_f32 v39, v39, v105
    v_cvt_pk_bf16_f32 v40, v32, v33
    v_cvt_pk_bf16_f32 v41, v34, v35
    v_cvt_pk_bf16_f32 v42, v36, v37
    v_cvt_pk_bf16_f32 v43, v38, v39
    buffer_store_dwordx4 v[40:43], v96, s[20:23], s43 offen nt
    s_waitcnt vmcnt(2)
    v_lshlrev_b32 v104, 16, v72
    v_and_b32 v105, 0xffff0000, v72
    v_add_f32 v64, v64, v104
    v_add_f32 v65, v65, v105
    v_lshlrev_b32 v104, 16, v73
    v_and_b32 v105, 0xffff0000, v73
    v_add_f32 v66, v66, v104
    v_add_f32 v67, v67, v105
    v_lshlrev_b32 v104, 16, v74
    v_and_b32 v105, 0xffff0000, v74
    v_add_f32 v68, v68, v104
    v_add_f32 v69, v69, v105
    v_lshlrev_b32 v104, 16, v75
    v_and_b32 v105, 0xffff0000, v75
    v_add_f32 v70, v70, v104
    v_add_f32 v71, v71, v105
    v_lshlrev_b32 v104, 16, v76
    v_and_b32 v105, 0xffff0000, v76
    v_add_f32 v64, v64, v104
    v_add_f32 v65, v65, v105
    v_lshlrev_b32 v104, 16, v77
    v_and_b32 v105, 0xffff0000, v77
    v_add_f32 v66, v66, v104
    v_add_f32 v67, v67, v105
    v_lshlrev_b32 v104, 16, v78
    v_and_b32 v105, 0xffff0000, v78
    v_add_f32 v68, v68, v104
    v_add_f32 v69, v69, v105
    v_lshlrev_b32 v104, 16, v79
    v_and_b32 v105, 0xffff0000, v79
    v_add_f32 v70, v70, v104
    v_add_f32 v71, v71, v105
    v_lshlrev_b32 v104, 16, v80
    v_and_b32 v105, 0xffff0000, v80
    v_add_f32 v64, v64, v104
    v_add_f32 v65, v65, v105
    v_lshlrev_b32 v104, 16, v81
    v_and_b32 v105, 0xffff0000, v81
    v_add_f32 v66, v66, v104
    v_add_f32 v67, v67, v105
    v_lshlrev_b32 v104, 16, v82
    v_and_b32 v105, 0xffff0000, v82
    v_add_f32 v68, v68, v104
    v_add_f32 v69, v69, v105
    v_lshlrev_b32 v104, 16, v83
    v_and_b32 v105, 0xffff0000, v83
    v_add_f32 v70, v70, v104
    v_add_f32 v71, v71, v105
    s_nop 1
    v_permlane32_swap_b32 v64, v68
    v_permlane32_swap_b32 v65, v69
    v_permlane32_swap_b32 v66, v70
    v_permlane32_swap_b32 v67, v71
    v_lshlrev_b32 v104, 16, v224
    v_and_b32 v105, 0xffff0000, v224
    v_add_f32 v64, v64, v104
    v_add_f32 v65, v65, v105
    v_lshlrev_b32 v104, 16, v228
    v_and_b32 v105, 0xffff0000, v228
    v_add_f32 v64, v64, v104
    v_add_f32 v65, v65, v105
    v_lshlrev_b32 v104, 16, v225
    v_and_b32 v105, 0xffff0000, v225
    v_add_f32 v66, v66, v104
    v_add_f32 v67, v67, v105
    v_lshlrev_b32 v104, 16, v229
    v_and_b32 v105, 0xffff0000, v229
    v_add_f32 v66, v66, v104
    v_add_f32 v67, v67, v105
    v_lshlrev_b32 v104, 16, v226
    v_and_b32 v105, 0xffff0000, v226
    v_add_f32 v68, v68, v104
    v_add_f32 v69, v69, v105
    v_lshlrev_b32 v104, 16, v230
    v_and_b32 v105, 0xffff0000, v230
    v_add_f32 v68, v68, v104
    v_add_f32 v69, v69, v105
    v_lshlrev_b32 v104, 16, v227
    v_and_b32 v105, 0xffff0000, v227
    v_add_f32 v70, v70, v104
    v_add_f32 v71, v71, v105
    v_lshlrev_b32 v104, 16, v231
    v_and_b32 v105, 0xffff0000, v231
    v_add_f32 v70, v70, v104
    v_add_f32 v71, v71, v105
    v_cvt_pk_bf16_f32 v72, v64, v65
    v_cvt_pk_bf16_f32 v73, v66, v67
    v_cvt_pk_bf16_f32 v74, v68, v69
    v_cvt_pk_bf16_f32 v75, v70, v71
    buffer_store_dwordx4 v[72:75], v96, s[20:23], s44 offen nt
    s_branch parallel_sum__compressed_kv_cla__moe_arch_mod__prompt_kernel_fin
parallel_sum__compressed_kv_cla__moe_arch_mod__prompt_kernel_addy:
    s_cmp_lg_u32 s33, 0
    s_cbranch_scc1 parallel_sum__compressed_kv_cla__moe_arch_mod__prompt_kernel_addy1
    s_mov_b32 s33, 1
    v_min_u32 v106, 47, v148
    v_lshlrev_b32 v106, 6, v106
    s_mov_b32 s65, 0x7bc000
    buffer_load_dword v107, v106, s[12:15], s65 offen sc1
    s_waitcnt vmcnt(0)
    s_mov_b32 s35, 0x40000
parallel_sum__compressed_kv_cla__moe_arch_mod__prompt_kernel_chk_yf:
    v_xor_b32 v107, s87, v107
    v_cmp_ne_u32 s[84:85], 0, v107
    s_nop 1
    s_cmp_eq_u64 s[84:85], 0
    s_cbranch_scc1 parallel_sum__compressed_kv_cla__moe_arch_mod__prompt_kernel_chk_yf_ok
    s_sub_u32 s35, s35, 1
    s_cbranch_scc1 parallel_sum__compressed_kv_cla__moe_arch_mod__prompt_kernel_chk_yf_ok
    s_sleep 1
    buffer_load_dword v107, v106, s[12:15], s65 offen sc1
    s_waitcnt vmcnt(0)
    s_branch parallel_sum__compressed_kv_cla__moe_arch_mod__prompt_kernel_chk_yf
parallel_sum__compressed_kv_cla__moe_arch_mod__prompt_kernel_chk_yf_ok:
parallel_sum__compressed_kv_cla__moe_arch_mod__prompt_kernel_addy1:
    v_readlane_b32 s54, v241, s64
    v_mul_u32_u24 v108, 0x1556, v148
    v_lshrrev_b32 v108, 16, v108
    v_mul_u32_u24 v109, 12, v108
    v_sub_u32 v109, v148, v109
    v_mul_u32_u24 v110, 18432, v108
    v_lshl_add_u32 v110, v109, 4, v110
    v_mov_b32 v109, 0x40000000
    v_cmp_gt_u32 vcc, 4, v108
    s_mul_i32 s46, s36, 192
    s_mul_i32 s55, s38, 768
    v_cndmask_b32 v110, v109, v110, vcc
    s_add_u32 s55, s55, s46
    s_mul_i32 s46, s64, 2304
    s_add_u32 s55, s55, s46
    s_add_u32 s55, s55, 0x250000
    buffer_load_dwordx4 v[112:115], v110, s[12:15], s55 offen sc1
    s_add_u32 s55, s55, 73728
    buffer_load_dwordx4 v[116:119], v110, s[12:15], s55 offen sc1
    s_add_u32 s55, s55, 73728
    buffer_load_dwordx4 v[120:123], v110, s[12:15], s55 offen sc1
    s_add_u32 s55, s55, 73728
    buffer_load_dwordx4 v[124:127], v110, s[12:15], s55 offen sc1
    s_add_u32 s55, s55, 73728
    buffer_load_dwordx4 v[128:131], v110, s[12:15], s55 offen sc1
    s_add_u32 s55, s55, 73728
    buffer_load_dwordx4 v[132:135], v110, s[12:15], s55 offen sc1
    s_add_u32 s55, s55, 73728
    buffer_load_dwordx4 v[184:187], v110, s[12:15], s55 offen sc1
    s_add_u32 s55, s55, 73728
    buffer_load_dwordx4 v[188:191], v110, s[12:15], s55 offen sc1
    s_add_u32 s55, s55, 73728
    buffer_load_dwordx4 v[192:195], v110, s[12:15], s55 offen sc1
    s_add_u32 s55, s55, 73728
    buffer_load_dwordx4 v[196:199], v110, s[12:15], s55 offen sc1
    s_add_u32 s55, s55, 73728
    buffer_load_dwordx4 v[200:203], v110, s[12:15], s55 offen sc1
    s_add_u32 s55, s55, 73728
    buffer_load_dwordx4 v[204:207], v110, s[12:15], s55 offen sc1
    s_add_u32 s55, s55, 73728
    v_cmp_eq_u32 vcc, s45, v99
    v_mov_b32 v109, s54
    v_lshlrev_b32 v108, 2, v101
    v_cndmask_b32 v109, 0, v109, vcc
    v_add_u32 v110, 96, v148
    v_lshlrev_b32 v106, 2, v148
    s_waitcnt vmcnt(7)
    v_add_f32 v112, v112, v116
    v_add_f32 v113, v113, v117
    v_add_f32 v114, v114, v118
    v_add_f32 v115, v115, v119
    v_add_f32 v112, v112, v120
    v_add_f32 v113, v113, v121
    v_add_f32 v114, v114, v122
    v_add_f32 v115, v115, v123
    v_add_f32 v112, v112, v124
    v_add_f32 v113, v113, v125
    v_add_f32 v114, v114, v126
    v_add_f32 v115, v115, v127
    v_add_f32 v112, v112, v128
    v_add_f32 v113, v113, v129
    v_add_f32 v114, v114, v130
    v_add_f32 v115, v115, v131
    s_waitcnt vmcnt(3)
    v_add_f32 v112, v112, v132
    v_add_f32 v113, v113, v133
    v_add_f32 v114, v114, v134
    v_add_f32 v115, v115, v135
    v_add_f32 v112, v112, v184
    v_add_f32 v113, v113, v185
    v_add_f32 v114, v114, v186
    v_add_f32 v115, v115, v187
    v_add_f32 v112, v112, v188
    v_add_f32 v113, v113, v189
    v_add_f32 v114, v114, v190
    v_add_f32 v115, v115, v191
    v_add_f32 v112, v112, v192
    v_add_f32 v113, v113, v193
    v_add_f32 v114, v114, v194
    v_add_f32 v115, v115, v195
    s_waitcnt vmcnt(0)
    v_add_f32 v112, v112, v196
    v_add_f32 v113, v113, v197
    v_add_f32 v114, v114, v198
    v_add_f32 v115, v115, v199
    v_add_f32 v112, v112, v200
    v_add_f32 v113, v113, v201
    v_add_f32 v114, v114, v202
    v_add_f32 v115, v115, v203
    v_add_f32 v112, v112, v204
    v_add_f32 v113, v113, v205
    v_add_f32 v114, v114, v206
    v_add_f32 v115, v115, v207
    v_add_u32 v110, 96, v106
    ds_bpermute_b32 v116, v110, v112
    ds_bpermute_b32 v117, v110, v113
    ds_bpermute_b32 v118, v110, v114
    ds_bpermute_b32 v119, v110, v115
    s_waitcnt lgkmcnt(0)
    v_add_f32 v112, v112, v116
    v_add_f32 v113, v113, v117
    v_add_f32 v114, v114, v118
    v_add_f32 v115, v115, v119
    v_add_u32 v110, 48, v106
    ds_bpermute_b32 v116, v110, v112
    ds_bpermute_b32 v117, v110, v113
    ds_bpermute_b32 v118, v110, v114
    ds_bpermute_b32 v119, v110, v115
    s_waitcnt lgkmcnt(0)
    v_add_f32 v112, v112, v116
    v_add_f32 v113, v113, v117
    v_add_f32 v114, v114, v118
    v_add_f32 v115, v115, v119
    v_add_u32 v110, 0, v108
    ds_bpermute_b32 v184, v110, v112
    ds_bpermute_b32 v185, v110, v113
    ds_bpermute_b32 v186, v110, v114
    ds_bpermute_b32 v187, v110, v115
    v_add_u32 v110, 8, v108
    ds_bpermute_b32 v188, v110, v112
    ds_bpermute_b32 v189, v110, v113
    ds_bpermute_b32 v190, v110, v114
    ds_bpermute_b32 v191, v110, v115
    v_add_u32 v110, 16, v108
    ds_bpermute_b32 v192, v110, v112
    ds_bpermute_b32 v193, v110, v113
    ds_bpermute_b32 v194, v110, v114
    ds_bpermute_b32 v195, v110, v115
    s_waitcnt lgkmcnt(0)
    v_add_u32 v110, 24, v108
    ds_bpermute_b32 v196, v110, v112
    ds_bpermute_b32 v197, v110, v113
    ds_bpermute_b32 v198, v110, v114
    ds_bpermute_b32 v199, v110, v115
    v_add_u32 v110, 32, v108
    ds_bpermute_b32 v200, v110, v112
    ds_bpermute_b32 v201, v110, v113
    ds_bpermute_b32 v202, v110, v114
    ds_bpermute_b32 v203, v110, v115
    v_add_u32 v110, 40, v108
    ds_bpermute_b32 v204, v110, v112
    ds_bpermute_b32 v205, v110, v113
    ds_bpermute_b32 v206, v110, v114
    ds_bpermute_b32 v207, v110, v115
    s_waitcnt lgkmcnt(0)
    v_fmac_f32 v160, v184, v109
    v_fmac_f32 v161, v185, v109
    v_fmac_f32 v162, v186, v109
    v_fmac_f32 v163, v187, v109
    v_fmac_f32 v164, v188, v109
    v_fmac_f32 v165, v189, v109
    v_fmac_f32 v166, v190, v109
    v_fmac_f32 v167, v191, v109
    v_fmac_f32 v168, v192, v109
    v_fmac_f32 v169, v193, v109
    v_fmac_f32 v170, v194, v109
    v_fmac_f32 v171, v195, v109
    v_fmac_f32 v172, v196, v109
    v_fmac_f32 v173, v197, v109
    v_fmac_f32 v174, v198, v109
    v_fmac_f32 v175, v199, v109
    v_fmac_f32 v176, v200, v109
    v_fmac_f32 v177, v201, v109
    v_fmac_f32 v178, v202, v109
    v_fmac_f32 v179, v203, v109
    v_fmac_f32 v180, v204, v109
    v_fmac_f32 v181, v205, v109
    v_fmac_f32 v182, v206, v109
    v_fmac_f32 v183, v207, v109
    s_setpc_b64 s[66:67]
parallel_sum__compressed_kv_cla__moe_arch_mod__prompt_kernel_fin:
    s_branch parallel_sum__compressed_kv_cla__moe_arch_mod__prompt_kernel_p3end
parallel_sum__compressed_kv_cla__moe_arch_mod__prompt_kernel_p3moe:
    s_sub_u32 s44, s2, 128
    s_mov_b32 s72, s28
    s_mov_b32 s73, s29
    s_mov_b32 s74, 0x510000
    s_mov_b32 s75, 0x20000
    s_mov_b32 s76, s30
    s_mov_b32 s77, s31
    s_mov_b32 s78, 0x510000
    s_mov_b32 s79, 0x20000
    s_barrier
    s_add_u32 s45, s68, 128
    s_add_u32 m0, s69, 73728
    s_nop 0
    buffer_load_dwordx4 v4, s[72:75], s45 offen lds
    s_add_u32 m0, s69, 110592
    s_nop 0
    buffer_load_dwordx4 v4, s[76:79], s45 offen lds
    s_add_u32 s45, s68, 147584
    s_add_u32 m0, s69, 74752
    s_nop 0
    buffer_load_dwordx4 v4, s[72:75], s45 offen lds
    s_add_u32 m0, s69, 111616
    s_nop 0
    buffer_load_dwordx4 v4, s[76:79], s45 offen lds
    s_add_u32 s45, s68, 295040
    s_add_u32 m0, s69, 75776
    s_nop 0
    buffer_load_dwordx4 v4, s[72:75], s45 offen lds
    s_add_u32 m0, s69, 112640
    s_nop 0
    buffer_load_dwordx4 v4, s[76:79], s45 offen lds
    s_add_u32 s45, s68, 442496
    s_add_u32 m0, s69, 76800
    s_nop 0
    buffer_load_dwordx4 v4, s[72:75], s45 offen lds
    s_add_u32 m0, s69, 113664
    s_nop 0
    buffer_load_dwordx4 v4, s[76:79], s45 offen lds
    s_add_u32 s45, s68, 589952
    s_add_u32 m0, s69, 77824
    s_nop 0
    buffer_load_dwordx4 v4, s[72:75], s45 offen lds
    s_add_u32 m0, s69, 114688
    s_nop 0
    buffer_load_dwordx4 v4, s[76:79], s45 offen lds
    s_add_u32 s45, s68, 737408
    s_add_u32 m0, s69, 78848
    s_nop 0
    buffer_load_dwordx4 v4, s[72:75], s45 offen lds
    s_add_u32 m0, s69, 115712
    s_nop 0
    buffer_load_dwordx4 v4, s[76:79], s45 offen lds
    s_add_u32 s45, s68, 884864
    s_add_u32 m0, s69, 79872
    s_nop 0
    buffer_load_dwordx4 v4, s[72:75], s45 offen lds
    s_add_u32 m0, s69, 116736
    s_nop 0
    buffer_load_dwordx4 v4, s[76:79], s45 offen lds
    s_add_u32 s45, s68, 1032320
    s_add_u32 m0, s69, 80896
    s_nop 0
    buffer_load_dwordx4 v4, s[72:75], s45 offen lds
    s_add_u32 m0, s69, 117760
    s_nop 0
    buffer_load_dwordx4 v4, s[76:79], s45 offen lds
    s_add_u32 s45, s68, 1179776
    s_add_u32 m0, s69, 81920
    s_nop 0
    buffer_load_dwordx4 v4, s[72:75], s45 offen lds
    s_add_u32 m0, s69, 118784
    s_nop 0
    buffer_load_dwordx4 v4, s[76:79], s45 offen lds
    v_add_u32 v25, s69, v243
    ds_write_b128 v25, v[60:63] offset:0
    ds_write_b128 v25, v[64:67] offset:36864
    ds_write_b128 v25, v[68:71] offset:1024
    ds_write_b128 v25, v[72:75] offset:37888
    ds_write_b128 v25, v[76:79] offset:2048
    ds_write_b128 v25, v[80:83] offset:38912
    ds_write_b128 v25, v[84:87] offset:3072
    ds_write_b128 v25, v[88:91] offset:39936
    s_waitcnt lgkmcnt(6)
    ds_write_b128 v25, v[92:95] offset:4096
    ds_write_b128 v25, v[96:99] offset:40960
    ds_write_b128 v25, v[100:103] offset:5120
    ds_write_b128 v25, v[104:107] offset:41984
    ds_write_b128 v25, v[108:111] offset:6144
    ds_write_b128 v25, v[112:115] offset:43008
    ds_write_b128 v25, v[116:119] offset:7168
    ds_write_b128 v25, v[120:123] offset:44032
    s_waitcnt lgkmcnt(6)
    ds_write_b128 v25, v[124:127] offset:8192
    ds_write_b128 v25, v[128:131] offset:45056
    v_bfe_u32 v16, v2, 2, 2
    v_lshl_add_u32 v17, v15, 3, v16
    v_lshlrev_b32 v17, 6, v17
    v_bfe_u32 v18, v2, 4, 1
    v_lshlrev_b32 v18, 5, v18
    v_and_b32 v19, 3, v2
    v_lshl_add_u32 v18, v19, 3, v18
    v_add3_u32 v17, v17, v18, s69
    v_add_u32 v22, 73728, v17
    v_lshl_add_u32 v19, v15, 2, v16
    v_mul_u32_u24 v19, 1152, v19
    s_lshl_b32 s45, s36, 6
    v_add3_u32 v19, v19, v18, s45
    v_add_u32 v23, 55296, v19
    v_lshl_add_u32 v20, v15, 3, v11
    v_lshlrev_b32 v20, 4, v20
    s_add_u32 s45, s69, 110592
    v_add_u32 v21, s45, v20
    s_mul_i32 s46, s36, 768
    s_add_u32 s46, s46, 110592
    v_add_u32 v24, s46, v20
    s_waitcnt lgkmcnt(0)
    ds_read_b64_tr_b16 v[40:41], v17 offset:0
    ds_read_b64_tr_b16 v[42:43], v17 offset:256
    ds_read_b64_tr_b16 v[44:45], v17 offset:36864
    ds_read_b64_tr_b16 v[46:47], v17 offset:37120
    ds_read_b64_tr_b16 v[48:49], v17 offset:1024
    ds_read_b64_tr_b16 v[50:51], v17 offset:1280
    ds_read_b64_tr_b16 v[52:53], v17 offset:37888
    ds_read_b64_tr_b16 v[54:55], v17 offset:38144
    s_waitcnt lgkmcnt(4)
    v_mfma_f32_32x32x16_bf16 v[60:75], v[40:43], v[204:207], 0
    v_mfma_f32_32x32x16_bf16 v[108:123], v[44:47], v[204:207], 0
    ds_read_b64_tr_b16 v[40:41], v17 offset:2048
    ds_read_b64_tr_b16 v[42:43], v17 offset:2304
    ds_read_b64_tr_b16 v[44:45], v17 offset:38912
    ds_read_b64_tr_b16 v[46:47], v17 offset:39168
    s_waitcnt lgkmcnt(4)
    v_mfma_f32_32x32x16_bf16 v[60:75], v[48:51], v[208:211], v[60:75]
    v_mfma_f32_32x32x16_bf16 v[108:123], v[52:55], v[208:211], v[108:123]
    ds_read_b64_tr_b16 v[48:49], v17 offset:3072
    ds_read_b64_tr_b16 v[50:51], v17 offset:3328
    ds_read_b64_tr_b16 v[52:53], v17 offset:39936
    ds_read_b64_tr_b16 v[54:55], v17 offset:40192
    s_waitcnt lgkmcnt(4)
    v_mfma_f32_32x32x16_bf16 v[60:75], v[40:43], v[212:215], v[60:75]
    v_mfma_f32_32x32x16_bf16 v[108:123], v[44:47], v[212:215], v[108:123]
    ds_read_b64_tr_b16 v[40:41], v17 offset:4096
    ds_read_b64_tr_b16 v[42:43], v17 offset:4352
    ds_read_b64_tr_b16 v[44:45], v17 offset:40960
    ds_read_b64_tr_b16 v[46:47], v17 offset:41216
    s_waitcnt lgkmcnt(4)
    v_mfma_f32_32x32x16_bf16 v[60:75], v[48:51], v[216:219], v[60:75]
    v_mfma_f32_32x32x16_bf16 v[108:123], v[52:55], v[216:219], v[108:123]
    ds_read_b64_tr_b16 v[48:49], v17 offset:5120
    ds_read_b64_tr_b16 v[50:51], v17 offset:5376
    ds_read_b64_tr_b16 v[52:53], v17 offset:41984
    ds_read_b64_tr_b16 v[54:55], v17 offset:42240
    s_waitcnt lgkmcnt(4)
    v_mfma_f32_32x32x16_bf16 v[60:75], v[40:43], v[220:223], v[60:75]
    v_mfma_f32_32x32x16_bf16 v[108:123], v[44:47], v[220:223], v[108:123]
    ds_read_b64_tr_b16 v[40:41], v17 offset:6144
    ds_read_b64_tr_b16 v[42:43], v17 offset:6400
    ds_read_b64_tr_b16 v[44:45], v17 offset:43008
    ds_read_b64_tr_b16 v[46:47], v17 offset:43264
    s_waitcnt lgkmcnt(4)
    v_mfma_f32_32x32x16_bf16 v[60:75], v[48:51], v[224:227], v[60:75]
    v_mfma_f32_32x32x16_bf16 v[108:123], v[52:55], v[224:227], v[108:123]
    ds_read_b64_tr_b16 v[48:49], v17 offset:7168
    ds_read_b64_tr_b16 v[50:51], v17 offset:7424
    ds_read_b64_tr_b16 v[52:53], v17 offset:44032
    ds_read_b64_tr_b16 v[54:55], v17 offset:44288
    s_waitcnt lgkmcnt(4)
    v_mfma_f32_32x32x16_bf16 v[60:75], v[40:43], v[228:231], v[60:75]
    v_mfma_f32_32x32x16_bf16 v[108:123], v[44:47], v[228:231], v[108:123]
    ds_read_b64_tr_b16 v[40:41], v17 offset:8192
    ds_read_b64_tr_b16 v[42:43], v17 offset:8448
    ds_read_b64_tr_b16 v[44:45], v17 offset:45056
    ds_read_b64_tr_b16 v[46:47], v17 offset:45312
    s_waitcnt lgkmcnt(4)
    v_mfma_f32_32x32x16_bf16 v[60:75], v[48:51], v[232:235], v[60:75]
    v_mfma_f32_32x32x16_bf16 v[108:123], v[52:55], v[232:235], v[108:123]
    s_waitcnt lgkmcnt(0)
    v_mfma_f32_32x32x16_bf16 v[60:75], v[40:43], v[236:239], v[60:75]
    v_mfma_f32_32x32x16_bf16 v[108:123], v[44:47], v[236:239], v[108:123]
    ds_write_b128 v25, v[132:135] offset:0
    ds_write_b128 v25, v[136:139] offset:36864
    ds_write_b128 v25, v[140:143] offset:1024
    ds_write_b128 v25, v[144:147] offset:37888
    ds_write_b128 v25, v[148:151] offset:2048
    ds_write_b128 v25, v[152:155] offset:38912
    ds_write_b128 v25, v[156:159] offset:3072
    ds_write_b128 v25, v[160:163] offset:39936
    s_waitcnt lgkmcnt(6)
    ds_write_b128 v25, v[164:167] offset:4096
    ds_write_b128 v25, v[168:171] offset:40960
    ds_write_b128 v25, v[172:175] offset:5120
    ds_write_b128 v25, v[176:179] offset:41984
    ds_write_b128 v25, v[180:183] offset:6144
    ds_write_b128 v25, v[184:187] offset:43008
    ds_write_b128 v25, v[188:191] offset:7168
    ds_write_b128 v25, v[192:195] offset:44032
    s_waitcnt lgkmcnt(6)
    ds_write_b128 v25, v[196:199] offset:8192
    ds_write_b128 v25, v[200:203] offset:45056
    s_waitcnt lgkmcnt(0)
    ds_read_b64_tr_b16 v[40:41], v17 offset:0
    ds_read_b64_tr_b16 v[42:43], v17 offset:256
    ds_read_b64_tr_b16 v[44:45], v17 offset:36864
    ds_read_b64_tr_b16 v[46:47], v17 offset:37120
    ds_read_b64_tr_b16 v[48:49], v17 offset:1024
    ds_read_b64_tr_b16 v[50:51], v17 offset:1280
    ds_read_b64_tr_b16 v[52:53], v17 offset:37888
    ds_read_b64_tr_b16 v[54:55], v17 offset:38144
    s_waitcnt lgkmcnt(4)
    v_mfma_f32_32x32x16_bf16 v[76:91], v[40:43], v[204:207], 0
    v_mfma_f32_32x32x16_bf16 v[124:139], v[44:47], v[204:207], 0
    ds_read_b64_tr_b16 v[40:41], v17 offset:2048
    ds_read_b64_tr_b16 v[42:43], v17 offset:2304
    ds_read_b64_tr_b16 v[44:45], v17 offset:38912
    ds_read_b64_tr_b16 v[46:47], v17 offset:39168
    s_waitcnt lgkmcnt(4)
    v_mfma_f32_32x32x16_bf16 v[76:91], v[48:51], v[208:211], v[76:91]
    v_mfma_f32_32x32x16_bf16 v[124:139], v[52:55], v[208:211], v[124:139]
    ds_read_b64_tr_b16 v[48:49], v17 offset:3072
    ds_read_b64_tr_b16 v[50:51], v17 offset:3328
    ds_read_b64_tr_b16 v[52:53], v17 offset:39936
    ds_read_b64_tr_b16 v[54:55], v17 offset:40192
    s_waitcnt lgkmcnt(4)
    v_mfma_f32_32x32x16_bf16 v[76:91], v[40:43], v[212:215], v[76:91]
    v_mfma_f32_32x32x16_bf16 v[124:139], v[44:47], v[212:215], v[124:139]
    ds_read_b64_tr_b16 v[40:41], v17 offset:4096
    ds_read_b64_tr_b16 v[42:43], v17 offset:4352
    ds_read_b64_tr_b16 v[44:45], v17 offset:40960
    ds_read_b64_tr_b16 v[46:47], v17 offset:41216
    s_waitcnt lgkmcnt(4)
    v_mfma_f32_32x32x16_bf16 v[76:91], v[48:51], v[216:219], v[76:91]
    v_mfma_f32_32x32x16_bf16 v[124:139], v[52:55], v[216:219], v[124:139]
    ds_read_b64_tr_b16 v[48:49], v17 offset:5120
    ds_read_b64_tr_b16 v[50:51], v17 offset:5376
    ds_read_b64_tr_b16 v[52:53], v17 offset:41984
    ds_read_b64_tr_b16 v[54:55], v17 offset:42240
    s_waitcnt lgkmcnt(4)
    v_mfma_f32_32x32x16_bf16 v[76:91], v[40:43], v[220:223], v[76:91]
    v_mfma_f32_32x32x16_bf16 v[124:139], v[44:47], v[220:223], v[124:139]
    ds_read_b64_tr_b16 v[40:41], v17 offset:6144
    ds_read_b64_tr_b16 v[42:43], v17 offset:6400
    ds_read_b64_tr_b16 v[44:45], v17 offset:43008
    ds_read_b64_tr_b16 v[46:47], v17 offset:43264
    s_waitcnt lgkmcnt(4)
    v_mfma_f32_32x32x16_bf16 v[76:91], v[48:51], v[224:227], v[76:91]
    v_mfma_f32_32x32x16_bf16 v[124:139], v[52:55], v[224:227], v[124:139]
    ds_read_b64_tr_b16 v[48:49], v17 offset:7168
    ds_read_b64_tr_b16 v[50:51], v17 offset:7424
    ds_read_b64_tr_b16 v[52:53], v17 offset:44032
    ds_read_b64_tr_b16 v[54:55], v17 offset:44288
    s_waitcnt lgkmcnt(4)
    v_mfma_f32_32x32x16_bf16 v[76:91], v[40:43], v[228:231], v[76:91]
    v_mfma_f32_32x32x16_bf16 v[124:139], v[44:47], v[228:231], v[124:139]
    ds_read_b64_tr_b16 v[40:41], v17 offset:8192
    ds_read_b64_tr_b16 v[42:43], v17 offset:8448
    ds_read_b64_tr_b16 v[44:45], v17 offset:45056
    ds_read_b64_tr_b16 v[46:47], v17 offset:45312
    s_waitcnt lgkmcnt(4)
    v_mfma_f32_32x32x16_bf16 v[76:91], v[48:51], v[232:235], v[76:91]
    v_mfma_f32_32x32x16_bf16 v[124:139], v[52:55], v[232:235], v[124:139]
    s_waitcnt lgkmcnt(0)
    v_mfma_f32_32x32x16_bf16 v[76:91], v[40:43], v[236:239], v[76:91]
    v_mfma_f32_32x32x16_bf16 v[124:139], v[44:47], v[236:239], v[124:139]
    s_waitcnt vmcnt(0)
    s_waitcnt lgkmcnt(0)
    ds_read_b64_tr_b16 v[40:41], v22 offset:0
    ds_read_b64_tr_b16 v[42:43], v22 offset:256
    ds_read_b64_tr_b16 v[44:45], v22 offset:36864
    ds_read_b64_tr_b16 v[46:47], v22 offset:37120
    ds_read_b64_tr_b16 v[48:49], v22 offset:1024
    ds_read_b64_tr_b16 v[50:51], v22 offset:1280
    ds_read_b64_tr_b16 v[52:53], v22 offset:37888
    ds_read_b64_tr_b16 v[54:55], v22 offset:38144
    s_waitcnt lgkmcnt(4)
    v_mfma_f32_32x32x16_bf16 v[92:107], v[40:43], v[204:207], 0
    v_mfma_f32_32x32x16_bf16 v[140:155], v[44:47], v[204:207], 0
    ds_read_b64_tr_b16 v[40:41], v22 offset:2048
    ds_read_b64_tr_b16 v[42:43], v22 offset:2304
    ds_read_b64_tr_b16 v[44:45], v22 offset:38912
    ds_read_b64_tr_b16 v[46:47], v22 offset:39168
    s_waitcnt lgkmcnt(4)
    v_mfma_f32_32x32x16_bf16 v[92:107], v[48:51], v[208:211], v[92:107]
    v_mfma_f32_32x32x16_bf16 v[140:155], v[52:55], v[208:211], v[140:155]
    ds_read_b64_tr_b16 v[48:49], v22 offset:3072
    ds_read_b64_tr_b16 v[50:51], v22 offset:3328
    ds_read_b64_tr_b16 v[52:53], v22 offset:39936
    ds_read_b64_tr_b16 v[54:55], v22 offset:40192
    s_waitcnt lgkmcnt(4)
    v_mfma_f32_32x32x16_bf16 v[92:107], v[40:43], v[212:215], v[92:107]
    v_mfma_f32_32x32x16_bf16 v[140:155], v[44:47], v[212:215], v[140:155]
    ds_read_b64_tr_b16 v[40:41], v22 offset:4096
    ds_read_b64_tr_b16 v[42:43], v22 offset:4352
    ds_read_b64_tr_b16 v[44:45], v22 offset:40960
    ds_read_b64_tr_b16 v[46:47], v22 offset:41216
    s_waitcnt lgkmcnt(4)
    v_mfma_f32_32x32x16_bf16 v[92:107], v[48:51], v[216:219], v[92:107]
    v_mfma_f32_32x32x16_bf16 v[140:155], v[52:55], v[216:219], v[140:155]
    ds_read_b64_tr_b16 v[48:49], v22 offset:5120
    ds_read_b64_tr_b16 v[50:51], v22 offset:5376
    ds_read_b64_tr_b16 v[52:53], v22 offset:41984
    ds_read_b64_tr_b16 v[54:55], v22 offset:42240
    s_waitcnt lgkmcnt(4)
    v_mfma_f32_32x32x16_bf16 v[92:107], v[40:43], v[220:223], v[92:107]
    v_mfma_f32_32x32x16_bf16 v[140:155], v[44:47], v[220:223], v[140:155]
    ds_read_b64_tr_b16 v[40:41], v22 offset:6144
    ds_read_b64_tr_b16 v[42:43], v22 offset:6400
    ds_read_b64_tr_b16 v[44:45], v22 offset:43008
    ds_read_b64_tr_b16 v[46:47], v22 offset:43264
    s_waitcnt lgkmcnt(4)
    v_mfma_f32_32x32x16_bf16 v[92:107], v[48:51], v[224:227], v[92:107]
    v_mfma_f32_32x32x16_bf16 v[140:155], v[52:55], v[224:227], v[140:155]
    ds_read_b64_tr_b16 v[48:49], v22 offset:7168
    ds_read_b64_tr_b16 v[50:51], v22 offset:7424
    ds_read_b64_tr_b16 v[52:53], v22 offset:44032
    ds_read_b64_tr_b16 v[54:55], v22 offset:44288
    s_waitcnt lgkmcnt(4)
    v_mfma_f32_32x32x16_bf16 v[92:107], v[40:43], v[228:231], v[92:107]
    v_mfma_f32_32x32x16_bf16 v[140:155], v[44:47], v[228:231], v[140:155]
    ds_read_b64_tr_b16 v[40:41], v22 offset:8192
    ds_read_b64_tr_b16 v[42:43], v22 offset:8448
    ds_read_b64_tr_b16 v[44:45], v22 offset:45056
    ds_read_b64_tr_b16 v[46:47], v22 offset:45312
    s_waitcnt lgkmcnt(4)
    v_mfma_f32_32x32x16_bf16 v[92:107], v[48:51], v[232:235], v[92:107]
    v_mfma_f32_32x32x16_bf16 v[140:155], v[52:55], v[232:235], v[140:155]
    s_waitcnt lgkmcnt(0)
    v_mfma_f32_32x32x16_bf16 v[92:107], v[40:43], v[236:239], v[92:107]
    v_mfma_f32_32x32x16_bf16 v[140:155], v[44:47], v[236:239], v[140:155]
    v_and_b32 v26, 31, v2
    v_cmp_gt_u32 vcc, 8, v26
    s_nop 15
    s_mov_b64 exec, vcc
    ds_write_b128 v21, v[60:63] offset:0
    ds_write_b128 v21, v[64:67] offset:256
    ds_write_b128 v21, v[68:71] offset:512
    ds_write_b128 v21, v[72:75] offset:768
    ds_write_b128 v21, v[76:79] offset:1024
    ds_write_b128 v21, v[80:83] offset:1280
    ds_write_b128 v21, v[84:87] offset:1536
    ds_write_b128 v21, v[88:91] offset:1792
    s_waitcnt lgkmcnt(4)
    ds_write_b128 v21, v[92:95] offset:2048
    ds_write_b128 v21, v[96:99] offset:2304
    ds_write_b128 v21, v[100:103] offset:2560
    ds_write_b128 v21, v[104:107] offset:2816
    ds_write_b128 v21, v[108:111] offset:3072
    ds_write_b128 v21, v[112:115] offset:3328
    ds_write_b128 v21, v[116:119] offset:3584
    ds_write_b128 v21, v[120:123] offset:3840
    s_waitcnt lgkmcnt(4)
    ds_write_b128 v21, v[124:127] offset:4096
    ds_write_b128 v21, v[128:131] offset:4352
    ds_write_b128 v21, v[132:135] offset:4608
    ds_write_b128 v21, v[136:139] offset:4864
    ds_write_b128 v21, v[140:143] offset:5120
    ds_write_b128 v21, v[144:147] offset:5376
    ds_write_b128 v21, v[148:151] offset:5632
    ds_write_b128 v21, v[152:155] offset:5888
    s_mov_b64 exec, -1
    s_waitcnt lgkmcnt(0)
    s_barrier
    ds_read_b128 v[60:63], v24 offset:0
    ds_read_b128 v[64:67], v24 offset:256
    ds_read_b128 v[68:71], v24 offset:512
    ds_read_b128 v[72:75], v24 offset:3072
    ds_read_b128 v[76:79], v24 offset:3328
    ds_read_b128 v[80:83], v24 offset:3584
    ds_read_b128 v[84:87], v24 offset:9216
    ds_read_b128 v[88:91], v24 offset:9472
    ds_read_b128 v[92:95], v24 offset:9728
    ds_read_b128 v[96:99], v24 offset:12288
    ds_read_b128 v[100:103], v24 offset:12544
    ds_read_b128 v[104:107], v24 offset:12800
    s_waitcnt lgkmcnt(3)
    ds_read_b128 v[108:111], v24 offset:18432
    ds_read_b128 v[112:115], v24 offset:18688
    ds_read_b128 v[116:119], v24 offset:18944
    ds_read_b128 v[120:123], v24 offset:21504
    ds_read_b128 v[124:127], v24 offset:21760
    ds_read_b128 v[128:131], v24 offset:22016
    ds_read_b128 v[132:135], v24 offset:27648
    ds_read_b128 v[136:139], v24 offset:27904
    ds_read_b128 v[140:143], v24 offset:28160
    ds_read_b128 v[144:147], v24 offset:30720
    ds_read_b128 v[148:151], v24 offset:30976
    ds_read_b128 v[152:155], v24 offset:31232
    s_waitcnt lgkmcnt(0)
    v_add_f32 v60, v60, v84
    v_add_f32 v61, v61, v85
    v_add_f32 v62, v62, v86
    v_add_f32 v63, v63, v87
    v_add_f32 v64, v64, v88
    v_add_f32 v65, v65, v89
    v_add_f32 v66, v66, v90
    v_add_f32 v67, v67, v91
    v_add_f32 v68, v68, v92
    v_add_f32 v69, v69, v93
    v_add_f32 v70, v70, v94
    v_add_f32 v71, v71, v95
    v_add_f32 v72, v72, v96
    v_add_f32 v73, v73, v97
    v_add_f32 v74, v74, v98
    v_add_f32 v75, v75, v99
    v_add_f32 v76, v76, v100
    v_add_f32 v77, v77, v101
    v_add_f32 v78, v78, v102
    v_add_f32 v79, v79, v103
    v_add_f32 v80, v80, v104
    v_add_f32 v81, v81, v105
    v_add_f32 v82, v82, v106
    v_add_f32 v83, v83, v107
    v_add_f32 v60, v60, v108
    v_add_f32 v61, v61, v109
    v_add_f32 v62, v62, v110
    v_add_f32 v63, v63, v111
    v_add_f32 v64, v64, v112
    v_add_f32 v65, v65, v113
    v_add_f32 v66, v66, v114
    v_add_f32 v67, v67, v115
    v_add_f32 v68, v68, v116
    v_add_f32 v69, v69, v117
    v_add_f32 v70, v70, v118
    v_add_f32 v71, v71, v119
    v_add_f32 v72, v72, v120
    v_add_f32 v73, v73, v121
    v_add_f32 v74, v74, v122
    v_add_f32 v75, v75, v123
    v_add_f32 v76, v76, v124
    v_add_f32 v77, v77, v125
    v_add_f32 v78, v78, v126
    v_add_f32 v79, v79, v127
    v_add_f32 v80, v80, v128
    v_add_f32 v81, v81, v129
    v_add_f32 v82, v82, v130
    v_add_f32 v83, v83, v131
    v_add_f32 v60, v60, v132
    v_add_f32 v61, v61, v133
    v_add_f32 v62, v62, v134
    v_add_f32 v63, v63, v135
    v_add_f32 v64, v64, v136
    v_add_f32 v65, v65, v137
    v_add_f32 v66, v66, v138
    v_add_f32 v67, v67, v139
    v_add_f32 v68, v68, v140
    v_add_f32 v69, v69, v141
    v_add_f32 v70, v70, v142
    v_add_f32 v71, v71, v143
    v_add_f32 v72, v72, v144
    v_add_f32 v73, v73, v145
    v_add_f32 v74, v74, v146
    v_add_f32 v75, v75, v147
    v_add_f32 v76, v76, v148
    v_add_f32 v77, v77, v149
    v_add_f32 v78, v78, v150
    v_add_f32 v79, v79, v151
    v_add_f32 v80, v80, v152
    v_add_f32 v81, v81, v153
    v_add_f32 v82, v82, v154
    v_add_f32 v83, v83, v155
    v_cvt_pk_bf16_f32 v26, v60, v61
    v_cvt_pk_bf16_f32 v27, v72, v73
    v_lshlrev_b32 v28, 16, v26
    v_and_b32 v29, 0xffff0000, v26
    v_mul_f32 v30, 0xbfb8aa3b, v28
    v_mul_f32 v31, 0xbfb8aa3b, v29
    v_exp_f32 v30, v30
    v_exp_f32 v31, v31
    v_add_f32 v30, 1.0, v30
    v_add_f32 v31, 1.0, v31
    v_rcp_f32 v30, v30
    v_rcp_f32 v31, v31
    v_mul_f32 v28, v28, v30
    v_mul_f32 v29, v29, v31
    v_cvt_pk_bf16_f32 v26, v28, v29
    v_lshlrev_b32 v30, 16, v27
    v_and_b32 v31, 0xffff0000, v27
    v_lshlrev_b32 v28, 16, v26
    v_and_b32 v29, 0xffff0000, v26
    v_mul_f32 v28, v28, v30
    v_mul_f32 v29, v29, v31
    v_cvt_pk_bf16_f32 v32, v28, v29
    v_cvt_pk_bf16_f32 v26, v62, v63
    v_cvt_pk_bf16_f32 v27, v74, v75
    v_lshlrev_b32 v28, 16, v26
    v_and_b32 v29, 0xffff0000, v26
    v_mul_f32 v30, 0xbfb8aa3b, v28
    v_mul_f32 v31, 0xbfb8aa3b, v29
    v_exp_f32 v30, v30
    v_exp_f32 v31, v31
    v_add_f32 v30, 1.0, v30
    v_add_f32 v31, 1.0, v31
    v_rcp_f32 v30, v30
    v_rcp_f32 v31, v31
    v_mul_f32 v28, v28, v30
    v_mul_f32 v29, v29, v31
    v_cvt_pk_bf16_f32 v26, v28, v29
    v_lshlrev_b32 v30, 16, v27
    v_and_b32 v31, 0xffff0000, v27
    v_lshlrev_b32 v28, 16, v26
    v_and_b32 v29, 0xffff0000, v26
    v_mul_f32 v28, v28, v30
    v_mul_f32 v29, v29, v31
    v_cvt_pk_bf16_f32 v33, v28, v29
    v_cvt_pk_bf16_f32 v26, v64, v65
    v_cvt_pk_bf16_f32 v27, v76, v77
    v_lshlrev_b32 v28, 16, v26
    v_and_b32 v29, 0xffff0000, v26
    v_mul_f32 v30, 0xbfb8aa3b, v28
    v_mul_f32 v31, 0xbfb8aa3b, v29
    v_exp_f32 v30, v30
    v_exp_f32 v31, v31
    v_add_f32 v30, 1.0, v30
    v_add_f32 v31, 1.0, v31
    v_rcp_f32 v30, v30
    v_rcp_f32 v31, v31
    v_mul_f32 v28, v28, v30
    v_mul_f32 v29, v29, v31
    v_cvt_pk_bf16_f32 v26, v28, v29
    v_lshlrev_b32 v30, 16, v27
    v_and_b32 v31, 0xffff0000, v27
    v_lshlrev_b32 v28, 16, v26
    v_and_b32 v29, 0xffff0000, v26
    v_mul_f32 v28, v28, v30
    v_mul_f32 v29, v29, v31
    v_cvt_pk_bf16_f32 v34, v28, v29
    v_cvt_pk_bf16_f32 v26, v66, v67
    v_cvt_pk_bf16_f32 v27, v78, v79
    v_lshlrev_b32 v28, 16, v26
    v_and_b32 v29, 0xffff0000, v26
    v_mul_f32 v30, 0xbfb8aa3b, v28
    v_mul_f32 v31, 0xbfb8aa3b, v29
    v_exp_f32 v30, v30
    v_exp_f32 v31, v31
    v_add_f32 v30, 1.0, v30
    v_add_f32 v31, 1.0, v31
    v_rcp_f32 v30, v30
    v_rcp_f32 v31, v31
    v_mul_f32 v28, v28, v30
    v_mul_f32 v29, v29, v31
    v_cvt_pk_bf16_f32 v26, v28, v29
    v_lshlrev_b32 v30, 16, v27
    v_and_b32 v31, 0xffff0000, v27
    v_lshlrev_b32 v28, 16, v26
    v_and_b32 v29, 0xffff0000, v26
    v_mul_f32 v28, v28, v30
    v_mul_f32 v29, v29, v31
    v_cvt_pk_bf16_f32 v35, v28, v29
    v_cvt_pk_bf16_f32 v26, v68, v69
    v_cvt_pk_bf16_f32 v27, v80, v81
    v_lshlrev_b32 v28, 16, v26
    v_and_b32 v29, 0xffff0000, v26
    v_mul_f32 v30, 0xbfb8aa3b, v28
    v_mul_f32 v31, 0xbfb8aa3b, v29
    v_exp_f32 v30, v30
    v_exp_f32 v31, v31
    v_add_f32 v30, 1.0, v30
    v_add_f32 v31, 1.0, v31
    v_rcp_f32 v30, v30
    v_rcp_f32 v31, v31
    v_mul_f32 v28, v28, v30
    v_mul_f32 v29, v29, v31
    v_cvt_pk_bf16_f32 v26, v28, v29
    v_lshlrev_b32 v30, 16, v27
    v_and_b32 v31, 0xffff0000, v27
    v_lshlrev_b32 v28, 16, v26
    v_and_b32 v29, 0xffff0000, v26
    v_mul_f32 v28, v28, v30
    v_mul_f32 v29, v29, v31
    v_cvt_pk_bf16_f32 v36, v28, v29
    v_cvt_pk_bf16_f32 v26, v70, v71
    v_cvt_pk_bf16_f32 v27, v82, v83
    v_lshlrev_b32 v28, 16, v26
    v_and_b32 v29, 0xffff0000, v26
    v_mul_f32 v30, 0xbfb8aa3b, v28
    v_mul_f32 v31, 0xbfb8aa3b, v29
    v_exp_f32 v30, v30
    v_exp_f32 v31, v31
    v_add_f32 v30, 1.0, v30
    v_add_f32 v31, 1.0, v31
    v_rcp_f32 v30, v30
    v_rcp_f32 v31, v31
    v_mul_f32 v28, v28, v30
    v_mul_f32 v29, v29, v31
    v_cvt_pk_bf16_f32 v26, v28, v29
    v_lshlrev_b32 v30, 16, v27
    v_and_b32 v31, 0xffff0000, v27
    v_lshlrev_b32 v28, 16, v26
    v_and_b32 v29, 0xffff0000, v26
    v_mul_f32 v28, v28, v30
    v_mul_f32 v29, v29, v31
    v_cvt_pk_bf16_f32 v37, v28, v29
    s_mul_i32 s45, s36, 3
    s_add_u32 s46, s45, 0
    s_lshr_b32 s47, s46, 1
    s_lshl_b32 s47, s47, 8
    s_and_b32 s46, s46, 1
    s_lshl_b32 s46, s46, 3
    s_add_u32 s47, s47, s46
    s_add_u32 s47, s47, 147456
    v_add_u32 v26, s47, v20
    ds_write_b64 v26, v[32:33]
    s_add_u32 s46, s45, 1
    s_lshr_b32 s47, s46, 1
    s_lshl_b32 s47, s47, 8
    s_and_b32 s46, s46, 1
    s_lshl_b32 s46, s46, 3
    s_add_u32 s47, s47, s46
    s_add_u32 s47, s47, 147456
    v_add_u32 v26, s47, v20
    ds_write_b64 v26, v[34:35]
    s_add_u32 s46, s45, 2
    s_lshr_b32 s47, s46, 1
    s_lshl_b32 s47, s47, 8
    s_and_b32 s46, s46, 1
    s_lshl_b32 s46, s46, 3
    s_add_u32 s47, s47, s46
    s_add_u32 s47, s47, 147456
    v_add_u32 v26, s47, v20
    ds_write_b64 v26, v[36:37]
    v_add_u32 v26, 147456, v20
    s_waitcnt lgkmcnt(0)
    s_barrier
    ds_read_b128 v[192:195], v26 offset:0
    ds_read_b128 v[196:199], v26 offset:256
    ds_read_b128 v[200:203], v26 offset:512
    ds_read_b128 v[204:207], v26 offset:768
    ds_read_b128 v[208:211], v26 offset:1024
    ds_read_b128 v[212:215], v26 offset:1280
    ds_read_b64_tr_b16 v[40:41], v19 offset:0
    ds_read_b64_tr_b16 v[42:43], v19 offset:9216
    ds_read_b64_tr_b16 v[44:45], v19 offset:18432
    ds_read_b64_tr_b16 v[46:47], v19 offset:27648
    ds_read_b64_tr_b16 v[48:49], v19 offset:36864
    ds_read_b64_tr_b16 v[50:51], v19 offset:46080
    s_waitcnt lgkmcnt(4)
    v_mfma_f32_32x32x16_bf16 v[60:75], v[40:43], v[192:195], 0
    ds_read_b64_tr_b16 v[52:53], v23 offset:0
    ds_read_b64_tr_b16 v[54:55], v23 offset:9216
    s_waitcnt lgkmcnt(4)
    v_mfma_f32_32x32x16_bf16 v[60:75], v[44:47], v[196:199], v[60:75]
    ds_read_b64_tr_b16 v[40:41], v23 offset:18432
    ds_read_b64_tr_b16 v[42:43], v23 offset:27648
    s_waitcnt lgkmcnt(4)
    v_mfma_f32_32x32x16_bf16 v[60:75], v[48:51], v[200:203], v[60:75]
    ds_read_b64_tr_b16 v[44:45], v23 offset:36864
    ds_read_b64_tr_b16 v[46:47], v23 offset:46080
    s_waitcnt lgkmcnt(4)
    v_mfma_f32_32x32x16_bf16 v[60:75], v[52:55], v[204:207], v[60:75]
    ds_read_b64_tr_b16 v[48:49], v19 offset:256
    ds_read_b64_tr_b16 v[50:51], v19 offset:9472
    s_waitcnt lgkmcnt(4)
    v_mfma_f32_32x32x16_bf16 v[60:75], v[40:43], v[208:211], v[60:75]
    ds_read_b64_tr_b16 v[52:53], v19 offset:18688
    ds_read_b64_tr_b16 v[54:55], v19 offset:27904
    s_waitcnt lgkmcnt(4)
    v_mfma_f32_32x32x16_bf16 v[60:75], v[44:47], v[212:215], v[60:75]
    ds_read_b64_tr_b16 v[40:41], v19 offset:37120
    ds_read_b64_tr_b16 v[42:43], v19 offset:46336
    s_waitcnt lgkmcnt(4)
    v_mfma_f32_32x32x16_bf16 v[76:91], v[48:51], v[192:195], 0
    ds_read_b64_tr_b16 v[44:45], v23 offset:256
    ds_read_b64_tr_b16 v[46:47], v23 offset:9472
    s_waitcnt lgkmcnt(4)
    v_mfma_f32_32x32x16_bf16 v[76:91], v[52:55], v[196:199], v[76:91]
    ds_read_b64_tr_b16 v[48:49], v23 offset:18688
    ds_read_b64_tr_b16 v[50:51], v23 offset:27904
    s_waitcnt lgkmcnt(4)
    v_mfma_f32_32x32x16_bf16 v[76:91], v[40:43], v[200:203], v[76:91]
    ds_read_b64_tr_b16 v[52:53], v23 offset:37120
    ds_read_b64_tr_b16 v[54:55], v23 offset:46336
    s_waitcnt lgkmcnt(4)
    v_mfma_f32_32x32x16_bf16 v[76:91], v[44:47], v[204:207], v[76:91]
    ds_read_b64_tr_b16 v[40:41], v19 offset:512
    ds_read_b64_tr_b16 v[42:43], v19 offset:9728
    s_waitcnt lgkmcnt(4)
    v_mfma_f32_32x32x16_bf16 v[76:91], v[48:51], v[208:211], v[76:91]
    ds_read_b64_tr_b16 v[44:45], v19 offset:18944
    ds_read_b64_tr_b16 v[46:47], v19 offset:28160
    s_waitcnt lgkmcnt(4)
    v_mfma_f32_32x32x16_bf16 v[76:91], v[52:55], v[212:215], v[76:91]
    ds_read_b64_tr_b16 v[48:49], v19 offset:37376
    ds_read_b64_tr_b16 v[50:51], v19 offset:46592
    s_waitcnt lgkmcnt(4)
    v_mfma_f32_32x32x16_bf16 v[92:107], v[40:43], v[192:195], 0
    ds_read_b64_tr_b16 v[52:53], v23 offset:512
    ds_read_b64_tr_b16 v[54:55], v23 offset:9728
    s_waitcnt lgkmcnt(4)
    v_mfma_f32_32x32x16_bf16 v[92:107], v[44:47], v[196:199], v[92:107]
    ds_read_b64_tr_b16 v[40:41], v23 offset:18944
    ds_read_b64_tr_b16 v[42:43], v23 offset:28160
    s_waitcnt lgkmcnt(4)
    v_mfma_f32_32x32x16_bf16 v[92:107], v[48:51], v[200:203], v[92:107]
    ds_read_b64_tr_b16 v[44:45], v23 offset:37376
    ds_read_b64_tr_b16 v[46:47], v23 offset:46592
    s_waitcnt lgkmcnt(4)
    v_mfma_f32_32x32x16_bf16 v[92:107], v[52:55], v[204:207], v[92:107]
    ds_read_b64_tr_b16 v[48:49], v19 offset:768
    ds_read_b64_tr_b16 v[50:51], v19 offset:9984
    s_waitcnt lgkmcnt(4)
    v_mfma_f32_32x32x16_bf16 v[92:107], v[40:43], v[208:211], v[92:107]
    ds_read_b64_tr_b16 v[52:53], v19 offset:19200
    ds_read_b64_tr_b16 v[54:55], v19 offset:28416
    s_waitcnt lgkmcnt(4)
    v_mfma_f32_32x32x16_bf16 v[92:107], v[44:47], v[212:215], v[92:107]
    ds_read_b64_tr_b16 v[40:41], v19 offset:37632
    ds_read_b64_tr_b16 v[42:43], v19 offset:46848
    s_waitcnt lgkmcnt(4)
    v_mfma_f32_32x32x16_bf16 v[108:123], v[48:51], v[192:195], 0
    ds_read_b64_tr_b16 v[44:45], v23 offset:768
    ds_read_b64_tr_b16 v[46:47], v23 offset:9984
    s_waitcnt lgkmcnt(4)
    v_mfma_f32_32x32x16_bf16 v[108:123], v[52:55], v[196:199], v[108:123]
    ds_read_b64_tr_b16 v[48:49], v23 offset:19200
    ds_read_b64_tr_b16 v[50:51], v23 offset:28416
    s_waitcnt lgkmcnt(4)
    v_mfma_f32_32x32x16_bf16 v[108:123], v[40:43], v[200:203], v[108:123]
    ds_read_b64_tr_b16 v[52:53], v23 offset:37632
    ds_read_b64_tr_b16 v[54:55], v23 offset:46848
    s_waitcnt lgkmcnt(4)
    v_mfma_f32_32x32x16_bf16 v[108:123], v[44:47], v[204:207], v[108:123]
    ds_read_b64_tr_b16 v[40:41], v19 offset:1024
    ds_read_b64_tr_b16 v[42:43], v19 offset:10240
    s_waitcnt lgkmcnt(4)
    v_mfma_f32_32x32x16_bf16 v[108:123], v[48:51], v[208:211], v[108:123]
    ds_read_b64_tr_b16 v[44:45], v19 offset:19456
    ds_read_b64_tr_b16 v[46:47], v19 offset:28672
    s_waitcnt lgkmcnt(4)
    v_mfma_f32_32x32x16_bf16 v[108:123], v[52:55], v[212:215], v[108:123]
    ds_read_b64_tr_b16 v[48:49], v19 offset:37888
    ds_read_b64_tr_b16 v[50:51], v19 offset:47104
    s_waitcnt lgkmcnt(4)
    v_mfma_f32_32x32x16_bf16 v[124:139], v[40:43], v[192:195], 0
    ds_read_b64_tr_b16 v[52:53], v23 offset:1024
    ds_read_b64_tr_b16 v[54:55], v23 offset:10240
    s_waitcnt lgkmcnt(4)
    v_mfma_f32_32x32x16_bf16 v[124:139], v[44:47], v[196:199], v[124:139]
    ds_read_b64_tr_b16 v[40:41], v23 offset:19456
    ds_read_b64_tr_b16 v[42:43], v23 offset:28672
    s_waitcnt lgkmcnt(4)
    v_mfma_f32_32x32x16_bf16 v[124:139], v[48:51], v[200:203], v[124:139]
    ds_read_b64_tr_b16 v[44:45], v23 offset:37888
    ds_read_b64_tr_b16 v[46:47], v23 offset:47104
    s_waitcnt lgkmcnt(4)
    v_mfma_f32_32x32x16_bf16 v[124:139], v[52:55], v[204:207], v[124:139]
    s_waitcnt lgkmcnt(2)
    v_mfma_f32_32x32x16_bf16 v[124:139], v[40:43], v[208:211], v[124:139]
    s_waitcnt lgkmcnt(0)
    v_mfma_f32_32x32x16_bf16 v[124:139], v[44:47], v[212:215], v[124:139]
    v_and_b32 v24, 31, v2
    v_mul_u32_u24 v25, 2320, v24
    v_lshl_add_u32 v25, v15, 4, v25
    s_lshl_b32 s46, s36, 7
    s_add_u32 s46, s46, 112640
    v_add_u32 v25, s46, v25
    v_cmp_gt_u32 vcc, 8, v24
    s_nop 7
    s_mov_b64 exec, vcc
    ds_write_b128 v25, v[60:63] offset:0
    ds_write_b128 v25, v[64:67] offset:32
    ds_write_b128 v25, v[68:71] offset:64
    ds_write_b128 v25, v[72:75] offset:96
    ds_write_b128 v25, v[76:79] offset:512
    ds_write_b128 v25, v[80:83] offset:544
    ds_write_b128 v25, v[84:87] offset:576
    ds_write_b128 v25, v[88:91] offset:608
    ds_write_b128 v25, v[92:95] offset:1024
    ds_write_b128 v25, v[96:99] offset:1056
    ds_write_b128 v25, v[100:103] offset:1088
    ds_write_b128 v25, v[104:107] offset:1120
    s_waitcnt lgkmcnt(4)
    ds_write_b128 v25, v[108:111] offset:1536
    ds_write_b128 v25, v[112:115] offset:1568
    ds_write_b128 v25, v[116:119] offset:1600
    ds_write_b128 v25, v[120:123] offset:1632
    s_cmp_lt_u32 s36, 2
    s_cbranch_scc0 parallel_sum__compressed_kv_cla__moe_arch_mod__prompt_kernel_mw
    ds_write_b128 v25, v[124:127] offset:2048
    ds_write_b128 v25, v[128:131] offset:2080
    ds_write_b128 v25, v[132:135] offset:2112
    ds_write_b128 v25, v[136:139] offset:2144
parallel_sum__compressed_kv_cla__moe_arch_mod__prompt_kernel_mw:
    s_mov_b64 exec, -1
    s_mul_i32 s46, s36, 4640
    s_add_u32 s46, s46, 112640
    v_add_u32 v25, s46, v243
    v_mov_b32 v26, 0x40000000
    v_cmp_gt_u32 vcc, 16, v2
    s_mul_i32 s45, s44, 18432
    s_mul_i32 s46, s36, 4608
    v_cndmask_b32 v26, v26, v243, vcc
    s_add_u32 s45, s45, s46
    s_add_u32 s45, s45, 0x250000
    s_add_u32 s46, s45, 2304
    s_waitcnt lgkmcnt(0)
    s_barrier
    ds_read_b128 v[32:35], v25 offset:0
    ds_read_b128 v[36:39], v25 offset:1024
    ds_read_b128 v[40:43], v25 offset:2048
    ds_read_b128 v[44:47], v25 offset:2320
    ds_read_b128 v[48:51], v25 offset:3344
    ds_read_b128 v[52:55], v25 offset:4368
    s_waitcnt lgkmcnt(5)
    buffer_store_dwordx4 v[32:35], v243, s[12:15], s45 offen offset:0 sc1
    s_waitcnt lgkmcnt(4)
    buffer_store_dwordx4 v[36:39], v243, s[12:15], s45 offen offset:1024 sc1
    s_waitcnt lgkmcnt(3)
    buffer_store_dwordx4 v[40:43], v26, s[12:15], s45 offen offset:2048 sc1
    s_waitcnt lgkmcnt(2)
    buffer_store_dwordx4 v[44:47], v243, s[12:15], s46 offen offset:0 sc1
    s_waitcnt lgkmcnt(1)
    buffer_store_dwordx4 v[48:51], v243, s[12:15], s46 offen offset:1024 sc1
    s_waitcnt lgkmcnt(0)
    buffer_store_dwordx4 v[52:55], v26, s[12:15], s46 offen offset:2048 sc1
    s_lshl_b32 s45, s44, 6
    s_add_u32 s45, s45, 0x7bc000
    s_waitcnt vmcnt(0)
    s_barrier
    s_cmp_eq_u32 s36, 0
    s_cbranch_scc0 parallel_sum__compressed_kv_cla__moe_arch_mod__prompt_kernel_mend
    v_mov_b32 v5, s87
    s_mov_b64 exec, 1
    buffer_store_dword v5, off, s[12:15], s45 sc1
    s_mov_b64 exec, -1
parallel_sum__compressed_kv_cla__moe_arch_mod__prompt_kernel_mend:
parallel_sum__compressed_kv_cla__moe_arch_mod__prompt_kernel_p3end:
    s_endpgm
parallel_sum__compressed_kv_cla__moe_arch_mod__prompt_kernel_B:
    s_cmp_lt_u32 s77, 2
    s_cbranch_scc0 parallel_sum__compressed_kv_cla__moe_arch_mod__prompt_kernel_B_qslow
    buffer_load_dwordx4 v[216:219], v255, s[12:15], s55 offen offset:2048 sc1
    buffer_load_dwordx4 v[220:223], v255, s[12:15], s55 offen offset:2304 sc1
    s_add_u32 s55, s55, 4096
    buffer_load_dwordx4 v[224:227], v255, s[12:15], s55 offen offset:0 sc1
    buffer_load_dwordx4 v[228:231], v255, s[12:15], s55 offen offset:256 sc1
    buffer_load_dwordx4 v[232:235], v255, s[12:15], s55 offen offset:2048 sc1
    buffer_load_dwordx4 v[236:239], v255, s[12:15], s55 offen offset:2304 sc1
    s_nop 7
    v_mul_f32 v64, s69, v64
    v_mul_f32 v65, s69, v65
    v_mul_f32 v66, s69, v66
    v_mul_f32 v67, s69, v67
    v_mul_f32 v80, s69, v80
    v_mul_f32 v81, s69, v81
    v_mul_f32 v82, s69, v82
    v_mul_f32 v83, s69, v83
    v_cvt_pk_bf16_f32 v128, v64, v65
    v_cvt_pk_bf16_f32 v129, v66, v67
    v_cvt_pk_bf16_f32 v130, v80, v81
    v_cvt_pk_bf16_f32 v131, v82, v83
    s_nop 1
    v_permlane32_swap_b32 v128, v130
    v_permlane32_swap_b32 v129, v131
    v_mul_f32 v68, s69, v68
    v_mul_f32 v69, s69, v69
    v_mul_f32 v70, s69, v70
    v_mul_f32 v71, s69, v71
    v_mul_f32 v84, s69, v84
    v_mul_f32 v85, s69, v85
    v_mul_f32 v86, s69, v86
    v_mul_f32 v87, s69, v87
    v_cvt_pk_bf16_f32 v132, v68, v69
    v_cvt_pk_bf16_f32 v133, v70, v71
    v_cvt_pk_bf16_f32 v134, v84, v85
    v_cvt_pk_bf16_f32 v135, v86, v87
    s_nop 1
    v_permlane32_swap_b32 v132, v134
    v_permlane32_swap_b32 v133, v135
    v_mul_f32 v72, s69, v72
    v_mul_f32 v73, s69, v73
    v_mul_f32 v74, s69, v74
    v_mul_f32 v75, s69, v75
    v_mul_f32 v88, s69, v88
    v_mul_f32 v89, s69, v89
    v_mul_f32 v90, s69, v90
    v_mul_f32 v91, s69, v91
    v_cvt_pk_bf16_f32 v136, v72, v73
    v_cvt_pk_bf16_f32 v137, v74, v75
    v_cvt_pk_bf16_f32 v138, v88, v89
    v_cvt_pk_bf16_f32 v139, v90, v91
    s_nop 1
    v_permlane32_swap_b32 v136, v138
    v_permlane32_swap_b32 v137, v139
    v_mul_f32 v76, s69, v76
    v_mul_f32 v77, s69, v77
    v_mul_f32 v78, s69, v78
    v_mul_f32 v79, s69, v79
    v_mul_f32 v92, s69, v92
    v_mul_f32 v93, s69, v93
    v_mul_f32 v94, s69, v94
    v_mul_f32 v95, s69, v95
    v_cvt_pk_bf16_f32 v140, v76, v77
    v_cvt_pk_bf16_f32 v141, v78, v79
    v_cvt_pk_bf16_f32 v142, v92, v93
    v_cvt_pk_bf16_f32 v143, v94, v95
    s_nop 1
    v_permlane32_swap_b32 v140, v142
    v_permlane32_swap_b32 v141, v143
    v_mul_f32 v96, s69, v96
    v_mul_f32 v97, s69, v97
    v_mul_f32 v98, s69, v98
    v_mul_f32 v99, s69, v99
    v_mul_f32 v112, s69, v112
    v_mul_f32 v113, s69, v113
    v_mul_f32 v114, s69, v114
    v_mul_f32 v115, s69, v115
    v_cvt_pk_bf16_f32 v144, v96, v97
    v_cvt_pk_bf16_f32 v145, v98, v99
    v_cvt_pk_bf16_f32 v146, v112, v113
    v_cvt_pk_bf16_f32 v147, v114, v115
    s_nop 1
    v_permlane32_swap_b32 v144, v146
    v_permlane32_swap_b32 v145, v147
    v_mul_f32 v100, s69, v100
    v_mul_f32 v101, s69, v101
    v_mul_f32 v102, s69, v102
    v_mul_f32 v103, s69, v103
    v_mul_f32 v116, s69, v116
    v_mul_f32 v117, s69, v117
    v_mul_f32 v118, s69, v118
    v_mul_f32 v119, s69, v119
    v_cvt_pk_bf16_f32 v148, v100, v101
    v_cvt_pk_bf16_f32 v149, v102, v103
    v_cvt_pk_bf16_f32 v150, v116, v117
    v_cvt_pk_bf16_f32 v151, v118, v119
    s_nop 1
    v_permlane32_swap_b32 v148, v150
    v_permlane32_swap_b32 v149, v151
    v_mul_f32 v104, s69, v104
    v_mul_f32 v105, s69, v105
    v_mul_f32 v106, s69, v106
    v_mul_f32 v107, s69, v107
    v_mul_f32 v120, s69, v120
    v_mul_f32 v121, s69, v121
    v_mul_f32 v122, s69, v122
    v_mul_f32 v123, s69, v123
    v_cvt_pk_bf16_f32 v152, v104, v105
    v_cvt_pk_bf16_f32 v153, v106, v107
    v_cvt_pk_bf16_f32 v154, v120, v121
    v_cvt_pk_bf16_f32 v155, v122, v123
    s_nop 1
    v_permlane32_swap_b32 v152, v154
    v_permlane32_swap_b32 v153, v155
    v_mul_f32 v108, s69, v108
    v_mul_f32 v109, s69, v109
    v_mul_f32 v110, s69, v110
    v_mul_f32 v111, s69, v111
    v_mul_f32 v124, s69, v124
    v_mul_f32 v125, s69, v125
    v_mul_f32 v126, s69, v126
    v_mul_f32 v127, s69, v127
    v_cvt_pk_bf16_f32 v156, v108, v109
    v_cvt_pk_bf16_f32 v157, v110, v111
    v_cvt_pk_bf16_f32 v158, v124, v125
    v_cvt_pk_bf16_f32 v159, v126, v127
    s_nop 1
    v_permlane32_swap_b32 v156, v158
    v_permlane32_swap_b32 v157, v159
    s_waitcnt vmcnt(24)
    s_barrier
    ds_read_b64_tr_b16 v[160:161], v246 offset:0
    ds_read_b64_tr_b16 v[162:163], v246 offset:1024
    ds_read_b64_tr_b16 v[164:165], v247 offset:0
    ds_read_b64_tr_b16 v[166:167], v247 offset:1024
    ds_read_b64_tr_b16 v[168:169], v248 offset:0
    ds_read_b64_tr_b16 v[170:171], v248 offset:1024
    ds_read_b64_tr_b16 v[172:173], v249 offset:0
    ds_read_b64_tr_b16 v[174:175], v249 offset:1024
    ds_read_b64_tr_b16 v[176:177], v250 offset:0
    ds_read_b64_tr_b16 v[178:179], v250 offset:1024
    ds_read_b64_tr_b16 v[180:181], v251 offset:0
    ds_read_b64_tr_b16 v[182:183], v251 offset:1024
    s_waitcnt vmcnt(10) lgkmcnt(8)
    v_mfma_f32_16x16x32_bf16 v[64:67], v[160:163], v[192:195], 0
    ds_read_b64_tr_b16 v[184:185], v252 offset:0
    ds_read_b64_tr_b16 v[186:187], v252 offset:1024
    v_mfma_f32_16x16x32_bf16 v[68:71], v[160:163], v[196:199], 0
    s_add_u32 s68, s68, 32768
    buffer_store_dwordx4 v[128:131], v242, s[12:15], s68 offen offset:0 sc1
    v_mul_f32 v0, s69, v0
    v_mul_f32 v1, s69, v1
    v_mul_f32 v2, s69, v2
    v_mul_f32 v3, s69, v3
    v_mfma_f32_16x16x32_bf16 v[72:75], v[164:167], v[192:195], 0
    ds_read_b64_tr_b16 v[188:189], v253 offset:0
    ds_read_b64_tr_b16 v[190:191], v253 offset:1024
    v_mfma_f32_16x16x32_bf16 v[76:79], v[164:167], v[196:199], 0
    buffer_store_dwordx4 v[132:135], v242, s[12:15], s68 offen offset:1024 sc1
    v_mul_f32 v16, s69, v16
    v_mul_f32 v17, s69, v17
    v_mul_f32 v18, s69, v18
    v_mul_f32 v19, s69, v19
    s_waitcnt lgkmcnt(8)
    v_mfma_f32_16x16x32_bf16 v[80:83], v[168:171], v[192:195], 0
    ds_read_b64_tr_b16 v[160:161], v246 offset:8192
    ds_read_b64_tr_b16 v[162:163], v246 offset:9216
    v_mfma_f32_16x16x32_bf16 v[84:87], v[168:171], v[196:199], 0
    buffer_store_dwordx4 v[136:139], v242, s[12:15], s68 offen offset:2048 sc1
    v_cvt_pk_bf16_f32 v0, v0, v1
    v_cvt_pk_bf16_f32 v1, v2, v3
    v_cvt_pk_bf16_f32 v2, v16, v17
    v_cvt_pk_bf16_f32 v3, v18, v19
    v_mfma_f32_16x16x32_bf16 v[88:91], v[172:175], v[192:195], 0
    ds_read_b64_tr_b16 v[164:165], v247 offset:8192
    ds_read_b64_tr_b16 v[166:167], v247 offset:9216
    v_mfma_f32_16x16x32_bf16 v[92:95], v[172:175], v[196:199], 0
    buffer_store_dwordx4 v[140:143], v242, s[12:15], s68 offen offset:3072 sc1
    s_add_u32 s68, s68, 16384
    s_nop 1
    v_permlane32_swap_b32 v0, v2
    v_permlane32_swap_b32 v1, v3
    v_mul_f32 v4, s69, v4
    s_waitcnt lgkmcnt(8)
    v_mfma_f32_16x16x32_bf16 v[96:99], v[176:179], v[192:195], 0
    ds_read_b64_tr_b16 v[168:169], v248 offset:8192
    ds_read_b64_tr_b16 v[170:171], v248 offset:9216
    v_mfma_f32_16x16x32_bf16 v[100:103], v[176:179], v[196:199], 0
    buffer_store_dwordx4 v[144:147], v242, s[12:15], s68 offen offset:0 sc1
    v_mul_f32 v5, s69, v5
    v_mul_f32 v6, s69, v6
    v_mul_f32 v7, s69, v7
    v_mul_f32 v20, s69, v20
    v_mfma_f32_16x16x32_bf16 v[104:107], v[180:183], v[192:195], 0
    ds_read_b64_tr_b16 v[172:173], v249 offset:8192
    ds_read_b64_tr_b16 v[174:175], v249 offset:9216
    v_mfma_f32_16x16x32_bf16 v[108:111], v[180:183], v[196:199], 0
    buffer_store_dwordx4 v[148:151], v242, s[12:15], s68 offen offset:1024 sc1
    v_mul_f32 v21, s69, v21
    v_mul_f32 v22, s69, v22
    v_mul_f32 v23, s69, v23
    v_cvt_pk_bf16_f32 v4, v4, v5
    s_waitcnt lgkmcnt(8)
    v_mfma_f32_16x16x32_bf16 v[112:115], v[184:187], v[192:195], 0
    ds_read_b64_tr_b16 v[176:177], v250 offset:8192
    ds_read_b64_tr_b16 v[178:179], v250 offset:9216
    v_mfma_f32_16x16x32_bf16 v[116:119], v[184:187], v[196:199], 0
    buffer_store_dwordx4 v[152:155], v242, s[12:15], s68 offen offset:2048 sc1
    v_cvt_pk_bf16_f32 v5, v6, v7
    v_cvt_pk_bf16_f32 v6, v20, v21
    v_cvt_pk_bf16_f32 v7, v22, v23
    s_nop 1
    v_mfma_f32_16x16x32_bf16 v[120:123], v[188:191], v[192:195], 0
    ds_read_b64_tr_b16 v[180:181], v251 offset:8192
    ds_read_b64_tr_b16 v[182:183], v251 offset:9216
    v_mfma_f32_16x16x32_bf16 v[124:127], v[188:191], v[196:199], 0
    buffer_store_dwordx4 v[156:159], v242, s[12:15], s68 offen offset:3072 sc1
    s_sub_u32 s68, s68, 49152
    v_permlane32_swap_b32 v4, v6
    v_permlane32_swap_b32 v5, v7
    v_mul_f32 v8, s69, v8
    v_mul_f32 v9, s69, v9
    s_waitcnt vmcnt(16) lgkmcnt(8)
    v_mfma_f32_16x16x32_bf16 v[64:67], v[160:163], v[200:203], v[64:67]
    ds_read_b64_tr_b16 v[184:185], v252 offset:8192
    ds_read_b64_tr_b16 v[186:187], v252 offset:9216
    v_mfma_f32_16x16x32_bf16 v[68:71], v[160:163], v[204:207], v[68:71]
    buffer_store_dwordx4 v[0:3], v242, s[12:15], s68 offen offset:0 sc1
    v_mul_f32 v10, s69, v10
    v_mul_f32 v11, s69, v11
    v_mul_f32 v24, s69, v24
    v_mul_f32 v25, s69, v25
    v_mfma_f32_16x16x32_bf16 v[72:75], v[164:167], v[200:203], v[72:75]
    ds_read_b64_tr_b16 v[188:189], v253 offset:8192
    ds_read_b64_tr_b16 v[190:191], v253 offset:9216
    v_mfma_f32_16x16x32_bf16 v[76:79], v[164:167], v[204:207], v[76:79]
    s_add_u32 s55, s55, 4096
    buffer_load_dwordx4 v[192:195], v255, s[12:15], s55 offen offset:0 sc1
    v_mul_f32 v26, s69, v26
    v_mul_f32 v27, s69, v27
    v_cvt_pk_bf16_f32 v8, v8, v9
    v_cvt_pk_bf16_f32 v9, v10, v11
    s_waitcnt lgkmcnt(8)
    v_mfma_f32_16x16x32_bf16 v[80:83], v[168:171], v[200:203], v[80:83]
    ds_read_b64_tr_b16 v[160:161], v246 offset:16384
    ds_read_b64_tr_b16 v[162:163], v246 offset:17408
    v_mfma_f32_16x16x32_bf16 v[84:87], v[168:171], v[204:207], v[84:87]
    buffer_load_dwordx4 v[196:199], v255, s[12:15], s55 offen offset:256 sc1
    v_cvt_pk_bf16_f32 v10, v24, v25
    v_cvt_pk_bf16_f32 v11, v26, v27
    s_nop 1
    v_permlane32_swap_b32 v8, v10
    v_mfma_f32_16x16x32_bf16 v[88:91], v[172:175], v[200:203], v[88:91]
    ds_read_b64_tr_b16 v[164:165], v247 offset:16384
    ds_read_b64_tr_b16 v[166:167], v247 offset:17408
    v_mfma_f32_16x16x32_bf16 v[92:95], v[172:175], v[204:207], v[92:95]
    v_permlane32_swap_b32 v9, v11
    v_mul_f32 v12, s69, v12
    v_mul_f32 v13, s69, v13
    v_mul_f32 v14, s69, v14
    s_waitcnt lgkmcnt(8)
    v_mfma_f32_16x16x32_bf16 v[96:99], v[176:179], v[200:203], v[96:99]
    ds_read_b64_tr_b16 v[168:169], v248 offset:16384
    ds_read_b64_tr_b16 v[170:171], v248 offset:17408
    v_mfma_f32_16x16x32_bf16 v[100:103], v[176:179], v[204:207], v[100:103]
    buffer_store_dwordx4 v[4:7], v242, s[12:15], s68 offen offset:1024 sc1
    v_mul_f32 v15, s69, v15
    v_mul_f32 v28, s69, v28
    v_mul_f32 v29, s69, v29
    v_mul_f32 v30, s69, v30
    v_mfma_f32_16x16x32_bf16 v[104:107], v[180:183], v[200:203], v[104:107]
    ds_read_b64_tr_b16 v[172:173], v249 offset:16384
    ds_read_b64_tr_b16 v[174:175], v249 offset:17408
    v_mfma_f32_16x16x32_bf16 v[108:111], v[180:183], v[204:207], v[108:111]
    v_mul_f32 v31, s69, v31
    v_cvt_pk_bf16_f32 v12, v12, v13
    v_cvt_pk_bf16_f32 v13, v14, v15
    v_cvt_pk_bf16_f32 v14, v28, v29
    s_waitcnt lgkmcnt(8)
    v_mfma_f32_16x16x32_bf16 v[112:115], v[184:187], v[200:203], v[112:115]
    ds_read_b64_tr_b16 v[176:177], v250 offset:16384
    ds_read_b64_tr_b16 v[178:179], v250 offset:17408
    v_mfma_f32_16x16x32_bf16 v[116:119], v[184:187], v[204:207], v[116:119]
    v_cvt_pk_bf16_f32 v15, v30, v31
    s_nop 1
    v_permlane32_swap_b32 v12, v14
    v_permlane32_swap_b32 v13, v15
    v_mfma_f32_16x16x32_bf16 v[120:123], v[188:191], v[200:203], v[120:123]
    ds_read_b64_tr_b16 v[180:181], v251 offset:16384
    ds_read_b64_tr_b16 v[182:183], v251 offset:17408
    v_mfma_f32_16x16x32_bf16 v[124:127], v[188:191], v[204:207], v[124:127]
    buffer_load_dwordx4 v[200:203], v255, s[12:15], s55 offen offset:2048 sc1
    v_mul_f32 v32, s69, v32
    v_mul_f32 v33, s69, v33
    v_mul_f32 v34, s69, v34
    v_mul_f32 v35, s69, v35
    s_waitcnt vmcnt(19) lgkmcnt(8)
    v_mfma_f32_16x16x32_bf16 v[64:67], v[160:163], v[208:211], v[64:67]
    ds_read_b64_tr_b16 v[184:185], v252 offset:16384
    ds_read_b64_tr_b16 v[186:187], v252 offset:17408
    v_mfma_f32_16x16x32_bf16 v[68:71], v[160:163], v[212:215], v[68:71]
    buffer_store_dwordx4 v[8:11], v242, s[12:15], s68 offen offset:2048 sc1
    v_mul_f32 v48, s69, v48
    v_mul_f32 v49, s69, v49
    v_mul_f32 v50, s69, v50
    v_mul_f32 v51, s69, v51
    v_mfma_f32_16x16x32_bf16 v[72:75], v[164:167], v[208:211], v[72:75]
    ds_read_b64_tr_b16 v[188:189], v253 offset:16384
    ds_read_b64_tr_b16 v[190:191], v253 offset:17408
    v_mfma_f32_16x16x32_bf16 v[76:79], v[164:167], v[212:215], v[76:79]
    buffer_load_dwordx4 v[204:207], v255, s[12:15], s55 offen offset:2304 sc1
    v_cvt_pk_bf16_f32 v16, v32, v33
    v_cvt_pk_bf16_f32 v17, v34, v35
    v_cvt_pk_bf16_f32 v18, v48, v49
    v_cvt_pk_bf16_f32 v19, v50, v51
    s_waitcnt lgkmcnt(8)
    v_mfma_f32_16x16x32_bf16 v[80:83], v[168:171], v[208:211], v[80:83]
    ds_read_b64_tr_b16 v[160:161], v246 offset:24576
    ds_read_b64_tr_b16 v[162:163], v246 offset:25600
    v_mfma_f32_16x16x32_bf16 v[84:87], v[168:171], v[212:215], v[84:87]
    s_nop 1
    v_permlane32_swap_b32 v16, v18
    v_permlane32_swap_b32 v17, v19
    v_mul_f32 v36, s69, v36
    v_mfma_f32_16x16x32_bf16 v[88:91], v[172:175], v[208:211], v[88:91]
    ds_read_b64_tr_b16 v[164:165], v247 offset:24576
    ds_read_b64_tr_b16 v[166:167], v247 offset:25600
    v_mfma_f32_16x16x32_bf16 v[92:95], v[172:175], v[212:215], v[92:95]
    v_mul_f32 v37, s69, v37
    v_mul_f32 v38, s69, v38
    v_mul_f32 v39, s69, v39
    v_mul_f32 v52, s69, v52
    s_waitcnt lgkmcnt(8)
    v_mfma_f32_16x16x32_bf16 v[96:99], v[176:179], v[208:211], v[96:99]
    ds_read_b64_tr_b16 v[168:169], v248 offset:24576
    ds_read_b64_tr_b16 v[170:171], v248 offset:25600
    v_mfma_f32_16x16x32_bf16 v[100:103], v[176:179], v[212:215], v[100:103]
    buffer_store_dwordx4 v[12:15], v242, s[12:15], s68 offen offset:3072 sc1
    s_add_u32 s68, s68, 16384
    v_mul_f32 v53, s69, v53
    v_mul_f32 v54, s69, v54
    v_mul_f32 v55, s69, v55
    v_cvt_pk_bf16_f32 v20, v36, v37
    v_mfma_f32_16x16x32_bf16 v[104:107], v[180:183], v[208:211], v[104:107]
    ds_read_b64_tr_b16 v[172:173], v249 offset:24576
    ds_read_b64_tr_b16 v[174:175], v249 offset:25600
    v_mfma_f32_16x16x32_bf16 v[108:111], v[180:183], v[212:215], v[108:111]
    v_cvt_pk_bf16_f32 v21, v38, v39
    v_cvt_pk_bf16_f32 v22, v52, v53
    v_cvt_pk_bf16_f32 v23, v54, v55
    s_nop 1
    s_waitcnt lgkmcnt(8)
    v_mfma_f32_16x16x32_bf16 v[112:115], v[184:187], v[208:211], v[112:115]
    ds_read_b64_tr_b16 v[176:177], v250 offset:24576
    ds_read_b64_tr_b16 v[178:179], v250 offset:25600
    v_mfma_f32_16x16x32_bf16 v[116:119], v[184:187], v[212:215], v[116:119]
    v_permlane32_swap_b32 v20, v22
    v_permlane32_swap_b32 v21, v23
    v_mul_f32 v40, s69, v40
    v_mul_f32 v41, s69, v41
    v_mfma_f32_16x16x32_bf16 v[120:123], v[188:191], v[208:211], v[120:123]
    ds_read_b64_tr_b16 v[180:181], v251 offset:24576
    ds_read_b64_tr_b16 v[182:183], v251 offset:25600
    v_mfma_f32_16x16x32_bf16 v[124:127], v[188:191], v[212:215], v[124:127]
    s_add_u32 s55, s55, 4096
    buffer_load_dwordx4 v[208:211], v255, s[12:15], s55 offen offset:0 sc1
    v_mul_f32 v42, s69, v42
    v_mul_f32 v43, s69, v43
    v_mul_f32 v56, s69, v56
    v_mul_f32 v57, s69, v57
    s_waitcnt vmcnt(21) lgkmcnt(8)
    v_mfma_f32_16x16x32_bf16 v[64:67], v[160:163], v[216:219], v[64:67]
    ds_read_b64_tr_b16 v[184:185], v252 offset:24576
    ds_read_b64_tr_b16 v[186:187], v252 offset:25600
    v_mfma_f32_16x16x32_bf16 v[68:71], v[160:163], v[220:223], v[68:71]
    buffer_store_dwordx4 v[16:19], v242, s[12:15], s68 offen offset:0 sc1
    v_mul_f32 v58, s69, v58
    v_mul_f32 v59, s69, v59
    v_cvt_pk_bf16_f32 v24, v40, v41
    v_cvt_pk_bf16_f32 v25, v42, v43
    v_mfma_f32_16x16x32_bf16 v[72:75], v[164:167], v[216:219], v[72:75]
    ds_read_b64_tr_b16 v[188:189], v253 offset:24576
    ds_read_b64_tr_b16 v[190:191], v253 offset:25600
    v_mfma_f32_16x16x32_bf16 v[76:79], v[164:167], v[220:223], v[76:79]
    buffer_load_dwordx4 v[212:215], v255, s[12:15], s55 offen offset:256 sc1
    v_cvt_pk_bf16_f32 v26, v56, v57
    v_cvt_pk_bf16_f32 v27, v58, v59
    s_nop 1
    v_permlane32_swap_b32 v24, v26
    s_waitcnt lgkmcnt(8)
    v_mfma_f32_16x16x32_bf16 v[80:83], v[168:171], v[216:219], v[80:83]
    s_waitcnt vmcnt(31)
    s_barrier
    ds_read_b64_tr_b16 v[160:161], v246 offset:32768
    ds_read_b64_tr_b16 v[162:163], v246 offset:33792
    v_mfma_f32_16x16x32_bf16 v[84:87], v[168:171], v[220:223], v[84:87]
    v_permlane32_swap_b32 v25, v27
    v_mul_f32 v44, s69, v44
    v_mul_f32 v45, s69, v45
    v_mul_f32 v46, s69, v46
    v_mfma_f32_16x16x32_bf16 v[88:91], v[172:175], v[216:219], v[88:91]
    ds_read_b64_tr_b16 v[164:165], v247 offset:32768
    ds_read_b64_tr_b16 v[166:167], v247 offset:33792
    v_mfma_f32_16x16x32_bf16 v[92:95], v[172:175], v[220:223], v[92:95]
    v_mul_f32 v47, s69, v47
    v_mul_f32 v60, s69, v60
    v_mul_f32 v61, s69, v61
    v_mul_f32 v62, s69, v62
    s_waitcnt lgkmcnt(8)
    v_mfma_f32_16x16x32_bf16 v[96:99], v[176:179], v[216:219], v[96:99]
    ds_read_b64_tr_b16 v[168:169], v248 offset:32768
    ds_read_b64_tr_b16 v[170:171], v248 offset:33792
    v_mfma_f32_16x16x32_bf16 v[100:103], v[176:179], v[220:223], v[100:103]
    buffer_store_dwordx4 v[20:23], v242, s[12:15], s68 offen offset:1024 sc1
    v_mul_f32 v63, s69, v63
    v_cvt_pk_bf16_f32 v28, v44, v45
    v_cvt_pk_bf16_f32 v29, v46, v47
    v_cvt_pk_bf16_f32 v30, v60, v61
    v_mfma_f32_16x16x32_bf16 v[104:107], v[180:183], v[216:219], v[104:107]
    ds_read_b64_tr_b16 v[172:173], v249 offset:32768
    ds_read_b64_tr_b16 v[174:175], v249 offset:33792
    v_mfma_f32_16x16x32_bf16 v[108:111], v[180:183], v[220:223], v[108:111]
    v_cvt_pk_bf16_f32 v31, v62, v63
    s_nop 1
    v_permlane32_swap_b32 v28, v30
    v_permlane32_swap_b32 v29, v31
    s_waitcnt lgkmcnt(8)
    v_mfma_f32_16x16x32_bf16 v[112:115], v[184:187], v[216:219], v[112:115]
    ds_read_b64_tr_b16 v[176:177], v250 offset:32768
    ds_read_b64_tr_b16 v[178:179], v250 offset:33792
    v_mfma_f32_16x16x32_bf16 v[116:119], v[184:187], v[220:223], v[116:119]
    v_mfma_f32_16x16x32_bf16 v[120:123], v[188:191], v[216:219], v[120:123]
    ds_read_b64_tr_b16 v[180:181], v251 offset:32768
    ds_read_b64_tr_b16 v[182:183], v251 offset:33792
    v_mfma_f32_16x16x32_bf16 v[124:127], v[188:191], v[220:223], v[124:127]
    buffer_load_dwordx4 v[216:219], v255, s[12:15], s55 offen offset:2048 sc1
    s_waitcnt vmcnt(23) lgkmcnt(8)
    v_mfma_f32_16x16x32_bf16 v[64:67], v[160:163], v[224:227], v[64:67]
    ds_read_b64_tr_b16 v[184:185], v252 offset:32768
    ds_read_b64_tr_b16 v[186:187], v252 offset:33792
    v_mfma_f32_16x16x32_bf16 v[68:71], v[160:163], v[228:231], v[68:71]
    buffer_store_dwordx4 v[24:27], v242, s[12:15], s68 offen offset:2048 sc1
    v_mfma_f32_16x16x32_bf16 v[72:75], v[164:167], v[224:227], v[72:75]
    ds_read_b64_tr_b16 v[188:189], v253 offset:32768
    ds_read_b64_tr_b16 v[190:191], v253 offset:33792
    v_mfma_f32_16x16x32_bf16 v[76:79], v[164:167], v[228:231], v[76:79]
    buffer_load_dwordx4 v[220:223], v255, s[12:15], s55 offen offset:2304 sc1
    s_waitcnt lgkmcnt(8)
    v_mfma_f32_16x16x32_bf16 v[80:83], v[168:171], v[224:227], v[80:83]
    ds_read_b64_tr_b16 v[160:161], v246 offset:40960
    ds_read_b64_tr_b16 v[162:163], v246 offset:41984
    v_mfma_f32_16x16x32_bf16 v[84:87], v[168:171], v[228:231], v[84:87]
    v_mfma_f32_16x16x32_bf16 v[88:91], v[172:175], v[224:227], v[88:91]
    ds_read_b64_tr_b16 v[164:165], v247 offset:40960
    ds_read_b64_tr_b16 v[166:167], v247 offset:41984
    v_mfma_f32_16x16x32_bf16 v[92:95], v[172:175], v[228:231], v[92:95]
    s_waitcnt lgkmcnt(8)
    v_mfma_f32_16x16x32_bf16 v[96:99], v[176:179], v[224:227], v[96:99]
    ds_read_b64_tr_b16 v[168:169], v248 offset:40960
    ds_read_b64_tr_b16 v[170:171], v248 offset:41984
    v_mfma_f32_16x16x32_bf16 v[100:103], v[176:179], v[228:231], v[100:103]
    buffer_store_dwordx4 v[28:31], v242, s[12:15], s68 offen offset:3072 sc1
    s_add_u32 s68, s68, 16384
    v_mfma_f32_16x16x32_bf16 v[104:107], v[180:183], v[224:227], v[104:107]
    ds_read_b64_tr_b16 v[172:173], v249 offset:40960
    ds_read_b64_tr_b16 v[174:175], v249 offset:41984
    v_mfma_f32_16x16x32_bf16 v[108:111], v[180:183], v[228:231], v[108:111]
    s_waitcnt lgkmcnt(8)
    v_mfma_f32_16x16x32_bf16 v[112:115], v[184:187], v[224:227], v[112:115]
    ds_read_b64_tr_b16 v[176:177], v250 offset:40960
    ds_read_b64_tr_b16 v[178:179], v250 offset:41984
    v_mfma_f32_16x16x32_bf16 v[116:119], v[184:187], v[228:231], v[116:119]
    v_mfma_f32_16x16x32_bf16 v[120:123], v[188:191], v[224:227], v[120:123]
    ds_read_b64_tr_b16 v[180:181], v251 offset:40960
    ds_read_b64_tr_b16 v[182:183], v251 offset:41984
    v_mfma_f32_16x16x32_bf16 v[124:127], v[188:191], v[228:231], v[124:127]
    s_add_u32 s55, s55, 4096
    buffer_load_dwordx4 v[224:227], v255, s[12:15], s55 offen offset:0 sc1
    s_waitcnt vmcnt(25) lgkmcnt(8)
    v_mfma_f32_16x16x32_bf16 v[64:67], v[160:163], v[232:235], v[64:67]
    ds_read_b64_tr_b16 v[184:185], v252 offset:40960
    ds_read_b64_tr_b16 v[186:187], v252 offset:41984
    v_mfma_f32_16x16x32_bf16 v[68:71], v[160:163], v[236:239], v[68:71]
    buffer_load_dwordx4 v[228:231], v255, s[12:15], s55 offen offset:256 sc1
    v_mfma_f32_16x16x32_bf16 v[72:75], v[164:167], v[232:235], v[72:75]
    ds_read_b64_tr_b16 v[188:189], v253 offset:40960
    ds_read_b64_tr_b16 v[190:191], v253 offset:41984
    v_mfma_f32_16x16x32_bf16 v[76:79], v[164:167], v[236:239], v[76:79]
    s_waitcnt lgkmcnt(8)
    v_mfma_f32_16x16x32_bf16 v[80:83], v[168:171], v[232:235], v[80:83]
    ds_read_b64_tr_b16 v[160:161], v246 offset:49152
    ds_read_b64_tr_b16 v[162:163], v246 offset:50176
    v_mfma_f32_16x16x32_bf16 v[84:87], v[168:171], v[236:239], v[84:87]
    v_mfma_f32_16x16x32_bf16 v[88:91], v[172:175], v[232:235], v[88:91]
    ds_read_b64_tr_b16 v[164:165], v247 offset:49152
    ds_read_b64_tr_b16 v[166:167], v247 offset:50176
    v_mfma_f32_16x16x32_bf16 v[92:95], v[172:175], v[236:239], v[92:95]
    s_waitcnt lgkmcnt(8)
    v_mfma_f32_16x16x32_bf16 v[96:99], v[176:179], v[232:235], v[96:99]
    ds_read_b64_tr_b16 v[168:169], v248 offset:49152
    ds_read_b64_tr_b16 v[170:171], v248 offset:50176
    v_mfma_f32_16x16x32_bf16 v[100:103], v[176:179], v[236:239], v[100:103]
    v_mfma_f32_16x16x32_bf16 v[104:107], v[180:183], v[232:235], v[104:107]
    ds_read_b64_tr_b16 v[172:173], v249 offset:49152
    ds_read_b64_tr_b16 v[174:175], v249 offset:50176
    v_mfma_f32_16x16x32_bf16 v[108:111], v[180:183], v[236:239], v[108:111]
    s_waitcnt lgkmcnt(8)
    v_mfma_f32_16x16x32_bf16 v[112:115], v[184:187], v[232:235], v[112:115]
    ds_read_b64_tr_b16 v[176:177], v250 offset:49152
    ds_read_b64_tr_b16 v[178:179], v250 offset:50176
    v_mfma_f32_16x16x32_bf16 v[116:119], v[184:187], v[236:239], v[116:119]
    v_mfma_f32_16x16x32_bf16 v[120:123], v[188:191], v[232:235], v[120:123]
    ds_read_b64_tr_b16 v[180:181], v251 offset:49152
    ds_read_b64_tr_b16 v[182:183], v251 offset:50176
    v_mfma_f32_16x16x32_bf16 v[124:127], v[188:191], v[236:239], v[124:127]
    buffer_load_dwordx4 v[232:235], v255, s[12:15], s55 offen offset:2048 sc1
    s_waitcnt vmcnt(16) lgkmcnt(8)
    v_mfma_f32_16x16x32_bf16 v[64:67], v[160:163], v[192:195], v[64:67]
    ds_read_b64_tr_b16 v[184:185], v252 offset:49152
    ds_read_b64_tr_b16 v[186:187], v252 offset:50176
    v_mfma_f32_16x16x32_bf16 v[68:71], v[160:163], v[196:199], v[68:71]
    buffer_load_dwordx4 v[236:239], v255, s[12:15], s55 offen offset:2304 sc1
    v_mfma_f32_16x16x32_bf16 v[72:75], v[164:167], v[192:195], v[72:75]
    ds_read_b64_tr_b16 v[188:189], v253 offset:49152
    ds_read_b64_tr_b16 v[190:191], v253 offset:50176
    v_mfma_f32_16x16x32_bf16 v[76:79], v[164:167], v[196:199], v[76:79]
    s_waitcnt lgkmcnt(8)
    v_mfma_f32_16x16x32_bf16 v[80:83], v[168:171], v[192:195], v[80:83]
    ds_read_b64_tr_b16 v[160:161], v246 offset:57344
    ds_read_b64_tr_b16 v[162:163], v246 offset:58368
    v_mfma_f32_16x16x32_bf16 v[84:87], v[168:171], v[196:199], v[84:87]
    v_mfma_f32_16x16x32_bf16 v[88:91], v[172:175], v[192:195], v[88:91]
    ds_read_b64_tr_b16 v[164:165], v247 offset:57344
    ds_read_b64_tr_b16 v[166:167], v247 offset:58368
    v_mfma_f32_16x16x32_bf16 v[92:95], v[172:175], v[196:199], v[92:95]
    s_waitcnt lgkmcnt(8)
    v_mfma_f32_16x16x32_bf16 v[96:99], v[176:179], v[192:195], v[96:99]
    ds_read_b64_tr_b16 v[168:169], v248 offset:57344
    ds_read_b64_tr_b16 v[170:171], v248 offset:58368
    v_mfma_f32_16x16x32_bf16 v[100:103], v[176:179], v[196:199], v[100:103]
    v_mfma_f32_16x16x32_bf16 v[104:107], v[180:183], v[192:195], v[104:107]
    ds_read_b64_tr_b16 v[172:173], v249 offset:57344
    ds_read_b64_tr_b16 v[174:175], v249 offset:58368
    v_mfma_f32_16x16x32_bf16 v[108:111], v[180:183], v[196:199], v[108:111]
    s_waitcnt lgkmcnt(8)
    v_mfma_f32_16x16x32_bf16 v[112:115], v[184:187], v[192:195], v[112:115]
    ds_read_b64_tr_b16 v[176:177], v250 offset:57344
    ds_read_b64_tr_b16 v[178:179], v250 offset:58368
    v_mfma_f32_16x16x32_bf16 v[116:119], v[184:187], v[196:199], v[116:119]
    v_mfma_f32_16x16x32_bf16 v[120:123], v[188:191], v[192:195], v[120:123]
    ds_read_b64_tr_b16 v[180:181], v251 offset:57344
    ds_read_b64_tr_b16 v[182:183], v251 offset:58368
    v_mfma_f32_16x16x32_bf16 v[124:127], v[188:191], v[196:199], v[124:127]
    s_add_u32 s55, s55, 4096
    buffer_load_dwordx4 v[192:195], v255, s[12:15], s55 offen offset:0 sc1
    s_waitcnt vmcnt(14) lgkmcnt(8)
    v_mfma_f32_16x16x32_bf16 v[64:67], v[160:163], v[200:203], v[64:67]
    ds_read_b64_tr_b16 v[184:185], v252 offset:57344
    ds_read_b64_tr_b16 v[186:187], v252 offset:58368
    v_mfma_f32_16x16x32_bf16 v[68:71], v[160:163], v[204:207], v[68:71]
    buffer_load_dwordx4 v[196:199], v255, s[12:15], s55 offen offset:256 sc1
    v_mfma_f32_16x16x32_bf16 v[72:75], v[164:167], v[200:203], v[72:75]
    ds_read_b64_tr_b16 v[188:189], v253 offset:57344
    ds_read_b64_tr_b16 v[190:191], v253 offset:58368
    v_mfma_f32_16x16x32_bf16 v[76:79], v[164:167], v[204:207], v[76:79]
    s_waitcnt lgkmcnt(8)
    v_mfma_f32_16x16x32_bf16 v[80:83], v[168:171], v[200:203], v[80:83]
    s_waitcnt vmcnt(6)
    s_barrier
    v_add_u32 v246, 0x10000, v246
    v_add_u32 v247, 0x10000, v247
    v_add_u32 v248, 0x10000, v248
    v_add_u32 v249, 0x10000, v249
    v_add_u32 v250, 0x10000, v250
    v_add_u32 v251, 0x10000, v251
    v_add_u32 v252, 0x10000, v252
    v_add_u32 v253, 0x10000, v253
    ds_read_b64_tr_b16 v[160:161], v246 offset:0
    ds_read_b64_tr_b16 v[162:163], v246 offset:1024
    v_mfma_f32_16x16x32_bf16 v[84:87], v[168:171], v[204:207], v[84:87]
    v_mfma_f32_16x16x32_bf16 v[88:91], v[172:175], v[200:203], v[88:91]
    ds_read_b64_tr_b16 v[164:165], v247 offset:0
    ds_read_b64_tr_b16 v[166:167], v247 offset:1024
    v_mfma_f32_16x16x32_bf16 v[92:95], v[172:175], v[204:207], v[92:95]
    s_waitcnt lgkmcnt(8)
    v_mfma_f32_16x16x32_bf16 v[96:99], v[176:179], v[200:203], v[96:99]
    ds_read_b64_tr_b16 v[168:169], v248 offset:0
    ds_read_b64_tr_b16 v[170:171], v248 offset:1024
    v_mfma_f32_16x16x32_bf16 v[100:103], v[176:179], v[204:207], v[100:103]
    v_mfma_f32_16x16x32_bf16 v[104:107], v[180:183], v[200:203], v[104:107]
    ds_read_b64_tr_b16 v[172:173], v249 offset:0
    ds_read_b64_tr_b16 v[174:175], v249 offset:1024
    v_mfma_f32_16x16x32_bf16 v[108:111], v[180:183], v[204:207], v[108:111]
    s_waitcnt lgkmcnt(8)
    v_mfma_f32_16x16x32_bf16 v[112:115], v[184:187], v[200:203], v[112:115]
    ds_read_b64_tr_b16 v[176:177], v250 offset:0
    ds_read_b64_tr_b16 v[178:179], v250 offset:1024
    v_mfma_f32_16x16x32_bf16 v[116:119], v[184:187], v[204:207], v[116:119]
    v_mfma_f32_16x16x32_bf16 v[120:123], v[188:191], v[200:203], v[120:123]
    ds_read_b64_tr_b16 v[180:181], v251 offset:0
    ds_read_b64_tr_b16 v[182:183], v251 offset:1024
    v_mfma_f32_16x16x32_bf16 v[124:127], v[188:191], v[204:207], v[124:127]
    buffer_load_dwordx4 v[200:203], v255, s[12:15], s55 offen offset:2048 sc1
    s_waitcnt vmcnt(12) lgkmcnt(8)
    v_mfma_f32_16x16x32_bf16 v[64:67], v[160:163], v[208:211], v[64:67]
    ds_read_b64_tr_b16 v[184:185], v252 offset:0
    ds_read_b64_tr_b16 v[186:187], v252 offset:1024
    v_mfma_f32_16x16x32_bf16 v[68:71], v[160:163], v[212:215], v[68:71]
    buffer_load_dwordx4 v[204:207], v255, s[12:15], s55 offen offset:2304 sc1
    v_mfma_f32_16x16x32_bf16 v[72:75], v[164:167], v[208:211], v[72:75]
    ds_read_b64_tr_b16 v[188:189], v253 offset:0
    ds_read_b64_tr_b16 v[190:191], v253 offset:1024
    v_mfma_f32_16x16x32_bf16 v[76:79], v[164:167], v[212:215], v[76:79]
    s_waitcnt lgkmcnt(8)
    v_mfma_f32_16x16x32_bf16 v[80:83], v[168:171], v[208:211], v[80:83]
    ds_read_b64_tr_b16 v[160:161], v246 offset:8192
    ds_read_b64_tr_b16 v[162:163], v246 offset:9216
    v_mfma_f32_16x16x32_bf16 v[84:87], v[168:171], v[212:215], v[84:87]
    v_mfma_f32_16x16x32_bf16 v[88:91], v[172:175], v[208:211], v[88:91]
    ds_read_b64_tr_b16 v[164:165], v247 offset:8192
    ds_read_b64_tr_b16 v[166:167], v247 offset:9216
    v_mfma_f32_16x16x32_bf16 v[92:95], v[172:175], v[212:215], v[92:95]
    s_waitcnt lgkmcnt(8)
    v_mfma_f32_16x16x32_bf16 v[96:99], v[176:179], v[208:211], v[96:99]
    ds_read_b64_tr_b16 v[168:169], v248 offset:8192
    ds_read_b64_tr_b16 v[170:171], v248 offset:9216
    v_mfma_f32_16x16x32_bf16 v[100:103], v[176:179], v[212:215], v[100:103]
    v_mfma_f32_16x16x32_bf16 v[104:107], v[180:183], v[208:211], v[104:107]
    ds_read_b64_tr_b16 v[172:173], v249 offset:8192
    ds_read_b64_tr_b16 v[174:175], v249 offset:9216
    v_mfma_f32_16x16x32_bf16 v[108:111], v[180:183], v[212:215], v[108:111]
    s_waitcnt lgkmcnt(8)
    v_mfma_f32_16x16x32_bf16 v[112:115], v[184:187], v[208:211], v[112:115]
    ds_read_b64_tr_b16 v[176:177], v250 offset:8192
    ds_read_b64_tr_b16 v[178:179], v250 offset:9216
    v_mfma_f32_16x16x32_bf16 v[116:119], v[184:187], v[212:215], v[116:119]
    v_mfma_f32_16x16x32_bf16 v[120:123], v[188:191], v[208:211], v[120:123]
    ds_read_b64_tr_b16 v[180:181], v251 offset:8192
    ds_read_b64_tr_b16 v[182:183], v251 offset:9216
    v_mfma_f32_16x16x32_bf16 v[124:127], v[188:191], v[212:215], v[124:127]
    s_add_u32 s55, s55, 4096
    buffer_load_dwordx4 v[208:211], v255, s[12:15], s55 offen offset:0 sc1
    s_waitcnt vmcnt(10) lgkmcnt(8)
    v_mfma_f32_16x16x32_bf16 v[64:67], v[160:163], v[216:219], v[64:67]
    ds_read_b64_tr_b16 v[184:185], v252 offset:8192
    ds_read_b64_tr_b16 v[186:187], v252 offset:9216
    v_mfma_f32_16x16x32_bf16 v[68:71], v[160:163], v[220:223], v[68:71]
    buffer_load_dwordx4 v[212:215], v255, s[12:15], s55 offen offset:256 sc1
    v_mfma_f32_16x16x32_bf16 v[72:75], v[164:167], v[216:219], v[72:75]
    ds_read_b64_tr_b16 v[188:189], v253 offset:8192
    ds_read_b64_tr_b16 v[190:191], v253 offset:9216
    v_mfma_f32_16x16x32_bf16 v[76:79], v[164:167], v[220:223], v[76:79]
    s_waitcnt lgkmcnt(8)
    v_mfma_f32_16x16x32_bf16 v[80:83], v[168:171], v[216:219], v[80:83]
    ds_read_b64_tr_b16 v[160:161], v246 offset:16384
    ds_read_b64_tr_b16 v[162:163], v246 offset:17408
    v_mfma_f32_16x16x32_bf16 v[84:87], v[168:171], v[220:223], v[84:87]
    v_mfma_f32_16x16x32_bf16 v[88:91], v[172:175], v[216:219], v[88:91]
    ds_read_b64_tr_b16 v[164:165], v247 offset:16384
    ds_read_b64_tr_b16 v[166:167], v247 offset:17408
    v_mfma_f32_16x16x32_bf16 v[92:95], v[172:175], v[220:223], v[92:95]
    s_waitcnt lgkmcnt(8)
    v_mfma_f32_16x16x32_bf16 v[96:99], v[176:179], v[216:219], v[96:99]
    ds_read_b64_tr_b16 v[168:169], v248 offset:16384
    ds_read_b64_tr_b16 v[170:171], v248 offset:17408
    v_mfma_f32_16x16x32_bf16 v[100:103], v[176:179], v[220:223], v[100:103]
    v_mfma_f32_16x16x32_bf16 v[104:107], v[180:183], v[216:219], v[104:107]
    ds_read_b64_tr_b16 v[172:173], v249 offset:16384
    ds_read_b64_tr_b16 v[174:175], v249 offset:17408
    v_mfma_f32_16x16x32_bf16 v[108:111], v[180:183], v[220:223], v[108:111]
    s_waitcnt lgkmcnt(8)
    v_mfma_f32_16x16x32_bf16 v[112:115], v[184:187], v[216:219], v[112:115]
    ds_read_b64_tr_b16 v[176:177], v250 offset:16384
    ds_read_b64_tr_b16 v[178:179], v250 offset:17408
    v_mfma_f32_16x16x32_bf16 v[116:119], v[184:187], v[220:223], v[116:119]
    v_mfma_f32_16x16x32_bf16 v[120:123], v[188:191], v[216:219], v[120:123]
    ds_read_b64_tr_b16 v[180:181], v251 offset:16384
    ds_read_b64_tr_b16 v[182:183], v251 offset:17408
    v_mfma_f32_16x16x32_bf16 v[124:127], v[188:191], v[220:223], v[124:127]
    buffer_load_dwordx4 v[216:219], v255, s[12:15], s55 offen offset:2048 sc1
    s_waitcnt vmcnt(9) lgkmcnt(8)
    v_mfma_f32_16x16x32_bf16 v[64:67], v[160:163], v[224:227], v[64:67]
    ds_read_b64_tr_b16 v[184:185], v252 offset:16384
    ds_read_b64_tr_b16 v[186:187], v252 offset:17408
    v_mfma_f32_16x16x32_bf16 v[68:71], v[160:163], v[228:231], v[68:71]
    buffer_load_dwordx4 v[220:223], v255, s[12:15], s55 offen offset:2304 sc1
    v_mfma_f32_16x16x32_bf16 v[72:75], v[164:167], v[224:227], v[72:75]
    ds_read_b64_tr_b16 v[188:189], v253 offset:16384
    ds_read_b64_tr_b16 v[190:191], v253 offset:17408
    v_mfma_f32_16x16x32_bf16 v[76:79], v[164:167], v[228:231], v[76:79]
    s_waitcnt lgkmcnt(8)
    v_mfma_f32_16x16x32_bf16 v[80:83], v[168:171], v[224:227], v[80:83]
    ds_read_b64_tr_b16 v[160:161], v246 offset:24576
    ds_read_b64_tr_b16 v[162:163], v246 offset:25600
    v_mfma_f32_16x16x32_bf16 v[84:87], v[168:171], v[228:231], v[84:87]
    v_mfma_f32_16x16x32_bf16 v[88:91], v[172:175], v[224:227], v[88:91]
    ds_read_b64_tr_b16 v[164:165], v247 offset:24576
    ds_read_b64_tr_b16 v[166:167], v247 offset:25600
    v_mfma_f32_16x16x32_bf16 v[92:95], v[172:175], v[228:231], v[92:95]
    s_waitcnt lgkmcnt(8)
    v_mfma_f32_16x16x32_bf16 v[96:99], v[176:179], v[224:227], v[96:99]
    ds_read_b64_tr_b16 v[168:169], v248 offset:24576
    ds_read_b64_tr_b16 v[170:171], v248 offset:25600
    v_mfma_f32_16x16x32_bf16 v[100:103], v[176:179], v[228:231], v[100:103]
    v_mfma_f32_16x16x32_bf16 v[104:107], v[180:183], v[224:227], v[104:107]
    ds_read_b64_tr_b16 v[172:173], v249 offset:24576
    ds_read_b64_tr_b16 v[174:175], v249 offset:25600
    v_mfma_f32_16x16x32_bf16 v[108:111], v[180:183], v[228:231], v[108:111]
    s_waitcnt lgkmcnt(8)
    v_mfma_f32_16x16x32_bf16 v[112:115], v[184:187], v[224:227], v[112:115]
    ds_read_b64_tr_b16 v[176:177], v250 offset:24576
    ds_read_b64_tr_b16 v[178:179], v250 offset:25600
    v_mfma_f32_16x16x32_bf16 v[116:119], v[184:187], v[228:231], v[116:119]
    v_mfma_f32_16x16x32_bf16 v[120:123], v[188:191], v[224:227], v[120:123]
    ds_read_b64_tr_b16 v[180:181], v251 offset:24576
    ds_read_b64_tr_b16 v[182:183], v251 offset:25600
    v_mfma_f32_16x16x32_bf16 v[124:127], v[188:191], v[228:231], v[124:127]
    s_add_u32 s55, s55, 4096
    buffer_load_dwordx4 v[224:227], v255, s[12:15], s55 offen offset:0 sc1
    s_waitcnt vmcnt(9) lgkmcnt(8)
    v_mfma_f32_16x16x32_bf16 v[64:67], v[160:163], v[232:235], v[64:67]
    ds_read_b64_tr_b16 v[184:185], v252 offset:24576
    ds_read_b64_tr_b16 v[186:187], v252 offset:25600
    v_mfma_f32_16x16x32_bf16 v[68:71], v[160:163], v[236:239], v[68:71]
    buffer_load_dwordx4 v[228:231], v255, s[12:15], s55 offen offset:256 sc1
    v_mfma_f32_16x16x32_bf16 v[72:75], v[164:167], v[232:235], v[72:75]
    ds_read_b64_tr_b16 v[188:189], v253 offset:24576
    ds_read_b64_tr_b16 v[190:191], v253 offset:25600
    v_mfma_f32_16x16x32_bf16 v[76:79], v[164:167], v[236:239], v[76:79]
    s_waitcnt lgkmcnt(8)
    v_mfma_f32_16x16x32_bf16 v[80:83], v[168:171], v[232:235], v[80:83]
    s_barrier
    ds_read_b64_tr_b16 v[160:161], v246 offset:32768
    ds_read_b64_tr_b16 v[162:163], v246 offset:33792
    v_mfma_f32_16x16x32_bf16 v[84:87], v[168:171], v[236:239], v[84:87]
    v_mfma_f32_16x16x32_bf16 v[88:91], v[172:175], v[232:235], v[88:91]
    ds_read_b64_tr_b16 v[164:165], v247 offset:32768
    ds_read_b64_tr_b16 v[166:167], v247 offset:33792
    v_mfma_f32_16x16x32_bf16 v[92:95], v[172:175], v[236:239], v[92:95]
    s_waitcnt lgkmcnt(8)
    v_mfma_f32_16x16x32_bf16 v[96:99], v[176:179], v[232:235], v[96:99]
    ds_read_b64_tr_b16 v[168:169], v248 offset:32768
    ds_read_b64_tr_b16 v[170:171], v248 offset:33792
    v_mfma_f32_16x16x32_bf16 v[100:103], v[176:179], v[236:239], v[100:103]
    v_mfma_f32_16x16x32_bf16 v[104:107], v[180:183], v[232:235], v[104:107]
    ds_read_b64_tr_b16 v[172:173], v249 offset:32768
    ds_read_b64_tr_b16 v[174:175], v249 offset:33792
    v_mfma_f32_16x16x32_bf16 v[108:111], v[180:183], v[236:239], v[108:111]
    s_waitcnt lgkmcnt(8)
    v_mfma_f32_16x16x32_bf16 v[112:115], v[184:187], v[232:235], v[112:115]
    ds_read_b64_tr_b16 v[176:177], v250 offset:32768
    ds_read_b64_tr_b16 v[178:179], v250 offset:33792
    v_mfma_f32_16x16x32_bf16 v[116:119], v[184:187], v[236:239], v[116:119]
    v_mfma_f32_16x16x32_bf16 v[120:123], v[188:191], v[232:235], v[120:123]
    ds_read_b64_tr_b16 v[180:181], v251 offset:32768
    ds_read_b64_tr_b16 v[182:183], v251 offset:33792
    v_mfma_f32_16x16x32_bf16 v[124:127], v[188:191], v[236:239], v[124:127]
    buffer_load_dwordx4 v[232:235], v255, s[12:15], s55 offen offset:2048 sc1
    s_waitcnt vmcnt(9) lgkmcnt(8)
    v_mfma_f32_16x16x32_bf16 v[64:67], v[160:163], v[192:195], v[64:67]
    ds_read_b64_tr_b16 v[184:185], v252 offset:32768
    ds_read_b64_tr_b16 v[186:187], v252 offset:33792
    v_mfma_f32_16x16x32_bf16 v[68:71], v[160:163], v[196:199], v[68:71]
    buffer_load_dwordx4 v[236:239], v255, s[12:15], s55 offen offset:2304 sc1
    v_mfma_f32_16x16x32_bf16 v[72:75], v[164:167], v[192:195], v[72:75]
    ds_read_b64_tr_b16 v[188:189], v253 offset:32768
    ds_read_b64_tr_b16 v[190:191], v253 offset:33792
    v_mfma_f32_16x16x32_bf16 v[76:79], v[164:167], v[196:199], v[76:79]
    s_waitcnt lgkmcnt(8)
    v_mfma_f32_16x16x32_bf16 v[80:83], v[168:171], v[192:195], v[80:83]
    ds_read_b64_tr_b16 v[160:161], v246 offset:40960
    ds_read_b64_tr_b16 v[162:163], v246 offset:41984
    v_mfma_f32_16x16x32_bf16 v[84:87], v[168:171], v[196:199], v[84:87]
    v_mfma_f32_16x16x32_bf16 v[88:91], v[172:175], v[192:195], v[88:91]
    ds_read_b64_tr_b16 v[164:165], v247 offset:40960
    ds_read_b64_tr_b16 v[166:167], v247 offset:41984
    v_mfma_f32_16x16x32_bf16 v[92:95], v[172:175], v[196:199], v[92:95]
    s_waitcnt lgkmcnt(8)
    v_mfma_f32_16x16x32_bf16 v[96:99], v[176:179], v[192:195], v[96:99]
    ds_read_b64_tr_b16 v[168:169], v248 offset:40960
    ds_read_b64_tr_b16 v[170:171], v248 offset:41984
    v_mfma_f32_16x16x32_bf16 v[100:103], v[176:179], v[196:199], v[100:103]
    v_mfma_f32_16x16x32_bf16 v[104:107], v[180:183], v[192:195], v[104:107]
    ds_read_b64_tr_b16 v[172:173], v249 offset:40960
    ds_read_b64_tr_b16 v[174:175], v249 offset:41984
    v_mfma_f32_16x16x32_bf16 v[108:111], v[180:183], v[196:199], v[108:111]
    s_waitcnt lgkmcnt(8)
    v_mfma_f32_16x16x32_bf16 v[112:115], v[184:187], v[192:195], v[112:115]
    ds_read_b64_tr_b16 v[176:177], v250 offset:40960
    ds_read_b64_tr_b16 v[178:179], v250 offset:41984
    v_mfma_f32_16x16x32_bf16 v[116:119], v[184:187], v[196:199], v[116:119]
    v_mfma_f32_16x16x32_bf16 v[120:123], v[188:191], v[192:195], v[120:123]
    ds_read_b64_tr_b16 v[180:181], v251 offset:40960
    ds_read_b64_tr_b16 v[182:183], v251 offset:41984
    v_mfma_f32_16x16x32_bf16 v[124:127], v[188:191], v[196:199], v[124:127]
    s_waitcnt vmcnt(8) lgkmcnt(8)
    v_mfma_f32_16x16x32_bf16 v[64:67], v[160:163], v[200:203], v[64:67]
    ds_read_b64_tr_b16 v[184:185], v252 offset:40960
    ds_read_b64_tr_b16 v[186:187], v252 offset:41984
    v_mfma_f32_16x16x32_bf16 v[68:71], v[160:163], v[204:207], v[68:71]
    v_mfma_f32_16x16x32_bf16 v[72:75], v[164:167], v[200:203], v[72:75]
    ds_read_b64_tr_b16 v[188:189], v253 offset:40960
    ds_read_b64_tr_b16 v[190:191], v253 offset:41984
    v_mfma_f32_16x16x32_bf16 v[76:79], v[164:167], v[204:207], v[76:79]
    s_waitcnt lgkmcnt(8)
    v_mfma_f32_16x16x32_bf16 v[80:83], v[168:171], v[200:203], v[80:83]
    ds_read_b64_tr_b16 v[160:161], v246 offset:49152
    ds_read_b64_tr_b16 v[162:163], v246 offset:50176
    v_mfma_f32_16x16x32_bf16 v[84:87], v[168:171], v[204:207], v[84:87]
    v_mfma_f32_16x16x32_bf16 v[88:91], v[172:175], v[200:203], v[88:91]
    ds_read_b64_tr_b16 v[164:165], v247 offset:49152
    ds_read_b64_tr_b16 v[166:167], v247 offset:50176
    v_mfma_f32_16x16x32_bf16 v[92:95], v[172:175], v[204:207], v[92:95]
    s_waitcnt lgkmcnt(8)
    v_mfma_f32_16x16x32_bf16 v[96:99], v[176:179], v[200:203], v[96:99]
    ds_read_b64_tr_b16 v[168:169], v248 offset:49152
    ds_read_b64_tr_b16 v[170:171], v248 offset:50176
    v_mfma_f32_16x16x32_bf16 v[100:103], v[176:179], v[204:207], v[100:103]
    v_mfma_f32_16x16x32_bf16 v[104:107], v[180:183], v[200:203], v[104:107]
    ds_read_b64_tr_b16 v[172:173], v249 offset:49152
    ds_read_b64_tr_b16 v[174:175], v249 offset:50176
    v_mfma_f32_16x16x32_bf16 v[108:111], v[180:183], v[204:207], v[108:111]
    s_waitcnt lgkmcnt(8)
    v_mfma_f32_16x16x32_bf16 v[112:115], v[184:187], v[200:203], v[112:115]
    ds_read_b64_tr_b16 v[176:177], v250 offset:49152
    ds_read_b64_tr_b16 v[178:179], v250 offset:50176
    v_mfma_f32_16x16x32_bf16 v[116:119], v[184:187], v[204:207], v[116:119]
    v_mfma_f32_16x16x32_bf16 v[120:123], v[188:191], v[200:203], v[120:123]
    ds_read_b64_tr_b16 v[180:181], v251 offset:49152
    ds_read_b64_tr_b16 v[182:183], v251 offset:50176
    v_mfma_f32_16x16x32_bf16 v[124:127], v[188:191], v[204:207], v[124:127]
    s_waitcnt vmcnt(6) lgkmcnt(8)
    v_mfma_f32_16x16x32_bf16 v[64:67], v[160:163], v[208:211], v[64:67]
    ds_read_b64_tr_b16 v[184:185], v252 offset:49152
    ds_read_b64_tr_b16 v[186:187], v252 offset:50176
    v_mfma_f32_16x16x32_bf16 v[68:71], v[160:163], v[212:215], v[68:71]
    v_mfma_f32_16x16x32_bf16 v[72:75], v[164:167], v[208:211], v[72:75]
    ds_read_b64_tr_b16 v[188:189], v253 offset:49152
    ds_read_b64_tr_b16 v[190:191], v253 offset:50176
    v_mfma_f32_16x16x32_bf16 v[76:79], v[164:167], v[212:215], v[76:79]
    s_waitcnt lgkmcnt(8)
    v_mfma_f32_16x16x32_bf16 v[80:83], v[168:171], v[208:211], v[80:83]
    ds_read_b64_tr_b16 v[160:161], v246 offset:57344
    ds_read_b64_tr_b16 v[162:163], v246 offset:58368
    v_mfma_f32_16x16x32_bf16 v[84:87], v[168:171], v[212:215], v[84:87]
    v_mfma_f32_16x16x32_bf16 v[88:91], v[172:175], v[208:211], v[88:91]
    ds_read_b64_tr_b16 v[164:165], v247 offset:57344
    ds_read_b64_tr_b16 v[166:167], v247 offset:58368
    v_mfma_f32_16x16x32_bf16 v[92:95], v[172:175], v[212:215], v[92:95]
    s_waitcnt lgkmcnt(8)
    v_mfma_f32_16x16x32_bf16 v[96:99], v[176:179], v[208:211], v[96:99]
    ds_read_b64_tr_b16 v[168:169], v248 offset:57344
    ds_read_b64_tr_b16 v[170:171], v248 offset:58368
    v_mfma_f32_16x16x32_bf16 v[100:103], v[176:179], v[212:215], v[100:103]
    v_mfma_f32_16x16x32_bf16 v[104:107], v[180:183], v[208:211], v[104:107]
    ds_read_b64_tr_b16 v[172:173], v249 offset:57344
    ds_read_b64_tr_b16 v[174:175], v249 offset:58368
    v_mfma_f32_16x16x32_bf16 v[108:111], v[180:183], v[212:215], v[108:111]
    s_waitcnt lgkmcnt(8)
    v_mfma_f32_16x16x32_bf16 v[112:115], v[184:187], v[208:211], v[112:115]
    ds_read_b64_tr_b16 v[176:177], v250 offset:57344
    ds_read_b64_tr_b16 v[178:179], v250 offset:58368
    v_mfma_f32_16x16x32_bf16 v[116:119], v[184:187], v[212:215], v[116:119]
    v_mfma_f32_16x16x32_bf16 v[120:123], v[188:191], v[208:211], v[120:123]
    ds_read_b64_tr_b16 v[180:181], v251 offset:57344
    ds_read_b64_tr_b16 v[182:183], v251 offset:58368
    v_mfma_f32_16x16x32_bf16 v[124:127], v[188:191], v[212:215], v[124:127]
    s_waitcnt vmcnt(4) lgkmcnt(8)
    v_mfma_f32_16x16x32_bf16 v[64:67], v[160:163], v[216:219], v[64:67]
    ds_read_b64_tr_b16 v[184:185], v252 offset:57344
    ds_read_b64_tr_b16 v[186:187], v252 offset:58368
    v_mfma_f32_16x16x32_bf16 v[68:71], v[160:163], v[220:223], v[68:71]
    v_mov_b32 v0, 0
    v_mov_b32 v1, 0
    v_mov_b32 v2, 0
    v_mov_b32 v3, 0
    v_mfma_f32_16x16x32_bf16 v[72:75], v[164:167], v[216:219], v[72:75]
    ds_read_b64_tr_b16 v[188:189], v253 offset:57344
    ds_read_b64_tr_b16 v[190:191], v253 offset:58368
    v_mfma_f32_16x16x32_bf16 v[76:79], v[164:167], v[220:223], v[76:79]
    v_mov_b32 v4, 0
    v_mov_b32 v5, 0
    v_mov_b32 v6, 0
    v_mov_b32 v7, 0
    s_waitcnt lgkmcnt(8)
    v_mfma_f32_16x16x32_bf16 v[80:83], v[168:171], v[216:219], v[80:83]
    s_barrier
    v_subrev_u32 v246, 0x10000, v246
    v_subrev_u32 v247, 0x10000, v247
    v_subrev_u32 v248, 0x10000, v248
    v_subrev_u32 v249, 0x10000, v249
    v_subrev_u32 v250, 0x10000, v250
    v_subrev_u32 v251, 0x10000, v251
    v_subrev_u32 v252, 0x10000, v252
    v_subrev_u32 v253, 0x10000, v253
    ds_read_b64_tr_b16 v[160:161], v246 offset:0
    ds_read_b64_tr_b16 v[162:163], v246 offset:1024
    v_mfma_f32_16x16x32_bf16 v[84:87], v[168:171], v[220:223], v[84:87]
    v_mov_b32 v8, 0
    v_mov_b32 v9, 0
    v_mov_b32 v10, 0
    v_mov_b32 v11, 0
    v_mfma_f32_16x16x32_bf16 v[88:91], v[172:175], v[216:219], v[88:91]
    ds_read_b64_tr_b16 v[164:165], v247 offset:0
    ds_read_b64_tr_b16 v[166:167], v247 offset:1024
    v_mfma_f32_16x16x32_bf16 v[92:95], v[172:175], v[220:223], v[92:95]
    v_mov_b32 v12, 0
    v_mov_b32 v13, 0
    v_mov_b32 v14, 0
    v_mov_b32 v15, 0
    s_waitcnt lgkmcnt(8)
    v_mfma_f32_16x16x32_bf16 v[96:99], v[176:179], v[216:219], v[96:99]
    ds_read_b64_tr_b16 v[168:169], v248 offset:0
    ds_read_b64_tr_b16 v[170:171], v248 offset:1024
    v_mfma_f32_16x16x32_bf16 v[100:103], v[176:179], v[220:223], v[100:103]
    v_mov_b32 v16, 0
    v_mov_b32 v17, 0
    v_mov_b32 v18, 0
    v_mov_b32 v19, 0
    v_mfma_f32_16x16x32_bf16 v[104:107], v[180:183], v[216:219], v[104:107]
    ds_read_b64_tr_b16 v[172:173], v249 offset:0
    ds_read_b64_tr_b16 v[174:175], v249 offset:1024
    v_mfma_f32_16x16x32_bf16 v[108:111], v[180:183], v[220:223], v[108:111]
    v_mov_b32 v20, 0
    v_mov_b32 v21, 0
    v_mov_b32 v22, 0
    v_mov_b32 v23, 0
    s_waitcnt lgkmcnt(8)
    v_mfma_f32_16x16x32_bf16 v[112:115], v[184:187], v[216:219], v[112:115]
    ds_read_b64_tr_b16 v[176:177], v250 offset:0
    ds_read_b64_tr_b16 v[178:179], v250 offset:1024
    v_mfma_f32_16x16x32_bf16 v[116:119], v[184:187], v[220:223], v[116:119]
    v_mov_b32 v24, 0
    v_mov_b32 v25, 0
    v_mov_b32 v26, 0
    v_mov_b32 v27, 0
    v_mfma_f32_16x16x32_bf16 v[120:123], v[188:191], v[216:219], v[120:123]
    ds_read_b64_tr_b16 v[180:181], v251 offset:0
    ds_read_b64_tr_b16 v[182:183], v251 offset:1024
    v_mfma_f32_16x16x32_bf16 v[124:127], v[188:191], v[220:223], v[124:127]
    v_mov_b32 v28, 0
    v_mov_b32 v29, 0
    v_mov_b32 v30, 0
    v_mov_b32 v31, 0
    s_waitcnt vmcnt(2) lgkmcnt(8)
    v_mfma_f32_16x16x32_bf16 v[64:67], v[160:163], v[224:227], v[64:67]
    ds_read_b64_tr_b16 v[184:185], v252 offset:0
    ds_read_b64_tr_b16 v[186:187], v252 offset:1024
    v_mfma_f32_16x16x32_bf16 v[68:71], v[160:163], v[228:231], v[68:71]
    v_mov_b32 v32, 0
    v_mov_b32 v33, 0
    v_mov_b32 v34, 0
    v_mov_b32 v35, 0
    v_mfma_f32_16x16x32_bf16 v[72:75], v[164:167], v[224:227], v[72:75]
    ds_read_b64_tr_b16 v[188:189], v253 offset:0
    ds_read_b64_tr_b16 v[190:191], v253 offset:1024
    v_mfma_f32_16x16x32_bf16 v[76:79], v[164:167], v[228:231], v[76:79]
    v_mov_b32 v36, 0
    v_mov_b32 v37, 0
    v_mov_b32 v38, 0
    v_mov_b32 v39, 0
    s_waitcnt lgkmcnt(8)
    v_mfma_f32_16x16x32_bf16 v[80:83], v[168:171], v[224:227], v[80:83]
    ds_read_b64_tr_b16 v[160:161], v246 offset:8192
    ds_read_b64_tr_b16 v[162:163], v246 offset:9216
    v_mfma_f32_16x16x32_bf16 v[84:87], v[168:171], v[228:231], v[84:87]
    v_mov_b32 v40, 0
    v_mov_b32 v41, 0
    v_mov_b32 v42, 0
    v_mov_b32 v43, 0
    v_mfma_f32_16x16x32_bf16 v[88:91], v[172:175], v[224:227], v[88:91]
    ds_read_b64_tr_b16 v[164:165], v247 offset:8192
    ds_read_b64_tr_b16 v[166:167], v247 offset:9216
    v_mfma_f32_16x16x32_bf16 v[92:95], v[172:175], v[228:231], v[92:95]
    v_mov_b32 v44, 0
    v_mov_b32 v45, 0
    v_mov_b32 v46, 0
    v_mov_b32 v47, 0
    s_waitcnt lgkmcnt(8)
    v_mfma_f32_16x16x32_bf16 v[96:99], v[176:179], v[224:227], v[96:99]
    ds_read_b64_tr_b16 v[168:169], v248 offset:8192
    ds_read_b64_tr_b16 v[170:171], v248 offset:9216
    v_mfma_f32_16x16x32_bf16 v[100:103], v[176:179], v[228:231], v[100:103]
    v_mov_b32 v48, 0
    v_mov_b32 v49, 0
    v_mov_b32 v50, 0
    v_mov_b32 v51, 0
    v_mfma_f32_16x16x32_bf16 v[104:107], v[180:183], v[224:227], v[104:107]
    ds_read_b64_tr_b16 v[172:173], v249 offset:8192
    ds_read_b64_tr_b16 v[174:175], v249 offset:9216
    v_mfma_f32_16x16x32_bf16 v[108:111], v[180:183], v[228:231], v[108:111]
    v_mov_b32 v52, 0
    v_mov_b32 v53, 0
    v_mov_b32 v54, 0
    v_mov_b32 v55, 0
    s_waitcnt lgkmcnt(8)
    v_mfma_f32_16x16x32_bf16 v[112:115], v[184:187], v[224:227], v[112:115]
    ds_read_b64_tr_b16 v[176:177], v250 offset:8192
    ds_read_b64_tr_b16 v[178:179], v250 offset:9216
    v_mfma_f32_16x16x32_bf16 v[116:119], v[184:187], v[228:231], v[116:119]
    v_mov_b32 v56, 0
    v_mov_b32 v57, 0
    v_mov_b32 v58, 0
    v_mov_b32 v59, 0
    v_mfma_f32_16x16x32_bf16 v[120:123], v[188:191], v[224:227], v[120:123]
    ds_read_b64_tr_b16 v[180:181], v251 offset:8192
    ds_read_b64_tr_b16 v[182:183], v251 offset:9216
    v_mfma_f32_16x16x32_bf16 v[124:127], v[188:191], v[228:231], v[124:127]
    v_mov_b32 v60, 0
    v_mov_b32 v61, 0
    v_mov_b32 v62, 0
    v_mov_b32 v63, 0
    s_waitcnt vmcnt(0) lgkmcnt(8)
    v_mfma_f32_16x16x32_bf16 v[64:67], v[160:163], v[232:235], v[64:67]
    ds_read_b64_tr_b16 v[184:185], v252 offset:8192
    ds_read_b64_tr_b16 v[186:187], v252 offset:9216
    v_mfma_f32_16x16x32_bf16 v[68:71], v[160:163], v[236:239], v[68:71]
    v_mfma_f32_16x16x32_bf16 v[72:75], v[164:167], v[232:235], v[72:75]
    ds_read_b64_tr_b16 v[188:189], v253 offset:8192
    ds_read_b64_tr_b16 v[190:191], v253 offset:9216
    v_mfma_f32_16x16x32_bf16 v[76:79], v[164:167], v[236:239], v[76:79]
    s_waitcnt lgkmcnt(8)
    v_mfma_f32_16x16x32_bf16 v[80:83], v[168:171], v[232:235], v[80:83]
    v_mfma_f32_16x16x32_bf16 v[84:87], v[168:171], v[236:239], v[84:87]
    v_mfma_f32_16x16x32_bf16 v[88:91], v[172:175], v[232:235], v[88:91]
    v_mfma_f32_16x16x32_bf16 v[92:95], v[172:175], v[236:239], v[92:95]
    s_waitcnt lgkmcnt(4)
    v_mfma_f32_16x16x32_bf16 v[96:99], v[176:179], v[232:235], v[96:99]
    v_mfma_f32_16x16x32_bf16 v[100:103], v[176:179], v[236:239], v[100:103]
    v_mfma_f32_16x16x32_bf16 v[104:107], v[180:183], v[232:235], v[104:107]
    v_mfma_f32_16x16x32_bf16 v[108:111], v[180:183], v[236:239], v[108:111]
    s_waitcnt lgkmcnt(0)
    v_mfma_f32_16x16x32_bf16 v[112:115], v[184:187], v[232:235], v[112:115]
    v_mfma_f32_16x16x32_bf16 v[116:119], v[184:187], v[236:239], v[116:119]
    v_mfma_f32_16x16x32_bf16 v[120:123], v[188:191], v[232:235], v[120:123]
    v_mfma_f32_16x16x32_bf16 v[124:127], v[188:191], v[236:239], v[124:127]
    s_nop 15
    v_cvt_pk_bf16_f32 v128, v64, v65
    v_cvt_pk_bf16_f32 v129, v66, v67
    v_cvt_pk_bf16_f32 v130, v68, v69
    v_cvt_pk_bf16_f32 v131, v70, v71
    v_cvt_pk_bf16_f32 v132, v72, v73
    v_cvt_pk_bf16_f32 v133, v74, v75
    v_cvt_pk_bf16_f32 v134, v76, v77
    v_cvt_pk_bf16_f32 v135, v78, v79
    v_cvt_pk_bf16_f32 v136, v80, v81
    v_cvt_pk_bf16_f32 v137, v82, v83
    v_cvt_pk_bf16_f32 v138, v84, v85
    v_cvt_pk_bf16_f32 v139, v86, v87
    v_cvt_pk_bf16_f32 v140, v88, v89
    v_cvt_pk_bf16_f32 v141, v90, v91
    v_cvt_pk_bf16_f32 v142, v92, v93
    v_cvt_pk_bf16_f32 v143, v94, v95
    v_cvt_pk_bf16_f32 v144, v96, v97
    v_cvt_pk_bf16_f32 v145, v98, v99
    v_cvt_pk_bf16_f32 v146, v100, v101
    v_cvt_pk_bf16_f32 v147, v102, v103
    v_cvt_pk_bf16_f32 v148, v104, v105
    v_cvt_pk_bf16_f32 v149, v106, v107
    v_cvt_pk_bf16_f32 v150, v108, v109
    v_cvt_pk_bf16_f32 v151, v110, v111
    v_cvt_pk_bf16_f32 v152, v112, v113
    v_cvt_pk_bf16_f32 v153, v114, v115
    v_cvt_pk_bf16_f32 v154, v116, v117
    v_cvt_pk_bf16_f32 v155, v118, v119
    v_cvt_pk_bf16_f32 v156, v120, v121
    v_cvt_pk_bf16_f32 v157, v122, v123
    v_cvt_pk_bf16_f32 v158, v124, v125
    v_cvt_pk_bf16_f32 v159, v126, v127
    v_mov_b32 v246, 0xff800000
    v_bfe_u32 v244, v243, 4, 5
    v_lshrrev_b32 v247, 9, v243
    v_lshlrev_b32 v247, 2, v247
    v_sub_u32 v244, v244, v247
    s_nop 1
    v_permlane16_swap_b32 v128, v130
    v_permlane16_swap_b32 v129, v131
    v_permlane16_swap_b32 v132, v134
    v_permlane16_swap_b32 v133, v135
    v_permlane16_swap_b32 v136, v138
    v_permlane16_swap_b32 v137, v139
    v_permlane16_swap_b32 v140, v142
    v_permlane16_swap_b32 v141, v143
    v_permlane16_swap_b32 v144, v146
    v_permlane16_swap_b32 v145, v147
    v_permlane16_swap_b32 v148, v150
    v_permlane16_swap_b32 v149, v151
    v_permlane16_swap_b32 v152, v154
    v_permlane16_swap_b32 v153, v155
    v_permlane16_swap_b32 v156, v158
    v_permlane16_swap_b32 v157, v159
    s_nop 1
    v_permlane32_swap_b32 v128, v130
    v_permlane32_swap_b32 v129, v131
    v_permlane32_swap_b32 v132, v134
    v_permlane32_swap_b32 v133, v135
    v_permlane32_swap_b32 v136, v138
    v_permlane32_swap_b32 v137, v139
    v_permlane32_swap_b32 v140, v142
    v_permlane32_swap_b32 v141, v143
    v_permlane32_swap_b32 v144, v146
    v_permlane32_swap_b32 v145, v147
    v_permlane32_swap_b32 v148, v150
    v_permlane32_swap_b32 v149, v151
    v_permlane32_swap_b32 v152, v154
    v_permlane32_swap_b32 v153, v155
    v_permlane32_swap_b32 v156, v158
    v_permlane32_swap_b32 v157, v159
    v_mov_b32 v120, 0
    v_mov_b32 v121, 0
    v_mov_b32 v122, 0
    v_mov_b32 v123, 0
    v_mov_b32 v124, 0
    v_mov_b32 v125, 0
    v_mov_b32 v126, 0
    v_mov_b32 v127, 0
    v_mov_b32 v96, 0
    v_mov_b32 v97, 0
    v_mov_b32 v98, 0
    v_mov_b32 v99, 0
    v_mov_b32 v100, 0
    v_mov_b32 v101, 0
    v_mov_b32 v102, 0
    v_mov_b32 v103, 0
    v_mov_b32 v104, 0
    v_mov_b32 v105, 0
    v_mov_b32 v106, 0
    v_mov_b32 v107, 0
    v_mov_b32 v108, 0
    v_mov_b32 v109, 0
    v_mov_b32 v110, 0
    v_mov_b32 v111, 0
    s_waitcnt vmcnt(0)
    s_branch parallel_sum__compressed_kv_cla__moe_arch_mod__prompt_kernel_B_qdone
parallel_sum__compressed_kv_cla__moe_arch_mod__prompt_kernel_B_qslow:
    buffer_load_dwordx4 v[216:219], v255, s[12:15], s55 offen offset:2048 sc1
    buffer_load_dwordx4 v[220:223], v255, s[12:15], s55 offen offset:2304 sc1
    s_add_u32 s55, s55, 4096
    buffer_load_dwordx4 v[224:227], v255, s[12:15], s55 offen offset:0 sc1
    buffer_load_dwordx4 v[228:231], v255, s[12:15], s55 offen offset:256 sc1
    buffer_load_dwordx4 v[232:235], v255, s[12:15], s55 offen offset:2048 sc1
    buffer_load_dwordx4 v[236:239], v255, s[12:15], s55 offen offset:2304 sc1
    s_nop 7
    v_mul_f32 v64, s69, v64
    v_mul_f32 v65, s69, v65
    v_mul_f32 v66, s69, v66
    v_mul_f32 v67, s69, v67
    v_mul_f32 v80, s69, v80
    v_mul_f32 v81, s69, v81
    v_mul_f32 v82, s69, v82
    v_mul_f32 v83, s69, v83
    v_cvt_pk_bf16_f32 v128, v64, v65
    v_cvt_pk_bf16_f32 v129, v66, v67
    v_cvt_pk_bf16_f32 v130, v80, v81
    v_cvt_pk_bf16_f32 v131, v82, v83
    s_nop 1
    v_permlane32_swap_b32 v128, v130
    v_permlane32_swap_b32 v129, v131
    v_mul_f32 v68, s69, v68
    v_mul_f32 v69, s69, v69
    v_mul_f32 v70, s69, v70
    v_mul_f32 v71, s69, v71
    v_mul_f32 v84, s69, v84
    v_mul_f32 v85, s69, v85
    v_mul_f32 v86, s69, v86
    v_mul_f32 v87, s69, v87
    v_cvt_pk_bf16_f32 v132, v68, v69
    v_cvt_pk_bf16_f32 v133, v70, v71
    v_cvt_pk_bf16_f32 v134, v84, v85
    v_cvt_pk_bf16_f32 v135, v86, v87
    s_nop 1
    v_permlane32_swap_b32 v132, v134
    v_permlane32_swap_b32 v133, v135
    v_mul_f32 v72, s69, v72
    v_mul_f32 v73, s69, v73
    v_mul_f32 v74, s69, v74
    v_mul_f32 v75, s69, v75
    v_mul_f32 v88, s69, v88
    v_mul_f32 v89, s69, v89
    v_mul_f32 v90, s69, v90
    v_mul_f32 v91, s69, v91
    v_cvt_pk_bf16_f32 v136, v72, v73
    v_cvt_pk_bf16_f32 v137, v74, v75
    v_cvt_pk_bf16_f32 v138, v88, v89
    v_cvt_pk_bf16_f32 v139, v90, v91
    s_nop 1
    v_permlane32_swap_b32 v136, v138
    v_permlane32_swap_b32 v137, v139
    v_mul_f32 v76, s69, v76
    v_mul_f32 v77, s69, v77
    v_mul_f32 v78, s69, v78
    v_mul_f32 v79, s69, v79
    v_mul_f32 v92, s69, v92
    v_mul_f32 v93, s69, v93
    v_mul_f32 v94, s69, v94
    v_mul_f32 v95, s69, v95
    v_cvt_pk_bf16_f32 v140, v76, v77
    v_cvt_pk_bf16_f32 v141, v78, v79
    v_cvt_pk_bf16_f32 v142, v92, v93
    v_cvt_pk_bf16_f32 v143, v94, v95
    s_nop 1
    v_permlane32_swap_b32 v140, v142
    v_permlane32_swap_b32 v141, v143
    v_mul_f32 v96, s69, v96
    v_mul_f32 v97, s69, v97
    v_mul_f32 v98, s69, v98
    v_mul_f32 v99, s69, v99
    v_mul_f32 v112, s69, v112
    v_mul_f32 v113, s69, v113
    v_mul_f32 v114, s69, v114
    v_mul_f32 v115, s69, v115
    v_cvt_pk_bf16_f32 v144, v96, v97
    v_cvt_pk_bf16_f32 v145, v98, v99
    v_cvt_pk_bf16_f32 v146, v112, v113
    v_cvt_pk_bf16_f32 v147, v114, v115
    s_nop 1
    v_permlane32_swap_b32 v144, v146
    v_permlane32_swap_b32 v145, v147
    v_mul_f32 v100, s69, v100
    v_mul_f32 v101, s69, v101
    v_mul_f32 v102, s69, v102
    v_mul_f32 v103, s69, v103
    v_mul_f32 v116, s69, v116
    v_mul_f32 v117, s69, v117
    v_mul_f32 v118, s69, v118
    v_mul_f32 v119, s69, v119
    v_cvt_pk_bf16_f32 v148, v100, v101
    v_cvt_pk_bf16_f32 v149, v102, v103
    v_cvt_pk_bf16_f32 v150, v116, v117
    v_cvt_pk_bf16_f32 v151, v118, v119
    s_nop 1
    v_permlane32_swap_b32 v148, v150
    v_permlane32_swap_b32 v149, v151
    v_mul_f32 v104, s69, v104
    v_mul_f32 v105, s69, v105
    v_mul_f32 v106, s69, v106
    v_mul_f32 v107, s69, v107
    v_mul_f32 v120, s69, v120
    v_mul_f32 v121, s69, v121
    v_mul_f32 v122, s69, v122
    v_mul_f32 v123, s69, v123
    v_cvt_pk_bf16_f32 v152, v104, v105
    v_cvt_pk_bf16_f32 v153, v106, v107
    v_cvt_pk_bf16_f32 v154, v120, v121
    v_cvt_pk_bf16_f32 v155, v122, v123
    s_nop 1
    v_permlane32_swap_b32 v152, v154
    v_permlane32_swap_b32 v153, v155
    v_mul_f32 v108, s69, v108
    v_mul_f32 v109, s69, v109
    v_mul_f32 v110, s69, v110
    v_mul_f32 v111, s69, v111
    v_mul_f32 v124, s69, v124
    v_mul_f32 v125, s69, v125
    v_mul_f32 v126, s69, v126
    v_mul_f32 v127, s69, v127
    v_cvt_pk_bf16_f32 v156, v108, v109
    v_cvt_pk_bf16_f32 v157, v110, v111
    v_cvt_pk_bf16_f32 v158, v124, v125
    v_cvt_pk_bf16_f32 v159, v126, v127
    s_nop 1
    v_permlane32_swap_b32 v156, v158
    v_permlane32_swap_b32 v157, v159
    s_waitcnt vmcnt(24)
    s_barrier
    ds_read_b64_tr_b16 v[160:161], v246 offset:0
    ds_read_b64_tr_b16 v[162:163], v246 offset:1024
    ds_read_b64_tr_b16 v[164:165], v247 offset:0
    ds_read_b64_tr_b16 v[166:167], v247 offset:1024
    ds_read_b64_tr_b16 v[168:169], v248 offset:0
    ds_read_b64_tr_b16 v[170:171], v248 offset:1024
    ds_read_b64_tr_b16 v[172:173], v249 offset:0
    ds_read_b64_tr_b16 v[174:175], v249 offset:1024
    ds_read_b64_tr_b16 v[176:177], v250 offset:0
    ds_read_b64_tr_b16 v[178:179], v250 offset:1024
    ds_read_b64_tr_b16 v[180:181], v251 offset:0
    ds_read_b64_tr_b16 v[182:183], v251 offset:1024
    s_waitcnt vmcnt(10) lgkmcnt(8)
    v_mfma_f32_16x16x32_bf16 v[64:67], v[160:163], v[192:195], 0
    ds_read_b64_tr_b16 v[184:185], v252 offset:0
    ds_read_b64_tr_b16 v[186:187], v252 offset:1024
    v_mfma_f32_16x16x32_bf16 v[68:71], v[160:163], v[196:199], 0
    v_mul_f32 v0, s69, v0
    v_mul_f32 v1, s69, v1
    v_mul_f32 v2, s69, v2
    v_mul_f32 v3, s69, v3
    v_mfma_f32_16x16x32_bf16 v[72:75], v[164:167], v[192:195], 0
    ds_read_b64_tr_b16 v[188:189], v253 offset:0
    ds_read_b64_tr_b16 v[190:191], v253 offset:1024
    v_mfma_f32_16x16x32_bf16 v[76:79], v[164:167], v[196:199], 0
    v_mul_f32 v16, s69, v16
    v_mul_f32 v17, s69, v17
    v_mul_f32 v18, s69, v18
    v_mul_f32 v19, s69, v19
    s_waitcnt lgkmcnt(8)
    v_mfma_f32_16x16x32_bf16 v[80:83], v[168:171], v[192:195], 0
    ds_read_b64_tr_b16 v[160:161], v246 offset:8192
    ds_read_b64_tr_b16 v[162:163], v246 offset:9216
    v_mfma_f32_16x16x32_bf16 v[84:87], v[168:171], v[196:199], 0
    v_cvt_pk_bf16_f32 v0, v0, v1
    v_cvt_pk_bf16_f32 v1, v2, v3
    v_cvt_pk_bf16_f32 v2, v16, v17
    v_cvt_pk_bf16_f32 v3, v18, v19
    v_mfma_f32_16x16x32_bf16 v[88:91], v[172:175], v[192:195], 0
    ds_read_b64_tr_b16 v[164:165], v247 offset:8192
    ds_read_b64_tr_b16 v[166:167], v247 offset:9216
    v_mfma_f32_16x16x32_bf16 v[92:95], v[172:175], v[196:199], 0
    s_nop 1
    v_permlane32_swap_b32 v0, v2
    v_permlane32_swap_b32 v1, v3
    v_mul_f32 v4, s69, v4
    s_waitcnt lgkmcnt(8)
    v_mfma_f32_16x16x32_bf16 v[96:99], v[176:179], v[192:195], 0
    ds_read_b64_tr_b16 v[168:169], v248 offset:8192
    ds_read_b64_tr_b16 v[170:171], v248 offset:9216
    v_mfma_f32_16x16x32_bf16 v[100:103], v[176:179], v[196:199], 0
    v_mul_f32 v5, s69, v5
    v_mul_f32 v6, s69, v6
    v_mul_f32 v7, s69, v7
    v_mul_f32 v20, s69, v20
    v_mfma_f32_16x16x32_bf16 v[104:107], v[180:183], v[192:195], 0
    ds_read_b64_tr_b16 v[172:173], v249 offset:8192
    ds_read_b64_tr_b16 v[174:175], v249 offset:9216
    v_mfma_f32_16x16x32_bf16 v[108:111], v[180:183], v[196:199], 0
    v_mul_f32 v21, s69, v21
    v_mul_f32 v22, s69, v22
    v_mul_f32 v23, s69, v23
    v_cvt_pk_bf16_f32 v4, v4, v5
    s_waitcnt lgkmcnt(8)
    v_mfma_f32_16x16x32_bf16 v[112:115], v[184:187], v[192:195], 0
    ds_read_b64_tr_b16 v[176:177], v250 offset:8192
    ds_read_b64_tr_b16 v[178:179], v250 offset:9216
    v_mfma_f32_16x16x32_bf16 v[116:119], v[184:187], v[196:199], 0
    v_cvt_pk_bf16_f32 v5, v6, v7
    v_cvt_pk_bf16_f32 v6, v20, v21
    v_cvt_pk_bf16_f32 v7, v22, v23
    s_nop 1
    v_mfma_f32_16x16x32_bf16 v[120:123], v[188:191], v[192:195], 0
    ds_read_b64_tr_b16 v[180:181], v251 offset:8192
    ds_read_b64_tr_b16 v[182:183], v251 offset:9216
    v_mfma_f32_16x16x32_bf16 v[124:127], v[188:191], v[196:199], 0
    s_add_u32 s55, s55, 4096
    buffer_load_dwordx4 v[192:195], v255, s[12:15], s55 offen offset:0 sc1
    v_permlane32_swap_b32 v4, v6
    v_permlane32_swap_b32 v5, v7
    v_mul_f32 v8, s69, v8
    v_mul_f32 v9, s69, v9
    s_waitcnt vmcnt(9) lgkmcnt(8)
    v_mfma_f32_16x16x32_bf16 v[64:67], v[160:163], v[200:203], v[64:67]
    ds_read_b64_tr_b16 v[184:185], v252 offset:8192
    ds_read_b64_tr_b16 v[186:187], v252 offset:9216
    v_mfma_f32_16x16x32_bf16 v[68:71], v[160:163], v[204:207], v[68:71]
    s_add_u32 s68, s68, 32768
    buffer_store_dwordx4 v[128:131], v242, s[12:15], s68 offen offset:0 sc1
    v_mul_f32 v10, s69, v10
    v_mul_f32 v11, s69, v11
    v_mul_f32 v24, s69, v24
    v_mul_f32 v25, s69, v25
    v_mfma_f32_16x16x32_bf16 v[72:75], v[164:167], v[200:203], v[72:75]
    ds_read_b64_tr_b16 v[188:189], v253 offset:8192
    ds_read_b64_tr_b16 v[190:191], v253 offset:9216
    v_mfma_f32_16x16x32_bf16 v[76:79], v[164:167], v[204:207], v[76:79]
    buffer_load_dwordx4 v[196:199], v255, s[12:15], s55 offen offset:256 sc1
    v_mul_f32 v26, s69, v26
    v_mul_f32 v27, s69, v27
    v_cvt_pk_bf16_f32 v8, v8, v9
    v_cvt_pk_bf16_f32 v9, v10, v11
    s_waitcnt lgkmcnt(8)
    v_mfma_f32_16x16x32_bf16 v[80:83], v[168:171], v[200:203], v[80:83]
    ds_read_b64_tr_b16 v[160:161], v246 offset:16384
    ds_read_b64_tr_b16 v[162:163], v246 offset:17408
    v_mfma_f32_16x16x32_bf16 v[84:87], v[168:171], v[204:207], v[84:87]
    v_cvt_pk_bf16_f32 v10, v24, v25
    v_cvt_pk_bf16_f32 v11, v26, v27
    s_nop 1
    v_permlane32_swap_b32 v8, v10
    v_mfma_f32_16x16x32_bf16 v[88:91], v[172:175], v[200:203], v[88:91]
    ds_read_b64_tr_b16 v[164:165], v247 offset:16384
    ds_read_b64_tr_b16 v[166:167], v247 offset:17408
    v_mfma_f32_16x16x32_bf16 v[92:95], v[172:175], v[204:207], v[92:95]
    v_permlane32_swap_b32 v9, v11
    v_mul_f32 v12, s69, v12
    v_mul_f32 v13, s69, v13
    v_mul_f32 v14, s69, v14
    s_waitcnt lgkmcnt(8)
    v_mfma_f32_16x16x32_bf16 v[96:99], v[176:179], v[200:203], v[96:99]
    ds_read_b64_tr_b16 v[168:169], v248 offset:16384
    ds_read_b64_tr_b16 v[170:171], v248 offset:17408
    v_mfma_f32_16x16x32_bf16 v[100:103], v[176:179], v[204:207], v[100:103]
    v_mul_f32 v15, s69, v15
    v_mul_f32 v28, s69, v28
    v_mul_f32 v29, s69, v29
    v_mul_f32 v30, s69, v30
    v_mfma_f32_16x16x32_bf16 v[104:107], v[180:183], v[200:203], v[104:107]
    ds_read_b64_tr_b16 v[172:173], v249 offset:16384
    ds_read_b64_tr_b16 v[174:175], v249 offset:17408
    v_mfma_f32_16x16x32_bf16 v[108:111], v[180:183], v[204:207], v[108:111]
    v_mul_f32 v31, s69, v31
    v_cvt_pk_bf16_f32 v12, v12, v13
    v_cvt_pk_bf16_f32 v13, v14, v15
    v_cvt_pk_bf16_f32 v14, v28, v29
    s_waitcnt lgkmcnt(8)
    v_mfma_f32_16x16x32_bf16 v[112:115], v[184:187], v[200:203], v[112:115]
    ds_read_b64_tr_b16 v[176:177], v250 offset:16384
    ds_read_b64_tr_b16 v[178:179], v250 offset:17408
    v_mfma_f32_16x16x32_bf16 v[116:119], v[184:187], v[204:207], v[116:119]
    v_cvt_pk_bf16_f32 v15, v30, v31
    s_nop 1
    v_permlane32_swap_b32 v12, v14
    v_permlane32_swap_b32 v13, v15
    v_mfma_f32_16x16x32_bf16 v[120:123], v[188:191], v[200:203], v[120:123]
    ds_read_b64_tr_b16 v[180:181], v251 offset:16384
    ds_read_b64_tr_b16 v[182:183], v251 offset:17408
    v_mfma_f32_16x16x32_bf16 v[124:127], v[188:191], v[204:207], v[124:127]
    buffer_store_dwordx4 v[132:135], v242, s[12:15], s68 offen offset:1024 sc1
    v_mul_f32 v32, s69, v32
    v_mul_f32 v33, s69, v33
    v_mul_f32 v34, s69, v34
    v_mul_f32 v35, s69, v35
    s_waitcnt vmcnt(10) lgkmcnt(8)
    v_mfma_f32_16x16x32_bf16 v[64:67], v[160:163], v[208:211], v[64:67]
    ds_read_b64_tr_b16 v[184:185], v252 offset:16384
    ds_read_b64_tr_b16 v[186:187], v252 offset:17408
    v_mfma_f32_16x16x32_bf16 v[68:71], v[160:163], v[212:215], v[68:71]
    buffer_load_dwordx4 v[200:203], v255, s[12:15], s55 offen offset:2048 sc1
    v_mul_f32 v48, s69, v48
    v_mul_f32 v49, s69, v49
    v_mul_f32 v50, s69, v50
    v_mul_f32 v51, s69, v51
    v_mfma_f32_16x16x32_bf16 v[72:75], v[164:167], v[208:211], v[72:75]
    ds_read_b64_tr_b16 v[188:189], v253 offset:16384
    ds_read_b64_tr_b16 v[190:191], v253 offset:17408
    v_mfma_f32_16x16x32_bf16 v[76:79], v[164:167], v[212:215], v[76:79]
    buffer_load_dwordx4 v[204:207], v255, s[12:15], s55 offen offset:2304 sc1
    v_cvt_pk_bf16_f32 v16, v32, v33
    v_cvt_pk_bf16_f32 v17, v34, v35
    v_cvt_pk_bf16_f32 v18, v48, v49
    v_cvt_pk_bf16_f32 v19, v50, v51
    s_waitcnt lgkmcnt(8)
    v_mfma_f32_16x16x32_bf16 v[80:83], v[168:171], v[208:211], v[80:83]
    ds_read_b64_tr_b16 v[160:161], v246 offset:24576
    ds_read_b64_tr_b16 v[162:163], v246 offset:25600
    v_mfma_f32_16x16x32_bf16 v[84:87], v[168:171], v[212:215], v[84:87]
    s_nop 1
    v_permlane32_swap_b32 v16, v18
    v_permlane32_swap_b32 v17, v19
    v_mul_f32 v36, s69, v36
    v_mfma_f32_16x16x32_bf16 v[88:91], v[172:175], v[208:211], v[88:91]
    ds_read_b64_tr_b16 v[164:165], v247 offset:24576
    ds_read_b64_tr_b16 v[166:167], v247 offset:25600
    v_mfma_f32_16x16x32_bf16 v[92:95], v[172:175], v[212:215], v[92:95]
    v_mul_f32 v37, s69, v37
    v_mul_f32 v38, s69, v38
    v_mul_f32 v39, s69, v39
    v_mul_f32 v52, s69, v52
    s_waitcnt lgkmcnt(8)
    v_mfma_f32_16x16x32_bf16 v[96:99], v[176:179], v[208:211], v[96:99]
    ds_read_b64_tr_b16 v[168:169], v248 offset:24576
    ds_read_b64_tr_b16 v[170:171], v248 offset:25600
    v_mfma_f32_16x16x32_bf16 v[100:103], v[176:179], v[212:215], v[100:103]
    v_mul_f32 v53, s69, v53
    v_mul_f32 v54, s69, v54
    v_mul_f32 v55, s69, v55
    v_cvt_pk_bf16_f32 v20, v36, v37
    v_mfma_f32_16x16x32_bf16 v[104:107], v[180:183], v[208:211], v[104:107]
    ds_read_b64_tr_b16 v[172:173], v249 offset:24576
    ds_read_b64_tr_b16 v[174:175], v249 offset:25600
    v_mfma_f32_16x16x32_bf16 v[108:111], v[180:183], v[212:215], v[108:111]
    v_cvt_pk_bf16_f32 v21, v38, v39
    v_cvt_pk_bf16_f32 v22, v52, v53
    v_cvt_pk_bf16_f32 v23, v54, v55
    s_nop 1
    s_waitcnt lgkmcnt(8)
    v_mfma_f32_16x16x32_bf16 v[112:115], v[184:187], v[208:211], v[112:115]
    ds_read_b64_tr_b16 v[176:177], v250 offset:24576
    ds_read_b64_tr_b16 v[178:179], v250 offset:25600
    v_mfma_f32_16x16x32_bf16 v[116:119], v[184:187], v[212:215], v[116:119]
    buffer_store_dwordx4 v[136:139], v242, s[12:15], s68 offen offset:2048 sc1
    v_permlane32_swap_b32 v20, v22
    v_permlane32_swap_b32 v21, v23
    v_mul_f32 v40, s69, v40
    v_mul_f32 v41, s69, v41
    v_mfma_f32_16x16x32_bf16 v[120:123], v[188:191], v[208:211], v[120:123]
    ds_read_b64_tr_b16 v[180:181], v251 offset:24576
    ds_read_b64_tr_b16 v[182:183], v251 offset:25600
    v_mfma_f32_16x16x32_bf16 v[124:127], v[188:191], v[212:215], v[124:127]
    s_add_u32 s55, s55, 4096
    buffer_load_dwordx4 v[208:211], v255, s[12:15], s55 offen offset:0 sc1
    v_mul_f32 v42, s69, v42
    v_mul_f32 v43, s69, v43
    v_mul_f32 v56, s69, v56
    v_mul_f32 v57, s69, v57
    s_waitcnt vmcnt(12) lgkmcnt(8)
    v_mfma_f32_16x16x32_bf16 v[64:67], v[160:163], v[216:219], v[64:67]
    ds_read_b64_tr_b16 v[184:185], v252 offset:24576
    ds_read_b64_tr_b16 v[186:187], v252 offset:25600
    v_mfma_f32_16x16x32_bf16 v[68:71], v[160:163], v[220:223], v[68:71]
    buffer_load_dwordx4 v[212:215], v255, s[12:15], s55 offen offset:256 sc1
    v_mul_f32 v58, s69, v58
    v_mul_f32 v59, s69, v59
    v_cvt_pk_bf16_f32 v24, v40, v41
    v_cvt_pk_bf16_f32 v25, v42, v43
    v_mfma_f32_16x16x32_bf16 v[72:75], v[164:167], v[216:219], v[72:75]
    ds_read_b64_tr_b16 v[188:189], v253 offset:24576
    ds_read_b64_tr_b16 v[190:191], v253 offset:25600
    v_mfma_f32_16x16x32_bf16 v[76:79], v[164:167], v[220:223], v[76:79]
    v_cvt_pk_bf16_f32 v26, v56, v57
    v_cvt_pk_bf16_f32 v27, v58, v59
    s_nop 1
    v_permlane32_swap_b32 v24, v26
    s_waitcnt lgkmcnt(8)
    v_mfma_f32_16x16x32_bf16 v[80:83], v[168:171], v[216:219], v[80:83]
    s_waitcnt vmcnt(21)
    s_barrier
    ds_read_b64_tr_b16 v[160:161], v246 offset:32768
    ds_read_b64_tr_b16 v[162:163], v246 offset:33792
    v_mfma_f32_16x16x32_bf16 v[84:87], v[168:171], v[220:223], v[84:87]
    v_permlane32_swap_b32 v25, v27
    v_mul_f32 v44, s69, v44
    v_mul_f32 v45, s69, v45
    v_mul_f32 v46, s69, v46
    v_mfma_f32_16x16x32_bf16 v[88:91], v[172:175], v[216:219], v[88:91]
    ds_read_b64_tr_b16 v[164:165], v247 offset:32768
    ds_read_b64_tr_b16 v[166:167], v247 offset:33792
    v_mfma_f32_16x16x32_bf16 v[92:95], v[172:175], v[220:223], v[92:95]
    v_mul_f32 v47, s69, v47
    v_mul_f32 v60, s69, v60
    v_mul_f32 v61, s69, v61
    v_mul_f32 v62, s69, v62
    s_waitcnt lgkmcnt(8)
    v_mfma_f32_16x16x32_bf16 v[96:99], v[176:179], v[216:219], v[96:99]
    ds_read_b64_tr_b16 v[168:169], v248 offset:32768
    ds_read_b64_tr_b16 v[170:171], v248 offset:33792
    v_mfma_f32_16x16x32_bf16 v[100:103], v[176:179], v[220:223], v[100:103]
    v_mul_f32 v63, s69, v63
    v_cvt_pk_bf16_f32 v28, v44, v45
    v_cvt_pk_bf16_f32 v29, v46, v47
    v_cvt_pk_bf16_f32 v30, v60, v61
    v_mfma_f32_16x16x32_bf16 v[104:107], v[180:183], v[216:219], v[104:107]
    ds_read_b64_tr_b16 v[172:173], v249 offset:32768
    ds_read_b64_tr_b16 v[174:175], v249 offset:33792
    v_mfma_f32_16x16x32_bf16 v[108:111], v[180:183], v[220:223], v[108:111]
    buffer_store_dwordx4 v[140:143], v242, s[12:15], s68 offen offset:3072 sc1
    s_add_u32 s68, s68, 16384
    v_cvt_pk_bf16_f32 v31, v62, v63
    s_nop 1
    v_permlane32_swap_b32 v28, v30
    v_permlane32_swap_b32 v29, v31
    s_waitcnt lgkmcnt(8)
    v_mfma_f32_16x16x32_bf16 v[112:115], v[184:187], v[216:219], v[112:115]
    ds_read_b64_tr_b16 v[176:177], v250 offset:32768
    ds_read_b64_tr_b16 v[178:179], v250 offset:33792
    v_mfma_f32_16x16x32_bf16 v[116:119], v[184:187], v[220:223], v[116:119]
    v_mfma_f32_16x16x32_bf16 v[120:123], v[188:191], v[216:219], v[120:123]
    ds_read_b64_tr_b16 v[180:181], v251 offset:32768
    ds_read_b64_tr_b16 v[182:183], v251 offset:33792
    v_mfma_f32_16x16x32_bf16 v[124:127], v[188:191], v[220:223], v[124:127]
    buffer_load_dwordx4 v[216:219], v255, s[12:15], s55 offen offset:2048 sc1
    s_waitcnt vmcnt(13) lgkmcnt(8)
    v_mfma_f32_16x16x32_bf16 v[64:67], v[160:163], v[224:227], v[64:67]
    ds_read_b64_tr_b16 v[184:185], v252 offset:32768
    ds_read_b64_tr_b16 v[186:187], v252 offset:33792
    v_mfma_f32_16x16x32_bf16 v[68:71], v[160:163], v[228:231], v[68:71]
    buffer_load_dwordx4 v[220:223], v255, s[12:15], s55 offen offset:2304 sc1
    v_mfma_f32_16x16x32_bf16 v[72:75], v[164:167], v[224:227], v[72:75]
    ds_read_b64_tr_b16 v[188:189], v253 offset:32768
    ds_read_b64_tr_b16 v[190:191], v253 offset:33792
    v_mfma_f32_16x16x32_bf16 v[76:79], v[164:167], v[228:231], v[76:79]
    s_waitcnt lgkmcnt(8)
    v_mfma_f32_16x16x32_bf16 v[80:83], v[168:171], v[224:227], v[80:83]
    ds_read_b64_tr_b16 v[160:161], v246 offset:40960
    ds_read_b64_tr_b16 v[162:163], v246 offset:41984
    v_mfma_f32_16x16x32_bf16 v[84:87], v[168:171], v[228:231], v[84:87]
    v_mfma_f32_16x16x32_bf16 v[88:91], v[172:175], v[224:227], v[88:91]
    ds_read_b64_tr_b16 v[164:165], v247 offset:40960
    ds_read_b64_tr_b16 v[166:167], v247 offset:41984
    v_mfma_f32_16x16x32_bf16 v[92:95], v[172:175], v[228:231], v[92:95]
    s_waitcnt lgkmcnt(8)
    v_mfma_f32_16x16x32_bf16 v[96:99], v[176:179], v[224:227], v[96:99]
    ds_read_b64_tr_b16 v[168:169], v248 offset:40960
    ds_read_b64_tr_b16 v[170:171], v248 offset:41984
    v_mfma_f32_16x16x32_bf16 v[100:103], v[176:179], v[228:231], v[100:103]
    buffer_store_dwordx4 v[144:147], v242, s[12:15], s68 offen offset:0 sc1
    v_mfma_f32_16x16x32_bf16 v[104:107], v[180:183], v[224:227], v[104:107]
    ds_read_b64_tr_b16 v[172:173], v249 offset:40960
    ds_read_b64_tr_b16 v[174:175], v249 offset:41984
    v_mfma_f32_16x16x32_bf16 v[108:111], v[180:183], v[228:231], v[108:111]
    s_waitcnt lgkmcnt(8)
    v_mfma_f32_16x16x32_bf16 v[112:115], v[184:187], v[224:227], v[112:115]
    ds_read_b64_tr_b16 v[176:177], v250 offset:40960
    ds_read_b64_tr_b16 v[178:179], v250 offset:41984
    v_mfma_f32_16x16x32_bf16 v[116:119], v[184:187], v[228:231], v[116:119]
    v_mfma_f32_16x16x32_bf16 v[120:123], v[188:191], v[224:227], v[120:123]
    ds_read_b64_tr_b16 v[180:181], v251 offset:40960
    ds_read_b64_tr_b16 v[182:183], v251 offset:41984
    v_mfma_f32_16x16x32_bf16 v[124:127], v[188:191], v[228:231], v[124:127]
    s_add_u32 s55, s55, 4096
    buffer_load_dwordx4 v[224:227], v255, s[12:15], s55 offen offset:0 sc1
    s_waitcnt vmcnt(14) lgkmcnt(8)
    v_mfma_f32_16x16x32_bf16 v[64:67], v[160:163], v[232:235], v[64:67]
    ds_read_b64_tr_b16 v[184:185], v252 offset:40960
    ds_read_b64_tr_b16 v[186:187], v252 offset:41984
    v_mfma_f32_16x16x32_bf16 v[68:71], v[160:163], v[236:239], v[68:71]
    buffer_load_dwordx4 v[228:231], v255, s[12:15], s55 offen offset:256 sc1
    v_mfma_f32_16x16x32_bf16 v[72:75], v[164:167], v[232:235], v[72:75]
    ds_read_b64_tr_b16 v[188:189], v253 offset:40960
    ds_read_b64_tr_b16 v[190:191], v253 offset:41984
    v_mfma_f32_16x16x32_bf16 v[76:79], v[164:167], v[236:239], v[76:79]
    s_waitcnt lgkmcnt(8)
    v_mfma_f32_16x16x32_bf16 v[80:83], v[168:171], v[232:235], v[80:83]
    ds_read_b64_tr_b16 v[160:161], v246 offset:49152
    ds_read_b64_tr_b16 v[162:163], v246 offset:50176
    v_mfma_f32_16x16x32_bf16 v[84:87], v[168:171], v[236:239], v[84:87]
    v_mfma_f32_16x16x32_bf16 v[88:91], v[172:175], v[232:235], v[88:91]
    ds_read_b64_tr_b16 v[164:165], v247 offset:49152
    ds_read_b64_tr_b16 v[166:167], v247 offset:50176
    v_mfma_f32_16x16x32_bf16 v[92:95], v[172:175], v[236:239], v[92:95]
    buffer_store_dwordx4 v[148:151], v242, s[12:15], s68 offen offset:1024 sc1
    s_waitcnt lgkmcnt(8)
    v_mfma_f32_16x16x32_bf16 v[96:99], v[176:179], v[232:235], v[96:99]
    ds_read_b64_tr_b16 v[168:169], v248 offset:49152
    ds_read_b64_tr_b16 v[170:171], v248 offset:50176
    v_mfma_f32_16x16x32_bf16 v[100:103], v[176:179], v[236:239], v[100:103]
    v_mfma_f32_16x16x32_bf16 v[104:107], v[180:183], v[232:235], v[104:107]
    ds_read_b64_tr_b16 v[172:173], v249 offset:49152
    ds_read_b64_tr_b16 v[174:175], v249 offset:50176
    v_mfma_f32_16x16x32_bf16 v[108:111], v[180:183], v[236:239], v[108:111]
    s_waitcnt lgkmcnt(8)
    v_mfma_f32_16x16x32_bf16 v[112:115], v[184:187], v[232:235], v[112:115]
    ds_read_b64_tr_b16 v[176:177], v250 offset:49152
    ds_read_b64_tr_b16 v[178:179], v250 offset:50176
    v_mfma_f32_16x16x32_bf16 v[116:119], v[184:187], v[236:239], v[116:119]
    v_mfma_f32_16x16x32_bf16 v[120:123], v[188:191], v[232:235], v[120:123]
    ds_read_b64_tr_b16 v[180:181], v251 offset:49152
    ds_read_b64_tr_b16 v[182:183], v251 offset:50176
    v_mfma_f32_16x16x32_bf16 v[124:127], v[188:191], v[236:239], v[124:127]
    buffer_load_dwordx4 v[232:235], v255, s[12:15], s55 offen offset:2048 sc1
    s_waitcnt vmcnt(14) lgkmcnt(8)
    v_mfma_f32_16x16x32_bf16 v[64:67], v[160:163], v[192:195], v[64:67]
    ds_read_b64_tr_b16 v[184:185], v252 offset:49152
    ds_read_b64_tr_b16 v[186:187], v252 offset:50176
    v_mfma_f32_16x16x32_bf16 v[68:71], v[160:163], v[196:199], v[68:71]
    buffer_load_dwordx4 v[236:239], v255, s[12:15], s55 offen offset:2304 sc1
    v_mfma_f32_16x16x32_bf16 v[72:75], v[164:167], v[192:195], v[72:75]
    ds_read_b64_tr_b16 v[188:189], v253 offset:49152
    ds_read_b64_tr_b16 v[190:191], v253 offset:50176
    v_mfma_f32_16x16x32_bf16 v[76:79], v[164:167], v[196:199], v[76:79]
    s_waitcnt lgkmcnt(8)
    v_mfma_f32_16x16x32_bf16 v[80:83], v[168:171], v[192:195], v[80:83]
    ds_read_b64_tr_b16 v[160:161], v246 offset:57344
    ds_read_b64_tr_b16 v[162:163], v246 offset:58368
    v_mfma_f32_16x16x32_bf16 v[84:87], v[168:171], v[196:199], v[84:87]
    buffer_store_dwordx4 v[152:155], v242, s[12:15], s68 offen offset:2048 sc1
    v_mfma_f32_16x16x32_bf16 v[88:91], v[172:175], v[192:195], v[88:91]
    ds_read_b64_tr_b16 v[164:165], v247 offset:57344
    ds_read_b64_tr_b16 v[166:167], v247 offset:58368
    v_mfma_f32_16x16x32_bf16 v[92:95], v[172:175], v[196:199], v[92:95]
    s_waitcnt lgkmcnt(8)
    v_mfma_f32_16x16x32_bf16 v[96:99], v[176:179], v[192:195], v[96:99]
    ds_read_b64_tr_b16 v[168:169], v248 offset:57344
    ds_read_b64_tr_b16 v[170:171], v248 offset:58368
    v_mfma_f32_16x16x32_bf16 v[100:103], v[176:179], v[196:199], v[100:103]
    v_mfma_f32_16x16x32_bf16 v[104:107], v[180:183], v[192:195], v[104:107]
    ds_read_b64_tr_b16 v[172:173], v249 offset:57344
    ds_read_b64_tr_b16 v[174:175], v249 offset:58368
    v_mfma_f32_16x16x32_bf16 v[108:111], v[180:183], v[196:199], v[108:111]
    s_waitcnt lgkmcnt(8)
    v_mfma_f32_16x16x32_bf16 v[112:115], v[184:187], v[192:195], v[112:115]
    ds_read_b64_tr_b16 v[176:177], v250 offset:57344
    ds_read_b64_tr_b16 v[178:179], v250 offset:58368
    v_mfma_f32_16x16x32_bf16 v[116:119], v[184:187], v[196:199], v[116:119]
    v_mfma_f32_16x16x32_bf16 v[120:123], v[188:191], v[192:195], v[120:123]
    ds_read_b64_tr_b16 v[180:181], v251 offset:57344
    ds_read_b64_tr_b16 v[182:183], v251 offset:58368
    v_mfma_f32_16x16x32_bf16 v[124:127], v[188:191], v[196:199], v[124:127]
    s_add_u32 s55, s55, 4096
    buffer_load_dwordx4 v[192:195], v255, s[12:15], s55 offen offset:0 sc1
    s_waitcnt vmcnt(14) lgkmcnt(8)
    v_mfma_f32_16x16x32_bf16 v[64:67], v[160:163], v[200:203], v[64:67]
    ds_read_b64_tr_b16 v[184:185], v252 offset:57344
    ds_read_b64_tr_b16 v[186:187], v252 offset:58368
    v_mfma_f32_16x16x32_bf16 v[68:71], v[160:163], v[204:207], v[68:71]
    buffer_load_dwordx4 v[196:199], v255, s[12:15], s55 offen offset:256 sc1
    v_mfma_f32_16x16x32_bf16 v[72:75], v[164:167], v[200:203], v[72:75]
    ds_read_b64_tr_b16 v[188:189], v253 offset:57344
    ds_read_b64_tr_b16 v[190:191], v253 offset:58368
    v_mfma_f32_16x16x32_bf16 v[76:79], v[164:167], v[204:207], v[76:79]
    buffer_store_dwordx4 v[156:159], v242, s[12:15], s68 offen offset:3072 sc1
    s_sub_u32 s68, s68, 49152
    s_waitcnt lgkmcnt(8)
    v_mfma_f32_16x16x32_bf16 v[80:83], v[168:171], v[200:203], v[80:83]
    s_waitcnt vmcnt(38)
    s_barrier
    v_add_u32 v246, 0x10000, v246
    v_add_u32 v247, 0x10000, v247
    v_add_u32 v248, 0x10000, v248
    v_add_u32 v249, 0x10000, v249
    v_add_u32 v250, 0x10000, v250
    v_add_u32 v251, 0x10000, v251
    v_add_u32 v252, 0x10000, v252
    v_add_u32 v253, 0x10000, v253
    ds_read_b64_tr_b16 v[160:161], v246 offset:0
    ds_read_b64_tr_b16 v[162:163], v246 offset:1024
    v_mfma_f32_16x16x32_bf16 v[84:87], v[168:171], v[204:207], v[84:87]
    v_mfma_f32_16x16x32_bf16 v[88:91], v[172:175], v[200:203], v[88:91]
    ds_read_b64_tr_b16 v[164:165], v247 offset:0
    ds_read_b64_tr_b16 v[166:167], v247 offset:1024
    v_mfma_f32_16x16x32_bf16 v[92:95], v[172:175], v[204:207], v[92:95]
    s_waitcnt lgkmcnt(8)
    v_mfma_f32_16x16x32_bf16 v[96:99], v[176:179], v[200:203], v[96:99]
    ds_read_b64_tr_b16 v[168:169], v248 offset:0
    ds_read_b64_tr_b16 v[170:171], v248 offset:1024
    v_mfma_f32_16x16x32_bf16 v[100:103], v[176:179], v[204:207], v[100:103]
    v_mfma_f32_16x16x32_bf16 v[104:107], v[180:183], v[200:203], v[104:107]
    ds_read_b64_tr_b16 v[172:173], v249 offset:0
    ds_read_b64_tr_b16 v[174:175], v249 offset:1024
    v_mfma_f32_16x16x32_bf16 v[108:111], v[180:183], v[204:207], v[108:111]
    s_waitcnt lgkmcnt(8)
    v_mfma_f32_16x16x32_bf16 v[112:115], v[184:187], v[200:203], v[112:115]
    ds_read_b64_tr_b16 v[176:177], v250 offset:0
    ds_read_b64_tr_b16 v[178:179], v250 offset:1024
    v_mfma_f32_16x16x32_bf16 v[116:119], v[184:187], v[204:207], v[116:119]
    v_mfma_f32_16x16x32_bf16 v[120:123], v[188:191], v[200:203], v[120:123]
    ds_read_b64_tr_b16 v[180:181], v251 offset:0
    ds_read_b64_tr_b16 v[182:183], v251 offset:1024
    v_mfma_f32_16x16x32_bf16 v[124:127], v[188:191], v[204:207], v[124:127]
    buffer_load_dwordx4 v[200:203], v255, s[12:15], s55 offen offset:2048 sc1
    s_waitcnt vmcnt(14) lgkmcnt(8)
    v_mfma_f32_16x16x32_bf16 v[64:67], v[160:163], v[208:211], v[64:67]
    ds_read_b64_tr_b16 v[184:185], v252 offset:0
    ds_read_b64_tr_b16 v[186:187], v252 offset:1024
    v_mfma_f32_16x16x32_bf16 v[68:71], v[160:163], v[212:215], v[68:71]
    buffer_store_dwordx4 v[0:3], v242, s[12:15], s68 offen offset:0 sc1
    v_mfma_f32_16x16x32_bf16 v[72:75], v[164:167], v[208:211], v[72:75]
    ds_read_b64_tr_b16 v[188:189], v253 offset:0
    ds_read_b64_tr_b16 v[190:191], v253 offset:1024
    v_mfma_f32_16x16x32_bf16 v[76:79], v[164:167], v[212:215], v[76:79]
    buffer_load_dwordx4 v[204:207], v255, s[12:15], s55 offen offset:2304 sc1
    s_waitcnt lgkmcnt(8)
    v_mfma_f32_16x16x32_bf16 v[80:83], v[168:171], v[208:211], v[80:83]
    ds_read_b64_tr_b16 v[160:161], v246 offset:8192
    ds_read_b64_tr_b16 v[162:163], v246 offset:9216
    v_mfma_f32_16x16x32_bf16 v[84:87], v[168:171], v[212:215], v[84:87]
    v_mfma_f32_16x16x32_bf16 v[88:91], v[172:175], v[208:211], v[88:91]
    ds_read_b64_tr_b16 v[164:165], v247 offset:8192
    ds_read_b64_tr_b16 v[166:167], v247 offset:9216
    v_mfma_f32_16x16x32_bf16 v[92:95], v[172:175], v[212:215], v[92:95]
    s_waitcnt lgkmcnt(8)
    v_mfma_f32_16x16x32_bf16 v[96:99], v[176:179], v[208:211], v[96:99]
    ds_read_b64_tr_b16 v[168:169], v248 offset:8192
    ds_read_b64_tr_b16 v[170:171], v248 offset:9216
    v_mfma_f32_16x16x32_bf16 v[100:103], v[176:179], v[212:215], v[100:103]
    v_mfma_f32_16x16x32_bf16 v[104:107], v[180:183], v[208:211], v[104:107]
    ds_read_b64_tr_b16 v[172:173], v249 offset:8192
    ds_read_b64_tr_b16 v[174:175], v249 offset:9216
    v_mfma_f32_16x16x32_bf16 v[108:111], v[180:183], v[212:215], v[108:111]
    s_waitcnt lgkmcnt(8)
    v_mfma_f32_16x16x32_bf16 v[112:115], v[184:187], v[208:211], v[112:115]
    ds_read_b64_tr_b16 v[176:177], v250 offset:8192
    ds_read_b64_tr_b16 v[178:179], v250 offset:9216
    v_mfma_f32_16x16x32_bf16 v[116:119], v[184:187], v[212:215], v[116:119]
    v_mfma_f32_16x16x32_bf16 v[120:123], v[188:191], v[208:211], v[120:123]
    ds_read_b64_tr_b16 v[180:181], v251 offset:8192
    ds_read_b64_tr_b16 v[182:183], v251 offset:9216
    v_mfma_f32_16x16x32_bf16 v[124:127], v[188:191], v[212:215], v[124:127]
    buffer_store_dwordx4 v[4:7], v242, s[12:15], s68 offen offset:1024 sc1
    s_waitcnt vmcnt(14) lgkmcnt(8)
    v_mfma_f32_16x16x32_bf16 v[64:67], v[160:163], v[216:219], v[64:67]
    ds_read_b64_tr_b16 v[184:185], v252 offset:8192
    ds_read_b64_tr_b16 v[186:187], v252 offset:9216
    v_mfma_f32_16x16x32_bf16 v[68:71], v[160:163], v[220:223], v[68:71]
    s_add_u32 s55, s55, 4096
    buffer_load_dwordx4 v[208:211], v255, s[12:15], s55 offen offset:0 sc1
    v_mfma_f32_16x16x32_bf16 v[72:75], v[164:167], v[216:219], v[72:75]
    ds_read_b64_tr_b16 v[188:189], v253 offset:8192
    ds_read_b64_tr_b16 v[190:191], v253 offset:9216
    v_mfma_f32_16x16x32_bf16 v[76:79], v[164:167], v[220:223], v[76:79]
    buffer_load_dwordx4 v[212:215], v255, s[12:15], s55 offen offset:256 sc1
    s_waitcnt lgkmcnt(8)
    v_mfma_f32_16x16x32_bf16 v[80:83], v[168:171], v[216:219], v[80:83]
    ds_read_b64_tr_b16 v[160:161], v246 offset:16384
    ds_read_b64_tr_b16 v[162:163], v246 offset:17408
    v_mfma_f32_16x16x32_bf16 v[84:87], v[168:171], v[220:223], v[84:87]
    v_mfma_f32_16x16x32_bf16 v[88:91], v[172:175], v[216:219], v[88:91]
    ds_read_b64_tr_b16 v[164:165], v247 offset:16384
    ds_read_b64_tr_b16 v[166:167], v247 offset:17408
    v_mfma_f32_16x16x32_bf16 v[92:95], v[172:175], v[220:223], v[92:95]
    s_waitcnt lgkmcnt(8)
    v_mfma_f32_16x16x32_bf16 v[96:99], v[176:179], v[216:219], v[96:99]
    ds_read_b64_tr_b16 v[168:169], v248 offset:16384
    ds_read_b64_tr_b16 v[170:171], v248 offset:17408
    v_mfma_f32_16x16x32_bf16 v[100:103], v[176:179], v[220:223], v[100:103]
    v_mfma_f32_16x16x32_bf16 v[104:107], v[180:183], v[216:219], v[104:107]
    ds_read_b64_tr_b16 v[172:173], v249 offset:16384
    ds_read_b64_tr_b16 v[174:175], v249 offset:17408
    v_mfma_f32_16x16x32_bf16 v[108:111], v[180:183], v[220:223], v[108:111]
    s_waitcnt lgkmcnt(8)
    v_mfma_f32_16x16x32_bf16 v[112:115], v[184:187], v[216:219], v[112:115]
    ds_read_b64_tr_b16 v[176:177], v250 offset:16384
    ds_read_b64_tr_b16 v[178:179], v250 offset:17408
    v_mfma_f32_16x16x32_bf16 v[116:119], v[184:187], v[220:223], v[116:119]
    buffer_store_dwordx4 v[8:11], v242, s[12:15], s68 offen offset:2048 sc1
    v_mfma_f32_16x16x32_bf16 v[120:123], v[188:191], v[216:219], v[120:123]
    ds_read_b64_tr_b16 v[180:181], v251 offset:16384
    ds_read_b64_tr_b16 v[182:183], v251 offset:17408
    v_mfma_f32_16x16x32_bf16 v[124:127], v[188:191], v[220:223], v[124:127]
    buffer_load_dwordx4 v[216:219], v255, s[12:15], s55 offen offset:2048 sc1
    s_waitcnt vmcnt(15) lgkmcnt(8)
    v_mfma_f32_16x16x32_bf16 v[64:67], v[160:163], v[224:227], v[64:67]
    ds_read_b64_tr_b16 v[184:185], v252 offset:16384
    ds_read_b64_tr_b16 v[186:187], v252 offset:17408
    v_mfma_f32_16x16x32_bf16 v[68:71], v[160:163], v[228:231], v[68:71]
    buffer_load_dwordx4 v[220:223], v255, s[12:15], s55 offen offset:2304 sc1
    v_mfma_f32_16x16x32_bf16 v[72:75], v[164:167], v[224:227], v[72:75]
    ds_read_b64_tr_b16 v[188:189], v253 offset:16384
    ds_read_b64_tr_b16 v[190:191], v253 offset:17408
    v_mfma_f32_16x16x32_bf16 v[76:79], v[164:167], v[228:231], v[76:79]
    s_waitcnt lgkmcnt(8)
    v_mfma_f32_16x16x32_bf16 v[80:83], v[168:171], v[224:227], v[80:83]
    ds_read_b64_tr_b16 v[160:161], v246 offset:24576
    ds_read_b64_tr_b16 v[162:163], v246 offset:25600
    v_mfma_f32_16x16x32_bf16 v[84:87], v[168:171], v[228:231], v[84:87]
    v_mfma_f32_16x16x32_bf16 v[88:91], v[172:175], v[224:227], v[88:91]
    ds_read_b64_tr_b16 v[164:165], v247 offset:24576
    ds_read_b64_tr_b16 v[166:167], v247 offset:25600
    v_mfma_f32_16x16x32_bf16 v[92:95], v[172:175], v[228:231], v[92:95]
    s_waitcnt lgkmcnt(8)
    v_mfma_f32_16x16x32_bf16 v[96:99], v[176:179], v[224:227], v[96:99]
    ds_read_b64_tr_b16 v[168:169], v248 offset:24576
    ds_read_b64_tr_b16 v[170:171], v248 offset:25600
    v_mfma_f32_16x16x32_bf16 v[100:103], v[176:179], v[228:231], v[100:103]
    v_mfma_f32_16x16x32_bf16 v[104:107], v[180:183], v[224:227], v[104:107]
    ds_read_b64_tr_b16 v[172:173], v249 offset:24576
    ds_read_b64_tr_b16 v[174:175], v249 offset:25600
    v_mfma_f32_16x16x32_bf16 v[108:111], v[180:183], v[228:231], v[108:111]
    buffer_store_dwordx4 v[12:15], v242, s[12:15], s68 offen offset:3072 sc1
    s_add_u32 s68, s68, 16384
    s_waitcnt lgkmcnt(8)
    v_mfma_f32_16x16x32_bf16 v[112:115], v[184:187], v[224:227], v[112:115]
    ds_read_b64_tr_b16 v[176:177], v250 offset:24576
    ds_read_b64_tr_b16 v[178:179], v250 offset:25600
    v_mfma_f32_16x16x32_bf16 v[116:119], v[184:187], v[228:231], v[116:119]
    v_mfma_f32_16x16x32_bf16 v[120:123], v[188:191], v[224:227], v[120:123]
    ds_read_b64_tr_b16 v[180:181], v251 offset:24576
    ds_read_b64_tr_b16 v[182:183], v251 offset:25600
    v_mfma_f32_16x16x32_bf16 v[124:127], v[188:191], v[228:231], v[124:127]
    s_add_u32 s55, s55, 4096
    buffer_load_dwordx4 v[224:227], v255, s[12:15], s55 offen offset:0 sc1
    s_waitcnt vmcnt(15) lgkmcnt(8)
    v_mfma_f32_16x16x32_bf16 v[64:67], v[160:163], v[232:235], v[64:67]
    ds_read_b64_tr_b16 v[184:185], v252 offset:24576
    ds_read_b64_tr_b16 v[186:187], v252 offset:25600
    v_mfma_f32_16x16x32_bf16 v[68:71], v[160:163], v[236:239], v[68:71]
    buffer_load_dwordx4 v[228:231], v255, s[12:15], s55 offen offset:256 sc1
    v_mfma_f32_16x16x32_bf16 v[72:75], v[164:167], v[232:235], v[72:75]
    ds_read_b64_tr_b16 v[188:189], v253 offset:24576
    ds_read_b64_tr_b16 v[190:191], v253 offset:25600
    v_mfma_f32_16x16x32_bf16 v[76:79], v[164:167], v[236:239], v[76:79]
    s_waitcnt lgkmcnt(8)
    v_mfma_f32_16x16x32_bf16 v[80:83], v[168:171], v[232:235], v[80:83]
    s_barrier
    ds_read_b64_tr_b16 v[160:161], v246 offset:32768
    ds_read_b64_tr_b16 v[162:163], v246 offset:33792
    v_mfma_f32_16x16x32_bf16 v[84:87], v[168:171], v[236:239], v[84:87]
    v_mfma_f32_16x16x32_bf16 v[88:91], v[172:175], v[232:235], v[88:91]
    ds_read_b64_tr_b16 v[164:165], v247 offset:32768
    ds_read_b64_tr_b16 v[166:167], v247 offset:33792
    v_mfma_f32_16x16x32_bf16 v[92:95], v[172:175], v[236:239], v[92:95]
    s_waitcnt lgkmcnt(8)
    v_mfma_f32_16x16x32_bf16 v[96:99], v[176:179], v[232:235], v[96:99]
    ds_read_b64_tr_b16 v[168:169], v248 offset:32768
    ds_read_b64_tr_b16 v[170:171], v248 offset:33792
    v_mfma_f32_16x16x32_bf16 v[100:103], v[176:179], v[236:239], v[100:103]
    buffer_store_dwordx4 v[16:19], v242, s[12:15], s68 offen offset:0 sc1
    v_mfma_f32_16x16x32_bf16 v[104:107], v[180:183], v[232:235], v[104:107]
    ds_read_b64_tr_b16 v[172:173], v249 offset:32768
    ds_read_b64_tr_b16 v[174:175], v249 offset:33792
    v_mfma_f32_16x16x32_bf16 v[108:111], v[180:183], v[236:239], v[108:111]
    s_waitcnt lgkmcnt(8)
    v_mfma_f32_16x16x32_bf16 v[112:115], v[184:187], v[232:235], v[112:115]
    ds_read_b64_tr_b16 v[176:177], v250 offset:32768
    ds_read_b64_tr_b16 v[178:179], v250 offset:33792
    v_mfma_f32_16x16x32_bf16 v[116:119], v[184:187], v[236:239], v[116:119]
    v_mfma_f32_16x16x32_bf16 v[120:123], v[188:191], v[232:235], v[120:123]
    ds_read_b64_tr_b16 v[180:181], v251 offset:32768
    ds_read_b64_tr_b16 v[182:183], v251 offset:33792
    v_mfma_f32_16x16x32_bf16 v[124:127], v[188:191], v[236:239], v[124:127]
    buffer_load_dwordx4 v[232:235], v255, s[12:15], s55 offen offset:2048 sc1
    s_waitcnt vmcnt(15) lgkmcnt(8)
    v_mfma_f32_16x16x32_bf16 v[64:67], v[160:163], v[192:195], v[64:67]
    ds_read_b64_tr_b16 v[184:185], v252 offset:32768
    ds_read_b64_tr_b16 v[186:187], v252 offset:33792
    v_mfma_f32_16x16x32_bf16 v[68:71], v[160:163], v[196:199], v[68:71]
    buffer_load_dwordx4 v[236:239], v255, s[12:15], s55 offen offset:2304 sc1
    v_mfma_f32_16x16x32_bf16 v[72:75], v[164:167], v[192:195], v[72:75]
    ds_read_b64_tr_b16 v[188:189], v253 offset:32768
    ds_read_b64_tr_b16 v[190:191], v253 offset:33792
    v_mfma_f32_16x16x32_bf16 v[76:79], v[164:167], v[196:199], v[76:79]
    s_waitcnt lgkmcnt(8)
    v_mfma_f32_16x16x32_bf16 v[80:83], v[168:171], v[192:195], v[80:83]
    ds_read_b64_tr_b16 v[160:161], v246 offset:40960
    ds_read_b64_tr_b16 v[162:163], v246 offset:41984
    v_mfma_f32_16x16x32_bf16 v[84:87], v[168:171], v[196:199], v[84:87]
    v_mfma_f32_16x16x32_bf16 v[88:91], v[172:175], v[192:195], v[88:91]
    ds_read_b64_tr_b16 v[164:165], v247 offset:40960
    ds_read_b64_tr_b16 v[166:167], v247 offset:41984
    v_mfma_f32_16x16x32_bf16 v[92:95], v[172:175], v[196:199], v[92:95]
    buffer_store_dwordx4 v[20:23], v242, s[12:15], s68 offen offset:1024 sc1
    s_waitcnt lgkmcnt(8)
    v_mfma_f32_16x16x32_bf16 v[96:99], v[176:179], v[192:195], v[96:99]
    ds_read_b64_tr_b16 v[168:169], v248 offset:40960
    ds_read_b64_tr_b16 v[170:171], v248 offset:41984
    v_mfma_f32_16x16x32_bf16 v[100:103], v[176:179], v[196:199], v[100:103]
    v_mfma_f32_16x16x32_bf16 v[104:107], v[180:183], v[192:195], v[104:107]
    ds_read_b64_tr_b16 v[172:173], v249 offset:40960
    ds_read_b64_tr_b16 v[174:175], v249 offset:41984
    v_mfma_f32_16x16x32_bf16 v[108:111], v[180:183], v[196:199], v[108:111]
    s_waitcnt lgkmcnt(8)
    v_mfma_f32_16x16x32_bf16 v[112:115], v[184:187], v[192:195], v[112:115]
    ds_read_b64_tr_b16 v[176:177], v250 offset:40960
    ds_read_b64_tr_b16 v[178:179], v250 offset:41984
    v_mfma_f32_16x16x32_bf16 v[116:119], v[184:187], v[196:199], v[116:119]
    v_mfma_f32_16x16x32_bf16 v[120:123], v[188:191], v[192:195], v[120:123]
    ds_read_b64_tr_b16 v[180:181], v251 offset:40960
    ds_read_b64_tr_b16 v[182:183], v251 offset:41984
    v_mfma_f32_16x16x32_bf16 v[124:127], v[188:191], v[196:199], v[124:127]
    s_waitcnt vmcnt(13) lgkmcnt(8)
    v_mfma_f32_16x16x32_bf16 v[64:67], v[160:163], v[200:203], v[64:67]
    ds_read_b64_tr_b16 v[184:185], v252 offset:40960
    ds_read_b64_tr_b16 v[186:187], v252 offset:41984
    v_mfma_f32_16x16x32_bf16 v[68:71], v[160:163], v[204:207], v[68:71]
    v_mfma_f32_16x16x32_bf16 v[72:75], v[164:167], v[200:203], v[72:75]
    ds_read_b64_tr_b16 v[188:189], v253 offset:40960
    ds_read_b64_tr_b16 v[190:191], v253 offset:41984
    v_mfma_f32_16x16x32_bf16 v[76:79], v[164:167], v[204:207], v[76:79]
    s_waitcnt lgkmcnt(8)
    v_mfma_f32_16x16x32_bf16 v[80:83], v[168:171], v[200:203], v[80:83]
    ds_read_b64_tr_b16 v[160:161], v246 offset:49152
    ds_read_b64_tr_b16 v[162:163], v246 offset:50176
    v_mfma_f32_16x16x32_bf16 v[84:87], v[168:171], v[204:207], v[84:87]
    buffer_store_dwordx4 v[24:27], v242, s[12:15], s68 offen offset:2048 sc1
    v_mfma_f32_16x16x32_bf16 v[88:91], v[172:175], v[200:203], v[88:91]
    ds_read_b64_tr_b16 v[164:165], v247 offset:49152
    ds_read_b64_tr_b16 v[166:167], v247 offset:50176
    v_mfma_f32_16x16x32_bf16 v[92:95], v[172:175], v[204:207], v[92:95]
    s_waitcnt lgkmcnt(8)
    v_mfma_f32_16x16x32_bf16 v[96:99], v[176:179], v[200:203], v[96:99]
    ds_read_b64_tr_b16 v[168:169], v248 offset:49152
    ds_read_b64_tr_b16 v[170:171], v248 offset:50176
    v_mfma_f32_16x16x32_bf16 v[100:103], v[176:179], v[204:207], v[100:103]
    v_mfma_f32_16x16x32_bf16 v[104:107], v[180:183], v[200:203], v[104:107]
    ds_read_b64_tr_b16 v[172:173], v249 offset:49152
    ds_read_b64_tr_b16 v[174:175], v249 offset:50176
    v_mfma_f32_16x16x32_bf16 v[108:111], v[180:183], v[204:207], v[108:111]
    s_waitcnt lgkmcnt(8)
    v_mfma_f32_16x16x32_bf16 v[112:115], v[184:187], v[200:203], v[112:115]
    ds_read_b64_tr_b16 v[176:177], v250 offset:49152
    ds_read_b64_tr_b16 v[178:179], v250 offset:50176
    v_mfma_f32_16x16x32_bf16 v[116:119], v[184:187], v[204:207], v[116:119]
    v_mfma_f32_16x16x32_bf16 v[120:123], v[188:191], v[200:203], v[120:123]
    ds_read_b64_tr_b16 v[180:181], v251 offset:49152
    ds_read_b64_tr_b16 v[182:183], v251 offset:50176
    v_mfma_f32_16x16x32_bf16 v[124:127], v[188:191], v[204:207], v[124:127]
    s_waitcnt vmcnt(11) lgkmcnt(8)
    v_mfma_f32_16x16x32_bf16 v[64:67], v[160:163], v[208:211], v[64:67]
    ds_read_b64_tr_b16 v[184:185], v252 offset:49152
    ds_read_b64_tr_b16 v[186:187], v252 offset:50176
    v_mfma_f32_16x16x32_bf16 v[68:71], v[160:163], v[212:215], v[68:71]
    v_mfma_f32_16x16x32_bf16 v[72:75], v[164:167], v[208:211], v[72:75]
    ds_read_b64_tr_b16 v[188:189], v253 offset:49152
    ds_read_b64_tr_b16 v[190:191], v253 offset:50176
    v_mfma_f32_16x16x32_bf16 v[76:79], v[164:167], v[212:215], v[76:79]
    buffer_store_dwordx4 v[28:31], v242, s[12:15], s68 offen offset:3072 sc1
    s_add_u32 s68, s68, 16384
    s_waitcnt lgkmcnt(8)
    v_mfma_f32_16x16x32_bf16 v[80:83], v[168:171], v[208:211], v[80:83]
    ds_read_b64_tr_b16 v[160:161], v246 offset:57344
    ds_read_b64_tr_b16 v[162:163], v246 offset:58368
    v_mfma_f32_16x16x32_bf16 v[84:87], v[168:171], v[212:215], v[84:87]
    v_mfma_f32_16x16x32_bf16 v[88:91], v[172:175], v[208:211], v[88:91]
    ds_read_b64_tr_b16 v[164:165], v247 offset:57344
    ds_read_b64_tr_b16 v[166:167], v247 offset:58368
    v_mfma_f32_16x16x32_bf16 v[92:95], v[172:175], v[212:215], v[92:95]
    s_waitcnt lgkmcnt(8)
    v_mfma_f32_16x16x32_bf16 v[96:99], v[176:179], v[208:211], v[96:99]
    ds_read_b64_tr_b16 v[168:169], v248 offset:57344
    ds_read_b64_tr_b16 v[170:171], v248 offset:58368
    v_mfma_f32_16x16x32_bf16 v[100:103], v[176:179], v[212:215], v[100:103]
    v_mfma_f32_16x16x32_bf16 v[104:107], v[180:183], v[208:211], v[104:107]
    ds_read_b64_tr_b16 v[172:173], v249 offset:57344
    ds_read_b64_tr_b16 v[174:175], v249 offset:58368
    v_mfma_f32_16x16x32_bf16 v[108:111], v[180:183], v[212:215], v[108:111]
    s_waitcnt lgkmcnt(8)
    v_mfma_f32_16x16x32_bf16 v[112:115], v[184:187], v[208:211], v[112:115]
    ds_read_b64_tr_b16 v[176:177], v250 offset:57344
    ds_read_b64_tr_b16 v[178:179], v250 offset:58368
    v_mfma_f32_16x16x32_bf16 v[116:119], v[184:187], v[212:215], v[116:119]
    v_mfma_f32_16x16x32_bf16 v[120:123], v[188:191], v[208:211], v[120:123]
    ds_read_b64_tr_b16 v[180:181], v251 offset:57344
    ds_read_b64_tr_b16 v[182:183], v251 offset:58368
    v_mfma_f32_16x16x32_bf16 v[124:127], v[188:191], v[212:215], v[124:127]
    s_waitcnt vmcnt(9) lgkmcnt(8)
    v_mfma_f32_16x16x32_bf16 v[64:67], v[160:163], v[216:219], v[64:67]
    ds_read_b64_tr_b16 v[184:185], v252 offset:57344
    ds_read_b64_tr_b16 v[186:187], v252 offset:58368
    v_mfma_f32_16x16x32_bf16 v[68:71], v[160:163], v[220:223], v[68:71]
    v_mov_b32 v0, 0
    v_mov_b32 v1, 0
    v_mov_b32 v2, 0
    v_mov_b32 v3, 0
    v_mfma_f32_16x16x32_bf16 v[72:75], v[164:167], v[216:219], v[72:75]
    ds_read_b64_tr_b16 v[188:189], v253 offset:57344
    ds_read_b64_tr_b16 v[190:191], v253 offset:58368
    v_mfma_f32_16x16x32_bf16 v[76:79], v[164:167], v[220:223], v[76:79]
    v_mov_b32 v4, 0
    v_mov_b32 v5, 0
    v_mov_b32 v6, 0
    v_mov_b32 v7, 0
    s_waitcnt lgkmcnt(8)
    v_mfma_f32_16x16x32_bf16 v[80:83], v[168:171], v[216:219], v[80:83]
    s_barrier
    v_subrev_u32 v246, 0x10000, v246
    v_subrev_u32 v247, 0x10000, v247
    v_subrev_u32 v248, 0x10000, v248
    v_subrev_u32 v249, 0x10000, v249
    v_subrev_u32 v250, 0x10000, v250
    v_subrev_u32 v251, 0x10000, v251
    v_subrev_u32 v252, 0x10000, v252
    v_subrev_u32 v253, 0x10000, v253
    ds_read_b64_tr_b16 v[160:161], v246 offset:0
    ds_read_b64_tr_b16 v[162:163], v246 offset:1024
    v_mfma_f32_16x16x32_bf16 v[84:87], v[168:171], v[220:223], v[84:87]
    v_mov_b32 v8, 0
    v_mov_b32 v9, 0
    v_mov_b32 v10, 0
    v_mov_b32 v11, 0
    v_mfma_f32_16x16x32_bf16 v[88:91], v[172:175], v[216:219], v[88:91]
    ds_read_b64_tr_b16 v[164:165], v247 offset:0
    ds_read_b64_tr_b16 v[166:167], v247 offset:1024
    v_mfma_f32_16x16x32_bf16 v[92:95], v[172:175], v[220:223], v[92:95]
    v_mov_b32 v12, 0
    v_mov_b32 v13, 0
    v_mov_b32 v14, 0
    v_mov_b32 v15, 0
    s_waitcnt lgkmcnt(8)
    v_mfma_f32_16x16x32_bf16 v[96:99], v[176:179], v[216:219], v[96:99]
    ds_read_b64_tr_b16 v[168:169], v248 offset:0
    ds_read_b64_tr_b16 v[170:171], v248 offset:1024
    v_mfma_f32_16x16x32_bf16 v[100:103], v[176:179], v[220:223], v[100:103]
    v_mov_b32 v16, 0
    v_mov_b32 v17, 0
    v_mov_b32 v18, 0
    v_mov_b32 v19, 0
    v_mfma_f32_16x16x32_bf16 v[104:107], v[180:183], v[216:219], v[104:107]
    ds_read_b64_tr_b16 v[172:173], v249 offset:0
    ds_read_b64_tr_b16 v[174:175], v249 offset:1024
    v_mfma_f32_16x16x32_bf16 v[108:111], v[180:183], v[220:223], v[108:111]
    v_mov_b32 v20, 0
    v_mov_b32 v21, 0
    v_mov_b32 v22, 0
    v_mov_b32 v23, 0
    s_waitcnt lgkmcnt(8)
    v_mfma_f32_16x16x32_bf16 v[112:115], v[184:187], v[216:219], v[112:115]
    ds_read_b64_tr_b16 v[176:177], v250 offset:0
    ds_read_b64_tr_b16 v[178:179], v250 offset:1024
    v_mfma_f32_16x16x32_bf16 v[116:119], v[184:187], v[220:223], v[116:119]
    v_mov_b32 v24, 0
    v_mov_b32 v25, 0
    v_mov_b32 v26, 0
    v_mov_b32 v27, 0
    v_mfma_f32_16x16x32_bf16 v[120:123], v[188:191], v[216:219], v[120:123]
    ds_read_b64_tr_b16 v[180:181], v251 offset:0
    ds_read_b64_tr_b16 v[182:183], v251 offset:1024
    v_mfma_f32_16x16x32_bf16 v[124:127], v[188:191], v[220:223], v[124:127]
    v_mov_b32 v28, 0
    v_mov_b32 v29, 0
    v_mov_b32 v30, 0
    v_mov_b32 v31, 0
    s_waitcnt vmcnt(6) lgkmcnt(8)
    v_mfma_f32_16x16x32_bf16 v[64:67], v[160:163], v[224:227], v[64:67]
    ds_read_b64_tr_b16 v[184:185], v252 offset:0
    ds_read_b64_tr_b16 v[186:187], v252 offset:1024
    v_mfma_f32_16x16x32_bf16 v[68:71], v[160:163], v[228:231], v[68:71]
    v_mov_b32 v32, 0
    v_mov_b32 v33, 0
    v_mov_b32 v34, 0
    v_mov_b32 v35, 0
    v_mfma_f32_16x16x32_bf16 v[72:75], v[164:167], v[224:227], v[72:75]
    ds_read_b64_tr_b16 v[188:189], v253 offset:0
    ds_read_b64_tr_b16 v[190:191], v253 offset:1024
    v_mfma_f32_16x16x32_bf16 v[76:79], v[164:167], v[228:231], v[76:79]
    v_mov_b32 v36, 0
    v_mov_b32 v37, 0
    v_mov_b32 v38, 0
    v_mov_b32 v39, 0
    s_waitcnt lgkmcnt(8)
    v_mfma_f32_16x16x32_bf16 v[80:83], v[168:171], v[224:227], v[80:83]
    ds_read_b64_tr_b16 v[160:161], v246 offset:8192
    ds_read_b64_tr_b16 v[162:163], v246 offset:9216
    v_mfma_f32_16x16x32_bf16 v[84:87], v[168:171], v[228:231], v[84:87]
    v_mov_b32 v40, 0
    v_mov_b32 v41, 0
    v_mov_b32 v42, 0
    v_mov_b32 v43, 0
    v_mfma_f32_16x16x32_bf16 v[88:91], v[172:175], v[224:227], v[88:91]
    ds_read_b64_tr_b16 v[164:165], v247 offset:8192
    ds_read_b64_tr_b16 v[166:167], v247 offset:9216
    v_mfma_f32_16x16x32_bf16 v[92:95], v[172:175], v[228:231], v[92:95]
    v_mov_b32 v44, 0
    v_mov_b32 v45, 0
    v_mov_b32 v46, 0
    v_mov_b32 v47, 0
    s_waitcnt lgkmcnt(8)
    v_mfma_f32_16x16x32_bf16 v[96:99], v[176:179], v[224:227], v[96:99]
    ds_read_b64_tr_b16 v[168:169], v248 offset:8192
    ds_read_b64_tr_b16 v[170:171], v248 offset:9216
    v_mfma_f32_16x16x32_bf16 v[100:103], v[176:179], v[228:231], v[100:103]
    v_mov_b32 v48, 0
    v_mov_b32 v49, 0
    v_mov_b32 v50, 0
    v_mov_b32 v51, 0
    v_mfma_f32_16x16x32_bf16 v[104:107], v[180:183], v[224:227], v[104:107]
    ds_read_b64_tr_b16 v[172:173], v249 offset:8192
    ds_read_b64_tr_b16 v[174:175], v249 offset:9216
    v_mfma_f32_16x16x32_bf16 v[108:111], v[180:183], v[228:231], v[108:111]
    v_mov_b32 v52, 0
    v_mov_b32 v53, 0
    v_mov_b32 v54, 0
    v_mov_b32 v55, 0
    s_waitcnt lgkmcnt(8)
    v_mfma_f32_16x16x32_bf16 v[112:115], v[184:187], v[224:227], v[112:115]
    ds_read_b64_tr_b16 v[176:177], v250 offset:8192
    ds_read_b64_tr_b16 v[178:179], v250 offset:9216
    v_mfma_f32_16x16x32_bf16 v[116:119], v[184:187], v[228:231], v[116:119]
    v_mov_b32 v56, 0
    v_mov_b32 v57, 0
    v_mov_b32 v58, 0
    v_mov_b32 v59, 0
    v_mfma_f32_16x16x32_bf16 v[120:123], v[188:191], v[224:227], v[120:123]
    ds_read_b64_tr_b16 v[180:181], v251 offset:8192
    ds_read_b64_tr_b16 v[182:183], v251 offset:9216
    v_mfma_f32_16x16x32_bf16 v[124:127], v[188:191], v[228:231], v[124:127]
    v_mov_b32 v60, 0
    v_mov_b32 v61, 0
    v_mov_b32 v62, 0
    v_mov_b32 v63, 0
    s_waitcnt vmcnt(3) lgkmcnt(8)
    v_mfma_f32_16x16x32_bf16 v[64:67], v[160:163], v[232:235], v[64:67]
    ds_read_b64_tr_b16 v[184:185], v252 offset:8192
    ds_read_b64_tr_b16 v[186:187], v252 offset:9216
    v_mfma_f32_16x16x32_bf16 v[68:71], v[160:163], v[236:239], v[68:71]
    v_mfma_f32_16x16x32_bf16 v[72:75], v[164:167], v[232:235], v[72:75]
    ds_read_b64_tr_b16 v[188:189], v253 offset:8192
    ds_read_b64_tr_b16 v[190:191], v253 offset:9216
    v_mfma_f32_16x16x32_bf16 v[76:79], v[164:167], v[236:239], v[76:79]
    s_waitcnt lgkmcnt(8)
    v_mfma_f32_16x16x32_bf16 v[80:83], v[168:171], v[232:235], v[80:83]
    v_mfma_f32_16x16x32_bf16 v[84:87], v[168:171], v[236:239], v[84:87]
    v_mfma_f32_16x16x32_bf16 v[88:91], v[172:175], v[232:235], v[88:91]
    v_mfma_f32_16x16x32_bf16 v[92:95], v[172:175], v[236:239], v[92:95]
    s_waitcnt lgkmcnt(4)
    v_mfma_f32_16x16x32_bf16 v[96:99], v[176:179], v[232:235], v[96:99]
    v_mfma_f32_16x16x32_bf16 v[100:103], v[176:179], v[236:239], v[100:103]
    v_mfma_f32_16x16x32_bf16 v[104:107], v[180:183], v[232:235], v[104:107]
    v_mfma_f32_16x16x32_bf16 v[108:111], v[180:183], v[236:239], v[108:111]
    s_waitcnt lgkmcnt(0)
    v_mfma_f32_16x16x32_bf16 v[112:115], v[184:187], v[232:235], v[112:115]
    v_mfma_f32_16x16x32_bf16 v[116:119], v[184:187], v[236:239], v[116:119]
    v_mfma_f32_16x16x32_bf16 v[120:123], v[188:191], v[232:235], v[120:123]
    v_mfma_f32_16x16x32_bf16 v[124:127], v[188:191], v[236:239], v[124:127]
    s_nop 15
    v_cvt_pk_bf16_f32 v128, v64, v65
    v_cvt_pk_bf16_f32 v129, v66, v67
    v_cvt_pk_bf16_f32 v130, v68, v69
    v_cvt_pk_bf16_f32 v131, v70, v71
    v_cvt_pk_bf16_f32 v132, v72, v73
    v_cvt_pk_bf16_f32 v133, v74, v75
    v_cvt_pk_bf16_f32 v134, v76, v77
    v_cvt_pk_bf16_f32 v135, v78, v79
    v_cvt_pk_bf16_f32 v136, v80, v81
    v_cvt_pk_bf16_f32 v137, v82, v83
    v_cvt_pk_bf16_f32 v138, v84, v85
    v_cvt_pk_bf16_f32 v139, v86, v87
    v_cvt_pk_bf16_f32 v140, v88, v89
    v_cvt_pk_bf16_f32 v141, v90, v91
    v_cvt_pk_bf16_f32 v142, v92, v93
    v_cvt_pk_bf16_f32 v143, v94, v95
    v_cvt_pk_bf16_f32 v144, v96, v97
    v_cvt_pk_bf16_f32 v145, v98, v99
    v_cvt_pk_bf16_f32 v146, v100, v101
    v_cvt_pk_bf16_f32 v147, v102, v103
    v_cvt_pk_bf16_f32 v148, v104, v105
    v_cvt_pk_bf16_f32 v149, v106, v107
    v_cvt_pk_bf16_f32 v150, v108, v109
    v_cvt_pk_bf16_f32 v151, v110, v111
    v_cvt_pk_bf16_f32 v152, v112, v113
    v_cvt_pk_bf16_f32 v153, v114, v115
    v_cvt_pk_bf16_f32 v154, v116, v117
    v_cvt_pk_bf16_f32 v155, v118, v119
    v_cvt_pk_bf16_f32 v156, v120, v121
    v_cvt_pk_bf16_f32 v157, v122, v123
    v_cvt_pk_bf16_f32 v158, v124, v125
    v_cvt_pk_bf16_f32 v159, v126, v127
    v_mov_b32 v246, 0xff800000
    v_bfe_u32 v244, v243, 4, 5
    v_lshrrev_b32 v247, 9, v243
    v_lshlrev_b32 v247, 2, v247
    v_sub_u32 v244, v244, v247
    s_nop 1
    v_permlane16_swap_b32 v128, v130
    v_permlane16_swap_b32 v129, v131
    v_permlane16_swap_b32 v132, v134
    v_permlane16_swap_b32 v133, v135
    v_permlane16_swap_b32 v136, v138
    v_permlane16_swap_b32 v137, v139
    v_permlane16_swap_b32 v140, v142
    v_permlane16_swap_b32 v141, v143
    v_permlane16_swap_b32 v144, v146
    v_permlane16_swap_b32 v145, v147
    v_permlane16_swap_b32 v148, v150
    v_permlane16_swap_b32 v149, v151
    v_permlane16_swap_b32 v152, v154
    v_permlane16_swap_b32 v153, v155
    v_permlane16_swap_b32 v156, v158
    v_permlane16_swap_b32 v157, v159
    s_nop 1
    v_permlane32_swap_b32 v128, v130
    v_permlane32_swap_b32 v129, v131
    v_permlane32_swap_b32 v132, v134
    v_permlane32_swap_b32 v133, v135
    v_permlane32_swap_b32 v136, v138
    v_permlane32_swap_b32 v137, v139
    v_permlane32_swap_b32 v140, v142
    v_permlane32_swap_b32 v141, v143
    v_permlane32_swap_b32 v144, v146
    v_permlane32_swap_b32 v145, v147
    v_permlane32_swap_b32 v148, v150
    v_permlane32_swap_b32 v149, v151
    v_permlane32_swap_b32 v152, v154
    v_permlane32_swap_b32 v153, v155
    v_permlane32_swap_b32 v156, v158
    v_permlane32_swap_b32 v157, v159
    v_mov_b32 v120, 0
    v_mov_b32 v121, 0
    v_mov_b32 v122, 0
    v_mov_b32 v123, 0
    v_mov_b32 v124, 0
    v_mov_b32 v125, 0
    v_mov_b32 v126, 0
    v_mov_b32 v127, 0
    v_mov_b32 v96, 0
    v_mov_b32 v97, 0
    v_mov_b32 v98, 0
    v_mov_b32 v99, 0
    v_mov_b32 v100, 0
    v_mov_b32 v101, 0
    v_mov_b32 v102, 0
    v_mov_b32 v103, 0
    v_mov_b32 v104, 0
    v_mov_b32 v105, 0
    v_mov_b32 v106, 0
    v_mov_b32 v107, 0
    v_mov_b32 v108, 0
    v_mov_b32 v109, 0
    v_mov_b32 v110, 0
    v_mov_b32 v111, 0
    s_waitcnt vmcnt(0)
parallel_sum__compressed_kv_cla__moe_arch_mod__prompt_kernel_B_qdone:
    s_barrier
    s_mov_b32 s42, 65536
    v_add_u32 v242, 32768, v243
    ds_read_b128 v[160:163], v242 offset:0
    ds_read_b128 v[164:167], v242 offset:1024
    ds_read_b128 v[168:171], v242 offset:2048
    ds_read_b128 v[172:175], v242 offset:3072
    ds_read_b128 v[176:179], v242 offset:4096
    ds_read_b128 v[180:183], v242 offset:5120
    ds_read_b128 v[184:187], v242 offset:6144
    ds_read_b128 v[188:191], v242 offset:7168
    v_mov_b32 v240, 0
    s_lshr_b32 s41, s40, 1
    s_cmp_eq_u32 s40, 1
    s_cbranch_scc0 parallel_sum__compressed_kv_cla__moe_arch_mod__prompt_kernel_B_nomask0
    v_cmp_le_i32 vcc, 0, v244
    s_nop 1
    v_cndmask_b32 v96, v246, v96, vcc
    v_cmp_le_i32 vcc, 1, v244
    s_nop 1
    v_cndmask_b32 v97, v246, v97, vcc
    v_cmp_le_i32 vcc, 2, v244
    s_nop 1
    v_cndmask_b32 v98, v246, v98, vcc
    v_cmp_le_i32 vcc, 3, v244
    s_nop 1
    v_cndmask_b32 v99, v246, v99, vcc
    v_cmp_le_i32 vcc, 8, v244
    s_nop 1
    v_cndmask_b32 v100, v246, v100, vcc
    v_cmp_le_i32 vcc, 9, v244
    s_nop 1
    v_cndmask_b32 v101, v246, v101, vcc
    v_cmp_le_i32 vcc, 10, v244
    s_nop 1
    v_cndmask_b32 v102, v246, v102, vcc
    v_cmp_le_i32 vcc, 11, v244
    s_nop 1
    v_cndmask_b32 v103, v246, v103, vcc
    v_cmp_le_i32 vcc, 16, v244
    s_nop 1
    v_cndmask_b32 v104, v246, v104, vcc
    v_cmp_le_i32 vcc, 17, v244
    s_nop 1
    v_cndmask_b32 v105, v246, v105, vcc
    v_cmp_le_i32 vcc, 18, v244
    s_nop 1
    v_cndmask_b32 v106, v246, v106, vcc
    v_cmp_le_i32 vcc, 19, v244
    s_nop 1
    v_cndmask_b32 v107, v246, v107, vcc
    v_cmp_le_i32 vcc, 24, v244
    s_nop 1
    v_cndmask_b32 v108, v246, v108, vcc
    v_cmp_le_i32 vcc, 25, v244
    s_nop 1
    v_cndmask_b32 v109, v246, v109, vcc
    v_cmp_le_i32 vcc, 26, v244
    s_nop 1
    v_cndmask_b32 v110, v246, v110, vcc
    v_cmp_le_i32 vcc, 27, v244
    s_nop 1
    v_cndmask_b32 v111, v246, v111, vcc
    s_nop 1
parallel_sum__compressed_kv_cla__moe_arch_mod__prompt_kernel_B_nomask0:
    s_waitcnt lgkmcnt(4)
    v_mfma_f32_32x32x16_bf16 v[64:79], v[160:163], v[128:131], v[96:111]
    ds_read_b128 v[160:163], v242 offset:8192
    v_mfma_f32_32x32x16_bf16 v[64:79], v[164:167], v[132:135], v[64:79]
    ds_read_b128 v[164:167], v242 offset:9216
    v_mfma_f32_32x32x16_bf16 v[64:79], v[168:171], v[136:139], v[64:79]
    ds_read_b128 v[168:171], v242 offset:10240
    v_mfma_f32_32x32x16_bf16 v[64:79], v[172:175], v[140:143], v[64:79]
    ds_read_b128 v[172:175], v242 offset:11264
    s_waitcnt lgkmcnt(4)
    v_mfma_f32_32x32x16_bf16 v[64:79], v[176:179], v[144:147], v[64:79]
    ds_read_b128 v[176:179], v242 offset:12288
    v_mfma_f32_32x32x16_bf16 v[64:79], v[180:183], v[148:151], v[64:79]
    ds_read_b128 v[180:183], v242 offset:13312
    v_mfma_f32_32x32x16_bf16 v[64:79], v[184:187], v[152:155], v[64:79]
    ds_read_b128 v[184:187], v242 offset:14336
    v_mfma_f32_32x32x16_bf16 v[64:79], v[188:191], v[156:159], v[64:79]
    ds_read_b128 v[188:191], v242 offset:15360
    s_nop 15
    v_max3_f32 v247, v64, v65, v66
    v_max3_f32 v247, v247, v67, v68
    v_max3_f32 v247, v247, v69, v70
    v_max3_f32 v247, v247, v71, v72
    v_max3_f32 v247, v247, v73, v74
    v_max3_f32 v247, v247, v75, v76
    v_max3_f32 v247, v247, v77, v78
    v_max_f32 v247, v247, v79
    v_mov_b32 v252, v247
    s_nop 1
    v_permlane32_swap_b32 v247, v252
    s_nop 1
    v_max_f32 v247, v247, v252
    v_sub_f32 v96, 0, v247
    v_sub_f32 v97, 0, v247
    v_sub_f32 v98, 0, v247
    v_sub_f32 v99, 0, v247
    v_sub_f32 v100, 0, v247
    v_sub_f32 v101, 0, v247
    v_sub_f32 v102, 0, v247
    v_sub_f32 v103, 0, v247
    v_sub_f32 v104, 0, v247
    v_sub_f32 v105, 0, v247
    v_sub_f32 v106, 0, v247
    v_sub_f32 v107, 0, v247
    v_sub_f32 v108, 0, v247
    v_sub_f32 v109, 0, v247
    v_sub_f32 v110, 0, v247
    v_sub_f32 v111, 0, v247
    v_sub_f32 v64, v64, v247
    v_sub_f32 v65, v65, v247
    v_sub_f32 v66, v66, v247
    v_sub_f32 v67, v67, v247
    v_sub_f32 v68, v68, v247
    v_sub_f32 v69, v69, v247
    v_sub_f32 v70, v70, v247
    v_sub_f32 v71, v71, v247
    v_sub_f32 v72, v72, v247
    v_sub_f32 v73, v73, v247
    v_sub_f32 v74, v74, v247
    v_sub_f32 v75, v75, v247
    v_sub_f32 v76, v76, v247
    v_sub_f32 v77, v77, v247
    v_sub_f32 v78, v78, v247
    v_sub_f32 v79, v79, v247
    s_mov_b32 s46, s41
    s_cmp_eq_u32 s41, 0
    s_cbranch_scc1 parallel_sum__compressed_kv_cla__moe_arch_mod__prompt_kernel_B_seqO2
    s_sub_u32 s41, s41, 1
    s_cmp_eq_u32 s41, 0
    s_cbranch_scc1 parallel_sum__compressed_kv_cla__moe_arch_mod__prompt_kernel_B_endseq
    s_branch parallel_sum__compressed_kv_cla__moe_arch_mod__prompt_kernel_B_h0
.p2align 6
parallel_sum__compressed_kv_cla__moe_arch_mod__prompt_kernel_B_rot:
    ds_read_b128 v[180:183], v242 offset:13312
    v_cvt_pk_bf16_f32 v127, v198, v199
    v_add_f32 v241, v241, v199
    v_mfma_f32_32x32x16_bf16 v[32:47], v[184:187], v[116:119], v[32:47]
    ds_read_b128 v[184:187], v242 offset:14336
    v_cmp_nge_f32 vcc, s52, v241
    v_mfma_f32_32x32x16_bf16 v[48:63], v[188:191], v[116:119], v[48:63]
    s_cbranch_vccnz parallel_sum__compressed_kv_cla__moe_arch_mod__prompt_kernel_chk_32_slow
parallel_sum__compressed_kv_cla__moe_arch_mod__prompt_kernel_chk_32_back:
    ds_read_b128 v[188:191], v242 offset:15360
    v_add_f32 v240, v240, v241
parallel_sum__compressed_kv_cla__moe_arch_mod__prompt_kernel_B_h0:
    s_waitcnt lgkmcnt(4)
    v_mfma_f32_32x32x16_bf16 v[80:95], v[160:163], v[128:131], v[96:111]
    s_barrier
    v_add_u32 v242, s42, v243
    ds_read_b128 v[160:163], v242 offset:16384
    v_exp_f32 v192, v64
    v_mfma_f32_32x32x16_bf16 v[80:95], v[164:167], v[132:135], v[80:95]
    ds_read_b128 v[164:167], v242 offset:18432
    v_exp_f32 v193, v65
    v_mfma_f32_32x32x16_bf16 v[80:95], v[168:171], v[136:139], v[80:95]
    ds_read_b128 v[168:171], v242 offset:20480
    v_exp_f32 v194, v66
    v_exp_f32 v195, v67
    v_cvt_pk_bf16_f32 v112, v192, v193
    v_add_f32 v241, v192, v193
    v_mfma_f32_32x32x16_bf16 v[80:95], v[172:175], v[140:143], v[80:95]
    ds_read_b128 v[172:175], v242 offset:22528
    v_exp_f32 v196, v68
    v_cvt_pk_bf16_f32 v113, v194, v195
    v_add_f32 v241, v241, v194
    v_add_f32 v241, v241, v195
    s_waitcnt lgkmcnt(4)
    v_mfma_f32_32x32x16_bf16 v[80:95], v[176:179], v[144:147], v[80:95]
    ds_read_b128 v[176:179], v242 offset:17408
    v_exp_f32 v197, v69
    v_exp_f32 v198, v70
    v_add_f32 v241, v241, v196
    v_mfma_f32_32x32x16_bf16 v[80:95], v[180:183], v[148:151], v[80:95]
    ds_read_b128 v[180:183], v242 offset:19456
    v_exp_f32 v199, v71
    v_cvt_pk_bf16_f32 v114, v196, v197
    v_add_f32 v241, v241, v197
    v_add_f32 v241, v241, v198
    v_mfma_f32_32x32x16_bf16 v[80:95], v[184:187], v[152:155], v[80:95]
    ds_read_b128 v[184:187], v242 offset:21504
    v_exp_f32 v192, v72
    v_exp_f32 v193, v73
    v_cvt_pk_bf16_f32 v115, v198, v199
    v_add_f32 v241, v241, v199
    v_mfma_f32_32x32x16_bf16 v[80:95], v[188:191], v[156:159], v[80:95]
    ds_read_b128 v[188:191], v242 offset:23552
    v_exp_f32 v194, v74
    v_cvt_pk_bf16_f32 v116, v192, v193
    v_add_f32 v241, v241, v192
    v_add_f32 v241, v241, v193
    s_waitcnt lgkmcnt(4)
    v_mfma_f32_32x32x16_bf16 v[0:15], v[160:163], v[120:123], v[0:15]
    ds_read_b128 v[160:163], v242 offset:0
    v_exp_f32 v195, v75
    v_add_f32 v241, v241, v194
    v_mfma_f32_32x32x16_bf16 v[16:31], v[164:167], v[120:123], v[16:31]
    ds_read_b128 v[164:167], v242 offset:1024
    v_exp_f32 v196, v76
    v_cvt_pk_bf16_f32 v117, v194, v195
    v_add_f32 v241, v241, v195
    v_mfma_f32_32x32x16_bf16 v[32:47], v[168:171], v[120:123], v[32:47]
    ds_read_b128 v[168:171], v242 offset:2048
    v_exp_f32 v197, v77
    v_add_f32 v241, v241, v196
    v_mfma_f32_32x32x16_bf16 v[48:63], v[172:175], v[120:123], v[48:63]
    ds_read_b128 v[172:175], v242 offset:3072
    v_exp_f32 v198, v78
    v_cvt_pk_bf16_f32 v118, v196, v197
    v_add_f32 v241, v241, v197
    s_waitcnt lgkmcnt(4)
    v_mfma_f32_32x32x16_bf16 v[0:15], v[176:179], v[124:127], v[0:15]
    ds_read_b128 v[176:179], v242 offset:4096
    v_exp_f32 v199, v79
    v_add_f32 v241, v241, v198
    v_mfma_f32_32x32x16_bf16 v[16:31], v[180:183], v[124:127], v[16:31]
    ds_read_b128 v[180:183], v242 offset:5120
    v_cvt_pk_bf16_f32 v119, v198, v199
    v_add_f32 v241, v241, v199
    v_mfma_f32_32x32x16_bf16 v[32:47], v[184:187], v[124:127], v[32:47]
    ds_read_b128 v[184:187], v242 offset:6144
    v_cmp_nge_f32 vcc, s52, v241
    v_mfma_f32_32x32x16_bf16 v[48:63], v[188:191], v[124:127], v[48:63]
    s_cbranch_vccnz parallel_sum__compressed_kv_cla__moe_arch_mod__prompt_kernel_chk_31_slow
parallel_sum__compressed_kv_cla__moe_arch_mod__prompt_kernel_chk_31_back:
    ds_read_b128 v[188:191], v242 offset:7168
    v_add_f32 v240, v240, v241
    s_waitcnt lgkmcnt(4)
    v_mfma_f32_32x32x16_bf16 v[64:79], v[160:163], v[128:131], v[96:111]
    ds_read_b128 v[160:163], v242 offset:24576
    v_exp_f32 v192, v80
    v_exp_f32 v193, v81
    v_mfma_f32_32x32x16_bf16 v[64:79], v[164:167], v[132:135], v[64:79]
    ds_read_b128 v[164:167], v242 offset:26624
    v_exp_f32 v194, v82
    v_cvt_pk_bf16_f32 v120, v192, v193
    v_add_f32 v241, v192, v193
    v_mfma_f32_32x32x16_bf16 v[64:79], v[168:171], v[136:139], v[64:79]
    ds_read_b128 v[168:171], v242 offset:28672
    v_exp_f32 v195, v83
    v_exp_f32 v196, v84
    v_add_f32 v241, v241, v194
    v_mfma_f32_32x32x16_bf16 v[64:79], v[172:175], v[140:143], v[64:79]
    ds_read_b128 v[172:175], v242 offset:30720
    v_exp_f32 v197, v85
    v_cvt_pk_bf16_f32 v121, v194, v195
    v_add_f32 v241, v241, v195
    v_add_f32 v241, v241, v196
    s_waitcnt lgkmcnt(4)
    v_mfma_f32_32x32x16_bf16 v[64:79], v[176:179], v[144:147], v[64:79]
    ds_read_b128 v[176:179], v242 offset:25600
    v_exp_f32 v198, v86
    v_cvt_pk_bf16_f32 v122, v196, v197
    v_add_f32 v241, v241, v197
    v_mfma_f32_32x32x16_bf16 v[64:79], v[180:183], v[148:151], v[64:79]
    ds_read_b128 v[180:183], v242 offset:27648
    v_exp_f32 v199, v87
    v_add_f32 v241, v241, v198
    v_mfma_f32_32x32x16_bf16 v[64:79], v[184:187], v[152:155], v[64:79]
    ds_read_b128 v[184:187], v242 offset:29696
    v_exp_f32 v192, v88
    v_exp_f32 v193, v89
    v_cvt_pk_bf16_f32 v123, v198, v199
    v_add_f32 v241, v241, v199
    v_mfma_f32_32x32x16_bf16 v[64:79], v[188:191], v[156:159], v[64:79]
    ds_read_b128 v[188:191], v242 offset:31744
    v_exp_f32 v194, v90
    v_cvt_pk_bf16_f32 v124, v192, v193
    v_add_f32 v241, v241, v192
    v_add_f32 v241, v241, v193
    s_waitcnt lgkmcnt(4)
    v_mfma_f32_32x32x16_bf16 v[0:15], v[160:163], v[112:115], v[0:15]
    ds_read_b128 v[160:163], v242 offset:8192
    v_exp_f32 v195, v91
    v_add_f32 v241, v241, v194
    v_mfma_f32_32x32x16_bf16 v[16:31], v[164:167], v[112:115], v[16:31]
    s_sub_u32 s41, s41, 1
    ds_read_b128 v[164:167], v242 offset:9216
    v_exp_f32 v196, v92
    v_cvt_pk_bf16_f32 v125, v194, v195
    v_add_f32 v241, v241, v195
    v_mfma_f32_32x32x16_bf16 v[32:47], v[168:171], v[112:115], v[32:47]
    ds_read_b128 v[168:171], v242 offset:10240
    v_exp_f32 v197, v93
    v_add_f32 v241, v241, v196
    v_mfma_f32_32x32x16_bf16 v[48:63], v[172:175], v[112:115], v[48:63]
    ds_read_b128 v[172:175], v242 offset:11264
    v_exp_f32 v198, v94
    v_cvt_pk_bf16_f32 v126, v196, v197
    v_add_f32 v241, v241, v197
    s_add_u32 s42, s42, 32768
    s_and_b32 s42, s42, 0x1ffff
    s_waitcnt lgkmcnt(4)
    v_mfma_f32_32x32x16_bf16 v[0:15], v[176:179], v[116:119], v[0:15]
    ds_read_b128 v[176:179], v242 offset:12288
    v_exp_f32 v199, v95
    v_add_f32 v241, v241, v198
    s_cmp_lg_u32 s41, 0
    v_mfma_f32_32x32x16_bf16 v[16:31], v[180:183], v[116:119], v[16:31]
    s_cbranch_scc1 parallel_sum__compressed_kv_cla__moe_arch_mod__prompt_kernel_B_rot
    ds_read_b128 v[180:183], v242 offset:13312
    v_cvt_pk_bf16_f32 v127, v198, v199
    v_add_f32 v241, v241, v199
    v_mfma_f32_32x32x16_bf16 v[32:47], v[184:187], v[116:119], v[32:47]
    ds_read_b128 v[184:187], v242 offset:14336
    v_cmp_nge_f32 vcc, s52, v241
    v_mfma_f32_32x32x16_bf16 v[48:63], v[188:191], v[116:119], v[48:63]
    s_cbranch_vccnz parallel_sum__compressed_kv_cla__moe_arch_mod__prompt_kernel_chk_34_slow
parallel_sum__compressed_kv_cla__moe_arch_mod__prompt_kernel_chk_34_back:
    ds_read_b128 v[188:191], v242 offset:15360
    v_add_f32 v240, v240, v241
parallel_sum__compressed_kv_cla__moe_arch_mod__prompt_kernel_B_endseq:
    s_bitcmp1_b32 s40, 0
    s_cbranch_scc1 parallel_sum__compressed_kv_cla__moe_arch_mod__prompt_kernel_B_seqO
    v_cmp_le_i32 vcc, 0, v244
    s_nop 1
    v_cndmask_b32 v96, v246, v96, vcc
    v_cmp_le_i32 vcc, 1, v244
    s_nop 1
    v_cndmask_b32 v97, v246, v97, vcc
    v_cmp_le_i32 vcc, 2, v244
    s_nop 1
    v_cndmask_b32 v98, v246, v98, vcc
    v_cmp_le_i32 vcc, 3, v244
    s_nop 1
    v_cndmask_b32 v99, v246, v99, vcc
    v_cmp_le_i32 vcc, 8, v244
    s_nop 1
    v_cndmask_b32 v100, v246, v100, vcc
    v_cmp_le_i32 vcc, 9, v244
    s_nop 1
    v_cndmask_b32 v101, v246, v101, vcc
    v_cmp_le_i32 vcc, 10, v244
    s_nop 1
    v_cndmask_b32 v102, v246, v102, vcc
    v_cmp_le_i32 vcc, 11, v244
    s_nop 1
    v_cndmask_b32 v103, v246, v103, vcc
    v_cmp_le_i32 vcc, 16, v244
    s_nop 1
    v_cndmask_b32 v104, v246, v104, vcc
    v_cmp_le_i32 vcc, 17, v244
    s_nop 1
    v_cndmask_b32 v105, v246, v105, vcc
    v_cmp_le_i32 vcc, 18, v244
    s_nop 1
    v_cndmask_b32 v106, v246, v106, vcc
    v_cmp_le_i32 vcc, 19, v244
    s_nop 1
    v_cndmask_b32 v107, v246, v107, vcc
    v_cmp_le_i32 vcc, 24, v244
    s_nop 1
    v_cndmask_b32 v108, v246, v108, vcc
    v_cmp_le_i32 vcc, 25, v244
    s_nop 1
    v_cndmask_b32 v109, v246, v109, vcc
    v_cmp_le_i32 vcc, 26, v244
    s_nop 1
    v_cndmask_b32 v110, v246, v110, vcc
    v_cmp_le_i32 vcc, 27, v244
    s_nop 1
    v_cndmask_b32 v111, v246, v111, vcc
    s_nop 1
    s_waitcnt lgkmcnt(4)
    v_mfma_f32_32x32x16_bf16 v[80:95], v[160:163], v[128:131], v[96:111]
    s_barrier
    v_add_u32 v242, s42, v243
    ds_read_b128 v[160:163], v242 offset:16384
    v_exp_f32 v192, v64
    v_mfma_f32_32x32x16_bf16 v[80:95], v[164:167], v[132:135], v[80:95]
    ds_read_b128 v[164:167], v242 offset:18432
    v_exp_f32 v193, v65
    v_mfma_f32_32x32x16_bf16 v[80:95], v[168:171], v[136:139], v[80:95]
    ds_read_b128 v[168:171], v242 offset:20480
    v_exp_f32 v194, v66
    v_exp_f32 v195, v67
    v_cvt_pk_bf16_f32 v112, v192, v193
    v_add_f32 v241, v192, v193
    v_mfma_f32_32x32x16_bf16 v[80:95], v[172:175], v[140:143], v[80:95]
    ds_read_b128 v[172:175], v242 offset:22528
    v_exp_f32 v196, v68
    v_cvt_pk_bf16_f32 v113, v194, v195
    v_add_f32 v241, v241, v194
    v_add_f32 v241, v241, v195
    s_waitcnt lgkmcnt(4)
    v_mfma_f32_32x32x16_bf16 v[80:95], v[176:179], v[144:147], v[80:95]
    ds_read_b128 v[176:179], v242 offset:17408
    v_exp_f32 v197, v69
    v_exp_f32 v198, v70
    v_add_f32 v241, v241, v196
    v_mfma_f32_32x32x16_bf16 v[80:95], v[180:183], v[148:151], v[80:95]
    ds_read_b128 v[180:183], v242 offset:19456
    v_exp_f32 v199, v71
    v_cvt_pk_bf16_f32 v114, v196, v197
    v_add_f32 v241, v241, v197
    v_add_f32 v241, v241, v198
    v_mfma_f32_32x32x16_bf16 v[80:95], v[184:187], v[152:155], v[80:95]
    ds_read_b128 v[184:187], v242 offset:21504
    v_exp_f32 v192, v72
    v_exp_f32 v193, v73
    v_cvt_pk_bf16_f32 v115, v198, v199
    v_add_f32 v241, v241, v199
    v_mfma_f32_32x32x16_bf16 v[80:95], v[188:191], v[156:159], v[80:95]
    ds_read_b128 v[188:191], v242 offset:23552
    v_exp_f32 v194, v74
    v_cvt_pk_bf16_f32 v116, v192, v193
    v_add_f32 v241, v241, v192
    v_add_f32 v241, v241, v193
    s_waitcnt lgkmcnt(4)
    v_mfma_f32_32x32x16_bf16 v[0:15], v[160:163], v[120:123], v[0:15]
    ds_read_b128 v[160:163], v242 offset:0
    v_exp_f32 v195, v75
    v_add_f32 v241, v241, v194
    v_mfma_f32_32x32x16_bf16 v[16:31], v[164:167], v[120:123], v[16:31]
    ds_read_b128 v[164:167], v242 offset:1024
    v_exp_f32 v196, v76
    v_cvt_pk_bf16_f32 v117, v194, v195
    v_add_f32 v241, v241, v195
    v_mfma_f32_32x32x16_bf16 v[32:47], v[168:171], v[120:123], v[32:47]
    ds_read_b128 v[168:171], v242 offset:2048
    v_exp_f32 v197, v77
    v_add_f32 v241, v241, v196
    v_mfma_f32_32x32x16_bf16 v[48:63], v[172:175], v[120:123], v[48:63]
    ds_read_b128 v[172:175], v242 offset:3072
    v_exp_f32 v198, v78
    v_cvt_pk_bf16_f32 v118, v196, v197
    v_add_f32 v241, v241, v197
    s_waitcnt lgkmcnt(4)
    v_mfma_f32_32x32x16_bf16 v[0:15], v[176:179], v[124:127], v[0:15]
    ds_read_b128 v[176:179], v242 offset:4096
    v_exp_f32 v199, v79
    v_add_f32 v241, v241, v198
    v_mfma_f32_32x32x16_bf16 v[16:31], v[180:183], v[124:127], v[16:31]
    ds_read_b128 v[180:183], v242 offset:5120
    v_cvt_pk_bf16_f32 v119, v198, v199
    v_add_f32 v241, v241, v199
    v_mfma_f32_32x32x16_bf16 v[32:47], v[184:187], v[124:127], v[32:47]
    ds_read_b128 v[184:187], v242 offset:6144
    v_cmp_nge_f32 vcc, s52, v241
    v_mfma_f32_32x32x16_bf16 v[48:63], v[188:191], v[124:127], v[48:63]
    s_cbranch_vccnz parallel_sum__compressed_kv_cla__moe_arch_mod__prompt_kernel_chk_35_slow
parallel_sum__compressed_kv_cla__moe_arch_mod__prompt_kernel_chk_35_back:
    ds_read_b128 v[188:191], v242 offset:7168
    v_add_f32 v240, v240, v241
    ds_read_b128 v[160:163], v242 offset:24576
    ds_read_b128 v[164:167], v242 offset:26624
    ds_read_b128 v[168:171], v242 offset:28672
    ds_read_b128 v[172:175], v242 offset:30720
    ds_read_b128 v[176:179], v242 offset:25600
    ds_read_b128 v[180:183], v242 offset:27648
    ds_read_b128 v[184:187], v242 offset:29696
    ds_read_b128 v[188:191], v242 offset:31744
    v_exp_f32 v192, v80
    v_exp_f32 v193, v81
    v_exp_f32 v194, v82
    v_cvt_pk_bf16_f32 v120, v192, v193
    v_add_f32 v241, v192, v193
    v_exp_f32 v195, v83
    v_exp_f32 v196, v84
    v_add_f32 v241, v241, v194
    v_exp_f32 v197, v85
    v_cvt_pk_bf16_f32 v121, v194, v195
    v_add_f32 v241, v241, v195
    v_add_f32 v241, v241, v196
    v_exp_f32 v198, v86
    v_cvt_pk_bf16_f32 v122, v196, v197
    v_add_f32 v241, v241, v197
    v_exp_f32 v199, v87
    v_add_f32 v241, v241, v198
    v_exp_f32 v192, v88
    v_exp_f32 v193, v89
    v_cvt_pk_bf16_f32 v123, v198, v199
    v_add_f32 v241, v241, v199
    v_exp_f32 v194, v90
    v_cvt_pk_bf16_f32 v124, v192, v193
    v_add_f32 v241, v241, v192
    v_add_f32 v241, v241, v193
    s_waitcnt lgkmcnt(4)
    v_mfma_f32_32x32x16_bf16 v[0:15], v[160:163], v[112:115], v[0:15]
    v_exp_f32 v195, v91
    v_add_f32 v241, v241, v194
    v_mfma_f32_32x32x16_bf16 v[16:31], v[164:167], v[112:115], v[16:31]
    v_exp_f32 v196, v92
    v_cvt_pk_bf16_f32 v125, v194, v195
    v_add_f32 v241, v241, v195
    v_mfma_f32_32x32x16_bf16 v[32:47], v[168:171], v[112:115], v[32:47]
    v_exp_f32 v197, v93
    v_add_f32 v241, v241, v196
    v_mfma_f32_32x32x16_bf16 v[48:63], v[172:175], v[112:115], v[48:63]
    v_exp_f32 v198, v94
    v_cvt_pk_bf16_f32 v126, v196, v197
    v_add_f32 v241, v241, v197
    s_waitcnt lgkmcnt(0)
    v_mfma_f32_32x32x16_bf16 v[0:15], v[176:179], v[116:119], v[0:15]
    v_exp_f32 v199, v95
    v_add_f32 v241, v241, v198
    v_mfma_f32_32x32x16_bf16 v[16:31], v[180:183], v[116:119], v[16:31]
    v_cvt_pk_bf16_f32 v127, v198, v199
    v_add_f32 v241, v241, v199
    v_mfma_f32_32x32x16_bf16 v[32:47], v[184:187], v[116:119], v[32:47]
    v_cmp_nge_f32 vcc, s52, v241
    v_mfma_f32_32x32x16_bf16 v[48:63], v[188:191], v[116:119], v[48:63]
    s_cbranch_vccnz parallel_sum__compressed_kv_cla__moe_arch_mod__prompt_kernel_chk_36_slow
parallel_sum__compressed_kv_cla__moe_arch_mod__prompt_kernel_chk_36_back:
    v_add_f32 v240, v240, v241
    s_add_u32 s42, s42, 32768
    s_and_b32 s42, s42, 0x1ffff
    s_barrier
    v_add_u32 v242, s42, v243
    ds_read_b128 v[160:163], v242 offset:16384
    ds_read_b128 v[164:167], v242 offset:18432
    ds_read_b128 v[168:171], v242 offset:20480
    ds_read_b128 v[172:175], v242 offset:22528
    ds_read_b128 v[176:179], v242 offset:17408
    ds_read_b128 v[180:183], v242 offset:19456
    ds_read_b128 v[184:187], v242 offset:21504
    ds_read_b128 v[188:191], v242 offset:23552
    s_waitcnt lgkmcnt(6)
    v_mfma_f32_32x32x16_bf16 v[0:15], v[160:163], v[120:123], v[0:15]
    v_mfma_f32_32x32x16_bf16 v[16:31], v[164:167], v[120:123], v[16:31]
    s_waitcnt lgkmcnt(4)
    v_mfma_f32_32x32x16_bf16 v[32:47], v[168:171], v[120:123], v[32:47]
    v_mfma_f32_32x32x16_bf16 v[48:63], v[172:175], v[120:123], v[48:63]
    s_waitcnt lgkmcnt(2)
    v_mfma_f32_32x32x16_bf16 v[0:15], v[176:179], v[124:127], v[0:15]
    v_mfma_f32_32x32x16_bf16 v[16:31], v[180:183], v[124:127], v[16:31]
    s_waitcnt lgkmcnt(0)
    v_mfma_f32_32x32x16_bf16 v[32:47], v[184:187], v[124:127], v[32:47]
    v_mfma_f32_32x32x16_bf16 v[48:63], v[188:191], v[124:127], v[48:63]
    s_branch parallel_sum__compressed_kv_cla__moe_arch_mod__prompt_kernel_B_epi
parallel_sum__compressed_kv_cla__moe_arch_mod__prompt_kernel_B_seqO:
    s_waitcnt lgkmcnt(4)
    v_mfma_f32_32x32x16_bf16 v[80:95], v[160:163], v[128:131], v[96:111]
    s_barrier
    v_add_u32 v242, s42, v243
    ds_read_b128 v[160:163], v242 offset:16384
    v_exp_f32 v192, v64
    v_mfma_f32_32x32x16_bf16 v[80:95], v[164:167], v[132:135], v[80:95]
    ds_read_b128 v[164:167], v242 offset:18432
    v_exp_f32 v193, v65
    v_mfma_f32_32x32x16_bf16 v[80:95], v[168:171], v[136:139], v[80:95]
    ds_read_b128 v[168:171], v242 offset:20480
    v_exp_f32 v194, v66
    v_exp_f32 v195, v67
    v_cvt_pk_bf16_f32 v112, v192, v193
    v_add_f32 v241, v192, v193
    v_mfma_f32_32x32x16_bf16 v[80:95], v[172:175], v[140:143], v[80:95]
    ds_read_b128 v[172:175], v242 offset:22528
    v_exp_f32 v196, v68
    v_cvt_pk_bf16_f32 v113, v194, v195
    v_add_f32 v241, v241, v194
    v_add_f32 v241, v241, v195
    s_waitcnt lgkmcnt(4)
    v_mfma_f32_32x32x16_bf16 v[80:95], v[176:179], v[144:147], v[80:95]
    ds_read_b128 v[176:179], v242 offset:17408
    v_exp_f32 v197, v69
    v_exp_f32 v198, v70
    v_add_f32 v241, v241, v196
    v_mfma_f32_32x32x16_bf16 v[80:95], v[180:183], v[148:151], v[80:95]
    ds_read_b128 v[180:183], v242 offset:19456
    v_exp_f32 v199, v71
    v_cvt_pk_bf16_f32 v114, v196, v197
    v_add_f32 v241, v241, v197
    v_add_f32 v241, v241, v198
    v_mfma_f32_32x32x16_bf16 v[80:95], v[184:187], v[152:155], v[80:95]
    ds_read_b128 v[184:187], v242 offset:21504
    v_exp_f32 v192, v72
    v_exp_f32 v193, v73
    v_cvt_pk_bf16_f32 v115, v198, v199
    v_add_f32 v241, v241, v199
    v_mfma_f32_32x32x16_bf16 v[80:95], v[188:191], v[156:159], v[80:95]
    ds_read_b128 v[188:191], v242 offset:23552
    v_exp_f32 v194, v74
    v_cvt_pk_bf16_f32 v116, v192, v193
    v_add_f32 v241, v241, v192
    v_add_f32 v241, v241, v193
    s_waitcnt lgkmcnt(4)
    v_mfma_f32_32x32x16_bf16 v[0:15], v[160:163], v[120:123], v[0:15]
    ds_read_b128 v[160:163], v242 offset:0
    v_exp_f32 v195, v75
    v_add_f32 v241, v241, v194
    v_mfma_f32_32x32x16_bf16 v[16:31], v[164:167], v[120:123], v[16:31]
    ds_read_b128 v[164:167], v242 offset:1024
    v_exp_f32 v196, v76
    v_cvt_pk_bf16_f32 v117, v194, v195
    v_add_f32 v241, v241, v195
    v_mfma_f32_32x32x16_bf16 v[32:47], v[168:171], v[120:123], v[32:47]
    ds_read_b128 v[168:171], v242 offset:2048
    v_exp_f32 v197, v77
    v_add_f32 v241, v241, v196
    v_mfma_f32_32x32x16_bf16 v[48:63], v[172:175], v[120:123], v[48:63]
    ds_read_b128 v[172:175], v242 offset:3072
    v_exp_f32 v198, v78
    v_cvt_pk_bf16_f32 v118, v196, v197
    v_add_f32 v241, v241, v197
    s_waitcnt lgkmcnt(4)
    v_mfma_f32_32x32x16_bf16 v[0:15], v[176:179], v[124:127], v[0:15]
    ds_read_b128 v[176:179], v242 offset:4096
    v_exp_f32 v199, v79
    v_add_f32 v241, v241, v198
    v_mfma_f32_32x32x16_bf16 v[16:31], v[180:183], v[124:127], v[16:31]
    ds_read_b128 v[180:183], v242 offset:5120
    v_cvt_pk_bf16_f32 v119, v198, v199
    v_add_f32 v241, v241, v199
    v_mfma_f32_32x32x16_bf16 v[32:47], v[184:187], v[124:127], v[32:47]
    ds_read_b128 v[184:187], v242 offset:6144
    v_cmp_nge_f32 vcc, s52, v241
    v_mfma_f32_32x32x16_bf16 v[48:63], v[188:191], v[124:127], v[48:63]
    s_cbranch_vccnz parallel_sum__compressed_kv_cla__moe_arch_mod__prompt_kernel_chk_37_slow
parallel_sum__compressed_kv_cla__moe_arch_mod__prompt_kernel_chk_37_back:
    ds_read_b128 v[188:191], v242 offset:7168
    v_add_f32 v240, v240, v241
    v_cmp_le_i32 vcc, 0, v244
    s_nop 1
    v_cndmask_b32 v96, v246, v96, vcc
    v_cmp_le_i32 vcc, 1, v244
    s_nop 1
    v_cndmask_b32 v97, v246, v97, vcc
    v_cmp_le_i32 vcc, 2, v244
    s_nop 1
    v_cndmask_b32 v98, v246, v98, vcc
    v_cmp_le_i32 vcc, 3, v244
    s_nop 1
    v_cndmask_b32 v99, v246, v99, vcc
    v_cmp_le_i32 vcc, 8, v244
    s_nop 1
    v_cndmask_b32 v100, v246, v100, vcc
    v_cmp_le_i32 vcc, 9, v244
    s_nop 1
    v_cndmask_b32 v101, v246, v101, vcc
    v_cmp_le_i32 vcc, 10, v244
    s_nop 1
    v_cndmask_b32 v102, v246, v102, vcc
    v_cmp_le_i32 vcc, 11, v244
    s_nop 1
    v_cndmask_b32 v103, v246, v103, vcc
    v_cmp_le_i32 vcc, 16, v244
    s_nop 1
    v_cndmask_b32 v104, v246, v104, vcc
    v_cmp_le_i32 vcc, 17, v244
    s_nop 1
    v_cndmask_b32 v105, v246, v105, vcc
    v_cmp_le_i32 vcc, 18, v244
    s_nop 1
    v_cndmask_b32 v106, v246, v106, vcc
    v_cmp_le_i32 vcc, 19, v244
    s_nop 1
    v_cndmask_b32 v107, v246, v107, vcc
    v_cmp_le_i32 vcc, 24, v244
    s_nop 1
    v_cndmask_b32 v108, v246, v108, vcc
    v_cmp_le_i32 vcc, 25, v244
    s_nop 1
    v_cndmask_b32 v109, v246, v109, vcc
    v_cmp_le_i32 vcc, 26, v244
    s_nop 1
    v_cndmask_b32 v110, v246, v110, vcc
    v_cmp_le_i32 vcc, 27, v244
    s_nop 1
    v_cndmask_b32 v111, v246, v111, vcc
    s_nop 1
    s_waitcnt lgkmcnt(4)
    v_mfma_f32_32x32x16_bf16 v[64:79], v[160:163], v[128:131], v[96:111]
    ds_read_b128 v[160:163], v242 offset:24576
    v_exp_f32 v192, v80
    v_exp_f32 v193, v81
    v_mfma_f32_32x32x16_bf16 v[64:79], v[164:167], v[132:135], v[64:79]
    ds_read_b128 v[164:167], v242 offset:26624
    v_exp_f32 v194, v82
    v_cvt_pk_bf16_f32 v120, v192, v193
    v_add_f32 v241, v192, v193
    v_mfma_f32_32x32x16_bf16 v[64:79], v[168:171], v[136:139], v[64:79]
    ds_read_b128 v[168:171], v242 offset:28672
    v_exp_f32 v195, v83
    v_exp_f32 v196, v84
    v_add_f32 v241, v241, v194
    v_mfma_f32_32x32x16_bf16 v[64:79], v[172:175], v[140:143], v[64:79]
    ds_read_b128 v[172:175], v242 offset:30720
    v_exp_f32 v197, v85
    v_cvt_pk_bf16_f32 v121, v194, v195
    v_add_f32 v241, v241, v195
    v_add_f32 v241, v241, v196
    s_waitcnt lgkmcnt(4)
    v_mfma_f32_32x32x16_bf16 v[64:79], v[176:179], v[144:147], v[64:79]
    ds_read_b128 v[176:179], v242 offset:25600
    v_exp_f32 v198, v86
    v_cvt_pk_bf16_f32 v122, v196, v197
    v_add_f32 v241, v241, v197
    v_mfma_f32_32x32x16_bf16 v[64:79], v[180:183], v[148:151], v[64:79]
    ds_read_b128 v[180:183], v242 offset:27648
    v_exp_f32 v199, v87
    v_add_f32 v241, v241, v198
    v_mfma_f32_32x32x16_bf16 v[64:79], v[184:187], v[152:155], v[64:79]
    ds_read_b128 v[184:187], v242 offset:29696
    v_exp_f32 v192, v88
    v_exp_f32 v193, v89
    v_cvt_pk_bf16_f32 v123, v198, v199
    v_add_f32 v241, v241, v199
    v_mfma_f32_32x32x16_bf16 v[64:79], v[188:191], v[156:159], v[64:79]
    ds_read_b128 v[188:191], v242 offset:31744
    v_exp_f32 v194, v90
    v_cvt_pk_bf16_f32 v124, v192, v193
    v_add_f32 v241, v241, v192
    v_add_f32 v241, v241, v193
    s_waitcnt lgkmcnt(4)
    v_mfma_f32_32x32x16_bf16 v[0:15], v[160:163], v[112:115], v[0:15]
    ds_read_b128 v[160:163], v242 offset:8192
    v_exp_f32 v195, v91
    v_add_f32 v241, v241, v194
    v_mfma_f32_32x32x16_bf16 v[16:31], v[164:167], v[112:115], v[16:31]
    ds_read_b128 v[164:167], v242 offset:9216
    v_exp_f32 v196, v92
    v_cvt_pk_bf16_f32 v125, v194, v195
    v_add_f32 v241, v241, v195
    v_mfma_f32_32x32x16_bf16 v[32:47], v[168:171], v[112:115], v[32:47]
    ds_read_b128 v[168:171], v242 offset:10240
    v_exp_f32 v197, v93
    v_add_f32 v241, v241, v196
    v_mfma_f32_32x32x16_bf16 v[48:63], v[172:175], v[112:115], v[48:63]
    ds_read_b128 v[172:175], v242 offset:11264
    v_exp_f32 v198, v94
    v_cvt_pk_bf16_f32 v126, v196, v197
    v_add_f32 v241, v241, v197
    s_add_u32 s42, s42, 32768
    s_and_b32 s42, s42, 0x1ffff
    s_waitcnt lgkmcnt(4)
    v_mfma_f32_32x32x16_bf16 v[0:15], v[176:179], v[116:119], v[0:15]
    ds_read_b128 v[176:179], v242 offset:12288
    v_exp_f32 v199, v95
    v_add_f32 v241, v241, v198
    v_mfma_f32_32x32x16_bf16 v[16:31], v[180:183], v[116:119], v[16:31]
    ds_read_b128 v[180:183], v242 offset:13312
    v_cvt_pk_bf16_f32 v127, v198, v199
    v_add_f32 v241, v241, v199
    v_mfma_f32_32x32x16_bf16 v[32:47], v[184:187], v[116:119], v[32:47]
    ds_read_b128 v[184:187], v242 offset:14336
    v_cmp_nge_f32 vcc, s52, v241
    v_mfma_f32_32x32x16_bf16 v[48:63], v[188:191], v[116:119], v[48:63]
    s_cbranch_vccnz parallel_sum__compressed_kv_cla__moe_arch_mod__prompt_kernel_chk_38_slow
parallel_sum__compressed_kv_cla__moe_arch_mod__prompt_kernel_chk_38_back:
    ds_read_b128 v[188:191], v242 offset:15360
    v_add_f32 v240, v240, v241
parallel_sum__compressed_kv_cla__moe_arch_mod__prompt_kernel_B_seqO2:
    s_barrier
    v_add_u32 v242, s42, v243
    ds_read_b128 v[160:163], v242 offset:16384
    ds_read_b128 v[164:167], v242 offset:18432
    ds_read_b128 v[168:171], v242 offset:20480
    ds_read_b128 v[172:175], v242 offset:22528
    ds_read_b128 v[176:179], v242 offset:17408
    ds_read_b128 v[180:183], v242 offset:19456
    ds_read_b128 v[184:187], v242 offset:21504
    ds_read_b128 v[188:191], v242 offset:23552
    v_exp_f32 v192, v64
    v_exp_f32 v193, v65
    v_exp_f32 v194, v66
    v_exp_f32 v195, v67
    v_cvt_pk_bf16_f32 v112, v192, v193
    v_add_f32 v241, v192, v193
    v_exp_f32 v196, v68
    v_cvt_pk_bf16_f32 v113, v194, v195
    v_add_f32 v241, v241, v194
    v_add_f32 v241, v241, v195
    v_exp_f32 v197, v69
    v_exp_f32 v198, v70
    v_add_f32 v241, v241, v196
    v_exp_f32 v199, v71
    v_cvt_pk_bf16_f32 v114, v196, v197
    v_add_f32 v241, v241, v197
    v_add_f32 v241, v241, v198
    v_exp_f32 v192, v72
    v_exp_f32 v193, v73
    v_cvt_pk_bf16_f32 v115, v198, v199
    v_add_f32 v241, v241, v199
    v_exp_f32 v194, v74
    v_cvt_pk_bf16_f32 v116, v192, v193
    v_add_f32 v241, v241, v192
    v_add_f32 v241, v241, v193
    s_waitcnt lgkmcnt(4)
    v_mfma_f32_32x32x16_bf16 v[0:15], v[160:163], v[120:123], v[0:15]
    v_exp_f32 v195, v75
    v_add_f32 v241, v241, v194
    v_mfma_f32_32x32x16_bf16 v[16:31], v[164:167], v[120:123], v[16:31]
    v_exp_f32 v196, v76
    v_cvt_pk_bf16_f32 v117, v194, v195
    v_add_f32 v241, v241, v195
    v_mfma_f32_32x32x16_bf16 v[32:47], v[168:171], v[120:123], v[32:47]
    v_exp_f32 v197, v77
    v_add_f32 v241, v241, v196
    v_mfma_f32_32x32x16_bf16 v[48:63], v[172:175], v[120:123], v[48:63]
    v_exp_f32 v198, v78
    v_cvt_pk_bf16_f32 v118, v196, v197
    v_add_f32 v241, v241, v197
    s_waitcnt lgkmcnt(0)
    v_mfma_f32_32x32x16_bf16 v[0:15], v[176:179], v[124:127], v[0:15]
    v_exp_f32 v199, v79
    v_add_f32 v241, v241, v198
    v_mfma_f32_32x32x16_bf16 v[16:31], v[180:183], v[124:127], v[16:31]
    v_cvt_pk_bf16_f32 v119, v198, v199
    v_add_f32 v241, v241, v199
    v_mfma_f32_32x32x16_bf16 v[32:47], v[184:187], v[124:127], v[32:47]
    v_cmp_nge_f32 vcc, s52, v241
    v_mfma_f32_32x32x16_bf16 v[48:63], v[188:191], v[124:127], v[48:63]
    s_cbranch_vccnz parallel_sum__compressed_kv_cla__moe_arch_mod__prompt_kernel_chk_39_slow
parallel_sum__compressed_kv_cla__moe_arch_mod__prompt_kernel_chk_39_back:
    v_add_f32 v240, v240, v241
    ds_read_b128 v[160:163], v242 offset:24576
    ds_read_b128 v[164:167], v242 offset:26624
    ds_read_b128 v[168:171], v242 offset:28672
    ds_read_b128 v[172:175], v242 offset:30720
    ds_read_b128 v[176:179], v242 offset:25600
    ds_read_b128 v[180:183], v242 offset:27648
    ds_read_b128 v[184:187], v242 offset:29696
    ds_read_b128 v[188:191], v242 offset:31744
    s_waitcnt lgkmcnt(6)
    v_mfma_f32_32x32x16_bf16 v[0:15], v[160:163], v[112:115], v[0:15]
    v_mfma_f32_32x32x16_bf16 v[16:31], v[164:167], v[112:115], v[16:31]
    s_waitcnt lgkmcnt(4)
    v_mfma_f32_32x32x16_bf16 v[32:47], v[168:171], v[112:115], v[32:47]
    v_mfma_f32_32x32x16_bf16 v[48:63], v[172:175], v[112:115], v[48:63]
    s_waitcnt lgkmcnt(2)
    v_mfma_f32_32x32x16_bf16 v[0:15], v[176:179], v[116:119], v[0:15]
    v_mfma_f32_32x32x16_bf16 v[16:31], v[180:183], v[116:119], v[16:31]
    s_waitcnt lgkmcnt(0)
    v_mfma_f32_32x32x16_bf16 v[32:47], v[184:187], v[116:119], v[32:47]
    v_mfma_f32_32x32x16_bf16 v[48:63], v[188:191], v[116:119], v[48:63]
parallel_sum__compressed_kv_cla__moe_arch_mod__prompt_kernel_B_epi:
    v_mov_b32 v252, v240
    s_nop 1
    v_permlane32_swap_b32 v240, v252
    s_lshl_b32 s47, s39, 5
    s_add_u32 s47, s47, s37
    v_add_f32 v240, v240, v252
    v_rcp_f32 v240, v240
    s_lshl_b32 s71, s47, 6
    s_add_u32 s71, s71, 0x788000
    s_lshl_b32 s47, s47, 13
    s_add_u32 s47, s47, 0x2800000
    s_add_u32 s48, s47, 4096
    s_nop 7
    v_mul_f32 v0, v0, v240
    v_mul_f32 v1, v1, v240
    v_mul_f32 v2, v2, v240
    v_mul_f32 v3, v3, v240
    v_mul_f32 v4, v4, v240
    v_mul_f32 v5, v5, v240
    v_mul_f32 v6, v6, v240
    v_mul_f32 v7, v7, v240
    v_cvt_pk_bf16_f32 v64, v0, v1
    v_cvt_pk_bf16_f32 v65, v2, v3
    v_cvt_pk_bf16_f32 v66, v4, v5
    v_cvt_pk_bf16_f32 v67, v6, v7
    buffer_store_dwordx4 v[64:67], v243, s[12:15], s47 offen offset:0 sc1
    v_mul_f32 v8, v8, v240
    v_mul_f32 v9, v9, v240
    v_mul_f32 v10, v10, v240
    v_mul_f32 v11, v11, v240
    v_mul_f32 v12, v12, v240
    v_mul_f32 v13, v13, v240
    v_mul_f32 v14, v14, v240
    v_mul_f32 v15, v15, v240
    v_cvt_pk_bf16_f32 v68, v8, v9
    v_cvt_pk_bf16_f32 v69, v10, v11
    v_cvt_pk_bf16_f32 v70, v12, v13
    v_cvt_pk_bf16_f32 v71, v14, v15
    buffer_store_dwordx4 v[68:71], v243, s[12:15], s47 offen offset:1024 sc1
    v_mul_f32 v16, v16, v240
    v_mul_f32 v17, v17, v240
    v_mul_f32 v18, v18, v240
    v_mul_f32 v19, v19, v240
    v_mul_f32 v20, v20, v240
    v_mul_f32 v21, v21, v240
    v_mul_f32 v22, v22, v240
    v_mul_f32 v23, v23, v240
    v_cvt_pk_bf16_f32 v72, v16, v17
    v_cvt_pk_bf16_f32 v73, v18, v19
    v_cvt_pk_bf16_f32 v74, v20, v21
    v_cvt_pk_bf16_f32 v75, v22, v23
    buffer_store_dwordx4 v[72:75], v243, s[12:15], s47 offen offset:2048 sc1
    v_mul_f32 v24, v24, v240
    v_mul_f32 v25, v25, v240
    v_mul_f32 v26, v26, v240
    v_mul_f32 v27, v27, v240
    v_mul_f32 v28, v28, v240
    v_mul_f32 v29, v29, v240
    v_mul_f32 v30, v30, v240
    v_mul_f32 v31, v31, v240
    v_cvt_pk_bf16_f32 v76, v24, v25
    v_cvt_pk_bf16_f32 v77, v26, v27
    v_cvt_pk_bf16_f32 v78, v28, v29
    v_cvt_pk_bf16_f32 v79, v30, v31
    buffer_store_dwordx4 v[76:79], v243, s[12:15], s47 offen offset:3072 sc1
    v_mul_f32 v32, v32, v240
    v_mul_f32 v33, v33, v240
    v_mul_f32 v34, v34, v240
    v_mul_f32 v35, v35, v240
    v_mul_f32 v36, v36, v240
    v_mul_f32 v37, v37, v240
    v_mul_f32 v38, v38, v240
    v_mul_f32 v39, v39, v240
    v_cvt_pk_bf16_f32 v80, v32, v33
    v_cvt_pk_bf16_f32 v81, v34, v35
    v_cvt_pk_bf16_f32 v82, v36, v37
    v_cvt_pk_bf16_f32 v83, v38, v39
    buffer_store_dwordx4 v[80:83], v243, s[12:15], s48 offen offset:0 sc1
    v_mul_f32 v40, v40, v240
    v_mul_f32 v41, v41, v240
    v_mul_f32 v42, v42, v240
    v_mul_f32 v43, v43, v240
    v_mul_f32 v44, v44, v240
    v_mul_f32 v45, v45, v240
    v_mul_f32 v46, v46, v240
    v_mul_f32 v47, v47, v240
    v_cvt_pk_bf16_f32 v84, v40, v41
    v_cvt_pk_bf16_f32 v85, v42, v43
    v_cvt_pk_bf16_f32 v86, v44, v45
    v_cvt_pk_bf16_f32 v87, v46, v47
    buffer_store_dwordx4 v[84:87], v243, s[12:15], s48 offen offset:1024 sc1
    v_mul_f32 v48, v48, v240
    v_mul_f32 v49, v49, v240
    v_mul_f32 v50, v50, v240
    v_mul_f32 v51, v51, v240
    v_mul_f32 v52, v52, v240
    v_mul_f32 v53, v53, v240
    v_mul_f32 v54, v54, v240
    v_mul_f32 v55, v55, v240
    v_cvt_pk_bf16_f32 v88, v48, v49
    v_cvt_pk_bf16_f32 v89, v50, v51
    v_cvt_pk_bf16_f32 v90, v52, v53
    v_cvt_pk_bf16_f32 v91, v54, v55
    buffer_store_dwordx4 v[88:91], v243, s[12:15], s48 offen offset:2048 sc1
    v_mul_f32 v56, v56, v240
    v_mul_f32 v57, v57, v240
    v_mul_f32 v58, v58, v240
    v_mul_f32 v59, v59, v240
    v_mul_f32 v60, v60, v240
    v_mul_f32 v61, v61, v240
    v_mul_f32 v62, v62, v240
    v_mul_f32 v63, v63, v240
    v_cvt_pk_bf16_f32 v92, v56, v57
    v_cvt_pk_bf16_f32 v93, v58, v59
    v_cvt_pk_bf16_f32 v94, v60, v61
    v_cvt_pk_bf16_f32 v95, v62, v63
    buffer_store_dwordx4 v[92:95], v243, s[12:15], s48 offen offset:3072 sc1
    s_waitcnt vmcnt(0)
    v_mov_b32 v254, s87
    s_mov_b64 exec, 1
    buffer_store_dword v254, off, s[12:15], s71 sc1
    s_mov_b64 exec, -1
    s_cmp_eq_u32 s36, 4
    s_cbranch_scc0 parallel_sum__compressed_kv_cla__moe_arch_mod__prompt_kernel_B_noE
    s_barrier
parallel_sum__compressed_kv_cla__moe_arch_mod__prompt_kernel_B_noE:
    s_sub_u32 s47, s2, 128
    s_cmp_lt_u32 s47, 48
    s_cbranch_scc1 parallel_sum__compressed_kv_cla__moe_arch_mod__prompt_kernel_helper
    s_endpgm
parallel_sum__compressed_kv_cla__moe_arch_mod__prompt_kernel_helper:
    s_cmp_eq_u32 s36, 4
    s_cbranch_scc1 parallel_sum__compressed_kv_cla__moe_arch_mod__prompt_kernel_hb0
    s_barrier
    s_barrier
    s_cmp_eq_u32 s36, 7
    s_cbranch_scc0 parallel_sum__compressed_kv_cla__moe_arch_mod__prompt_kernel_hb0
    s_barrier
parallel_sum__compressed_kv_cla__moe_arch_mod__prompt_kernel_hb0:
    s_mov_b32 s8, s26
    s_mov_b32 s9, s27
    s_mov_b32 s10, 0x510000
    s_mov_b32 s11, 0x20000
    s_sub_u32 s45, s36, 4
    s_mul_i32 s45, s45, 27648
    s_sub_u32 s46, s2, 128
    s_mul_i32 s46, s46, 110592
    s_add_u32 s46, s46, s45
    s_add_u32 s47, s46, 0
    buffer_load_dwordx4 v[0:3], v243, s[8:11], s47 offen offset:0
    buffer_load_dwordx4 v[4:7], v243, s[8:11], s47 offen offset:1024
    buffer_load_dwordx4 v[8:11], v243, s[8:11], s47 offen offset:2048
    buffer_load_dwordx4 v[12:15], v243, s[8:11], s47 offen offset:3072
    s_add_u32 s47, s46, 4096
    buffer_load_dwordx4 v[16:19], v243, s[8:11], s47 offen offset:0
    buffer_load_dwordx4 v[20:23], v243, s[8:11], s47 offen offset:1024
    buffer_load_dwordx4 v[24:27], v243, s[8:11], s47 offen offset:2048
    buffer_load_dwordx4 v[28:31], v243, s[8:11], s47 offen offset:3072
    s_add_u32 s47, s46, 8192
    buffer_load_dwordx4 v[32:35], v243, s[8:11], s47 offen offset:0
    buffer_load_dwordx4 v[36:39], v243, s[8:11], s47 offen offset:1024
    buffer_load_dwordx4 v[40:43], v243, s[8:11], s47 offen offset:2048
    buffer_load_dwordx4 v[44:47], v243, s[8:11], s47 offen offset:3072
    s_add_u32 s47, s46, 12288
    buffer_load_dwordx4 v[48:51], v243, s[8:11], s47 offen offset:0
    buffer_load_dwordx4 v[52:55], v243, s[8:11], s47 offen offset:1024
    buffer_load_dwordx4 v[56:59], v243, s[8:11], s47 offen offset:2048
    buffer_load_dwordx4 v[60:63], v243, s[8:11], s47 offen offset:3072
    s_add_u32 s47, s46, 16384
    buffer_load_dwordx4 v[64:67], v243, s[8:11], s47 offen offset:0
    buffer_load_dwordx4 v[68:71], v243, s[8:11], s47 offen offset:1024
    buffer_load_dwordx4 v[72:75], v243, s[8:11], s47 offen offset:2048
    buffer_load_dwordx4 v[76:79], v243, s[8:11], s47 offen offset:3072
    s_add_u32 s47, s46, 20480
    buffer_load_dwordx4 v[80:83], v243, s[8:11], s47 offen offset:0
    buffer_load_dwordx4 v[84:87], v243, s[8:11], s47 offen offset:1024
    buffer_load_dwordx4 v[88:91], v243, s[8:11], s47 offen offset:2048
    buffer_load_dwordx4 v[92:95], v243, s[8:11], s47 offen offset:3072
    s_add_u32 s47, s46, 24576
    buffer_load_dwordx4 v[96:99], v243, s[8:11], s47 offen offset:0
    buffer_load_dwordx4 v[100:103], v243, s[8:11], s47 offen offset:1024
    buffer_load_dwordx4 v[104:107], v243, s[8:11], s47 offen offset:2048
    v_add_u32 v120, s45, v243
    s_waitcnt vmcnt(0)
    s_barrier
    ds_write_b128 v120, v[0:3] offset:0
    ds_write_b128 v120, v[4:7] offset:1024
    ds_write_b128 v120, v[8:11] offset:2048
    ds_write_b128 v120, v[12:15] offset:3072
    ds_write_b128 v120, v[16:19] offset:4096
    ds_write_b128 v120, v[20:23] offset:5120
    ds_write_b128 v120, v[24:27] offset:6144
    ds_write_b128 v120, v[28:31] offset:7168
    s_waitcnt lgkmcnt(4)
    ds_write_b128 v120, v[32:35] offset:8192
    ds_write_b128 v120, v[36:39] offset:9216
    ds_write_b128 v120, v[40:43] offset:10240
    ds_write_b128 v120, v[44:47] offset:11264
    ds_write_b128 v120, v[48:51] offset:12288
    ds_write_b128 v120, v[52:55] offset:13312
    ds_write_b128 v120, v[56:59] offset:14336
    ds_write_b128 v120, v[60:63] offset:15360
    s_waitcnt lgkmcnt(4)
    ds_write_b128 v120, v[64:67] offset:16384
    ds_write_b128 v120, v[68:71] offset:17408
    ds_write_b128 v120, v[72:75] offset:18432
    ds_write_b128 v120, v[76:79] offset:19456
    ds_write_b128 v120, v[80:83] offset:20480
    ds_write_b128 v120, v[84:87] offset:21504
    ds_write_b128 v120, v[88:91] offset:22528
    ds_write_b128 v120, v[92:95] offset:23552
    s_waitcnt lgkmcnt(4)
    ds_write_b128 v120, v[96:99] offset:24576
    ds_write_b128 v120, v[100:103] offset:25600
    ds_write_b128 v120, v[104:107] offset:26624
    s_waitcnt lgkmcnt(0)
    s_barrier
    s_endpgm
parallel_sum__compressed_kv_cla__moe_arch_mod__prompt_kernel_trg_1:
    s_call_b64 s[50:51], parallel_sum__compressed_kv_cla__moe_arch_mod__prompt_kernel_trig
    s_branch parallel_sum__compressed_kv_cla__moe_arch_mod__prompt_kernel_trg_1_back
parallel_sum__compressed_kv_cla__moe_arch_mod__prompt_kernel_trg_2:
    s_call_b64 s[50:51], parallel_sum__compressed_kv_cla__moe_arch_mod__prompt_kernel_trig
    s_branch parallel_sum__compressed_kv_cla__moe_arch_mod__prompt_kernel_trg_2_back
parallel_sum__compressed_kv_cla__moe_arch_mod__prompt_kernel_trg_8:
    s_call_b64 s[50:51], parallel_sum__compressed_kv_cla__moe_arch_mod__prompt_kernel_trig
    s_branch parallel_sum__compressed_kv_cla__moe_arch_mod__prompt_kernel_trg_8_back
parallel_sum__compressed_kv_cla__moe_arch_mod__prompt_kernel_trg_11:
    s_call_b64 s[50:51], parallel_sum__compressed_kv_cla__moe_arch_mod__prompt_kernel_trig
    s_branch parallel_sum__compressed_kv_cla__moe_arch_mod__prompt_kernel_trg_11_back
parallel_sum__compressed_kv_cla__moe_arch_mod__prompt_kernel_trg_12:
    s_call_b64 s[50:51], parallel_sum__compressed_kv_cla__moe_arch_mod__prompt_kernel_trig
    s_branch parallel_sum__compressed_kv_cla__moe_arch_mod__prompt_kernel_trg_12_back
parallel_sum__compressed_kv_cla__moe_arch_mod__prompt_kernel_trg_15:
    s_call_b64 s[50:51], parallel_sum__compressed_kv_cla__moe_arch_mod__prompt_kernel_trig
    s_branch parallel_sum__compressed_kv_cla__moe_arch_mod__prompt_kernel_trg_15_back
parallel_sum__compressed_kv_cla__moe_arch_mod__prompt_kernel_trg_17:
    s_call_b64 s[50:51], parallel_sum__compressed_kv_cla__moe_arch_mod__prompt_kernel_trig
    s_branch parallel_sum__compressed_kv_cla__moe_arch_mod__prompt_kernel_trg_17_back
parallel_sum__compressed_kv_cla__moe_arch_mod__prompt_kernel_trg_18:
    s_call_b64 s[50:51], parallel_sum__compressed_kv_cla__moe_arch_mod__prompt_kernel_trig
    s_branch parallel_sum__compressed_kv_cla__moe_arch_mod__prompt_kernel_trg_18_back
parallel_sum__compressed_kv_cla__moe_arch_mod__prompt_kernel_trg_19:
    s_call_b64 s[50:51], parallel_sum__compressed_kv_cla__moe_arch_mod__prompt_kernel_trig
    s_branch parallel_sum__compressed_kv_cla__moe_arch_mod__prompt_kernel_trg_19_back
parallel_sum__compressed_kv_cla__moe_arch_mod__prompt_kernel_trg_20:
    s_call_b64 s[50:51], parallel_sum__compressed_kv_cla__moe_arch_mod__prompt_kernel_trig
    s_branch parallel_sum__compressed_kv_cla__moe_arch_mod__prompt_kernel_trg_20_back
parallel_sum__compressed_kv_cla__moe_arch_mod__prompt_kernel_trg_21:
    s_call_b64 s[50:51], parallel_sum__compressed_kv_cla__moe_arch_mod__prompt_kernel_trig
    s_branch parallel_sum__compressed_kv_cla__moe_arch_mod__prompt_kernel_trg_21_back
parallel_sum__compressed_kv_cla__moe_arch_mod__prompt_kernel_trg_22:
    s_call_b64 s[50:51], parallel_sum__compressed_kv_cla__moe_arch_mod__prompt_kernel_trig
    s_branch parallel_sum__compressed_kv_cla__moe_arch_mod__prompt_kernel_trg_22_back
parallel_sum__compressed_kv_cla__moe_arch_mod__prompt_kernel_trg_23:
    s_call_b64 s[50:51], parallel_sum__compressed_kv_cla__moe_arch_mod__prompt_kernel_trig
    s_branch parallel_sum__compressed_kv_cla__moe_arch_mod__prompt_kernel_trg_23_back
parallel_sum__compressed_kv_cla__moe_arch_mod__prompt_kernel_trg_24:
    s_call_b64 s[50:51], parallel_sum__compressed_kv_cla__moe_arch_mod__prompt_kernel_trig
    s_branch parallel_sum__compressed_kv_cla__moe_arch_mod__prompt_kernel_trg_24_back
parallel_sum__compressed_kv_cla__moe_arch_mod__prompt_kernel_trg_25:
    s_call_b64 s[50:51], parallel_sum__compressed_kv_cla__moe_arch_mod__prompt_kernel_trig
    s_branch parallel_sum__compressed_kv_cla__moe_arch_mod__prompt_kernel_trg_25_back
parallel_sum__compressed_kv_cla__moe_arch_mod__prompt_kernel_trg_26:
    s_call_b64 s[50:51], parallel_sum__compressed_kv_cla__moe_arch_mod__prompt_kernel_trig
    s_branch parallel_sum__compressed_kv_cla__moe_arch_mod__prompt_kernel_trg_26_back
parallel_sum__compressed_kv_cla__moe_arch_mod__prompt_kernel_trg_27:
    s_call_b64 s[50:51], parallel_sum__compressed_kv_cla__moe_arch_mod__prompt_kernel_trig
    s_branch parallel_sum__compressed_kv_cla__moe_arch_mod__prompt_kernel_trg_27_back
parallel_sum__compressed_kv_cla__moe_arch_mod__prompt_kernel_trg_28:
    s_call_b64 s[50:51], parallel_sum__compressed_kv_cla__moe_arch_mod__prompt_kernel_trig
    s_branch parallel_sum__compressed_kv_cla__moe_arch_mod__prompt_kernel_trg_28_back
parallel_sum__compressed_kv_cla__moe_arch_mod__prompt_kernel_trg_29:
    s_call_b64 s[50:51], parallel_sum__compressed_kv_cla__moe_arch_mod__prompt_kernel_trig
    s_branch parallel_sum__compressed_kv_cla__moe_arch_mod__prompt_kernel_trg_29_back
parallel_sum__compressed_kv_cla__moe_arch_mod__prompt_kernel_trg_30:
    s_call_b64 s[50:51], parallel_sum__compressed_kv_cla__moe_arch_mod__prompt_kernel_trig
    s_branch parallel_sum__compressed_kv_cla__moe_arch_mod__prompt_kernel_trg_30_back
parallel_sum__compressed_kv_cla__moe_arch_mod__prompt_kernel_trig:
    s_cmp_eq_u32 s86, 0
    s_cbranch_scc1 parallel_sum__compressed_kv_cla__moe_arch_mod__prompt_kernel_trig0
    v_bfe_u32 v238, v243, 4, 4
    v_lshlrev_b32 v238, 6, v238
    buffer_load_dword v239, v238, s[12:15], s70 offen sc1
    s_setpc_b64 s[50:51]
parallel_sum__compressed_kv_cla__moe_arch_mod__prompt_kernel_trig0:
    s_waitcnt vmcnt(9)
    s_mov_b32 s35, 0x40000
parallel_sum__compressed_kv_cla__moe_arch_mod__prompt_kernel_chk_late:
    v_xor_b32 v239, s87, v239
    v_cmp_ne_u32 s[84:85], 0, v239
    s_nop 1
    s_cmp_eq_u64 s[84:85], 0
    s_cbranch_scc1 parallel_sum__compressed_kv_cla__moe_arch_mod__prompt_kernel_chk_late_ok
    s_sub_u32 s35, s35, 1
    s_cbranch_scc1 parallel_sum__compressed_kv_cla__moe_arch_mod__prompt_kernel_chk_late_ok
    s_sleep 1
    buffer_load_dword v239, v238, s[12:15], s70 offen sc1
    s_waitcnt vmcnt(0)
    s_branch parallel_sum__compressed_kv_cla__moe_arch_mod__prompt_kernel_chk_late
parallel_sum__compressed_kv_cla__moe_arch_mod__prompt_kernel_chk_late_ok:
    s_setpc_b64 s[50:51]
parallel_sum__compressed_kv_cla__moe_arch_mod__prompt_kernel_chk_3_slow:
    s_call_b64 s[50:51], parallel_sum__compressed_kv_cla__moe_arch_mod__prompt_kernel_slow0
    s_branch parallel_sum__compressed_kv_cla__moe_arch_mod__prompt_kernel_chk_3_back
parallel_sum__compressed_kv_cla__moe_arch_mod__prompt_kernel_chk_4_slow:
    s_call_b64 s[50:51], parallel_sum__compressed_kv_cla__moe_arch_mod__prompt_kernel_slow1
    s_branch parallel_sum__compressed_kv_cla__moe_arch_mod__prompt_kernel_chk_4_back
parallel_sum__compressed_kv_cla__moe_arch_mod__prompt_kernel_chk_7_slow:
    s_call_b64 s[50:51], parallel_sum__compressed_kv_cla__moe_arch_mod__prompt_kernel_slow1
    s_branch parallel_sum__compressed_kv_cla__moe_arch_mod__prompt_kernel_chk_7_back
parallel_sum__compressed_kv_cla__moe_arch_mod__prompt_kernel_chk_9_slow:
    s_call_b64 s[50:51], parallel_sum__compressed_kv_cla__moe_arch_mod__prompt_kernel_slow0
    s_branch parallel_sum__compressed_kv_cla__moe_arch_mod__prompt_kernel_chk_9_back
parallel_sum__compressed_kv_cla__moe_arch_mod__prompt_kernel_chk_10_slow:
    s_call_b64 s[50:51], parallel_sum__compressed_kv_cla__moe_arch_mod__prompt_kernel_slow1
    s_branch parallel_sum__compressed_kv_cla__moe_arch_mod__prompt_kernel_chk_10_back
parallel_sum__compressed_kv_cla__moe_arch_mod__prompt_kernel_chk_13_slow:
    s_call_b64 s[50:51], parallel_sum__compressed_kv_cla__moe_arch_mod__prompt_kernel_slow0
    s_branch parallel_sum__compressed_kv_cla__moe_arch_mod__prompt_kernel_chk_13_back
parallel_sum__compressed_kv_cla__moe_arch_mod__prompt_kernel_chk_14_slow:
    s_call_b64 s[50:51], parallel_sum__compressed_kv_cla__moe_arch_mod__prompt_kernel_slow1
    s_branch parallel_sum__compressed_kv_cla__moe_arch_mod__prompt_kernel_chk_14_back
parallel_sum__compressed_kv_cla__moe_arch_mod__prompt_kernel_chk_16_slow:
    s_call_b64 s[50:51], parallel_sum__compressed_kv_cla__moe_arch_mod__prompt_kernel_slow0
    s_branch parallel_sum__compressed_kv_cla__moe_arch_mod__prompt_kernel_chk_16_back
parallel_sum__compressed_kv_cla__moe_arch_mod__prompt_kernel_chk_31_slow:
    s_call_b64 s[50:51], parallel_sum__compressed_kv_cla__moe_arch_mod__prompt_kernel_slow0
    s_branch parallel_sum__compressed_kv_cla__moe_arch_mod__prompt_kernel_chk_31_back
parallel_sum__compressed_kv_cla__moe_arch_mod__prompt_kernel_chk_32_slow:
    s_call_b64 s[50:51], parallel_sum__compressed_kv_cla__moe_arch_mod__prompt_kernel_slow1
    s_branch parallel_sum__compressed_kv_cla__moe_arch_mod__prompt_kernel_chk_32_back
parallel_sum__compressed_kv_cla__moe_arch_mod__prompt_kernel_chk_34_slow:
    s_call_b64 s[50:51], parallel_sum__compressed_kv_cla__moe_arch_mod__prompt_kernel_slow1
    s_branch parallel_sum__compressed_kv_cla__moe_arch_mod__prompt_kernel_chk_34_back
parallel_sum__compressed_kv_cla__moe_arch_mod__prompt_kernel_chk_35_slow:
    s_call_b64 s[50:51], parallel_sum__compressed_kv_cla__moe_arch_mod__prompt_kernel_slow0
    s_branch parallel_sum__compressed_kv_cla__moe_arch_mod__prompt_kernel_chk_35_back
parallel_sum__compressed_kv_cla__moe_arch_mod__prompt_kernel_chk_36_slow:
    s_call_b64 s[50:51], parallel_sum__compressed_kv_cla__moe_arch_mod__prompt_kernel_slow1
    s_branch parallel_sum__compressed_kv_cla__moe_arch_mod__prompt_kernel_chk_36_back
parallel_sum__compressed_kv_cla__moe_arch_mod__prompt_kernel_chk_37_slow:
    s_call_b64 s[50:51], parallel_sum__compressed_kv_cla__moe_arch_mod__prompt_kernel_slow0
    s_branch parallel_sum__compressed_kv_cla__moe_arch_mod__prompt_kernel_chk_37_back
parallel_sum__compressed_kv_cla__moe_arch_mod__prompt_kernel_chk_38_slow:
    s_call_b64 s[50:51], parallel_sum__compressed_kv_cla__moe_arch_mod__prompt_kernel_slow1
    s_branch parallel_sum__compressed_kv_cla__moe_arch_mod__prompt_kernel_chk_38_back
parallel_sum__compressed_kv_cla__moe_arch_mod__prompt_kernel_chk_39_slow:
    s_call_b64 s[50:51], parallel_sum__compressed_kv_cla__moe_arch_mod__prompt_kernel_slow0
    s_branch parallel_sum__compressed_kv_cla__moe_arch_mod__prompt_kernel_chk_39_back
parallel_sum__compressed_kv_cla__moe_arch_mod__prompt_kernel_slow0:
    s_nop 15
    v_max3_f32 v247, v64, v65, v66
    v_max3_f32 v247, v247, v67, v68
    v_max3_f32 v247, v247, v69, v70
    v_max3_f32 v247, v247, v71, v72
    v_max3_f32 v247, v247, v73, v74
    v_max3_f32 v247, v247, v75, v76
    v_max3_f32 v247, v247, v77, v78
    v_max3_f32 v247, v247, v79, 0
    v_mov_b32 v252, v247
    s_nop 1
    v_permlane32_swap_b32 v247, v252
    s_nop 1
    v_max_f32 v247, v247, v252
    v_exp_f32 v252, -v247
    v_sub_f32 v64, v64, v247
    v_sub_f32 v80, v80, v247
    v_sub_f32 v96, v96, v247
    v_sub_f32 v65, v65, v247
    v_sub_f32 v81, v81, v247
    v_sub_f32 v97, v97, v247
    v_sub_f32 v66, v66, v247
    v_sub_f32 v82, v82, v247
    v_sub_f32 v98, v98, v247
    v_sub_f32 v67, v67, v247
    v_sub_f32 v83, v83, v247
    v_sub_f32 v99, v99, v247
    v_sub_f32 v68, v68, v247
    v_sub_f32 v84, v84, v247
    v_sub_f32 v100, v100, v247
    v_sub_f32 v69, v69, v247
    v_sub_f32 v85, v85, v247
    v_sub_f32 v101, v101, v247
    v_sub_f32 v70, v70, v247
    v_sub_f32 v86, v86, v247
    v_sub_f32 v102, v102, v247
    v_sub_f32 v71, v71, v247
    v_sub_f32 v87, v87, v247
    v_sub_f32 v103, v103, v247
    v_sub_f32 v72, v72, v247
    v_sub_f32 v88, v88, v247
    v_sub_f32 v104, v104, v247
    v_sub_f32 v73, v73, v247
    v_sub_f32 v89, v89, v247
    v_sub_f32 v105, v105, v247
    v_sub_f32 v74, v74, v247
    v_sub_f32 v90, v90, v247
    v_sub_f32 v106, v106, v247
    v_sub_f32 v75, v75, v247
    v_sub_f32 v91, v91, v247
    v_sub_f32 v107, v107, v247
    v_sub_f32 v76, v76, v247
    v_sub_f32 v92, v92, v247
    v_sub_f32 v108, v108, v247
    v_sub_f32 v77, v77, v247
    v_sub_f32 v93, v93, v247
    v_sub_f32 v109, v109, v247
    v_sub_f32 v78, v78, v247
    v_sub_f32 v94, v94, v247
    v_sub_f32 v110, v110, v247
    v_sub_f32 v79, v79, v247
    v_sub_f32 v95, v95, v247
    v_sub_f32 v111, v111, v247
    v_mul_f32 v0, v0, v252
    v_mul_f32 v1, v1, v252
    v_mul_f32 v2, v2, v252
    v_mul_f32 v3, v3, v252
    v_mul_f32 v4, v4, v252
    v_mul_f32 v5, v5, v252
    v_mul_f32 v6, v6, v252
    v_mul_f32 v7, v7, v252
    v_mul_f32 v8, v8, v252
    v_mul_f32 v9, v9, v252
    v_mul_f32 v10, v10, v252
    v_mul_f32 v11, v11, v252
    v_mul_f32 v12, v12, v252
    v_mul_f32 v13, v13, v252
    v_mul_f32 v14, v14, v252
    v_mul_f32 v15, v15, v252
    v_mul_f32 v16, v16, v252
    v_mul_f32 v17, v17, v252
    v_mul_f32 v18, v18, v252
    v_mul_f32 v19, v19, v252
    v_mul_f32 v20, v20, v252
    v_mul_f32 v21, v21, v252
    v_mul_f32 v22, v22, v252
    v_mul_f32 v23, v23, v252
    v_mul_f32 v24, v24, v252
    v_mul_f32 v25, v25, v252
    v_mul_f32 v26, v26, v252
    v_mul_f32 v27, v27, v252
    v_mul_f32 v28, v28, v252
    v_mul_f32 v29, v29, v252
    v_mul_f32 v30, v30, v252
    v_mul_f32 v31, v31, v252
    v_mul_f32 v32, v32, v252
    v_mul_f32 v33, v33, v252
    v_mul_f32 v34, v34, v252
    v_mul_f32 v35, v35, v252
    v_mul_f32 v36, v36, v252
    v_mul_f32 v37, v37, v252
    v_mul_f32 v38, v38, v252
    v_mul_f32 v39, v39, v252
    v_mul_f32 v40, v40, v252
    v_mul_f32 v41, v41, v252
    v_mul_f32 v42, v42, v252
    v_mul_f32 v43, v43, v252
    v_mul_f32 v44, v44, v252
    v_mul_f32 v45, v45, v252
    v_mul_f32 v46, v46, v252
    v_mul_f32 v47, v47, v252
    v_mul_f32 v48, v48, v252
    v_mul_f32 v49, v49, v252
    v_mul_f32 v50, v50, v252
    v_mul_f32 v51, v51, v252
    v_mul_f32 v52, v52, v252
    v_mul_f32 v53, v53, v252
    v_mul_f32 v54, v54, v252
    v_mul_f32 v55, v55, v252
    v_mul_f32 v56, v56, v252
    v_mul_f32 v57, v57, v252
    v_mul_f32 v58, v58, v252
    v_mul_f32 v59, v59, v252
    v_mul_f32 v60, v60, v252
    v_mul_f32 v61, v61, v252
    v_mul_f32 v62, v62, v252
    v_mul_f32 v63, v63, v252
    v_mul_f32 v240, v240, v252
    v_mov_b32 v241, 0
    v_exp_f32 v192, v64
    v_exp_f32 v193, v65
    v_add_f32 v241, v241, v192
    v_add_f32 v241, v241, v193
    v_cvt_pk_bf16_f32 v112, v192, v193
    v_exp_f32 v192, v66
    v_exp_f32 v193, v67
    v_add_f32 v241, v241, v192
    v_add_f32 v241, v241, v193
    v_cvt_pk_bf16_f32 v113, v192, v193
    v_exp_f32 v192, v68
    v_exp_f32 v193, v69
    v_add_f32 v241, v241, v192
    v_add_f32 v241, v241, v193
    v_cvt_pk_bf16_f32 v114, v192, v193
    v_exp_f32 v192, v70
    v_exp_f32 v193, v71
    v_add_f32 v241, v241, v192
    v_add_f32 v241, v241, v193
    v_cvt_pk_bf16_f32 v115, v192, v193
    v_exp_f32 v192, v72
    v_exp_f32 v193, v73
    v_add_f32 v241, v241, v192
    v_add_f32 v241, v241, v193
    v_cvt_pk_bf16_f32 v116, v192, v193
    v_exp_f32 v192, v74
    v_exp_f32 v193, v75
    v_add_f32 v241, v241, v192
    v_add_f32 v241, v241, v193
    v_cvt_pk_bf16_f32 v117, v192, v193
    v_exp_f32 v192, v76
    v_exp_f32 v193, v77
    v_add_f32 v241, v241, v192
    v_add_f32 v241, v241, v193
    v_cvt_pk_bf16_f32 v118, v192, v193
    v_exp_f32 v192, v78
    v_exp_f32 v193, v79
    v_add_f32 v241, v241, v192
    v_add_f32 v241, v241, v193
    v_cvt_pk_bf16_f32 v119, v192, v193
    s_nop 1
    s_setpc_b64 s[50:51]
parallel_sum__compressed_kv_cla__moe_arch_mod__prompt_kernel_slow1:
    s_nop 15
    v_max3_f32 v247, v80, v81, v82
    v_max3_f32 v247, v247, v83, v84
    v_max3_f32 v247, v247, v85, v86
    v_max3_f32 v247, v247, v87, v88
    v_max3_f32 v247, v247, v89, v90
    v_max3_f32 v247, v247, v91, v92
    v_max3_f32 v247, v247, v93, v94
    v_max3_f32 v247, v247, v95, 0
    v_mov_b32 v252, v247
    s_nop 1
    v_permlane32_swap_b32 v247, v252
    s_nop 1
    v_max_f32 v247, v247, v252
    v_exp_f32 v252, -v247
    v_sub_f32 v80, v80, v247
    v_sub_f32 v64, v64, v247
    v_sub_f32 v96, v96, v247
    v_sub_f32 v81, v81, v247
    v_sub_f32 v65, v65, v247
    v_sub_f32 v97, v97, v247
    v_sub_f32 v82, v82, v247
    v_sub_f32 v66, v66, v247
    v_sub_f32 v98, v98, v247
    v_sub_f32 v83, v83, v247
    v_sub_f32 v67, v67, v247
    v_sub_f32 v99, v99, v247
    v_sub_f32 v84, v84, v247
    v_sub_f32 v68, v68, v247
    v_sub_f32 v100, v100, v247
    v_sub_f32 v85, v85, v247
    v_sub_f32 v69, v69, v247
    v_sub_f32 v101, v101, v247
    v_sub_f32 v86, v86, v247
    v_sub_f32 v70, v70, v247
    v_sub_f32 v102, v102, v247
    v_sub_f32 v87, v87, v247
    v_sub_f32 v71, v71, v247
    v_sub_f32 v103, v103, v247
    v_sub_f32 v88, v88, v247
    v_sub_f32 v72, v72, v247
    v_sub_f32 v104, v104, v247
    v_sub_f32 v89, v89, v247
    v_sub_f32 v73, v73, v247
    v_sub_f32 v105, v105, v247
    v_sub_f32 v90, v90, v247
    v_sub_f32 v74, v74, v247
    v_sub_f32 v106, v106, v247
    v_sub_f32 v91, v91, v247
    v_sub_f32 v75, v75, v247
    v_sub_f32 v107, v107, v247
    v_sub_f32 v92, v92, v247
    v_sub_f32 v76, v76, v247
    v_sub_f32 v108, v108, v247
    v_sub_f32 v93, v93, v247
    v_sub_f32 v77, v77, v247
    v_sub_f32 v109, v109, v247
    v_sub_f32 v94, v94, v247
    v_sub_f32 v78, v78, v247
    v_sub_f32 v110, v110, v247
    v_sub_f32 v95, v95, v247
    v_sub_f32 v79, v79, v247
    v_sub_f32 v111, v111, v247
    v_mul_f32 v0, v0, v252
    v_mul_f32 v1, v1, v252
    v_mul_f32 v2, v2, v252
    v_mul_f32 v3, v3, v252
    v_mul_f32 v4, v4, v252
    v_mul_f32 v5, v5, v252
    v_mul_f32 v6, v6, v252
    v_mul_f32 v7, v7, v252
    v_mul_f32 v8, v8, v252
    v_mul_f32 v9, v9, v252
    v_mul_f32 v10, v10, v252
    v_mul_f32 v11, v11, v252
    v_mul_f32 v12, v12, v252
    v_mul_f32 v13, v13, v252
    v_mul_f32 v14, v14, v252
    v_mul_f32 v15, v15, v252
    v_mul_f32 v16, v16, v252
    v_mul_f32 v17, v17, v252
    v_mul_f32 v18, v18, v252
    v_mul_f32 v19, v19, v252
    v_mul_f32 v20, v20, v252
    v_mul_f32 v21, v21, v252
    v_mul_f32 v22, v22, v252
    v_mul_f32 v23, v23, v252
    v_mul_f32 v24, v24, v252
    v_mul_f32 v25, v25, v252
    v_mul_f32 v26, v26, v252
    v_mul_f32 v27, v27, v252
    v_mul_f32 v28, v28, v252
    v_mul_f32 v29, v29, v252
    v_mul_f32 v30, v30, v252
    v_mul_f32 v31, v31, v252
    v_mul_f32 v32, v32, v252
    v_mul_f32 v33, v33, v252
    v_mul_f32 v34, v34, v252
    v_mul_f32 v35, v35, v252
    v_mul_f32 v36, v36, v252
    v_mul_f32 v37, v37, v252
    v_mul_f32 v38, v38, v252
    v_mul_f32 v39, v39, v252
    v_mul_f32 v40, v40, v252
    v_mul_f32 v41, v41, v252
    v_mul_f32 v42, v42, v252
    v_mul_f32 v43, v43, v252
    v_mul_f32 v44, v44, v252
    v_mul_f32 v45, v45, v252
    v_mul_f32 v46, v46, v252
    v_mul_f32 v47, v47, v252
    v_mul_f32 v48, v48, v252
    v_mul_f32 v49, v49, v252
    v_mul_f32 v50, v50, v252
    v_mul_f32 v51, v51, v252
    v_mul_f32 v52, v52, v252
    v_mul_f32 v53, v53, v252
    v_mul_f32 v54, v54, v252
    v_mul_f32 v55, v55, v252
    v_mul_f32 v56, v56, v252
    v_mul_f32 v57, v57, v252
    v_mul_f32 v58, v58, v252
    v_mul_f32 v59, v59, v252
    v_mul_f32 v60, v60, v252
    v_mul_f32 v61, v61, v252
    v_mul_f32 v62, v62, v252
    v_mul_f32 v63, v63, v252
    v_mul_f32 v240, v240, v252
    v_mov_b32 v241, 0
    v_exp_f32 v192, v80
    v_exp_f32 v193, v81
    v_add_f32 v241, v241, v192
    v_add_f32 v241, v241, v193
    v_cvt_pk_bf16_f32 v120, v192, v193
    v_exp_f32 v192, v82
    v_exp_f32 v193, v83
    v_add_f32 v241, v241, v192
    v_add_f32 v241, v241, v193
    v_cvt_pk_bf16_f32 v121, v192, v193
    v_exp_f32 v192, v84
    v_exp_f32 v193, v85
    v_add_f32 v241, v241, v192
    v_add_f32 v241, v241, v193
    v_cvt_pk_bf16_f32 v122, v192, v193
    v_exp_f32 v192, v86
    v_exp_f32 v193, v87
    v_add_f32 v241, v241, v192
    v_add_f32 v241, v241, v193
    v_cvt_pk_bf16_f32 v123, v192, v193
    v_exp_f32 v192, v88
    v_exp_f32 v193, v89
    v_add_f32 v241, v241, v192
    v_add_f32 v241, v241, v193
    v_cvt_pk_bf16_f32 v124, v192, v193
    v_exp_f32 v192, v90
    v_exp_f32 v193, v91
    v_add_f32 v241, v241, v192
    v_add_f32 v241, v241, v193
    v_cvt_pk_bf16_f32 v125, v192, v193
    v_exp_f32 v192, v92
    v_exp_f32 v193, v93
    v_add_f32 v241, v241, v192
    v_add_f32 v241, v241, v193
    v_cvt_pk_bf16_f32 v126, v192, v193
    v_exp_f32 v192, v94
    v_exp_f32 v193, v95
    v_add_f32 v241, v241, v192
    v_add_f32 v241, v241, v193
    v_cvt_pk_bf16_f32 v127, v192, v193
    s_nop 1
    s_setpc_b64 s[50:51]
parallel_sum__compressed_kv_cla__moe_arch_mod__prompt_kernel_end:
    s_endpgm
.section .rodata,"a"
.p2align 6
.amdhsa_kernel parallel_sum__compressed_kv_cla__moe_arch_mod__prompt_kernel
  .amdhsa_next_free_vgpr 256
  .amdhsa_next_free_sgpr 102
  .amdhsa_accum_offset 256
  .amdhsa_group_segment_fixed_size 0
  .amdhsa_kernarg_size 112
  .amdhsa_user_sgpr_count 2
  .amdhsa_user_sgpr_kernarg_segment_ptr 1
  .amdhsa_system_sgpr_workgroup_id_x 1
  .amdhsa_float_denorm_mode_32 3
.end_amdhsa_kernel
```
